```python
import torch

def _softmax(x, axis=-1):
    return torch.softmax(x, dim=axis)

def _gelu(x):
    return torch.nn.functional.gelu(x, approximate='tanh')

def _silu(x):
    return torch.nn.functional.silu(x)

def _sigmoid(x):
    return torch.sigmoid(x)

def _layernorm(x, axis=-1, eps=1e-05):
    m = x.mean(dim=axis, keepdim=True)
    v = x.var(dim=axis, keepdim=True, unbiased=False)
    return (x - m) / torch.sqrt(v + eps)

def _scatter_add(tgt, idx, src, axis=0):
    return tgt.clone().index_add_(axis, idx, src)

def _segment_sum(src, seg, n):
    out = torch.zeros((n,) + src.shape[1:], dtype=src.dtype)
    return out.index_add_(0, seg, src)

def _pad(x, pw):
    flat = tuple((v for pair in reversed(pw) for v in pair))
    return torch.nn.functional.pad(x, flat)
kernel_name = 'interleave_layers__memory_aug_recurrent_mem_tr__dense_activation_gelu__prompt'

def setup_inputs():

    _w = lambda a: (lambda t: t.to(torch.bfloat16) if t.is_floating_point() else t)(torch.as_tensor(a))

    def _A_setup():
        B, S, Dm = (1, 2048, 512)
        H, Dh = (32, 128)
        M, seg = (8, 32)
        seg = min(seg, S)
        S = S // seg * seg
        return {'x': _w((lambda *s: torch.randn(*s, dtype=torch.bfloat16) * 0.05)(B, S, Dm)), 'mem0': _w((lambda *s: torch.randn(*s, dtype=torch.bfloat16) * 0.2)(B, M, Dm)), 'Wq': _w((lambda *s: torch.randn(*s, dtype=torch.bfloat16) * 1.6)(Dm, H, Dh) * Dm ** (-0.5)), 'Wk': _w((lambda *s: torch.randn(*s, dtype=torch.bfloat16) * 1.6)(Dm, H, Dh) * Dm ** (-0.5)), 'Wv': _w((lambda *s: torch.randn(*s, dtype=torch.bfloat16) * 0.2)(Dm, H, Dh) * Dm ** (-0.5)), 'Wo': _w((lambda *s: torch.randn(*s, dtype=torch.bfloat16) * 0.2)(H, Dh, Dm) * (H * Dh) ** (-0.5)), 'seg_len': seg}
    _A_in = _A_setup()

    def _B_setup():
        B, S, D, F = (1, 2048, 512, 1376)
        return {'x': _w((lambda *s: torch.randn(*s, dtype=torch.bfloat16) * 0.05)(B, S, D)), 'w1': _w((lambda *s: torch.randn(*s, dtype=torch.bfloat16) * 0.4)(D, F) * D ** (-0.5)), 'b1': _w((lambda *s: torch.randn(*s, dtype=torch.bfloat16) * 12.8)(F) * 0.01), 'w2': _w((lambda *s: torch.randn(*s, dtype=torch.bfloat16) * 0.1)(F, D) * F ** (-0.5)), 'b2': _w((lambda *s: torch.randn(*s, dtype=torch.bfloat16) * 0.8)(D) * 0.01)}
    _B_in = _B_setup()
    return {'A_x': _A_in['x'], 'A_mem0': _A_in['mem0'], 'A_Wq': _A_in['Wq'], 'A_Wk': _A_in['Wk'], 'A_Wv': _A_in['Wv'], 'A_Wo': _A_in['Wo'], 'A_seg_len': _A_in['seg_len'], 'B_x': _B_in['x'], 'B_w1': _B_in['w1'], 'B_b1': _B_in['b1'], 'B_w2': _B_in['w2'], 'B_b2': _B_in['b2']}

def reference(A_x, A_mem0, A_Wq, A_Wk, A_Wv, A_Wo, A_seg_len, B_x, B_w1, B_b1, B_w2, B_b2):

    def _A_ref(x, mem0, Wq, Wk, Wv, Wo, seg_len):
        B, S, Dm = x.shape
        H, Dh = (Wq.shape[1], Wq.shape[2])
        M = mem0.shape[1]
        scale = Dh ** (-0.5)
        n_seg = S // seg_len
        L = M + seg_len
        idx = torch.arange(L)
        mask = (idx[:, None] < M) | (idx[:, None] >= idx[None, :])
        mem = mem0
        outs = []
        for s in range(n_seg):
            xs = x[:, s * seg_len:(s + 1) * seg_len, :].clone()
            h = torch.concatenate([mem, xs], axis=1)
            q = torch.einsum('btd,dhe->bhte', h, Wq)
            k = torch.einsum('btd,dhe->bhte', h, Wk)
            v = torch.einsum('btd,dhe->bhte', h, Wv)
            scores = torch.einsum('bhqe,bhke->bhqk', q, k) * scale
            scores = torch.where(mask[None, None], scores, -1000000000.0)
            p = _softmax(scores, axis=-1)
            o = torch.einsum('bhqk,bhke->bhqe', p, v)
            o = torch.einsum('bhte,hed->btd', o, Wo)
            mem = o[:, :M, :].clone()
            outs.append(o[:, M:, :])
        return torch.concatenate(outs, axis=1)

    def _B_ref(x, w1, b1, w2, b2):
        h = torch.einsum('bsd,df->bsf', x, w1) + b1
        h = _gelu(h)
        return torch.einsum('bsf,fd->bsd', h, w2) + b2
    x = A_x
    x = x + _A_ref(_layernorm(x, axis=-1), A_mem0, A_Wq, A_Wk, A_Wv, A_Wo, A_seg_len)
    x = x + _B_ref(_layernorm(x, axis=-1), B_w1, B_b1, B_w2, B_b2)
    x = x + _A_ref(_layernorm(x, axis=-1), A_mem0, A_Wq, A_Wk, A_Wv, A_Wo, A_seg_len)
    x = x + _B_ref(_layernorm(x, axis=-1), B_w1, B_b1, B_w2, B_b2)
    return x
```

```asm
; @launch grid=(256,1,1) block=(256,1,1) lds=163840
.amdgcn_target "amdgcn-amd-amdhsa--gfx950"
.text
.globl interleave_layers__memory_aug_recurrent_mem_tr__dense_activation_gelu__prompt_kernel
.p2align 8
.type interleave_layers__memory_aug_recurrent_mem_tr__dense_activation_gelu__prompt_kernel,@function
interleave_layers__memory_aug_recurrent_mem_tr__dense_activation_gelu__prompt_kernel:
    s_cmp_ge_u32 s2, 256
    s_cbranch_scc1 L_end0
    s_load_dwordx2 s[4:5], s[0:1], 112
    s_load_dwordx2 s[10:11], s[0:1], 104
    s_getreg_b32 s6, hwreg(HW_REG_XCC_ID)
    s_and_b32 s6, s6, 7
    v_lshrrev_b32 v1, 6, v0
    s_nop 0
    v_readfirstlane_b32 s9, v1
    s_waitcnt lgkmcnt(0)
    s_cmp_lg_u32 s9, 0
    s_nop 2
    s_cbranch_scc1 L_pfx_2
    s_lshl_b32 s38, s2, 9
    s_add_u32 s38, s38, 117440512
    v_lshlrev_b32 v5, 3, v0
    v_add_u32 v5, s38, v5
    v_mov_b32 v6, 0
    v_mov_b32 v7, 0
    s_lshl_b32 s38, s6, 2
    v_mov_b32 v1, s38
    v_mov_b32 v2, 1
    s_mov_b64 exec, 1
    global_atomic_add v3, v1, v2, s[10:11] sc0 sc1
    s_mov_b64 exec, -1
    global_store_dwordx2 v5, v[6:7], s[4:5] sc1
    s_waitcnt vmcnt(1)
    s_mov_b64 exec, 1
    v_mov_b32 v1, 161792
    ds_write_b32 v1, v3
    s_waitcnt lgkmcnt(0)
    s_mov_b64 exec, -1
    s_branch L_reg_1
L_pfx_2:
    s_lshl_b32 s38, s9, 3
    s_add_u32 s38, s38, 8
    s_load_dwordx2 s[12:13], s[0:1], s38
    s_load_dwordx2 s[14:15], s[0:1], 40
    s_load_dwordx2 s[16:17], s[0:1], 64
    s_load_dwordx2 s[18:19], s[0:1], 80
    v_and_b32 v1, 63, v0
    v_lshlrev_b32 v1, 4, v1
    s_lshl_b32 s38, s2, 14
    v_add_u32 v2, s38, v1
    s_waitcnt lgkmcnt(0)
    global_load_dwordx4 v[108:111], v2, s[12:13] offset:0
    global_load_dwordx4 v[108:111], v2, s[12:13] offset:1024
    global_load_dwordx4 v[108:111], v2, s[12:13] offset:2048
    global_load_dwordx4 v[108:111], v2, s[12:13] offset:3072
    v_add_u32 v2, 4096, v2
    global_load_dwordx4 v[108:111], v2, s[12:13] offset:0
    global_load_dwordx4 v[108:111], v2, s[12:13] offset:1024
    global_load_dwordx4 v[108:111], v2, s[12:13] offset:2048
    global_load_dwordx4 v[108:111], v2, s[12:13] offset:3072
    v_add_u32 v2, 4096, v2
    global_load_dwordx4 v[108:111], v2, s[12:13] offset:0
    global_load_dwordx4 v[108:111], v2, s[12:13] offset:1024
    global_load_dwordx4 v[108:111], v2, s[12:13] offset:2048
    global_load_dwordx4 v[108:111], v2, s[12:13] offset:3072
    v_add_u32 v2, 4096, v2
    global_load_dwordx4 v[108:111], v2, s[12:13] offset:0
    global_load_dwordx4 v[108:111], v2, s[12:13] offset:1024
    global_load_dwordx4 v[108:111], v2, s[12:13] offset:2048
    global_load_dwordx4 v[108:111], v2, s[12:13] offset:3072
    v_add_u32 v2, 4096, v2
    s_cmp_eq_u32 s9, 3
    s_nop 0
    s_cbranch_scc1 L_pf3_3
    s_lshl_b32 s39, s9, 13
    s_add_u32 s38, s38, s39
    s_sub_u32 s38, s38, 8192
    v_add_u32 v2, s38, v1
    global_load_dwordx4 v[108:111], v2, s[14:15] offset:0
    global_load_dwordx4 v[108:111], v2, s[14:15] offset:1024
    global_load_dwordx4 v[108:111], v2, s[14:15] offset:2048
    global_load_dwordx4 v[108:111], v2, s[14:15] offset:3072
    v_add_u32 v2, 4096, v2
    global_load_dwordx4 v[108:111], v2, s[14:15] offset:0
    global_load_dwordx4 v[108:111], v2, s[14:15] offset:1024
    global_load_dwordx4 v[108:111], v2, s[14:15] offset:2048
    global_load_dwordx4 v[108:111], v2, s[14:15] offset:3072
    v_add_u32 v2, 4096, v2
    s_nop 1
    s_branch L_reg_1
L_pf3_3:
    s_mul_i32 s38, s2, 5120
    v_add_u32 v2, s38, v1
    v_add_u32 v3, 4096, v2
    global_load_dwordx4 v[108:111], v2, s[16:17] offset:0
    global_load_dwordx4 v[108:111], v2, s[16:17] offset:1024
    global_load_dwordx4 v[108:111], v2, s[16:17] offset:2048
    global_load_dwordx4 v[108:111], v2, s[16:17] offset:3072
    global_load_dwordx4 v[108:111], v3, s[16:17]
    global_load_dwordx4 v[108:111], v2, s[18:19] offset:0
    global_load_dwordx4 v[108:111], v2, s[18:19] offset:1024
    global_load_dwordx4 v[108:111], v2, s[18:19] offset:2048
    global_load_dwordx4 v[108:111], v2, s[18:19] offset:3072
    global_load_dwordx4 v[108:111], v3, s[18:19]
L_reg_1:
    s_barrier
    v_mov_b32 v1, 161792
    ds_read_b32 v2, v1
    s_cmp_lg_u32 s9, 0
    s_cbranch_scc1 L_reg2_4
    s_waitcnt vmcnt(0) lgkmcnt(0)
    v_mov_b32 v4, v2
    v_mov_b32 v1, 32
    v_mov_b32 v2, 1
    s_mov_b64 exec, 1
    global_atomic_add v1, v2, s[10:11] sc1
    s_mov_b64 exec, -1
    v_mov_b32 v2, v4
    s_nop 1
L_reg2_4:
    s_waitcnt lgkmcnt(0)
    v_readfirstlane_b32 s7, v2
    s_barrier
    s_nop 3
    s_branch L_start
L_end0:
    s_waitcnt vmcnt(0) lgkmcnt(0)
    s_endpgm
L_start:
    s_lshl_b32 s38, s6, 23
    s_add_u32 s38, s38, 134217728
    s_add_u32 s20, s4, s38
    s_addc_u32 s21, s5, 0
    s_cmp_ge_u32 s7, 32
    s_cbranch_scc1 L_norank
    s_cmp_eq_u32 s6, 7
    s_cbranch_scc1 L_fast_f
    s_cmp_ge_u32 s6, 2
    s_cbranch_scc1 L_fast_x
    s_branch L_fast_r
L_norank:
    s_cmp_lg_u32 s9, 0
    s_cbranch_scc1 L_wg_5
    v_and_b32 v16, 15, v0
    v_lshlrev_b32 v16, 2, v16
    v_mov_b32 v17, 0
    s_mov_b32 s41, 2097152
    s_mov_b64 exec, 0x1ff
L_wgp_6:
    global_atomic_add v18, v16, v17, s[10:11] sc0 sc1
    s_waitcnt vmcnt(0)
    v_readlane_b32 s38, v18, 8
    s_sub_u32 s41, s41, 1
    s_cmp_eq_u32 s41, 0
    s_nop 2
    s_cbranch_scc1 L_end0
    s_cmp_lt_u32 s38, 256
    s_cbranch_scc1 L_wgp_6
    global_atomic_add v18, v16, v17, s[10:11] sc0 sc1
    s_waitcnt vmcnt(0)
    s_mov_b64 exec, 0xff
    v_cmp_ne_u32 vcc, 32, v18
    s_mov_b64 exec, -1
    s_nop 0
    v_mov_b32 v18, vcc_lo
    v_mov_b32 v16, 161792
    ds_write_b32 v16, v18
    s_waitcnt lgkmcnt(0)
L_wg_5:
    s_barrier
    v_mov_b32 v16, 161792
    ds_read_b32 v18, v16
    s_waitcnt lgkmcnt(0)
    v_readfirstlane_b32 s38, v18
    s_barrier
    s_cmp_lg_u32 s38, 0
    s_nop 2
    s_cbranch_scc1 L_safe_far_r
L_safe_far_r:
    s_branch L_safe
L_fast_r:
    s_cmp_lg_u32 s6, 1
    s_cbranch_scc1 L_xn0_8
    s_load_dwordx2 s[14:15], s[0:1], 0
    s_add_u32 s16, s4, 146800640
    s_addc_u32 s17, s5, 0
    v_lshlrev_b32 v12, 4, v0
    s_lshl_b32 s38, s7, 12
    v_add_u32 v12, s38, v12
    s_mov_b32 s40, 0
    s_waitcnt lgkmcnt(0)
L_xnl_9:
    v_add_u32 v4, 0, v12
    global_load_dwordx4 v[16:19], v4, s[14:15]
    v_add_u32 v5, 131072, v12
    global_load_dwordx4 v[20:23], v5, s[14:15]
    v_add_u32 v6, 262144, v12
    global_load_dwordx4 v[24:27], v6, s[14:15]
    v_add_u32 v7, 393216, v12
    global_load_dwordx4 v[28:31], v7, s[14:15]
    s_waitcnt vmcnt(3)
    v_lshlrev_b32 v32, 16, v16
    v_and_b32 v33, 0xffff0000, v16
    v_lshlrev_b32 v34, 16, v17
    v_and_b32 v35, 0xffff0000, v17
    v_lshlrev_b32 v36, 16, v18
    v_and_b32 v37, 0xffff0000, v18
    v_lshlrev_b32 v38, 16, v19
    v_and_b32 v39, 0xffff0000, v19
    v_pk_add_f32 v[40:41], v[32:33], v[34:35]
    v_pk_add_f32 v[42:43], v[36:37], v[38:39]
    v_pk_add_f32 v[40:41], v[40:41], v[42:43]
    v_add_f32 v64, v40, v41
    s_nop 1
    v_add_f32_dpp v65, v64, v64 quad_perm:[1,0,3,2] row_mask:0xf bank_mask:0xf
    s_nop 1
    v_add_f32_dpp v64, v65, v65 quad_perm:[2,3,0,1] row_mask:0xf bank_mask:0xf
    s_nop 1
    v_add_f32_dpp v65, v64, v64 row_half_mirror row_mask:0xf bank_mask:0xf
    s_nop 1
    v_add_f32_dpp v64, v65, v65 row_mirror row_mask:0xf bank_mask:0xf
    v_mov_b32 v65, v64
    s_nop 1
    v_permlane16_swap_b32 v65, v64
    v_add_f32 v64, v64, v65
    v_mov_b32 v65, v64
    s_nop 1
    v_permlane32_swap_b32 v65, v64
    v_add_f32 v64, v64, v65
    v_mul_f32 v64, 0x3b000000, v64
    v_pk_add_f32 v[40:41], v[32:33], v[64:65] op_sel_hi:[1,0] neg_lo:[0,1] neg_hi:[0,1]
    v_pk_add_f32 v[42:43], v[34:35], v[64:65] op_sel_hi:[1,0] neg_lo:[0,1] neg_hi:[0,1]
    v_pk_add_f32 v[44:45], v[36:37], v[64:65] op_sel_hi:[1,0] neg_lo:[0,1] neg_hi:[0,1]
    v_pk_add_f32 v[46:47], v[38:39], v[64:65] op_sel_hi:[1,0] neg_lo:[0,1] neg_hi:[0,1]
    v_pk_mul_f32 v[66:67], v[40:41], v[40:41]
    v_pk_fma_f32 v[66:67], v[42:43], v[42:43], v[66:67]
    v_pk_fma_f32 v[66:67], v[44:45], v[44:45], v[66:67]
    v_pk_fma_f32 v[66:67], v[46:47], v[46:47], v[66:67]
    v_add_f32 v66, v66, v67
    s_nop 1
    v_add_f32_dpp v67, v66, v66 quad_perm:[1,0,3,2] row_mask:0xf bank_mask:0xf
    s_nop 1
    v_add_f32_dpp v66, v67, v67 quad_perm:[2,3,0,1] row_mask:0xf bank_mask:0xf
    s_nop 1
    v_add_f32_dpp v67, v66, v66 row_half_mirror row_mask:0xf bank_mask:0xf
    s_nop 1
    v_add_f32_dpp v66, v67, v67 row_mirror row_mask:0xf bank_mask:0xf
    v_mov_b32 v67, v66
    s_nop 1
    v_permlane16_swap_b32 v67, v66
    v_add_f32 v66, v66, v67
    v_mov_b32 v67, v66
    s_nop 1
    v_permlane32_swap_b32 v67, v66
    v_add_f32 v66, v66, v67
    v_mul_f32 v66, 0x3b000000, v66
    v_cvt_pk_bf16_f32 v64, v64, v64
    v_and_b32 v64, 0xffff0000, v64
    v_cvt_pk_bf16_f32 v66, v66, v66
    v_and_b32 v66, 0xffff0000, v66
    v_add_f32 v66, 0x3727c5ac, v66
    v_cvt_pk_bf16_f32 v66, v66, v66
    v_and_b32 v66, 0xffff0000, v66
    v_sqrt_f32 v66, v66
    s_nop 0
    v_cvt_pk_bf16_f32 v66, v66, v66
    v_and_b32 v66, 0xffff0000, v66
    v_rcp_f32 v66, v66
    v_pk_add_f32 v[40:41], v[32:33], v[64:65] op_sel_hi:[1,0] neg_lo:[0,1] neg_hi:[0,1]
    v_pk_add_f32 v[42:43], v[34:35], v[64:65] op_sel_hi:[1,0] neg_lo:[0,1] neg_hi:[0,1]
    v_pk_add_f32 v[44:45], v[36:37], v[64:65] op_sel_hi:[1,0] neg_lo:[0,1] neg_hi:[0,1]
    v_pk_add_f32 v[46:47], v[38:39], v[64:65] op_sel_hi:[1,0] neg_lo:[0,1] neg_hi:[0,1]
    v_cvt_pk_bf16_f32 v48, v40, v41
    v_cvt_pk_bf16_f32 v49, v42, v43
    v_cvt_pk_bf16_f32 v50, v44, v45
    v_cvt_pk_bf16_f32 v51, v46, v47
    v_lshlrev_b32 v40, 16, v48
    v_and_b32 v41, 0xffff0000, v48
    v_lshlrev_b32 v42, 16, v49
    v_and_b32 v43, 0xffff0000, v49
    v_lshlrev_b32 v44, 16, v50
    v_and_b32 v45, 0xffff0000, v50
    v_lshlrev_b32 v46, 16, v51
    v_and_b32 v47, 0xffff0000, v51
    v_pk_mul_f32 v[40:41], v[40:41], v[66:67] op_sel_hi:[1,0]
    v_pk_mul_f32 v[42:43], v[42:43], v[66:67] op_sel_hi:[1,0]
    v_pk_mul_f32 v[44:45], v[44:45], v[66:67] op_sel_hi:[1,0]
    v_pk_mul_f32 v[46:47], v[46:47], v[66:67] op_sel_hi:[1,0]
    v_cvt_pk_bf16_f32 v48, v40, v41
    v_cvt_pk_bf16_f32 v49, v42, v43
    v_cvt_pk_bf16_f32 v50, v44, v45
    v_cvt_pk_bf16_f32 v51, v46, v47
    v_min_u32 v48, -2, v48
    global_store_dwordx4 v4, v[48:51], s[16:17] sc1
    s_waitcnt vmcnt(3)
    v_lshlrev_b32 v32, 16, v20
    v_and_b32 v33, 0xffff0000, v20
    v_lshlrev_b32 v34, 16, v21
    v_and_b32 v35, 0xffff0000, v21
    v_lshlrev_b32 v36, 16, v22
    v_and_b32 v37, 0xffff0000, v22
    v_lshlrev_b32 v38, 16, v23
    v_and_b32 v39, 0xffff0000, v23
    v_pk_add_f32 v[40:41], v[32:33], v[34:35]
    v_pk_add_f32 v[42:43], v[36:37], v[38:39]
    v_pk_add_f32 v[40:41], v[40:41], v[42:43]
    v_add_f32 v64, v40, v41
    s_nop 1
    v_add_f32_dpp v65, v64, v64 quad_perm:[1,0,3,2] row_mask:0xf bank_mask:0xf
    s_nop 1
    v_add_f32_dpp v64, v65, v65 quad_perm:[2,3,0,1] row_mask:0xf bank_mask:0xf
    s_nop 1
    v_add_f32_dpp v65, v64, v64 row_half_mirror row_mask:0xf bank_mask:0xf
    s_nop 1
    v_add_f32_dpp v64, v65, v65 row_mirror row_mask:0xf bank_mask:0xf
    v_mov_b32 v65, v64
    s_nop 1
    v_permlane16_swap_b32 v65, v64
    v_add_f32 v64, v64, v65
    v_mov_b32 v65, v64
    s_nop 1
    v_permlane32_swap_b32 v65, v64
    v_add_f32 v64, v64, v65
    v_mul_f32 v64, 0x3b000000, v64
    v_pk_add_f32 v[40:41], v[32:33], v[64:65] op_sel_hi:[1,0] neg_lo:[0,1] neg_hi:[0,1]
    v_pk_add_f32 v[42:43], v[34:35], v[64:65] op_sel_hi:[1,0] neg_lo:[0,1] neg_hi:[0,1]
    v_pk_add_f32 v[44:45], v[36:37], v[64:65] op_sel_hi:[1,0] neg_lo:[0,1] neg_hi:[0,1]
    v_pk_add_f32 v[46:47], v[38:39], v[64:65] op_sel_hi:[1,0] neg_lo:[0,1] neg_hi:[0,1]
    v_pk_mul_f32 v[66:67], v[40:41], v[40:41]
    v_pk_fma_f32 v[66:67], v[42:43], v[42:43], v[66:67]
    v_pk_fma_f32 v[66:67], v[44:45], v[44:45], v[66:67]
    v_pk_fma_f32 v[66:67], v[46:47], v[46:47], v[66:67]
    v_add_f32 v66, v66, v67
    s_nop 1
    v_add_f32_dpp v67, v66, v66 quad_perm:[1,0,3,2] row_mask:0xf bank_mask:0xf
    s_nop 1
    v_add_f32_dpp v66, v67, v67 quad_perm:[2,3,0,1] row_mask:0xf bank_mask:0xf
    s_nop 1
    v_add_f32_dpp v67, v66, v66 row_half_mirror row_mask:0xf bank_mask:0xf
    s_nop 1
    v_add_f32_dpp v66, v67, v67 row_mirror row_mask:0xf bank_mask:0xf
    v_mov_b32 v67, v66
    s_nop 1
    v_permlane16_swap_b32 v67, v66
    v_add_f32 v66, v66, v67
    v_mov_b32 v67, v66
    s_nop 1
    v_permlane32_swap_b32 v67, v66
    v_add_f32 v66, v66, v67
    v_mul_f32 v66, 0x3b000000, v66
    v_cvt_pk_bf16_f32 v64, v64, v64
    v_and_b32 v64, 0xffff0000, v64
    v_cvt_pk_bf16_f32 v66, v66, v66
    v_and_b32 v66, 0xffff0000, v66
    v_add_f32 v66, 0x3727c5ac, v66
    v_cvt_pk_bf16_f32 v66, v66, v66
    v_and_b32 v66, 0xffff0000, v66
    v_sqrt_f32 v66, v66
    s_nop 0
    v_cvt_pk_bf16_f32 v66, v66, v66
    v_and_b32 v66, 0xffff0000, v66
    v_rcp_f32 v66, v66
    v_pk_add_f32 v[40:41], v[32:33], v[64:65] op_sel_hi:[1,0] neg_lo:[0,1] neg_hi:[0,1]
    v_pk_add_f32 v[42:43], v[34:35], v[64:65] op_sel_hi:[1,0] neg_lo:[0,1] neg_hi:[0,1]
    v_pk_add_f32 v[44:45], v[36:37], v[64:65] op_sel_hi:[1,0] neg_lo:[0,1] neg_hi:[0,1]
    v_pk_add_f32 v[46:47], v[38:39], v[64:65] op_sel_hi:[1,0] neg_lo:[0,1] neg_hi:[0,1]
    v_cvt_pk_bf16_f32 v52, v40, v41
    v_cvt_pk_bf16_f32 v53, v42, v43
    v_cvt_pk_bf16_f32 v54, v44, v45
    v_cvt_pk_bf16_f32 v55, v46, v47
    v_lshlrev_b32 v40, 16, v52
    v_and_b32 v41, 0xffff0000, v52
    v_lshlrev_b32 v42, 16, v53
    v_and_b32 v43, 0xffff0000, v53
    v_lshlrev_b32 v44, 16, v54
    v_and_b32 v45, 0xffff0000, v54
    v_lshlrev_b32 v46, 16, v55
    v_and_b32 v47, 0xffff0000, v55
    v_pk_mul_f32 v[40:41], v[40:41], v[66:67] op_sel_hi:[1,0]
    v_pk_mul_f32 v[42:43], v[42:43], v[66:67] op_sel_hi:[1,0]
    v_pk_mul_f32 v[44:45], v[44:45], v[66:67] op_sel_hi:[1,0]
    v_pk_mul_f32 v[46:47], v[46:47], v[66:67] op_sel_hi:[1,0]
    v_cvt_pk_bf16_f32 v52, v40, v41
    v_cvt_pk_bf16_f32 v53, v42, v43
    v_cvt_pk_bf16_f32 v54, v44, v45
    v_cvt_pk_bf16_f32 v55, v46, v47
    v_min_u32 v52, -2, v52
    global_store_dwordx4 v5, v[52:55], s[16:17] sc1
    s_waitcnt vmcnt(3)
    v_lshlrev_b32 v32, 16, v24
    v_and_b32 v33, 0xffff0000, v24
    v_lshlrev_b32 v34, 16, v25
    v_and_b32 v35, 0xffff0000, v25
    v_lshlrev_b32 v36, 16, v26
    v_and_b32 v37, 0xffff0000, v26
    v_lshlrev_b32 v38, 16, v27
    v_and_b32 v39, 0xffff0000, v27
    v_pk_add_f32 v[40:41], v[32:33], v[34:35]
    v_pk_add_f32 v[42:43], v[36:37], v[38:39]
    v_pk_add_f32 v[40:41], v[40:41], v[42:43]
    v_add_f32 v64, v40, v41
    s_nop 1
    v_add_f32_dpp v65, v64, v64 quad_perm:[1,0,3,2] row_mask:0xf bank_mask:0xf
    s_nop 1
    v_add_f32_dpp v64, v65, v65 quad_perm:[2,3,0,1] row_mask:0xf bank_mask:0xf
    s_nop 1
    v_add_f32_dpp v65, v64, v64 row_half_mirror row_mask:0xf bank_mask:0xf
    s_nop 1
    v_add_f32_dpp v64, v65, v65 row_mirror row_mask:0xf bank_mask:0xf
    v_mov_b32 v65, v64
    s_nop 1
    v_permlane16_swap_b32 v65, v64
    v_add_f32 v64, v64, v65
    v_mov_b32 v65, v64
    s_nop 1
    v_permlane32_swap_b32 v65, v64
    v_add_f32 v64, v64, v65
    v_mul_f32 v64, 0x3b000000, v64
    v_pk_add_f32 v[40:41], v[32:33], v[64:65] op_sel_hi:[1,0] neg_lo:[0,1] neg_hi:[0,1]
    v_pk_add_f32 v[42:43], v[34:35], v[64:65] op_sel_hi:[1,0] neg_lo:[0,1] neg_hi:[0,1]
    v_pk_add_f32 v[44:45], v[36:37], v[64:65] op_sel_hi:[1,0] neg_lo:[0,1] neg_hi:[0,1]
    v_pk_add_f32 v[46:47], v[38:39], v[64:65] op_sel_hi:[1,0] neg_lo:[0,1] neg_hi:[0,1]
    v_pk_mul_f32 v[66:67], v[40:41], v[40:41]
    v_pk_fma_f32 v[66:67], v[42:43], v[42:43], v[66:67]
    v_pk_fma_f32 v[66:67], v[44:45], v[44:45], v[66:67]
    v_pk_fma_f32 v[66:67], v[46:47], v[46:47], v[66:67]
    v_add_f32 v66, v66, v67
    s_nop 1
    v_add_f32_dpp v67, v66, v66 quad_perm:[1,0,3,2] row_mask:0xf bank_mask:0xf
    s_nop 1
    v_add_f32_dpp v66, v67, v67 quad_perm:[2,3,0,1] row_mask:0xf bank_mask:0xf
    s_nop 1
    v_add_f32_dpp v67, v66, v66 row_half_mirror row_mask:0xf bank_mask:0xf
    s_nop 1
    v_add_f32_dpp v66, v67, v67 row_mirror row_mask:0xf bank_mask:0xf
    v_mov_b32 v67, v66
    s_nop 1
    v_permlane16_swap_b32 v67, v66
    v_add_f32 v66, v66, v67
    v_mov_b32 v67, v66
    s_nop 1
    v_permlane32_swap_b32 v67, v66
    v_add_f32 v66, v66, v67
    v_mul_f32 v66, 0x3b000000, v66
    v_cvt_pk_bf16_f32 v64, v64, v64
    v_and_b32 v64, 0xffff0000, v64
    v_cvt_pk_bf16_f32 v66, v66, v66
    v_and_b32 v66, 0xffff0000, v66
    v_add_f32 v66, 0x3727c5ac, v66
    v_cvt_pk_bf16_f32 v66, v66, v66
    v_and_b32 v66, 0xffff0000, v66
    v_sqrt_f32 v66, v66
    s_nop 0
    v_cvt_pk_bf16_f32 v66, v66, v66
    v_and_b32 v66, 0xffff0000, v66
    v_rcp_f32 v66, v66
    v_pk_add_f32 v[40:41], v[32:33], v[64:65] op_sel_hi:[1,0] neg_lo:[0,1] neg_hi:[0,1]
    v_pk_add_f32 v[42:43], v[34:35], v[64:65] op_sel_hi:[1,0] neg_lo:[0,1] neg_hi:[0,1]
    v_pk_add_f32 v[44:45], v[36:37], v[64:65] op_sel_hi:[1,0] neg_lo:[0,1] neg_hi:[0,1]
    v_pk_add_f32 v[46:47], v[38:39], v[64:65] op_sel_hi:[1,0] neg_lo:[0,1] neg_hi:[0,1]
    v_cvt_pk_bf16_f32 v56, v40, v41
    v_cvt_pk_bf16_f32 v57, v42, v43
    v_cvt_pk_bf16_f32 v58, v44, v45
    v_cvt_pk_bf16_f32 v59, v46, v47
    v_lshlrev_b32 v40, 16, v56
    v_and_b32 v41, 0xffff0000, v56
    v_lshlrev_b32 v42, 16, v57
    v_and_b32 v43, 0xffff0000, v57
    v_lshlrev_b32 v44, 16, v58
    v_and_b32 v45, 0xffff0000, v58
    v_lshlrev_b32 v46, 16, v59
    v_and_b32 v47, 0xffff0000, v59
    v_pk_mul_f32 v[40:41], v[40:41], v[66:67] op_sel_hi:[1,0]
    v_pk_mul_f32 v[42:43], v[42:43], v[66:67] op_sel_hi:[1,0]
    v_pk_mul_f32 v[44:45], v[44:45], v[66:67] op_sel_hi:[1,0]
    v_pk_mul_f32 v[46:47], v[46:47], v[66:67] op_sel_hi:[1,0]
    v_cvt_pk_bf16_f32 v56, v40, v41
    v_cvt_pk_bf16_f32 v57, v42, v43
    v_cvt_pk_bf16_f32 v58, v44, v45
    v_cvt_pk_bf16_f32 v59, v46, v47
    v_min_u32 v56, -2, v56
    global_store_dwordx4 v6, v[56:59], s[16:17] sc1
    s_waitcnt vmcnt(3)
    v_lshlrev_b32 v32, 16, v28
    v_and_b32 v33, 0xffff0000, v28
    v_lshlrev_b32 v34, 16, v29
    v_and_b32 v35, 0xffff0000, v29
    v_lshlrev_b32 v36, 16, v30
    v_and_b32 v37, 0xffff0000, v30
    v_lshlrev_b32 v38, 16, v31
    v_and_b32 v39, 0xffff0000, v31
    v_pk_add_f32 v[40:41], v[32:33], v[34:35]
    v_pk_add_f32 v[42:43], v[36:37], v[38:39]
    v_pk_add_f32 v[40:41], v[40:41], v[42:43]
    v_add_f32 v64, v40, v41
    s_nop 1
    v_add_f32_dpp v65, v64, v64 quad_perm:[1,0,3,2] row_mask:0xf bank_mask:0xf
    s_nop 1
    v_add_f32_dpp v64, v65, v65 quad_perm:[2,3,0,1] row_mask:0xf bank_mask:0xf
    s_nop 1
    v_add_f32_dpp v65, v64, v64 row_half_mirror row_mask:0xf bank_mask:0xf
    s_nop 1
    v_add_f32_dpp v64, v65, v65 row_mirror row_mask:0xf bank_mask:0xf
    v_mov_b32 v65, v64
    s_nop 1
    v_permlane16_swap_b32 v65, v64
    v_add_f32 v64, v64, v65
    v_mov_b32 v65, v64
    s_nop 1
    v_permlane32_swap_b32 v65, v64
    v_add_f32 v64, v64, v65
    v_mul_f32 v64, 0x3b000000, v64
    v_pk_add_f32 v[40:41], v[32:33], v[64:65] op_sel_hi:[1,0] neg_lo:[0,1] neg_hi:[0,1]
    v_pk_add_f32 v[42:43], v[34:35], v[64:65] op_sel_hi:[1,0] neg_lo:[0,1] neg_hi:[0,1]
    v_pk_add_f32 v[44:45], v[36:37], v[64:65] op_sel_hi:[1,0] neg_lo:[0,1] neg_hi:[0,1]
    v_pk_add_f32 v[46:47], v[38:39], v[64:65] op_sel_hi:[1,0] neg_lo:[0,1] neg_hi:[0,1]
    v_pk_mul_f32 v[66:67], v[40:41], v[40:41]
    v_pk_fma_f32 v[66:67], v[42:43], v[42:43], v[66:67]
    v_pk_fma_f32 v[66:67], v[44:45], v[44:45], v[66:67]
    v_pk_fma_f32 v[66:67], v[46:47], v[46:47], v[66:67]
    v_add_f32 v66, v66, v67
    s_nop 1
    v_add_f32_dpp v67, v66, v66 quad_perm:[1,0,3,2] row_mask:0xf bank_mask:0xf
    s_nop 1
    v_add_f32_dpp v66, v67, v67 quad_perm:[2,3,0,1] row_mask:0xf bank_mask:0xf
    s_nop 1
    v_add_f32_dpp v67, v66, v66 row_half_mirror row_mask:0xf bank_mask:0xf
    s_nop 1
    v_add_f32_dpp v66, v67, v67 row_mirror row_mask:0xf bank_mask:0xf
    v_mov_b32 v67, v66
    s_nop 1
    v_permlane16_swap_b32 v67, v66
    v_add_f32 v66, v66, v67
    v_mov_b32 v67, v66
    s_nop 1
    v_permlane32_swap_b32 v67, v66
    v_add_f32 v66, v66, v67
    v_mul_f32 v66, 0x3b000000, v66
    v_cvt_pk_bf16_f32 v64, v64, v64
    v_and_b32 v64, 0xffff0000, v64
    v_cvt_pk_bf16_f32 v66, v66, v66
    v_and_b32 v66, 0xffff0000, v66
    v_add_f32 v66, 0x3727c5ac, v66
    v_cvt_pk_bf16_f32 v66, v66, v66
    v_and_b32 v66, 0xffff0000, v66
    v_sqrt_f32 v66, v66
    s_nop 0
    v_cvt_pk_bf16_f32 v66, v66, v66
    v_and_b32 v66, 0xffff0000, v66
    v_rcp_f32 v66, v66
    v_pk_add_f32 v[40:41], v[32:33], v[64:65] op_sel_hi:[1,0] neg_lo:[0,1] neg_hi:[0,1]
    v_pk_add_f32 v[42:43], v[34:35], v[64:65] op_sel_hi:[1,0] neg_lo:[0,1] neg_hi:[0,1]
    v_pk_add_f32 v[44:45], v[36:37], v[64:65] op_sel_hi:[1,0] neg_lo:[0,1] neg_hi:[0,1]
    v_pk_add_f32 v[46:47], v[38:39], v[64:65] op_sel_hi:[1,0] neg_lo:[0,1] neg_hi:[0,1]
    v_cvt_pk_bf16_f32 v60, v40, v41
    v_cvt_pk_bf16_f32 v61, v42, v43
    v_cvt_pk_bf16_f32 v62, v44, v45
    v_cvt_pk_bf16_f32 v63, v46, v47
    v_lshlrev_b32 v40, 16, v60
    v_and_b32 v41, 0xffff0000, v60
    v_lshlrev_b32 v42, 16, v61
    v_and_b32 v43, 0xffff0000, v61
    v_lshlrev_b32 v44, 16, v62
    v_and_b32 v45, 0xffff0000, v62
    v_lshlrev_b32 v46, 16, v63
    v_and_b32 v47, 0xffff0000, v63
    v_pk_mul_f32 v[40:41], v[40:41], v[66:67] op_sel_hi:[1,0]
    v_pk_mul_f32 v[42:43], v[42:43], v[66:67] op_sel_hi:[1,0]
    v_pk_mul_f32 v[44:45], v[44:45], v[66:67] op_sel_hi:[1,0]
    v_pk_mul_f32 v[46:47], v[46:47], v[66:67] op_sel_hi:[1,0]
    v_cvt_pk_bf16_f32 v60, v40, v41
    v_cvt_pk_bf16_f32 v61, v42, v43
    v_cvt_pk_bf16_f32 v62, v44, v45
    v_cvt_pk_bf16_f32 v63, v46, v47
    v_min_u32 v60, -2, v60
    global_store_dwordx4 v7, v[60:63], s[16:17] sc1
    v_add_u32 v12, 524288, v12
    s_add_u32 s40, s40, 1
    s_cmp_lt_u32 s40, 4
    s_cbranch_scc1 L_xnl_9
    s_waitcnt vmcnt(0)
    s_barrier
    s_cmp_lg_u32 s9, 0
    s_cbranch_scc1 L_arr_10
    v_mov_b32 v1, 128
    v_mov_b32 v2, 1
    s_mov_b64 exec, 1
    global_atomic_add v1, v2, s[10:11] sc1
    s_mov_b64 exec, -1
L_arr_10:
    s_sleep 127
    s_sleep 127
L_xn0_8:
    s_lshl_b32 s46, s9, 12
    s_lshl_b32 s38, s6, 25
    s_lshl_b32 s39, s7, 14
    s_add_u32 s38, s38, s39
    s_add_u32 s38, s38, s46
    s_add_u32 s30, s4, s38
    s_addc_u32 s31, s5, 0
    s_lshl_b32 s38, s6, 23
    s_lshl_b32 s39, s7, 12
    s_add_u32 s38, s38, s39
    s_add_u32 s38, s38, 100663296
    s_add_u32 s32, s4, s38
    s_addc_u32 s33, s5, 0
    s_lshl_b32 s38, s6, 13
    s_lshl_b32 s39, s7, 2
    s_add_u32 s38, s38, s39
    s_add_u32 s39, s38, 117440512
    s_add_u32 s34, s4, s39
    s_addc_u32 s35, s5, 0
    s_lshl_b32 s38, s38, 2
    s_lshl_b32 s39, s9, 2
    s_add_u32 s38, s38, s39
    s_add_u32 s39, s38, 117506048
    s_add_u32 s36, s4, s39
    s_addc_u32 s37, s5, 0
    s_mov_b64 s[56:57], 0
    s_add_u32 s22, s20, 0
    s_addc_u32 s23, s21, 0
    s_add_u32 s24, s20, 8192
    s_addc_u32 s25, s21, 0
    s_add_u32 s28, s20, 65536
    s_addc_u32 s29, s21, 0
    s_add_u32 s50, s20, 98304
    s_addc_u32 s51, s21, 0
    s_add_u32 s52, s20, 131072
    s_addc_u32 s53, s21, 0
    s_add_u32 s54, s20, 163840
    s_addc_u32 s55, s21, 0
    s_lshl_b32 s38, s7, 14
    s_add_u32 s38, s38, s46
    s_add_u32 s26, s28, s38
    s_addc_u32 s27, s29, 0
    s_mov_b32 s42, 0x00550055
    s_mov_b32 s43, 0x00550055
    s_mov_b32 s44, 0x3e0293ee
    s_mov_b32 s45, 0x3e0293ee
    s_cmp_lg_u32 s9, 0
    s_cbranch_scc1 L_minit_11
    s_load_dwordx2 s[12:13], s[0:1], 8
    v_bfe_u32 v17, v0, 2, 3
    v_lshlrev_b32 v17, 10, v17
    v_and_b32 v18, 3, v0
    v_lshl_add_u32 v17, v18, 3, v17
    v_lshrrev_b32 v18, 5, v0
    v_lshl_add_u32 v17, v18, 2, v17
    s_lshl_b32 s38, s7, 5
    v_add_u32 v17, s38, v17
    s_waitcnt lgkmcnt(0)
    global_load_dword v107, v17, s[12:13]
L_minit_11:
    s_load_dwordx2 s[12:13], s[0:1], 16
    s_load_dwordx2 s[14:15], s[0:1], 24
    s_load_dwordx2 s[16:17], s[0:1], 32
    s_load_dwordx2 s[18:19], s[0:1], 40
    v_lshrrev_b32 v1, 4, v0
    v_and_b32 v2, 15, v0
    v_lshlrev_b32 v3, 13, v1
    v_lshl_add_u32 v3, v2, 4, v3
    s_lshl_b32 s38, s7, 8
    v_add_u32 v3, s38, v3
    v_lshlrev_b32 v4, 10, v1
    v_lshrrev_b32 v5, 2, v2
    v_lshl_add_u32 v4, v5, 8, v4
    v_and_b32 v5, 3, v2
    v_lshl_add_u32 v4, v5, 4, v4
    s_lshl_b32 s38, s7, 17
    v_add_u32 v4, s38, v4
    v_and_b32 v5, 3, v1
    v_lshlrev_b32 v5, 5, v5
    v_bfe_u32 v6, v1, 3, 1
    v_lshlrev_b32 v6, 7, v6
    v_xor_b32 v5, v5, v6
    v_lshlrev_b32 v6, 4, v2
    v_xor_b32 v5, v5, v6
    v_lshl_add_u32 v5, v1, 8, v5
    v_add_u32 v5, 16384, v5
    v_and_b32 v6, 63, v0
    v_lshrrev_b32 v7, 4, v6
    v_bfe_u32 v8, v6, 2, 2
    v_and_b32 v9, 3, v6
    v_lshl_add_u32 v10, v7, 3, v8
    v_lshlrev_b32 v10, 8, v10
    v_add_u32 v10, 16384, v10
    v_lshlrev_b32 v8, 5, v8
    v_and_b32 v7, 1, v7
    v_lshlrev_b32 v7, 7, v7
    v_xor_b32 v8, v8, v7
    s_lshl_b32 s38, s9, 6
    v_lshlrev_b32 v12, 3, v9
    v_add_u32 v12, s38, v12
    v_xor_b32 v12, v12, v8
    v_add_u32 v6, v10, v12
    v_xor_b32 v12, 32, v12
    v_add_u32 v7, v10, v12
    v_and_b32 v8, 63, v0
    v_lshlrev_b32 v8, 4, v8
    s_mul_i32 s38, s9, 28672
    s_add_u32 s38, s38, 49152
    v_add_u32 v8, s38, v8
    v_lshrrev_b32 v15, 2, v2
    v_lshlrev_b32 v15, 20, v15
    s_waitcnt lgkmcnt(0)
    v_add_u32 v11, 0, v15
    v_and_b32 v11, 0x3fffff, v11
    v_add_u32 v11, v11, v3
    global_load_dwordx4 v[16:19], v11, s[14:15]
    v_add_u32 v11, 0, v15
    v_and_b32 v11, 0x3fffff, v11
    v_add_u32 v11, v11, v3
    v_add_u32 v11, 131072, v11
    global_load_dwordx4 v[20:23], v11, s[14:15]
    v_add_u32 v11, 0, v15
    v_and_b32 v11, 0x3fffff, v11
    v_add_u32 v11, v11, v3
    v_add_u32 v11, 262144, v11
    global_load_dwordx4 v[24:27], v11, s[14:15]
    v_add_u32 v11, 0, v15
    v_and_b32 v11, 0x3fffff, v11
    v_add_u32 v11, v11, v3
    v_add_u32 v11, 393216, v11
    global_load_dwordx4 v[28:31], v11, s[14:15]
    v_add_u32 v11, 524288, v15
    v_and_b32 v11, 0x3fffff, v11
    v_add_u32 v11, v11, v3
    global_load_dwordx4 v[32:35], v11, s[14:15]
    v_add_u32 v11, 524288, v15
    v_and_b32 v11, 0x3fffff, v11
    v_add_u32 v11, v11, v3
    v_add_u32 v11, 131072, v11
    global_load_dwordx4 v[36:39], v11, s[14:15]
    v_add_u32 v11, 524288, v15
    v_and_b32 v11, 0x3fffff, v11
    v_add_u32 v11, v11, v3
    v_add_u32 v11, 262144, v11
    global_load_dwordx4 v[40:43], v11, s[14:15]
    v_add_u32 v11, 524288, v15
    v_and_b32 v11, 0x3fffff, v11
    v_add_u32 v11, v11, v3
    v_add_u32 v11, 393216, v11
    global_load_dwordx4 v[44:47], v11, s[14:15]
    v_add_u32 v11, 1048576, v15
    v_and_b32 v11, 0x3fffff, v11
    v_add_u32 v11, v11, v3
    global_load_dwordx4 v[48:51], v11, s[14:15]
    v_add_u32 v11, 1048576, v15
    v_and_b32 v11, 0x3fffff, v11
    v_add_u32 v11, v11, v3
    v_add_u32 v11, 131072, v11
    global_load_dwordx4 v[52:55], v11, s[14:15]
    v_add_u32 v11, 1048576, v15
    v_and_b32 v11, 0x3fffff, v11
    v_add_u32 v11, v11, v3
    v_add_u32 v11, 262144, v11
    global_load_dwordx4 v[56:59], v11, s[14:15]
    v_add_u32 v11, 1048576, v15
    v_and_b32 v11, 0x3fffff, v11
    v_add_u32 v11, v11, v3
    v_add_u32 v11, 393216, v11
    global_load_dwordx4 v[60:63], v11, s[14:15]
    v_add_u32 v11, 1572864, v15
    v_and_b32 v11, 0x3fffff, v11
    v_add_u32 v11, v11, v3
    global_load_dwordx4 v[64:67], v11, s[14:15]
    v_add_u32 v11, 1572864, v15
    v_and_b32 v11, 0x3fffff, v11
    v_add_u32 v11, v11, v3
    v_add_u32 v11, 131072, v11
    global_load_dwordx4 v[68:71], v11, s[14:15]
    v_add_u32 v11, 1572864, v15
    v_and_b32 v11, 0x3fffff, v11
    v_add_u32 v11, v11, v3
    v_add_u32 v11, 262144, v11
    global_load_dwordx4 v[72:75], v11, s[14:15]
    v_add_u32 v11, 1572864, v15
    v_and_b32 v11, 0x3fffff, v11
    v_add_u32 v11, v11, v3
    v_add_u32 v11, 393216, v11
    global_load_dwordx4 v[76:79], v11, s[14:15]
    v_add_u32 v11, 2097152, v15
    v_and_b32 v11, 0x3fffff, v11
    v_add_u32 v11, v11, v3
    global_load_dwordx4 v[80:83], v11, s[14:15]
    v_add_u32 v11, 2097152, v15
    v_and_b32 v11, 0x3fffff, v11
    v_add_u32 v11, v11, v3
    v_add_u32 v11, 131072, v11
    global_load_dwordx4 v[84:87], v11, s[14:15]
    v_add_u32 v11, 2097152, v15
    v_and_b32 v11, 0x3fffff, v11
    v_add_u32 v11, v11, v3
    v_add_u32 v11, 262144, v11
    global_load_dwordx4 v[88:91], v11, s[14:15]
    v_add_u32 v11, 2097152, v15
    v_and_b32 v11, 0x3fffff, v11
    v_add_u32 v11, v11, v3
    v_add_u32 v11, 393216, v11
    global_load_dwordx4 v[92:95], v11, s[14:15]
    v_and_b32 v100, 63, v0
    v_lshlrev_b32 v101, 4, v100
    v_mov_b32 v96, 0
    v_mov_b32 v97, 0
    v_mov_b32 v98, 0
    v_mov_b32 v99, 0
    s_cmp_lg_u32 s9, 0
    s_nop 0
    s_cbranch_scc1 L_minit_12
    s_lshl_b32 s38, s7, 8
    v_lshlrev_b32 v102, 2, v100
    v_add_u32 v102, s38, v102
    v_mov_b32 v103, -1
    s_waitcnt vmcnt(20)
    v_min_u32 v107, -2, v107
    global_store_dword v102, v103, s[24:25]
    global_store_dword v102, v107, s[22:23]
L_minit_12:
    global_store_dwordx4 v101, v[96:99], s[26:27] offset:0
    global_store_dwordx4 v101, v[96:99], s[26:27] offset:1024
    s_waitcnt vmcnt(16)
    ds_write_b128 v5, v[16:19] offset:0
    ds_write_b128 v5, v[20:23] offset:4096
    ds_write_b128 v5, v[24:27] offset:8192
    ds_write_b128 v5, v[28:31] offset:12288
    s_waitcnt lgkmcnt(0)
    v_add_u32 v11, 2621440, v15
    v_and_b32 v11, 0x3fffff, v11
    v_add_u32 v11, v11, v3
    global_load_dwordx4 v[16:19], v11, s[14:15]
    v_add_u32 v11, 2621440, v15
    v_and_b32 v11, 0x3fffff, v11
    v_add_u32 v11, v11, v3
    v_add_u32 v11, 131072, v11
    global_load_dwordx4 v[20:23], v11, s[14:15]
    v_add_u32 v11, 2621440, v15
    v_and_b32 v11, 0x3fffff, v11
    v_add_u32 v11, v11, v3
    v_add_u32 v11, 262144, v11
    global_load_dwordx4 v[24:27], v11, s[14:15]
    v_add_u32 v11, 2621440, v15
    v_and_b32 v11, 0x3fffff, v11
    v_add_u32 v11, v11, v3
    v_add_u32 v11, 393216, v11
    global_load_dwordx4 v[28:31], v11, s[14:15]
    s_barrier
    ds_read_b64_tr_b16 v[96:97], v6 offset:0
    ds_read_b64_tr_b16 v[98:99], v6 offset:1024
    ds_read_b64_tr_b16 v[100:101], v6 offset:8192
    ds_read_b64_tr_b16 v[102:103], v6 offset:9216
    s_waitcnt lgkmcnt(0)
    ds_write_b128 v8, v[96:99] offset:4096
    ds_write_b128 v8, v[100:103] offset:5120
    ds_read_b64_tr_b16 v[96:97], v7 offset:0
    ds_read_b64_tr_b16 v[98:99], v7 offset:1024
    ds_read_b64_tr_b16 v[100:101], v7 offset:8192
    ds_read_b64_tr_b16 v[102:103], v7 offset:9216
    s_waitcnt lgkmcnt(0)
    ds_write_b128 v8, v[96:99] offset:6144
    ds_write_b128 v8, v[100:103] offset:7168
    s_waitcnt lgkmcnt(0)
    s_waitcnt vmcnt(16)
    ds_write_b128 v5, v[32:35] offset:16384
    ds_write_b128 v5, v[36:39] offset:20480
    ds_write_b128 v5, v[40:43] offset:24576
    ds_write_b128 v5, v[44:47] offset:28672
    s_waitcnt lgkmcnt(0)
    v_add_u32 v11, 3145728, v15
    v_and_b32 v11, 0x3fffff, v11
    v_add_u32 v11, v11, v3
    global_load_dwordx4 v[32:35], v11, s[14:15]
    v_add_u32 v11, 3145728, v15
    v_and_b32 v11, 0x3fffff, v11
    v_add_u32 v11, v11, v3
    v_add_u32 v11, 131072, v11
    global_load_dwordx4 v[36:39], v11, s[14:15]
    v_add_u32 v11, 3145728, v15
    v_and_b32 v11, 0x3fffff, v11
    v_add_u32 v11, v11, v3
    v_add_u32 v11, 262144, v11
    global_load_dwordx4 v[40:43], v11, s[14:15]
    v_add_u32 v11, 3145728, v15
    v_and_b32 v11, 0x3fffff, v11
    v_add_u32 v11, v11, v3
    v_add_u32 v11, 393216, v11
    global_load_dwordx4 v[44:47], v11, s[14:15]
    s_barrier
    ds_read_b64_tr_b16 v[96:97], v6 offset:16384
    ds_read_b64_tr_b16 v[98:99], v6 offset:17408
    ds_read_b64_tr_b16 v[100:101], v6 offset:24576
    ds_read_b64_tr_b16 v[102:103], v6 offset:25600
    s_waitcnt lgkmcnt(0)
    ds_write_b128 v8, v[96:99] offset:12288
    ds_write_b128 v8, v[100:103] offset:13312
    ds_read_b64_tr_b16 a[0:1], v7 offset:16384
    ds_read_b64_tr_b16 a[2:3], v7 offset:17408
    ds_read_b64_tr_b16 a[4:5], v7 offset:24576
    ds_read_b64_tr_b16 a[6:7], v7 offset:25600
    s_waitcnt lgkmcnt(0)
    s_waitcnt vmcnt(16)
    ds_write_b128 v5, v[48:51] offset:0
    ds_write_b128 v5, v[52:55] offset:4096
    ds_write_b128 v5, v[56:59] offset:8192
    ds_write_b128 v5, v[60:63] offset:12288
    s_waitcnt lgkmcnt(0)
    v_add_u32 v11, 3670016, v15
    v_and_b32 v11, 0x3fffff, v11
    v_add_u32 v11, v11, v3
    global_load_dwordx4 v[48:51], v11, s[14:15]
    v_add_u32 v11, 3670016, v15
    v_and_b32 v11, 0x3fffff, v11
    v_add_u32 v11, v11, v3
    v_add_u32 v11, 131072, v11
    global_load_dwordx4 v[52:55], v11, s[14:15]
    v_add_u32 v11, 3670016, v15
    v_and_b32 v11, 0x3fffff, v11
    v_add_u32 v11, v11, v3
    v_add_u32 v11, 262144, v11
    global_load_dwordx4 v[56:59], v11, s[14:15]
    v_add_u32 v11, 3670016, v15
    v_and_b32 v11, 0x3fffff, v11
    v_add_u32 v11, v11, v3
    v_add_u32 v11, 393216, v11
    global_load_dwordx4 v[60:63], v11, s[14:15]
    s_barrier
    ds_read_b64_tr_b16 v[208:209], v6 offset:0
    ds_read_b64_tr_b16 v[210:211], v6 offset:1024
    ds_read_b64_tr_b16 v[212:213], v6 offset:8192
    ds_read_b64_tr_b16 v[214:215], v6 offset:9216
    ds_read_b64_tr_b16 a[8:9], v7 offset:0
    ds_read_b64_tr_b16 a[10:11], v7 offset:1024
    ds_read_b64_tr_b16 a[12:13], v7 offset:8192
    ds_read_b64_tr_b16 a[14:15], v7 offset:9216
    s_waitcnt lgkmcnt(0)
    s_waitcnt vmcnt(16)
    ds_write_b128 v5, v[64:67] offset:16384
    ds_write_b128 v5, v[68:71] offset:20480
    ds_write_b128 v5, v[72:75] offset:24576
    ds_write_b128 v5, v[76:79] offset:28672
    s_waitcnt lgkmcnt(0)
    v_add_u32 v11, 0, v15
    v_and_b32 v11, 0x3fffff, v11
    v_add_u32 v11, v11, v3
    global_load_dwordx4 v[64:67], v11, s[16:17]
    v_add_u32 v11, 0, v15
    v_and_b32 v11, 0x3fffff, v11
    v_add_u32 v11, v11, v3
    v_add_u32 v11, 131072, v11
    global_load_dwordx4 v[68:71], v11, s[16:17]
    v_add_u32 v11, 0, v15
    v_and_b32 v11, 0x3fffff, v11
    v_add_u32 v11, v11, v3
    v_add_u32 v11, 262144, v11
    global_load_dwordx4 v[72:75], v11, s[16:17]
    v_add_u32 v11, 0, v15
    v_and_b32 v11, 0x3fffff, v11
    v_add_u32 v11, v11, v3
    v_add_u32 v11, 393216, v11
    global_load_dwordx4 v[76:79], v11, s[16:17]
    s_barrier
    ds_read_b64_tr_b16 v[216:217], v6 offset:16384
    ds_read_b64_tr_b16 v[218:219], v6 offset:17408
    ds_read_b64_tr_b16 v[220:221], v6 offset:24576
    ds_read_b64_tr_b16 v[222:223], v6 offset:25600
    ds_read_b64_tr_b16 a[16:17], v7 offset:16384
    ds_read_b64_tr_b16 a[18:19], v7 offset:17408
    ds_read_b64_tr_b16 a[20:21], v7 offset:24576
    ds_read_b64_tr_b16 a[22:23], v7 offset:25600
    s_waitcnt lgkmcnt(0)
    s_waitcnt vmcnt(16)
    ds_write_b128 v5, v[80:83] offset:0
    ds_write_b128 v5, v[84:87] offset:4096
    ds_write_b128 v5, v[88:91] offset:8192
    ds_write_b128 v5, v[92:95] offset:12288
    s_waitcnt lgkmcnt(0)
    v_add_u32 v11, 524288, v15
    v_and_b32 v11, 0x3fffff, v11
    v_add_u32 v11, v11, v3
    global_load_dwordx4 v[80:83], v11, s[16:17]
    v_add_u32 v11, 524288, v15
    v_and_b32 v11, 0x3fffff, v11
    v_add_u32 v11, v11, v3
    v_add_u32 v11, 131072, v11
    global_load_dwordx4 v[84:87], v11, s[16:17]
    v_add_u32 v11, 524288, v15
    v_and_b32 v11, 0x3fffff, v11
    v_add_u32 v11, v11, v3
    v_add_u32 v11, 262144, v11
    global_load_dwordx4 v[88:91], v11, s[16:17]
    v_add_u32 v11, 524288, v15
    v_and_b32 v11, 0x3fffff, v11
    v_add_u32 v11, v11, v3
    v_add_u32 v11, 393216, v11
    global_load_dwordx4 v[92:95], v11, s[16:17]
    s_barrier
    ds_read_b64_tr_b16 v[224:225], v6 offset:0
    ds_read_b64_tr_b16 v[226:227], v6 offset:1024
    ds_read_b64_tr_b16 v[228:229], v6 offset:8192
    ds_read_b64_tr_b16 v[230:231], v6 offset:9216
    ds_read_b64_tr_b16 a[24:25], v7 offset:0
    ds_read_b64_tr_b16 a[26:27], v7 offset:1024
    ds_read_b64_tr_b16 a[28:29], v7 offset:8192
    ds_read_b64_tr_b16 a[30:31], v7 offset:9216
    s_waitcnt lgkmcnt(0)
    s_waitcnt vmcnt(16)
    ds_write_b128 v5, v[16:19] offset:16384
    ds_write_b128 v5, v[20:23] offset:20480
    ds_write_b128 v5, v[24:27] offset:24576
    ds_write_b128 v5, v[28:31] offset:28672
    s_waitcnt lgkmcnt(0)
    v_add_u32 v11, 1048576, v15
    v_and_b32 v11, 0x3fffff, v11
    v_add_u32 v11, v11, v3
    global_load_dwordx4 v[16:19], v11, s[16:17]
    v_add_u32 v11, 1048576, v15
    v_and_b32 v11, 0x3fffff, v11
    v_add_u32 v11, v11, v3
    v_add_u32 v11, 131072, v11
    global_load_dwordx4 v[20:23], v11, s[16:17]
    v_add_u32 v11, 1048576, v15
    v_and_b32 v11, 0x3fffff, v11
    v_add_u32 v11, v11, v3
    v_add_u32 v11, 262144, v11
    global_load_dwordx4 v[24:27], v11, s[16:17]
    v_add_u32 v11, 1048576, v15
    v_and_b32 v11, 0x3fffff, v11
    v_add_u32 v11, v11, v3
    v_add_u32 v11, 393216, v11
    global_load_dwordx4 v[28:31], v11, s[16:17]
    s_barrier
    ds_read_b64_tr_b16 v[232:233], v6 offset:16384
    ds_read_b64_tr_b16 v[234:235], v6 offset:17408
    ds_read_b64_tr_b16 v[236:237], v6 offset:24576
    ds_read_b64_tr_b16 v[238:239], v6 offset:25600
    ds_read_b64_tr_b16 a[32:33], v7 offset:16384
    ds_read_b64_tr_b16 a[34:35], v7 offset:17408
    ds_read_b64_tr_b16 a[36:37], v7 offset:24576
    ds_read_b64_tr_b16 a[38:39], v7 offset:25600
    s_waitcnt lgkmcnt(0)
    s_lshl_b32 s38, s6, 2
    s_add_u32 s38, s38, 64
    s_cmp_lg_u32 s9, 0
    s_cbranch_scc1 L_arr_13
    v_mov_b32 v1, s38
    v_mov_b32 v2, 1
    s_mov_b64 exec, 1
    global_atomic_add v1, v2, s[10:11] sc1
    s_mov_b64 exec, -1
L_arr_13:
    s_waitcnt vmcnt(16)
    ds_write_b128 v5, v[32:35] offset:0
    ds_write_b128 v5, v[36:39] offset:4096
    ds_write_b128 v5, v[40:43] offset:8192
    ds_write_b128 v5, v[44:47] offset:12288
    s_waitcnt lgkmcnt(0)
    v_add_u32 v11, 1572864, v15
    v_and_b32 v11, 0x3fffff, v11
    v_add_u32 v11, v11, v3
    global_load_dwordx4 v[32:35], v11, s[16:17]
    v_add_u32 v11, 1572864, v15
    v_and_b32 v11, 0x3fffff, v11
    v_add_u32 v11, v11, v3
    v_add_u32 v11, 131072, v11
    global_load_dwordx4 v[36:39], v11, s[16:17]
    v_add_u32 v11, 1572864, v15
    v_and_b32 v11, 0x3fffff, v11
    v_add_u32 v11, v11, v3
    v_add_u32 v11, 262144, v11
    global_load_dwordx4 v[40:43], v11, s[16:17]
    v_add_u32 v11, 1572864, v15
    v_and_b32 v11, 0x3fffff, v11
    v_add_u32 v11, v11, v3
    v_add_u32 v11, 393216, v11
    global_load_dwordx4 v[44:47], v11, s[16:17]
    s_barrier
    ds_read_b64_tr_b16 v[240:241], v6 offset:0
    ds_read_b64_tr_b16 v[242:243], v6 offset:1024
    ds_read_b64_tr_b16 v[244:245], v6 offset:8192
    ds_read_b64_tr_b16 v[246:247], v6 offset:9216
    ds_read_b64_tr_b16 a[40:41], v7 offset:0
    ds_read_b64_tr_b16 a[42:43], v7 offset:1024
    ds_read_b64_tr_b16 a[44:45], v7 offset:8192
    ds_read_b64_tr_b16 a[46:47], v7 offset:9216
    s_waitcnt lgkmcnt(0)
    s_waitcnt vmcnt(16)
    ds_write_b128 v5, v[48:51] offset:16384
    ds_write_b128 v5, v[52:55] offset:20480
    ds_write_b128 v5, v[56:59] offset:24576
    ds_write_b128 v5, v[60:63] offset:28672
    s_waitcnt lgkmcnt(0)
    v_add_u32 v11, 2097152, v15
    v_and_b32 v11, 0x3fffff, v11
    v_add_u32 v11, v11, v3
    global_load_dwordx4 v[48:51], v11, s[16:17]
    v_add_u32 v11, 2097152, v15
    v_and_b32 v11, 0x3fffff, v11
    v_add_u32 v11, v11, v3
    v_add_u32 v11, 131072, v11
    global_load_dwordx4 v[52:55], v11, s[16:17]
    v_add_u32 v11, 2097152, v15
    v_and_b32 v11, 0x3fffff, v11
    v_add_u32 v11, v11, v3
    v_add_u32 v11, 262144, v11
    global_load_dwordx4 v[56:59], v11, s[16:17]
    v_add_u32 v11, 2097152, v15
    v_and_b32 v11, 0x3fffff, v11
    v_add_u32 v11, v11, v3
    v_add_u32 v11, 393216, v11
    global_load_dwordx4 v[60:63], v11, s[16:17]
    s_barrier
    ds_read_b64_tr_b16 v[248:249], v6 offset:16384
    ds_read_b64_tr_b16 v[250:251], v6 offset:17408
    ds_read_b64_tr_b16 v[252:253], v6 offset:24576
    ds_read_b64_tr_b16 v[254:255], v6 offset:25600
    ds_read_b64_tr_b16 a[48:49], v7 offset:16384
    ds_read_b64_tr_b16 a[50:51], v7 offset:17408
    ds_read_b64_tr_b16 a[52:53], v7 offset:24576
    ds_read_b64_tr_b16 a[54:55], v7 offset:25600
    s_waitcnt lgkmcnt(0)
    s_waitcnt vmcnt(16)
    ds_write_b128 v5, v[64:67] offset:0
    ds_write_b128 v5, v[68:71] offset:4096
    ds_write_b128 v5, v[72:75] offset:8192
    ds_write_b128 v5, v[76:79] offset:12288
    s_waitcnt lgkmcnt(0)
    v_add_u32 v11, 2621440, v15
    v_and_b32 v11, 0x3fffff, v11
    v_add_u32 v11, v11, v3
    global_load_dwordx4 v[64:67], v11, s[16:17]
    v_add_u32 v11, 2621440, v15
    v_and_b32 v11, 0x3fffff, v11
    v_add_u32 v11, v11, v3
    v_add_u32 v11, 131072, v11
    global_load_dwordx4 v[68:71], v11, s[16:17]
    v_add_u32 v11, 2621440, v15
    v_and_b32 v11, 0x3fffff, v11
    v_add_u32 v11, v11, v3
    v_add_u32 v11, 262144, v11
    global_load_dwordx4 v[72:75], v11, s[16:17]
    v_add_u32 v11, 2621440, v15
    v_and_b32 v11, 0x3fffff, v11
    v_add_u32 v11, v11, v3
    v_add_u32 v11, 393216, v11
    global_load_dwordx4 v[76:79], v11, s[16:17]
    s_barrier
    ds_read_b64_tr_b16 a[56:57], v6 offset:0
    ds_read_b64_tr_b16 a[58:59], v6 offset:1024
    ds_read_b64_tr_b16 a[60:61], v6 offset:8192
    ds_read_b64_tr_b16 a[62:63], v6 offset:9216
    ds_read_b64_tr_b16 a[120:121], v7 offset:0
    ds_read_b64_tr_b16 a[122:123], v7 offset:1024
    ds_read_b64_tr_b16 a[124:125], v7 offset:8192
    ds_read_b64_tr_b16 a[126:127], v7 offset:9216
    s_waitcnt lgkmcnt(0)
    s_waitcnt vmcnt(16)
    ds_write_b128 v5, v[80:83] offset:16384
    ds_write_b128 v5, v[84:87] offset:20480
    ds_write_b128 v5, v[88:91] offset:24576
    ds_write_b128 v5, v[92:95] offset:28672
    s_waitcnt lgkmcnt(0)
    v_add_u32 v11, 3145728, v15
    v_and_b32 v11, 0x3fffff, v11
    v_add_u32 v11, v11, v3
    global_load_dwordx4 v[80:83], v11, s[16:17]
    v_add_u32 v11, 3145728, v15
    v_and_b32 v11, 0x3fffff, v11
    v_add_u32 v11, v11, v3
    v_add_u32 v11, 131072, v11
    global_load_dwordx4 v[84:87], v11, s[16:17]
    v_add_u32 v11, 3145728, v15
    v_and_b32 v11, 0x3fffff, v11
    v_add_u32 v11, v11, v3
    v_add_u32 v11, 262144, v11
    global_load_dwordx4 v[88:91], v11, s[16:17]
    v_add_u32 v11, 3145728, v15
    v_and_b32 v11, 0x3fffff, v11
    v_add_u32 v11, v11, v3
    v_add_u32 v11, 393216, v11
    global_load_dwordx4 v[92:95], v11, s[16:17]
    s_barrier
    ds_read_b64_tr_b16 a[64:65], v6 offset:16384
    ds_read_b64_tr_b16 a[66:67], v6 offset:17408
    ds_read_b64_tr_b16 a[68:69], v6 offset:24576
    ds_read_b64_tr_b16 a[70:71], v6 offset:25600
    ds_read_b64_tr_b16 a[128:129], v7 offset:16384
    ds_read_b64_tr_b16 a[130:131], v7 offset:17408
    ds_read_b64_tr_b16 a[132:133], v7 offset:24576
    ds_read_b64_tr_b16 a[134:135], v7 offset:25600
    s_waitcnt lgkmcnt(0)
    s_waitcnt vmcnt(16)
    ds_write_b128 v5, v[16:19] offset:0
    ds_write_b128 v5, v[20:23] offset:4096
    ds_write_b128 v5, v[24:27] offset:8192
    ds_write_b128 v5, v[28:31] offset:12288
    s_waitcnt lgkmcnt(0)
    v_add_u32 v11, 3670016, v15
    v_and_b32 v11, 0x3fffff, v11
    v_add_u32 v11, v11, v3
    global_load_dwordx4 v[16:19], v11, s[16:17]
    v_add_u32 v11, 3670016, v15
    v_and_b32 v11, 0x3fffff, v11
    v_add_u32 v11, v11, v3
    v_add_u32 v11, 131072, v11
    global_load_dwordx4 v[20:23], v11, s[16:17]
    v_add_u32 v11, 3670016, v15
    v_and_b32 v11, 0x3fffff, v11
    v_add_u32 v11, v11, v3
    v_add_u32 v11, 262144, v11
    global_load_dwordx4 v[24:27], v11, s[16:17]
    v_add_u32 v11, 3670016, v15
    v_and_b32 v11, 0x3fffff, v11
    v_add_u32 v11, v11, v3
    v_add_u32 v11, 393216, v11
    global_load_dwordx4 v[28:31], v11, s[16:17]
    s_barrier
    ds_read_b64_tr_b16 a[72:73], v6 offset:0
    ds_read_b64_tr_b16 a[74:75], v6 offset:1024
    ds_read_b64_tr_b16 a[76:77], v6 offset:8192
    ds_read_b64_tr_b16 a[78:79], v6 offset:9216
    ds_read_b64_tr_b16 a[136:137], v7 offset:0
    ds_read_b64_tr_b16 a[138:139], v7 offset:1024
    ds_read_b64_tr_b16 a[140:141], v7 offset:8192
    ds_read_b64_tr_b16 a[142:143], v7 offset:9216
    s_waitcnt lgkmcnt(0)
    s_waitcnt vmcnt(16)
    ds_write_b128 v5, v[32:35] offset:16384
    ds_write_b128 v5, v[36:39] offset:20480
    ds_write_b128 v5, v[40:43] offset:24576
    ds_write_b128 v5, v[44:47] offset:28672
    s_waitcnt lgkmcnt(0)
    v_add_u32 v11, 0, v15
    v_and_b32 v11, 0x3fffff, v11
    v_add_u32 v11, v11, v3
    global_load_dwordx4 v[32:35], v11, s[12:13]
    v_add_u32 v11, 0, v15
    v_and_b32 v11, 0x3fffff, v11
    v_add_u32 v11, v11, v3
    v_add_u32 v11, 131072, v11
    global_load_dwordx4 v[36:39], v11, s[12:13]
    v_add_u32 v11, 0, v15
    v_and_b32 v11, 0x3fffff, v11
    v_add_u32 v11, v11, v3
    v_add_u32 v11, 262144, v11
    global_load_dwordx4 v[40:43], v11, s[12:13]
    v_add_u32 v11, 0, v15
    v_and_b32 v11, 0x3fffff, v11
    v_add_u32 v11, v11, v3
    v_add_u32 v11, 393216, v11
    global_load_dwordx4 v[44:47], v11, s[12:13]
    s_barrier
    ds_read_b64_tr_b16 a[80:81], v6 offset:16384
    ds_read_b64_tr_b16 a[82:83], v6 offset:17408
    ds_read_b64_tr_b16 a[84:85], v6 offset:24576
    ds_read_b64_tr_b16 a[86:87], v6 offset:25600
    ds_read_b64_tr_b16 a[144:145], v7 offset:16384
    ds_read_b64_tr_b16 a[146:147], v7 offset:17408
    ds_read_b64_tr_b16 a[148:149], v7 offset:24576
    ds_read_b64_tr_b16 a[150:151], v7 offset:25600
    s_waitcnt lgkmcnt(0)
    s_waitcnt vmcnt(16)
    ds_write_b128 v5, v[48:51] offset:0
    ds_write_b128 v5, v[52:55] offset:4096
    ds_write_b128 v5, v[56:59] offset:8192
    ds_write_b128 v5, v[60:63] offset:12288
    s_waitcnt lgkmcnt(0)
    v_add_u32 v11, 524288, v15
    v_and_b32 v11, 0x3fffff, v11
    v_add_u32 v11, v11, v3
    global_load_dwordx4 v[48:51], v11, s[12:13]
    v_add_u32 v11, 524288, v15
    v_and_b32 v11, 0x3fffff, v11
    v_add_u32 v11, v11, v3
    v_add_u32 v11, 131072, v11
    global_load_dwordx4 v[52:55], v11, s[12:13]
    v_add_u32 v11, 524288, v15
    v_and_b32 v11, 0x3fffff, v11
    v_add_u32 v11, v11, v3
    v_add_u32 v11, 262144, v11
    global_load_dwordx4 v[56:59], v11, s[12:13]
    v_add_u32 v11, 524288, v15
    v_and_b32 v11, 0x3fffff, v11
    v_add_u32 v11, v11, v3
    v_add_u32 v11, 393216, v11
    global_load_dwordx4 v[60:63], v11, s[12:13]
    s_barrier
    ds_read_b64_tr_b16 a[88:89], v6 offset:0
    ds_read_b64_tr_b16 a[90:91], v6 offset:1024
    ds_read_b64_tr_b16 a[92:93], v6 offset:8192
    ds_read_b64_tr_b16 a[94:95], v6 offset:9216
    ds_read_b64_tr_b16 a[152:153], v7 offset:0
    ds_read_b64_tr_b16 a[154:155], v7 offset:1024
    ds_read_b64_tr_b16 a[156:157], v7 offset:8192
    ds_read_b64_tr_b16 a[158:159], v7 offset:9216
    s_waitcnt lgkmcnt(0)
    s_cmp_lg_u32 s9, 0
    s_cbranch_scc1 L_rd_14
    v_lshlrev_b32 v1, 2, v0
    v_mov_b32 v2, 0
    global_atomic_add v104, v1, v2, s[10:11] sc0 sc1
    s_nop 0
L_rd_14:
    s_waitcnt vmcnt(16)
    ds_write_b128 v5, v[64:67] offset:16384
    ds_write_b128 v5, v[68:71] offset:20480
    ds_write_b128 v5, v[72:75] offset:24576
    ds_write_b128 v5, v[76:79] offset:28672
    s_waitcnt lgkmcnt(0)
    v_add_u32 v11, 1048576, v15
    v_and_b32 v11, 0x3fffff, v11
    v_add_u32 v11, v11, v3
    global_load_dwordx4 v[64:67], v11, s[12:13]
    v_add_u32 v11, 1048576, v15
    v_and_b32 v11, 0x3fffff, v11
    v_add_u32 v11, v11, v3
    v_add_u32 v11, 131072, v11
    global_load_dwordx4 v[68:71], v11, s[12:13]
    v_add_u32 v11, 1048576, v15
    v_and_b32 v11, 0x3fffff, v11
    v_add_u32 v11, v11, v3
    v_add_u32 v11, 262144, v11
    global_load_dwordx4 v[72:75], v11, s[12:13]
    v_add_u32 v11, 1048576, v15
    v_and_b32 v11, 0x3fffff, v11
    v_add_u32 v11, v11, v3
    v_add_u32 v11, 393216, v11
    global_load_dwordx4 v[76:79], v11, s[12:13]
    s_barrier
    ds_read_b64_tr_b16 a[96:97], v6 offset:16384
    ds_read_b64_tr_b16 a[98:99], v6 offset:17408
    ds_read_b64_tr_b16 a[100:101], v6 offset:24576
    ds_read_b64_tr_b16 a[102:103], v6 offset:25600
    ds_read_b64_tr_b16 a[160:161], v7 offset:16384
    ds_read_b64_tr_b16 a[162:163], v7 offset:17408
    ds_read_b64_tr_b16 a[164:165], v7 offset:24576
    ds_read_b64_tr_b16 a[166:167], v7 offset:25600
    s_waitcnt lgkmcnt(0)
    s_waitcnt vmcnt(16)
    ds_write_b128 v5, v[80:83] offset:0
    ds_write_b128 v5, v[84:87] offset:4096
    ds_write_b128 v5, v[88:91] offset:8192
    ds_write_b128 v5, v[92:95] offset:12288
    s_waitcnt lgkmcnt(0)
    v_add_u32 v11, 1572864, v15
    v_and_b32 v11, 0x3fffff, v11
    v_add_u32 v11, v11, v3
    global_load_dwordx4 v[80:83], v11, s[12:13]
    v_add_u32 v11, 1572864, v15
    v_and_b32 v11, 0x3fffff, v11
    v_add_u32 v11, v11, v3
    v_add_u32 v11, 131072, v11
    global_load_dwordx4 v[84:87], v11, s[12:13]
    v_add_u32 v11, 1572864, v15
    v_and_b32 v11, 0x3fffff, v11
    v_add_u32 v11, v11, v3
    v_add_u32 v11, 262144, v11
    global_load_dwordx4 v[88:91], v11, s[12:13]
    v_add_u32 v11, 1572864, v15
    v_and_b32 v11, 0x3fffff, v11
    v_add_u32 v11, v11, v3
    v_add_u32 v11, 393216, v11
    global_load_dwordx4 v[92:95], v11, s[12:13]
    s_barrier
    ds_read_b64_tr_b16 a[104:105], v6 offset:0
    ds_read_b64_tr_b16 a[106:107], v6 offset:1024
    ds_read_b64_tr_b16 a[108:109], v6 offset:8192
    ds_read_b64_tr_b16 a[110:111], v6 offset:9216
    ds_read_b64_tr_b16 a[168:169], v7 offset:0
    ds_read_b64_tr_b16 a[170:171], v7 offset:1024
    ds_read_b64_tr_b16 a[172:173], v7 offset:8192
    ds_read_b64_tr_b16 a[174:175], v7 offset:9216
    s_waitcnt lgkmcnt(0)
    s_waitcnt vmcnt(16)
    ds_write_b128 v5, v[16:19] offset:16384
    ds_write_b128 v5, v[20:23] offset:20480
    ds_write_b128 v5, v[24:27] offset:24576
    ds_write_b128 v5, v[28:31] offset:28672
    s_waitcnt lgkmcnt(0)
    v_add_u32 v11, 2097152, v15
    v_and_b32 v11, 0x3fffff, v11
    v_add_u32 v11, v11, v3
    global_load_dwordx4 v[16:19], v11, s[12:13]
    v_add_u32 v11, 2097152, v15
    v_and_b32 v11, 0x3fffff, v11
    v_add_u32 v11, v11, v3
    v_add_u32 v11, 131072, v11
    global_load_dwordx4 v[20:23], v11, s[12:13]
    v_add_u32 v11, 2097152, v15
    v_and_b32 v11, 0x3fffff, v11
    v_add_u32 v11, v11, v3
    v_add_u32 v11, 262144, v11
    global_load_dwordx4 v[24:27], v11, s[12:13]
    v_add_u32 v11, 2097152, v15
    v_and_b32 v11, 0x3fffff, v11
    v_add_u32 v11, v11, v3
    v_add_u32 v11, 393216, v11
    global_load_dwordx4 v[28:31], v11, s[12:13]
    s_barrier
    ds_read_b64_tr_b16 a[112:113], v6 offset:16384
    ds_read_b64_tr_b16 a[114:115], v6 offset:17408
    ds_read_b64_tr_b16 a[116:117], v6 offset:24576
    ds_read_b64_tr_b16 a[118:119], v6 offset:25600
    ds_read_b64_tr_b16 a[176:177], v7 offset:16384
    ds_read_b64_tr_b16 a[178:179], v7 offset:17408
    ds_read_b64_tr_b16 a[180:181], v7 offset:24576
    ds_read_b64_tr_b16 a[182:183], v7 offset:25600
    s_waitcnt lgkmcnt(0)
    s_waitcnt vmcnt(16)
    ds_write_b128 v5, v[32:35] offset:0
    ds_write_b128 v5, v[36:39] offset:4096
    ds_write_b128 v5, v[40:43] offset:8192
    ds_write_b128 v5, v[44:47] offset:12288
    s_waitcnt lgkmcnt(0)
    v_add_u32 v11, 2621440, v15
    v_and_b32 v11, 0x3fffff, v11
    v_add_u32 v11, v11, v3
    global_load_dwordx4 v[32:35], v11, s[12:13]
    v_add_u32 v11, 2621440, v15
    v_and_b32 v11, 0x3fffff, v11
    v_add_u32 v11, v11, v3
    v_add_u32 v11, 131072, v11
    global_load_dwordx4 v[36:39], v11, s[12:13]
    v_add_u32 v11, 2621440, v15
    v_and_b32 v11, 0x3fffff, v11
    v_add_u32 v11, v11, v3
    v_add_u32 v11, 262144, v11
    global_load_dwordx4 v[40:43], v11, s[12:13]
    v_add_u32 v11, 2621440, v15
    v_and_b32 v11, 0x3fffff, v11
    v_add_u32 v11, v11, v3
    v_add_u32 v11, 393216, v11
    global_load_dwordx4 v[44:47], v11, s[12:13]
    s_barrier
    ds_read_b64_tr_b16 v[96:97], v6 offset:0
    ds_read_b64_tr_b16 v[98:99], v6 offset:1024
    ds_read_b64_tr_b16 v[100:101], v6 offset:8192
    ds_read_b64_tr_b16 v[102:103], v6 offset:9216
    s_waitcnt lgkmcnt(0)
    ds_write_b128 v8, v[96:99] offset:0
    ds_write_b128 v8, v[100:103] offset:1024
    ds_read_b64_tr_b16 v[96:97], v7 offset:0
    ds_read_b64_tr_b16 v[98:99], v7 offset:1024
    ds_read_b64_tr_b16 v[100:101], v7 offset:8192
    ds_read_b64_tr_b16 v[102:103], v7 offset:9216
    s_waitcnt lgkmcnt(0)
    ds_write_b128 v8, v[96:99] offset:2048
    ds_write_b128 v8, v[100:103] offset:3072
    s_waitcnt lgkmcnt(0)
    s_waitcnt vmcnt(16)
    ds_write_b128 v5, v[48:51] offset:16384
    ds_write_b128 v5, v[52:55] offset:20480
    ds_write_b128 v5, v[56:59] offset:24576
    ds_write_b128 v5, v[60:63] offset:28672
    s_waitcnt lgkmcnt(0)
    v_add_u32 v11, 3145728, v15
    v_and_b32 v11, 0x3fffff, v11
    v_add_u32 v11, v11, v3
    global_load_dwordx4 v[48:51], v11, s[12:13]
    v_add_u32 v11, 3145728, v15
    v_and_b32 v11, 0x3fffff, v11
    v_add_u32 v11, v11, v3
    v_add_u32 v11, 131072, v11
    global_load_dwordx4 v[52:55], v11, s[12:13]
    v_add_u32 v11, 3145728, v15
    v_and_b32 v11, 0x3fffff, v11
    v_add_u32 v11, v11, v3
    v_add_u32 v11, 262144, v11
    global_load_dwordx4 v[56:59], v11, s[12:13]
    v_add_u32 v11, 3145728, v15
    v_and_b32 v11, 0x3fffff, v11
    v_add_u32 v11, v11, v3
    v_add_u32 v11, 393216, v11
    global_load_dwordx4 v[60:63], v11, s[12:13]
    s_barrier
    ds_read_b64_tr_b16 v[96:97], v6 offset:16384
    ds_read_b64_tr_b16 v[98:99], v6 offset:17408
    ds_read_b64_tr_b16 v[100:101], v6 offset:24576
    ds_read_b64_tr_b16 v[102:103], v6 offset:25600
    s_waitcnt lgkmcnt(0)
    ds_write_b128 v8, v[96:99] offset:8192
    ds_write_b128 v8, v[100:103] offset:9216
    ds_read_b64_tr_b16 v[96:97], v7 offset:16384
    ds_read_b64_tr_b16 v[98:99], v7 offset:17408
    ds_read_b64_tr_b16 v[100:101], v7 offset:24576
    ds_read_b64_tr_b16 v[102:103], v7 offset:25600
    s_waitcnt lgkmcnt(0)
    ds_write_b128 v8, v[96:99] offset:10240
    ds_write_b128 v8, v[100:103] offset:11264
    s_waitcnt lgkmcnt(0)
    s_waitcnt vmcnt(16)
    ds_write_b128 v5, v[64:67] offset:0
    ds_write_b128 v5, v[68:71] offset:4096
    ds_write_b128 v5, v[72:75] offset:8192
    ds_write_b128 v5, v[76:79] offset:12288
    s_waitcnt lgkmcnt(0)
    v_add_u32 v11, 3670016, v15
    v_and_b32 v11, 0x3fffff, v11
    v_add_u32 v11, v11, v3
    global_load_dwordx4 v[64:67], v11, s[12:13]
    v_add_u32 v11, 3670016, v15
    v_and_b32 v11, 0x3fffff, v11
    v_add_u32 v11, v11, v3
    v_add_u32 v11, 131072, v11
    global_load_dwordx4 v[68:71], v11, s[12:13]
    v_add_u32 v11, 3670016, v15
    v_and_b32 v11, 0x3fffff, v11
    v_add_u32 v11, v11, v3
    v_add_u32 v11, 262144, v11
    global_load_dwordx4 v[72:75], v11, s[12:13]
    v_add_u32 v11, 3670016, v15
    v_and_b32 v11, 0x3fffff, v11
    v_add_u32 v11, v11, v3
    v_add_u32 v11, 393216, v11
    global_load_dwordx4 v[76:79], v11, s[12:13]
    s_barrier
    ds_read_b64_tr_b16 v[112:113], v6 offset:0
    ds_read_b64_tr_b16 v[114:115], v6 offset:1024
    ds_read_b64_tr_b16 v[116:117], v6 offset:8192
    ds_read_b64_tr_b16 v[118:119], v6 offset:9216
    ds_read_b64_tr_b16 v[160:161], v7 offset:0
    ds_read_b64_tr_b16 v[162:163], v7 offset:1024
    ds_read_b64_tr_b16 v[164:165], v7 offset:8192
    ds_read_b64_tr_b16 v[166:167], v7 offset:9216
    s_waitcnt lgkmcnt(0)
    s_waitcnt vmcnt(16)
    ds_write_b128 v5, v[80:83] offset:16384
    ds_write_b128 v5, v[84:87] offset:20480
    ds_write_b128 v5, v[88:91] offset:24576
    ds_write_b128 v5, v[92:95] offset:28672
    s_waitcnt lgkmcnt(0)
    v_mov_b32 v11, v4
    global_load_dwordx4 v[80:83], v11, s[18:19]
    v_add_u32 v11, 16384, v4
    global_load_dwordx4 v[84:87], v11, s[18:19]
    v_add_u32 v11, 32768, v4
    global_load_dwordx4 v[88:91], v11, s[18:19]
    v_add_u32 v11, 49152, v4
    global_load_dwordx4 v[92:95], v11, s[18:19]
    s_barrier
    ds_read_b64_tr_b16 v[120:121], v6 offset:16384
    ds_read_b64_tr_b16 v[122:123], v6 offset:17408
    ds_read_b64_tr_b16 v[124:125], v6 offset:24576
    ds_read_b64_tr_b16 v[126:127], v6 offset:25600
    ds_read_b64_tr_b16 v[168:169], v7 offset:16384
    ds_read_b64_tr_b16 v[170:171], v7 offset:17408
    ds_read_b64_tr_b16 v[172:173], v7 offset:24576
    ds_read_b64_tr_b16 v[174:175], v7 offset:25600
    s_waitcnt lgkmcnt(0)
    s_waitcnt vmcnt(16)
    ds_write_b128 v5, v[16:19] offset:0
    ds_write_b128 v5, v[20:23] offset:4096
    ds_write_b128 v5, v[24:27] offset:8192
    ds_write_b128 v5, v[28:31] offset:12288
    s_waitcnt lgkmcnt(0)
    v_add_u32 v11, 64, v4
    global_load_dwordx4 v[16:19], v11, s[18:19]
    v_add_u32 v11, 16448, v4
    global_load_dwordx4 v[20:23], v11, s[18:19]
    v_add_u32 v11, 32832, v4
    global_load_dwordx4 v[24:27], v11, s[18:19]
    v_add_u32 v11, 49216, v4
    global_load_dwordx4 v[28:31], v11, s[18:19]
    s_barrier
    ds_read_b64_tr_b16 v[128:129], v6 offset:0
    ds_read_b64_tr_b16 v[130:131], v6 offset:1024
    ds_read_b64_tr_b16 v[132:133], v6 offset:8192
    ds_read_b64_tr_b16 v[134:135], v6 offset:9216
    ds_read_b64_tr_b16 v[176:177], v7 offset:0
    ds_read_b64_tr_b16 v[178:179], v7 offset:1024
    ds_read_b64_tr_b16 v[180:181], v7 offset:8192
    ds_read_b64_tr_b16 v[182:183], v7 offset:9216
    s_waitcnt lgkmcnt(0)
    s_waitcnt vmcnt(16)
    ds_write_b128 v5, v[32:35] offset:16384
    ds_write_b128 v5, v[36:39] offset:20480
    ds_write_b128 v5, v[40:43] offset:24576
    ds_write_b128 v5, v[44:47] offset:28672
    s_waitcnt lgkmcnt(0)
    v_add_u32 v11, 128, v4
    global_load_dwordx4 v[32:35], v11, s[18:19]
    v_add_u32 v11, 16512, v4
    global_load_dwordx4 v[36:39], v11, s[18:19]
    v_add_u32 v11, 32896, v4
    global_load_dwordx4 v[40:43], v11, s[18:19]
    v_add_u32 v11, 49280, v4
    global_load_dwordx4 v[44:47], v11, s[18:19]
    s_barrier
    ds_read_b64_tr_b16 v[136:137], v6 offset:16384
    ds_read_b64_tr_b16 v[138:139], v6 offset:17408
    ds_read_b64_tr_b16 v[140:141], v6 offset:24576
    ds_read_b64_tr_b16 v[142:143], v6 offset:25600
    ds_read_b64_tr_b16 v[184:185], v7 offset:16384
    ds_read_b64_tr_b16 v[186:187], v7 offset:17408
    ds_read_b64_tr_b16 v[188:189], v7 offset:24576
    ds_read_b64_tr_b16 v[190:191], v7 offset:25600
    s_waitcnt lgkmcnt(0)
    s_waitcnt vmcnt(16)
    ds_write_b128 v5, v[48:51] offset:0
    ds_write_b128 v5, v[52:55] offset:4096
    ds_write_b128 v5, v[56:59] offset:8192
    ds_write_b128 v5, v[60:63] offset:12288
    s_waitcnt lgkmcnt(0)
    v_add_u32 v11, 192, v4
    global_load_dwordx4 v[48:51], v11, s[18:19]
    v_add_u32 v11, 16576, v4
    global_load_dwordx4 v[52:55], v11, s[18:19]
    v_add_u32 v11, 32960, v4
    global_load_dwordx4 v[56:59], v11, s[18:19]
    v_add_u32 v11, 49344, v4
    global_load_dwordx4 v[60:63], v11, s[18:19]
    s_barrier
    ds_read_b64_tr_b16 v[144:145], v6 offset:0
    ds_read_b64_tr_b16 v[146:147], v6 offset:1024
    ds_read_b64_tr_b16 v[148:149], v6 offset:8192
    ds_read_b64_tr_b16 v[150:151], v6 offset:9216
    ds_read_b64_tr_b16 v[192:193], v7 offset:0
    ds_read_b64_tr_b16 v[194:195], v7 offset:1024
    ds_read_b64_tr_b16 v[196:197], v7 offset:8192
    ds_read_b64_tr_b16 v[198:199], v7 offset:9216
    s_waitcnt lgkmcnt(0)
    s_waitcnt vmcnt(16)
    ds_write_b128 v5, v[64:67] offset:16384
    ds_write_b128 v5, v[68:71] offset:20480
    ds_write_b128 v5, v[72:75] offset:24576
    ds_write_b128 v5, v[76:79] offset:28672
    s_waitcnt lgkmcnt(0)
    v_add_u32 v11, 65536, v4
    global_load_dwordx4 v[64:67], v11, s[18:19]
    v_add_u32 v11, 81920, v4
    global_load_dwordx4 v[68:71], v11, s[18:19]
    v_add_u32 v11, 98304, v4
    global_load_dwordx4 v[72:75], v11, s[18:19]
    v_add_u32 v11, 114688, v4
    global_load_dwordx4 v[76:79], v11, s[18:19]
    s_barrier
    ds_read_b64_tr_b16 v[152:153], v6 offset:16384
    ds_read_b64_tr_b16 v[154:155], v6 offset:17408
    ds_read_b64_tr_b16 v[156:157], v6 offset:24576
    ds_read_b64_tr_b16 v[158:159], v6 offset:25600
    ds_read_b64_tr_b16 v[200:201], v7 offset:16384
    ds_read_b64_tr_b16 v[202:203], v7 offset:17408
    ds_read_b64_tr_b16 v[204:205], v7 offset:24576
    ds_read_b64_tr_b16 v[206:207], v7 offset:25600
    s_waitcnt lgkmcnt(0)
    s_waitcnt vmcnt(16)
    ds_write_b128 v5, v[80:83] offset:0
    ds_write_b128 v5, v[84:87] offset:4096
    ds_write_b128 v5, v[88:91] offset:8192
    ds_write_b128 v5, v[92:95] offset:12288
    s_waitcnt lgkmcnt(0)
    v_add_u32 v11, 65600, v4
    global_load_dwordx4 v[80:83], v11, s[18:19]
    v_add_u32 v11, 81984, v4
    global_load_dwordx4 v[84:87], v11, s[18:19]
    v_add_u32 v11, 98368, v4
    global_load_dwordx4 v[88:91], v11, s[18:19]
    v_add_u32 v11, 114752, v4
    global_load_dwordx4 v[92:95], v11, s[18:19]
    s_barrier
    ds_read_b64_tr_b16 a[184:185], v6 offset:0
    ds_read_b64_tr_b16 a[186:187], v6 offset:1024
    ds_read_b64_tr_b16 a[188:189], v6 offset:8192
    ds_read_b64_tr_b16 a[190:191], v6 offset:9216
    ds_read_b64_tr_b16 a[192:193], v7 offset:0
    ds_read_b64_tr_b16 a[194:195], v7 offset:1024
    ds_read_b64_tr_b16 a[196:197], v7 offset:8192
    ds_read_b64_tr_b16 a[198:199], v7 offset:9216
    s_waitcnt lgkmcnt(0)
    s_cmp_lg_u32 s9, 0
    s_cbranch_scc1 L_rd_15
    v_lshlrev_b32 v1, 2, v0
    v_mov_b32 v2, 0
    global_atomic_add v105, v1, v2, s[10:11] sc0 sc1
    s_nop 0
L_rd_15:
    s_waitcnt vmcnt(16)
    ds_write_b128 v5, v[16:19] offset:16384
    ds_write_b128 v5, v[20:23] offset:20480
    ds_write_b128 v5, v[24:27] offset:24576
    ds_write_b128 v5, v[28:31] offset:28672
    s_waitcnt lgkmcnt(0)
    v_add_u32 v11, 65664, v4
    global_load_dwordx4 v[16:19], v11, s[18:19]
    v_add_u32 v11, 82048, v4
    global_load_dwordx4 v[20:23], v11, s[18:19]
    v_add_u32 v11, 98432, v4
    global_load_dwordx4 v[24:27], v11, s[18:19]
    v_add_u32 v11, 114816, v4
    global_load_dwordx4 v[28:31], v11, s[18:19]
    s_barrier
    ds_read_b64_tr_b16 a[200:201], v6 offset:16384
    ds_read_b64_tr_b16 a[202:203], v6 offset:17408
    ds_read_b64_tr_b16 a[204:205], v6 offset:24576
    ds_read_b64_tr_b16 a[206:207], v6 offset:25600
    ds_read_b64_tr_b16 a[208:209], v7 offset:16384
    ds_read_b64_tr_b16 a[210:211], v7 offset:17408
    ds_read_b64_tr_b16 a[212:213], v7 offset:24576
    ds_read_b64_tr_b16 a[214:215], v7 offset:25600
    s_waitcnt lgkmcnt(0)
    s_waitcnt vmcnt(16)
    ds_write_b128 v5, v[32:35] offset:0
    ds_write_b128 v5, v[36:39] offset:4096
    ds_write_b128 v5, v[40:43] offset:8192
    ds_write_b128 v5, v[44:47] offset:12288
    s_waitcnt lgkmcnt(0)
    v_add_u32 v11, 65728, v4
    global_load_dwordx4 v[32:35], v11, s[18:19]
    v_add_u32 v11, 82112, v4
    global_load_dwordx4 v[36:39], v11, s[18:19]
    v_add_u32 v11, 98496, v4
    global_load_dwordx4 v[40:43], v11, s[18:19]
    v_add_u32 v11, 114880, v4
    global_load_dwordx4 v[44:47], v11, s[18:19]
    s_barrier
    ds_read_b64_tr_b16 a[216:217], v6 offset:0
    ds_read_b64_tr_b16 a[218:219], v6 offset:1024
    ds_read_b64_tr_b16 a[220:221], v6 offset:8192
    ds_read_b64_tr_b16 a[222:223], v6 offset:9216
    ds_read_b64_tr_b16 a[224:225], v7 offset:0
    ds_read_b64_tr_b16 a[226:227], v7 offset:1024
    ds_read_b64_tr_b16 a[228:229], v7 offset:8192
    ds_read_b64_tr_b16 a[230:231], v7 offset:9216
    s_waitcnt lgkmcnt(0)
    s_waitcnt vmcnt(16)
    ds_write_b128 v5, v[48:51] offset:16384
    ds_write_b128 v5, v[52:55] offset:20480
    ds_write_b128 v5, v[56:59] offset:24576
    ds_write_b128 v5, v[60:63] offset:28672
    s_waitcnt lgkmcnt(0)
    s_barrier
    ds_read_b64_tr_b16 a[232:233], v6 offset:16384
    ds_read_b64_tr_b16 a[234:235], v6 offset:17408
    ds_read_b64_tr_b16 a[236:237], v6 offset:24576
    ds_read_b64_tr_b16 a[238:239], v6 offset:25600
    ds_read_b64_tr_b16 a[240:241], v7 offset:16384
    ds_read_b64_tr_b16 a[242:243], v7 offset:17408
    ds_read_b64_tr_b16 a[244:245], v7 offset:24576
    ds_read_b64_tr_b16 a[246:247], v7 offset:25600
    s_waitcnt lgkmcnt(0)
    s_waitcnt vmcnt(12)
    ds_write_b128 v5, v[64:67] offset:0
    ds_write_b128 v5, v[68:71] offset:4096
    ds_write_b128 v5, v[72:75] offset:8192
    ds_write_b128 v5, v[76:79] offset:12288
    s_waitcnt lgkmcnt(0)
    s_barrier
    ds_read_b64_tr_b16 v[96:97], v6 offset:0
    ds_read_b64_tr_b16 v[98:99], v6 offset:1024
    ds_read_b64_tr_b16 v[100:101], v6 offset:8192
    ds_read_b64_tr_b16 v[102:103], v6 offset:9216
    s_waitcnt lgkmcnt(0)
    ds_write_b128 v8, v[96:99] offset:14336
    ds_write_b128 v8, v[100:103] offset:15360
    ds_read_b64_tr_b16 v[96:97], v7 offset:0
    ds_read_b64_tr_b16 v[98:99], v7 offset:1024
    ds_read_b64_tr_b16 v[100:101], v7 offset:8192
    ds_read_b64_tr_b16 v[102:103], v7 offset:9216
    s_waitcnt lgkmcnt(0)
    ds_write_b128 v8, v[96:99] offset:16384
    ds_write_b128 v8, v[100:103] offset:17408
    s_waitcnt lgkmcnt(0)
    s_waitcnt vmcnt(8)
    ds_write_b128 v5, v[80:83] offset:16384
    ds_write_b128 v5, v[84:87] offset:20480
    ds_write_b128 v5, v[88:91] offset:24576
    ds_write_b128 v5, v[92:95] offset:28672
    s_waitcnt lgkmcnt(0)
    s_barrier
    ds_read_b64_tr_b16 v[96:97], v6 offset:16384
    ds_read_b64_tr_b16 v[98:99], v6 offset:17408
    ds_read_b64_tr_b16 v[100:101], v6 offset:24576
    ds_read_b64_tr_b16 v[102:103], v6 offset:25600
    s_waitcnt lgkmcnt(0)
    ds_write_b128 v8, v[96:99] offset:18432
    ds_write_b128 v8, v[100:103] offset:19456
    ds_read_b64_tr_b16 v[96:97], v7 offset:16384
    ds_read_b64_tr_b16 v[98:99], v7 offset:17408
    ds_read_b64_tr_b16 v[100:101], v7 offset:24576
    ds_read_b64_tr_b16 v[102:103], v7 offset:25600
    s_waitcnt lgkmcnt(0)
    ds_write_b128 v8, v[96:99] offset:20480
    ds_write_b128 v8, v[100:103] offset:21504
    s_waitcnt lgkmcnt(0)
    s_waitcnt vmcnt(4)
    ds_write_b128 v5, v[16:19] offset:0
    ds_write_b128 v5, v[20:23] offset:4096
    ds_write_b128 v5, v[24:27] offset:8192
    ds_write_b128 v5, v[28:31] offset:12288
    s_waitcnt lgkmcnt(0)
    s_barrier
    ds_read_b64_tr_b16 v[96:97], v6 offset:0
    ds_read_b64_tr_b16 v[98:99], v6 offset:1024
    ds_read_b64_tr_b16 v[100:101], v6 offset:8192
    ds_read_b64_tr_b16 v[102:103], v6 offset:9216
    s_waitcnt lgkmcnt(0)
    ds_write_b128 v8, v[96:99] offset:22528
    ds_write_b128 v8, v[100:103] offset:23552
    ds_read_b64_tr_b16 v[96:97], v7 offset:0
    ds_read_b64_tr_b16 v[98:99], v7 offset:1024
    ds_read_b64_tr_b16 v[100:101], v7 offset:8192
    ds_read_b64_tr_b16 v[102:103], v7 offset:9216
    s_waitcnt lgkmcnt(0)
    ds_write_b128 v8, v[96:99] offset:24576
    ds_write_b128 v8, v[100:103] offset:25600
    s_waitcnt lgkmcnt(0)
    s_waitcnt vmcnt(0)
    ds_write_b128 v5, v[32:35] offset:16384
    ds_write_b128 v5, v[36:39] offset:20480
    ds_write_b128 v5, v[40:43] offset:24576
    ds_write_b128 v5, v[44:47] offset:28672
    s_waitcnt lgkmcnt(0)
    s_barrier
    ds_read_b64_tr_b16 v[96:97], v6 offset:16384
    ds_read_b64_tr_b16 v[98:99], v6 offset:17408
    ds_read_b64_tr_b16 v[100:101], v6 offset:24576
    ds_read_b64_tr_b16 v[102:103], v6 offset:25600
    s_waitcnt lgkmcnt(0)
    ds_write_b128 v8, v[96:99] offset:26624
    ds_write_b128 v8, v[100:103] offset:27648
    ds_read_b64_tr_b16 a[248:249], v7 offset:16384
    ds_read_b64_tr_b16 a[250:251], v7 offset:17408
    ds_read_b64_tr_b16 a[252:253], v7 offset:24576
    ds_read_b64_tr_b16 a[254:255], v7 offset:25600
    s_waitcnt lgkmcnt(0)
    s_cmp_lg_u32 s9, 0
    s_cbranch_scc1 L_ev_16
    s_waitcnt vmcnt(0)
    v_readlane_b32 s38, v104, 8
    v_cmp_eq_u32 vcc, 32, v105
    s_add_u32 s39, s6, 16
    s_lshl_b64 s[12:13], 1, s39
    s_or_b32 s12, s12, 255
    v_mov_b32 v1, 14336
    s_nop 1
    s_andn2_b64 s[12:13], s[12:13], vcc
    s_cselect_b32 s39, 1, 0
    s_cmp_lg_u32 s38, 256
    s_cselect_b32 s39, 1, s39
    v_mov_b32 v2, s39
    ds_write_b32 v1, v2
    s_waitcnt lgkmcnt(0)
L_ev_16:
    s_barrier
    v_mov_b32 v16, 14336
    ds_read_b32 v17, v16
    s_waitcnt lgkmcnt(0)
    v_readfirstlane_b32 s38, v17
    s_barrier
    s_cmp_eq_u32 s38, 0
    s_nop 2
    s_cbranch_scc1 L_go_17
    s_cmp_lg_u32 s9, 0
    s_cbranch_scc1 L_wg_18
    v_and_b32 v16, 15, v0
    v_lshlrev_b32 v16, 2, v16
    v_mov_b32 v17, 0
    s_mov_b32 s41, 2097152
    s_mov_b64 exec, 0x1ff
L_wgp_19:
    global_atomic_add v18, v16, v17, s[10:11] sc0 sc1
    s_waitcnt vmcnt(0)
    v_readlane_b32 s38, v18, 8
    s_sub_u32 s41, s41, 1
    s_cmp_eq_u32 s41, 0
    s_nop 2
    s_cbranch_scc1 L_end_7
    s_cmp_lt_u32 s38, 256
    s_cbranch_scc1 L_wgp_19
    global_atomic_add v18, v16, v17, s[10:11] sc0 sc1
    s_waitcnt vmcnt(0)
    s_mov_b64 exec, 0xff
    v_cmp_ne_u32 vcc, 32, v18
    s_mov_b64 exec, -1
    s_nop 0
    v_mov_b32 v18, vcc_lo
    v_mov_b32 v16, 14336
    ds_write_b32 v16, v18
    s_waitcnt lgkmcnt(0)
L_wg_18:
    s_barrier
    v_mov_b32 v16, 14336
    ds_read_b32 v18, v16
    s_waitcnt lgkmcnt(0)
    v_readfirstlane_b32 s38, v18
    s_barrier
    s_cmp_lg_u32 s38, 0
    s_nop 2
    s_cbranch_scc1 L_safe_far_r
    s_lshl_b32 s39, s6, 2
    s_add_u32 s39, s39, 64
    v_mov_b32 v17, s39
    s_mov_b32 s41, 2097152
    s_nop 0
L_dw_20:
    global_load_dword v18, v17, s[10:11] sc1
    s_waitcnt vmcnt(0)
    v_readfirstlane_b32 s38, v18
    s_sub_u32 s41, s41, 1
    s_cmp_eq_u32 s41, 0
    s_nop 2
    s_cbranch_scc1 L_end_7
    s_cmp_lt_u32 s38, 32
    s_cbranch_scc1 L_dw_20
L_go_17:
    v_and_b32 v20, 63, v0
    v_lshlrev_b32 v1, 4, v20
    v_mov_b32 v11, -1
    v_mov_b32 v16, 0
    v_mov_b32 v21, 0xff800000
    v_cmp_le_u32 vcc, 32, v20
    s_nop 1
    v_cndmask_b32 v18, v16, v21, vcc
    v_bfe_u32 v21, v20, 1, 1
    v_lshlrev_b32 v10, 7, v21
    v_bfe_u32 v21, v20, 2, 1
    v_lshl_add_u32 v10, v21, 6, v10
    v_lshrrev_b32 v21, 4, v20
    v_lshl_add_u32 v10, v21, 4, v10
    s_lshl_b32 s38, s7, 8
    s_lshl_b32 s39, s9, 2
    s_add_u32 s38, s38, s39
    v_add_u32 v10, s38, v10
    v_and_b32 v21, 8, v20
    v_cmp_ne_u32 vcc, 0, v21
    v_mov_b32 v21, 0x4444
    v_mov_b32 v22, 0xeeee
    v_cndmask_b32 v2, v21, v22, vcc
    s_lshl_b32 s38, s9, 11
    v_add_u32 v12, s38, v1
    s_add_u32 s38, s9, 1
    s_and_b32 s38, s38, 3
    s_lshl_b32 s38, s38, 11
    v_add_u32 v13, s38, v1
    s_add_u32 s38, s9, 2
    s_and_b32 s38, s38, 3
    s_lshl_b32 s38, s38, 11
    v_add_u32 v14, s38, v1
    s_add_u32 s38, s9, 3
    s_and_b32 s38, s38, 3
    s_lshl_b32 s38, s38, 11
    v_add_u32 v15, s38, v1
    v_lshrrev_b32 v21, 5, v20
    v_lshlrev_b32 v21, 4, v21
    v_and_b32 v22, 15, v20
    v_add_u32 v21, v21, v22
    v_lshlrev_b32 v21, 4, v21
    v_bfe_u32 v22, v20, 4, 1
    v_lshl_add_u32 v21, v22, 3, v21
    s_lshl_b32 s38, s9, 9
    v_add_u32 v21, s38, v21
    v_add_u32 v3, 8192, v21
    v_add_u32 v9, 2048, v21
    v_lshrrev_b32 v21, 4, v20
    v_lshlrev_b32 v21, 2, v21
    v_bfe_u32 v22, v20, 2, 2
    v_add_u32 v21, v21, v22
    v_lshlrev_b32 v21, 4, v21
    v_and_b32 v22, 1, v20
    v_lshl_add_u32 v21, v22, 3, v21
    v_add_u32 v4, 8192, v21
    s_lshl_b32 s38, s9, 9
    v_add_u32 v17, s38, v4
    v_and_b32 v21, 7, v20
    v_lshlrev_b32 v21, 4, v21
    v_lshrrev_b32 v22, 4, v20
    v_lshl_add_u32 v21, v22, 2, v21
    s_lshl_b32 s38, s9, 9
    s_add_u32 s38, s38, 12288
    v_add_u32 v5, s38, v21
    s_mul_i32 s38, s9, 28672
    s_add_u32 s38, s38, 49152
    v_add_u32 v6, s38, v1
    v_lshrrev_b32 v21, 5, v20
    v_lshlrev_b32 v21, 14, v21
    v_bfe_u32 v22, v20, 2, 2
    v_lshl_add_u32 v21, v22, 12, v21
    v_bfe_u32 v22, v20, 4, 1
    v_lshl_add_u32 v21, v22, 5, v21
    v_and_b32 v22, 3, v20
    v_lshl_add_u32 v21, v22, 3, v21
    s_lshl_b32 s38, s9, 17
    s_lshl_b32 s39, s7, 6
    s_add_u32 s38, s38, s39
    v_add_u32 v7, s38, v21
    v_lshrrev_b32 v21, 4, v20
    v_lshlrev_b32 v21, 7, v21
    v_and_b32 v22, 7, v20
    v_lshl_add_u32 v21, v22, 4, v21
    s_lshl_b32 s38, s9, 9
    v_add_u32 v8, s38, v21
    s_mov_b32 s41, 2097152
    s_nop 0
L_fsp_21:
    global_load_dword v0, v16, s[34:35] sc1
    s_sub_u32 s41, s41, 1
    s_cmp_eq_u32 s41, 0
    s_cbranch_scc1 L_end_7
    s_waitcnt vmcnt(0)
    v_cmp_eq_u32 vcc, 0, v0
    s_nop 4
    s_cbranch_vccnz L_fsp_21
    s_add_u32 m0, s46, 16384
    s_nop 0
    global_load_lds_dwordx4 v1, s[30:31] offset:0 sc1
    global_load_lds_dwordx4 v1, s[30:31] offset:1024 sc1
    global_load_lds_dwordx4 v1, s[30:31] offset:2048 sc1
    global_load_lds_dwordx4 v1, s[30:31] offset:3072 sc1
    s_add_u32 s30, s30, 524288
    s_addc_u32 s31, s31, 0
    s_add_u32 s34, s34, 128
    s_addc_u32 s35, s35, 0
    s_mov_b32 s8, 0
    global_load_dwordx4 v[20:23], v12, s[22:23] offset:0 sc1
    global_load_dwordx4 v[24:27], v12, s[22:23] offset:1024 sc1
    ds_read_b128 v[28:31], v6 offset:0
    ds_read_b128 v[32:35], v6 offset:1024
    ds_read_b128 v[36:39], v6 offset:2048
    ds_read_b128 v[40:43], v6 offset:3072
    ds_read_b128 v[44:47], v6 offset:4096
    ds_read_b128 v[48:51], v6 offset:5120
    ds_read_b128 v[92:95], v6 offset:6144
    ds_read_b128 v[96:99], v6 offset:7168
    ds_read_b128 v[100:103], v6 offset:8192
    ds_read_b128 v[104:107], v6 offset:9216
    v_mov_b64 v[52:53], 0
    v_mov_b64 v[54:55], 0
    v_mov_b64 v[56:57], 0
    v_mov_b64 v[58:59], 0
    v_mov_b64 v[60:61], 0
    v_mov_b64 v[62:63], 0
    v_mov_b64 v[64:65], 0
    v_mov_b64 v[66:67], 0
    v_mov_b64 v[68:69], 0
    v_mov_b64 v[70:71], 0
    v_mov_b64 v[72:73], 0
    v_mov_b64 v[74:75], 0
    v_mov_b32 v108, v18
    v_mov_b32 v109, v18
    v_mov_b32 v110, v18
    v_mov_b32 v111, v18
    ds_read_b128 v[76:79], v6 offset:10240
    ds_read_b128 v[80:83], v6 offset:11264
    ds_read_b128 v[84:87], v6 offset:12288
    ds_read_b128 v[88:91], v6 offset:13312
L_rstep_23:
    s_mov_b32 s41, 2097152
L_pa_24:
    s_waitcnt vmcnt(0) lgkmcnt(0)
    v_max3_u32 v0, v20, v21, v22
    v_max3_u32 v0, v0, v23, v24
    v_max3_u32 v0, v0, v25, v26
    v_max_u32 v0, v0, v27
    v_cmp_eq_u32 vcc, -1, v0
    s_nop 4
    s_cbranch_vccz L_pg_25
    s_mov_b64 exec, vcc
    global_load_dwordx4 v[20:23], v12, s[22:23] offset:0 sc1
    global_load_dwordx4 v[24:27], v12, s[22:23] offset:1024 sc1
    s_mov_b64 exec, -1
    s_sub_u32 s41, s41, 1
    s_cmp_eq_u32 s41, 0
    s_cbranch_scc1 L_end_7
    s_branch L_pa_24
L_pg_25:
    ds_write_b128 v12, v[20:23] offset:0
    ds_write_b128 v12, v[24:27] offset:1024
    global_load_dword v19, v16, s[34:35] sc1
    v_smfmac_f32_16x16x64_bf16 v[52:55], v[20:23], v[28:35], v2
    v_smfmac_f32_16x16x64_bf16 v[56:59], v[20:23], v[36:43], v2
    v_smfmac_f32_16x16x64_bf16 v[60:63], v[20:23], v[44:51], v2
    v_smfmac_f32_16x16x64_bf16 v[64:67], v[20:23], v[92:99], v2
    s_waitcnt lgkmcnt(0)
    s_barrier
    ds_read_b128 v[28:31], v13 offset:0
    ds_read_b128 v[32:35], v13 offset:1024
    ds_read_b128 v[36:39], v14 offset:0
    ds_read_b128 v[40:43], v14 offset:1024
    ds_read_b128 v[44:47], v15 offset:0
    ds_read_b128 v[48:51], v15 offset:1024
    v_smfmac_f32_16x16x64_bf16 v[52:55], v[24:27], v[100:107], v2
    v_smfmac_f32_16x16x64_bf16 v[64:67], v[24:27], a[0:7], v2
    v_smfmac_f32_16x16x64_bf16 v[56:59], v[24:27], v[76:83], v2
    s_add_u32 m0, s46, 32768
    v_smfmac_f32_16x16x64_bf16 v[60:63], v[24:27], v[84:91], v2
    v_smfmac_f32_16x16x64_bf16 v[68:71], v[20:23], a[56:63], v2
    ds_read_b128 v[92:95], v1 offset:20480
    ds_read_b128 v[96:99], v1 offset:21504
    v_smfmac_f32_16x16x64_bf16 v[72:75], v[20:23], a[120:127], v2
    ds_read_b128 v[100:103], v1 offset:22528
    ds_read_b128 v[104:107], v1 offset:23552
    v_smfmac_f32_16x16x64_bf16 v[68:71], v[24:27], a[64:71], v2
    ds_read_b128 v[76:79], v1 offset:16384
    ds_read_b128 v[80:83], v1 offset:17408
    v_smfmac_f32_16x16x64_bf16 v[72:75], v[24:27], a[128:135], v2
    ds_read_b128 v[84:87], v1 offset:18432
    ds_read_b128 v[88:91], v1 offset:19456
    s_waitcnt lgkmcnt(13)
    v_smfmac_f32_16x16x64_bf16 v[52:55], v[28:31], v[112:119], v2
    v_smfmac_f32_16x16x64_bf16 v[56:59], v[28:31], v[160:167], v2
    v_smfmac_f32_16x16x64_bf16 v[60:63], v[28:31], v[208:215], v2
    v_smfmac_f32_16x16x64_bf16 v[64:67], v[28:31], a[8:15], v2
    s_waitcnt lgkmcnt(12)
    v_smfmac_f32_16x16x64_bf16 v[52:55], v[32:35], v[120:127], v2
    v_smfmac_f32_16x16x64_bf16 v[56:59], v[32:35], v[168:175], v2
    v_smfmac_f32_16x16x64_bf16 v[60:63], v[32:35], v[216:223], v2
    v_smfmac_f32_16x16x64_bf16 v[64:67], v[32:35], a[16:23], v2
    s_waitcnt lgkmcnt(11)
    v_smfmac_f32_16x16x64_bf16 v[52:55], v[36:39], v[128:135], v2
    v_smfmac_f32_16x16x64_bf16 v[56:59], v[36:39], v[176:183], v2
    v_smfmac_f32_16x16x64_bf16 v[60:63], v[36:39], v[224:231], v2
    v_smfmac_f32_16x16x64_bf16 v[64:67], v[36:39], a[24:31], v2
    s_waitcnt lgkmcnt(10)
    v_smfmac_f32_16x16x64_bf16 v[52:55], v[40:43], v[136:143], v2
    v_smfmac_f32_16x16x64_bf16 v[56:59], v[40:43], v[184:191], v2
    v_smfmac_f32_16x16x64_bf16 v[60:63], v[40:43], v[232:239], v2
    v_smfmac_f32_16x16x64_bf16 v[64:67], v[40:43], a[32:39], v2
    s_waitcnt lgkmcnt(9)
    v_smfmac_f32_16x16x64_bf16 v[52:55], v[44:47], v[144:151], v2
    v_smfmac_f32_16x16x64_bf16 v[56:59], v[44:47], v[192:199], v2
    v_smfmac_f32_16x16x64_bf16 v[60:63], v[44:47], v[240:247], v2
    v_smfmac_f32_16x16x64_bf16 v[64:67], v[44:47], a[40:47], v2
    s_waitcnt lgkmcnt(8)
    v_smfmac_f32_16x16x64_bf16 v[52:55], v[48:51], v[152:159], v2
    v_smfmac_f32_16x16x64_bf16 v[56:59], v[48:51], v[200:207], v2
    v_smfmac_f32_16x16x64_bf16 v[60:63], v[48:51], v[248:255], v2
    v_smfmac_f32_16x16x64_bf16 v[64:67], v[48:51], a[48:55], v2
    v_smfmac_f32_16x16x64_bf16 v[68:71], v[28:31], a[72:79], v2
    v_smfmac_f32_16x16x64_bf16 v[72:75], v[28:31], a[136:143], v2
    s_nop 3
    v_permlane32_swap_b32 v52, v56
    v_permlane32_swap_b32 v53, v57
    v_permlane32_swap_b32 v54, v58
    v_permlane32_swap_b32 v55, v59
    v_smfmac_f32_16x16x64_bf16 v[68:71], v[32:35], a[80:87], v2
    v_permlane32_swap_b32 v60, v64
    v_permlane32_swap_b32 v61, v65
    v_permlane32_swap_b32 v62, v66
    v_permlane32_swap_b32 v63, v67
    v_smfmac_f32_16x16x64_bf16 v[72:75], v[32:35], a[144:151], v2
    v_add_f32 v52, v52, v56
    v_add_f32 v53, v53, v57
    v_add_f32 v54, v54, v58
    v_add_f32 v55, v55, v59
    v_cvt_pk_bf16_f32 v56, v52, v53
    v_cvt_pk_bf16_f32 v57, v54, v55
    ds_write_b64 v3, v[56:57] offset:0
    v_smfmac_f32_16x16x64_bf16 v[68:71], v[36:39], a[88:95], v2
    v_add_f32 v60, v60, v64
    v_add_f32 v61, v61, v65
    v_add_f32 v62, v62, v66
    v_add_f32 v63, v63, v67
    v_cvt_pk_bf16_f32 v64, v60, v61
    v_cvt_pk_bf16_f32 v65, v62, v63
    ds_write_b64 v3, v[64:65] offset:2048
    v_smfmac_f32_16x16x64_bf16 v[72:75], v[36:39], a[152:159], v2
    s_waitcnt lgkmcnt(0)
    s_barrier
    ds_read_b64_tr_b16 v[20:21], v4 offset:0
    ds_read_b64_tr_b16 v[22:23], v4 offset:256
    ds_read_b64_tr_b16 v[52:53], v4 offset:2048
    ds_read_b64_tr_b16 v[54:55], v4 offset:2304
    v_smfmac_f32_16x16x64_bf16 v[68:71], v[40:43], a[96:103], v2
    ds_read_b64_tr_b16 v[24:25], v4 offset:512
    ds_read_b64_tr_b16 v[26:27], v4 offset:768
    ds_read_b64_tr_b16 v[56:57], v4 offset:2560
    ds_read_b64_tr_b16 v[58:59], v4 offset:2816
    s_waitcnt vmcnt(0)
    v_cmp_ne_u32 s[100:101], 0, v19
    v_smfmac_f32_16x16x64_bf16 v[72:75], v[40:43], a[160:167], v2
    ds_read_b64_tr_b16 v[28:29], v4 offset:1024
    ds_read_b64_tr_b16 v[30:31], v4 offset:1280
    ds_read_b64_tr_b16 v[36:37], v4 offset:3072
    ds_read_b64_tr_b16 v[38:39], v4 offset:3328
    v_smfmac_f32_16x16x64_bf16 v[68:71], v[44:47], a[104:111], v2
    ds_read_b64_tr_b16 v[32:33], v4 offset:1536
    ds_read_b64_tr_b16 v[34:35], v4 offset:1792
    ds_read_b64_tr_b16 v[40:41], v4 offset:3584
    v_smfmac_f32_16x16x64_bf16 v[72:75], v[44:47], a[168:175], v2
    s_mov_b64 exec, s[100:101]
    global_load_lds_dwordx4 v1, s[30:31] offset:0 sc1
    s_mov_b64 exec, -1
    s_mov_b64 exec, s[100:101]
    global_load_lds_dwordx4 v1, s[30:31] offset:1024 sc1
    s_mov_b64 exec, -1
    v_smfmac_f32_16x16x64_bf16 v[68:71], v[48:51], a[112:119], v2
    s_mov_b64 exec, s[100:101]
    global_load_lds_dwordx4 v1, s[30:31] offset:2048 sc1
    s_mov_b64 exec, -1
    s_mov_b64 exec, s[100:101]
    global_load_lds_dwordx4 v1, s[30:31] offset:3072 sc1
    s_mov_b64 exec, -1
    v_smfmac_f32_16x16x64_bf16 v[72:75], v[48:51], a[176:183], v2
    s_waitcnt lgkmcnt(11)
    ds_read_b64_tr_b16 v[42:43], v4 offset:3840
    v_mfma_f32_16x16x32_bf16 v[60:63], v[76:79], v[20:23], 0
    v_mfma_f32_16x16x32_bf16 v[64:67], v[92:95], v[20:23], 0
    v_mfma_f32_16x16x32_bf16 v[108:111], v[52:55], v[20:23], v[108:111]
    s_nop 2
    v_permlane32_swap_b32 v68, v72
    v_permlane32_swap_b32 v69, v73
    s_waitcnt lgkmcnt(8)
    v_mfma_f32_16x16x32_bf16 v[60:63], v[80:83], v[24:27], v[60:63]
    v_permlane32_swap_b32 v70, v74
    v_permlane32_swap_b32 v71, v75
    v_mfma_f32_16x16x32_bf16 v[64:67], v[96:99], v[24:27], v[64:67]
    v_add_f32 v68, v68, v72
    v_add_f32 v69, v69, v73
    v_mfma_f32_16x16x32_bf16 v[108:111], v[56:59], v[24:27], v[108:111]
    v_add_f32 v70, v70, v74
    v_add_f32 v71, v71, v75
    s_waitcnt lgkmcnt(4)
    v_mfma_f32_16x16x32_bf16 v[60:63], v[84:87], v[28:31], v[60:63]
    v_cvt_pk_bf16_f32 v72, v68, v69
    v_cvt_pk_bf16_f32 v73, v70, v71
    v_mfma_f32_16x16x32_bf16 v[64:67], v[100:103], v[28:31], v[64:67]
    v_min_u32 v72, -2, v72
    v_min_u32 v73, -2, v73
    v_mfma_f32_16x16x32_bf16 v[108:111], v[36:39], v[28:31], v[108:111]
    v_mov_b64 v[74:75], v[72:73]
    global_store_dwordx2 v9, v[72:73], s[32:33] sc1
    s_waitcnt lgkmcnt(0)
    v_mfma_f32_16x16x32_bf16 v[60:63], v[88:91], v[32:35], v[60:63]
    v_permlane32_swap_b32 v72, v74
    v_permlane32_swap_b32 v73, v75
    v_mfma_f32_16x16x32_bf16 v[64:67], v[104:107], v[32:35], v[64:67]
    v_mov_b32 v68, 0x3f803f80
    v_mov_b32 v69, 0x3f803f80
    v_mfma_f32_16x16x32_bf16 v[108:111], v[40:43], v[32:35], v[108:111]
    v_mov_b32 v70, 0x3f803f80
    v_mov_b32 v71, 0x3f803f80
    ds_read_b128 v[20:23], v12 offset:24576
    ds_read_b128 v[24:27], v12 offset:25600
    ds_read_b64_tr_b16 v[28:29], v17 offset:2048
    ds_read_b64_tr_b16 v[30:31], v17 offset:2304
    ds_read_b128 v[76:79], v6 offset:14336
    ds_read_b128 v[80:83], v6 offset:15360
    ds_read_b128 v[84:87], v6 offset:16384
    ds_read_b128 v[88:91], v6 offset:17408
    ds_read_b128 v[92:95], v6 offset:18432
    ds_read_b128 v[96:99], v6 offset:19456
    ds_read_b128 v[100:103], v6 offset:20480
    ds_read_b128 v[104:107], v6 offset:21504
    ds_read_b128 v[36:39], v6 offset:22528
    ds_read_b128 v[40:43], v6 offset:23552
    v_max3_f32 v32, v60, v61, v62
    v_max3_f32 v33, v63, v64, v65
    v_max3_f32 v32, v32, v66, v67
    v_max3_f32 v33, v33, v108, v109
    v_max3_f32 v32, v32, v110, v111
    v_max_f32 v32, v32, v33
    v_mov_b32 v33, v32
    s_nop 1
    v_permlane16_swap_b32 v33, v32
    v_max_f32 v32, v32, v33
    v_mov_b32 v33, v32
    s_nop 1
    v_permlane32_swap_b32 v33, v32
    v_max_f32 v32, v32, v33
    v_mul_f32 v32, s44, v32
    s_waitcnt lgkmcnt(10)
    v_min_u32 v28, -2, v28
    v_min_u32 v29, -2, v29
    v_min_u32 v30, -2, v30
    v_min_u32 v31, -2, v31
    global_store_dwordx4 v8, v[28:31], s[32:33] sc1
    v_pk_fma_f32 v[108:109], v[108:109], s[44:45], v[32:33] op_sel_hi:[1,1,0] neg_lo:[0,0,1] neg_hi:[0,0,1]
    v_pk_fma_f32 v[110:111], v[110:111], s[44:45], v[32:33] op_sel_hi:[1,1,0] neg_lo:[0,0,1] neg_hi:[0,0,1]
    v_pk_fma_f32 v[60:61], v[60:61], s[44:45], v[32:33] op_sel_hi:[1,1,0] neg_lo:[0,0,1] neg_hi:[0,0,1]
    v_pk_fma_f32 v[62:63], v[62:63], s[44:45], v[32:33] op_sel_hi:[1,1,0] neg_lo:[0,0,1] neg_hi:[0,0,1]
    v_pk_fma_f32 v[64:65], v[64:65], s[44:45], v[32:33] op_sel_hi:[1,1,0] neg_lo:[0,0,1] neg_hi:[0,0,1]
    v_pk_fma_f32 v[66:67], v[66:67], s[44:45], v[32:33] op_sel_hi:[1,1,0] neg_lo:[0,0,1] neg_hi:[0,0,1]
    v_exp_f32 v108, v108
    v_exp_f32 v109, v109
    v_exp_f32 v110, v110
    v_exp_f32 v111, v111
    v_exp_f32 v60, v60
    v_cvt_pk_bf16_f32 v44, v108, v109
    v_cvt_pk_bf16_f32 v45, v110, v111
    v_exp_f32 v61, v61
    v_exp_f32 v62, v62
    v_mfma_f32_16x16x16_bf16 v[32:35], v[68:69], v[44:45], 0
    v_mfma_f32_16x16x16_bf16 v[52:55], v[72:73], v[44:45], 0
    v_mfma_f32_16x16x16_bf16 v[56:59], v[74:75], v[44:45], 0
    v_exp_f32 v63, v63
    v_exp_f32 v64, v64
    v_exp_f32 v65, v65
    v_exp_f32 v66, v66
    v_exp_f32 v67, v67
    v_cvt_pk_bf16_f32 v48, v60, v61
    v_cvt_pk_bf16_f32 v49, v62, v63
    v_cvt_pk_bf16_f32 v50, v64, v65
    v_cvt_pk_bf16_f32 v51, v66, v67
    s_nop 1
    v_mfma_f32_16x16x32_bf16 v[32:35], v[68:71], v[48:51], v[32:35]
    v_mfma_f32_16x16x32_bf16 v[52:55], v[20:23], v[48:51], v[52:55]
    v_mfma_f32_16x16x32_bf16 v[56:59], v[24:27], v[48:51], v[56:59]
    s_nop 5
    v_rcp_f32 v32, v32
    v_mov_b64 v[60:61], 0
    v_mov_b64 v[62:63], 0
    v_pk_mul_f32 v[52:53], v[52:53], v[32:33] op_sel_hi:[1,0]
    v_pk_mul_f32 v[54:55], v[54:55], v[32:33] op_sel_hi:[1,0]
    v_cvt_pk_bf16_f32 v52, v52, v53
    v_cvt_pk_bf16_f32 v53, v54, v55
    ds_write2_b32 v5, v52, v53 offset0:0 offset1:32
    v_pk_mul_f32 v[56:57], v[56:57], v[32:33] op_sel_hi:[1,0]
    v_pk_mul_f32 v[58:59], v[58:59], v[32:33] op_sel_hi:[1,0]
    v_cvt_pk_bf16_f32 v56, v56, v57
    v_cvt_pk_bf16_f32 v57, v58, v59
    ds_write2_b32 v5, v56, v57 offset0:64 offset1:96
    v_mov_b64 v[64:65], 0
    v_mov_b64 v[66:67], 0
    v_mov_b64 v[44:45], 0
    v_mov_b64 v[46:47], 0
    v_mov_b64 v[48:49], 0
    v_mov_b64 v[50:51], 0
    s_waitcnt lgkmcnt(0)
    s_barrier
    ds_read_b128 v[20:23], v1 offset:12288
    ds_read_b128 v[24:27], v1 offset:13312
    ds_read_b128 v[52:55], v6 offset:24576
    ds_read_b128 v[56:59], v6 offset:25600
    s_add_u32 s32, s32, 131072
    s_addc_u32 s33, s33, 0
    v_mov_b64 v[68:69], 0
    v_mov_b64 v[70:71], 0
    v_mov_b64 v[72:73], 0
    v_mov_b64 v[74:75], 0
    v_mov_b64 v[32:33], 0
    v_mov_b64 v[34:35], 0
    v_mov_b64 v[28:29], 0
    v_mov_b64 v[30:31], 0
    s_waitcnt lgkmcnt(3)
    s_nop 0
    v_smfmac_f32_16x16x64_bf16 v[28:31], v[20:23], a[184:191], v2
    v_smfmac_f32_16x16x64_bf16 v[32:35], v[20:23], a[192:199], v2
    v_smfmac_f32_16x16x64_bf16 v[44:47], v[20:23], a[200:207], v2
    v_smfmac_f32_16x16x64_bf16 v[48:51], v[20:23], a[208:215], v2
    s_waitcnt lgkmcnt(2)
    v_smfmac_f32_16x16x64_bf16 v[28:31], v[24:27], v[76:83], v2
    v_smfmac_f32_16x16x64_bf16 v[32:35], v[24:27], v[84:91], v2
    ds_read_b128 v[76:79], v6 offset:26624
    ds_read_b128 v[80:83], v6 offset:27648
    v_smfmac_f32_16x16x64_bf16 v[44:47], v[24:27], v[92:99], v2
    v_smfmac_f32_16x16x64_bf16 v[48:51], v[24:27], v[100:107], v2
    v_smfmac_f32_16x16x64_bf16 v[60:63], v[20:23], a[216:223], v2
    v_smfmac_f32_16x16x64_bf16 v[64:67], v[20:23], a[224:231], v2
    s_nop 1
    v_permlane32_swap_b32 v28, v32
    v_permlane32_swap_b32 v29, v33
    v_permlane32_swap_b32 v30, v34
    v_smfmac_f32_16x16x64_bf16 v[68:71], v[20:23], a[232:239], v2
    v_permlane32_swap_b32 v31, v35
    v_add_f32 v28, v28, v32
    v_add_f32 v29, v29, v33
    v_smfmac_f32_16x16x64_bf16 v[72:75], v[20:23], a[240:247], v2
    v_add_f32 v30, v30, v34
    v_add_f32 v31, v31, v35
    v_cvt_pk_bf16_f32 v28, v28, v29
    v_smfmac_f32_16x16x64_bf16 v[60:63], v[24:27], v[36:43], v2
    v_cvt_pk_bf16_f32 v29, v30, v31
    v_or_b32 v28, 1, v28
    global_store_dwordx2 v7, v[28:29], s[28:29]
    s_waitcnt lgkmcnt(2)
    v_smfmac_f32_16x16x64_bf16 v[64:67], v[24:27], v[52:59], v2
    v_permlane32_swap_b32 v44, v48
    v_permlane32_swap_b32 v45, v49
    v_permlane32_swap_b32 v46, v50
    v_permlane32_swap_b32 v47, v51
    v_smfmac_f32_16x16x64_bf16 v[72:75], v[24:27], a[248:255], v2
    v_add_f32 v44, v44, v48
    v_add_f32 v45, v45, v49
    v_add_f32 v46, v46, v50
    v_add_f32 v47, v47, v51
    s_waitcnt lgkmcnt(0)
    v_smfmac_f32_16x16x64_bf16 v[68:71], v[24:27], v[76:83], v2
    v_cvt_pk_bf16_f32 v44, v44, v45
    v_cvt_pk_bf16_f32 v45, v46, v47
    v_or_b32 v44, 1, v44
    global_store_dwordx2 v7, v[44:45], s[50:51]
    v_permlane32_swap_b32 v60, v64
    v_permlane32_swap_b32 v61, v65
    v_permlane32_swap_b32 v62, v66
    v_permlane32_swap_b32 v63, v67
    v_add_f32 v60, v60, v64
    v_add_f32 v61, v61, v65
    v_add_f32 v62, v62, v66
    v_add_f32 v63, v63, v67
    v_cvt_pk_bf16_f32 v60, v60, v61
    v_cvt_pk_bf16_f32 v61, v62, v63
    v_or_b32 v60, 1, v60
    global_store_dwordx2 v7, v[60:61], s[52:53]
    v_permlane32_swap_b32 v68, v72
    v_permlane32_swap_b32 v69, v73
    v_permlane32_swap_b32 v70, v74
    v_permlane32_swap_b32 v71, v75
    v_add_f32 v68, v68, v72
    v_add_f32 v69, v69, v73
    v_add_f32 v70, v70, v74
    v_add_f32 v71, v71, v75
    v_cvt_pk_bf16_f32 v68, v68, v69
    v_cvt_pk_bf16_f32 v69, v70, v71
    v_or_b32 v68, 1, v68
    global_store_dwordx2 v7, v[68:69], s[54:55]
    v_lshrrev_b32 v83, 1, v1
    ds_read_b128 v[28:31], v6 offset:0
    ds_read_b128 v[32:35], v6 offset:1024
    ds_read_b128 v[36:39], v6 offset:2048
    ds_read_b128 v[40:43], v6 offset:3072
    ds_read_b128 v[44:47], v6 offset:4096
    ds_read_b128 v[48:51], v6 offset:5120
    ds_read_b128 v[92:95], v6 offset:6144
    ds_read_b128 v[96:99], v6 offset:7168
    ds_read_b128 v[100:103], v6 offset:8192
    ds_read_b128 v[104:107], v6 offset:9216
    v_mov_b64 v[52:53], 0
    v_mov_b64 v[54:55], 0
    v_mov_b64 v[56:57], 0
    v_mov_b64 v[58:59], 0
    v_mov_b64 v[60:61], 0
    v_mov_b64 v[62:63], 0
    v_mov_b64 v[64:65], 0
    v_mov_b64 v[66:67], 0
    v_mov_b64 v[68:69], 0
    v_mov_b64 v[70:71], 0
    v_mov_b64 v[72:73], 0
    v_mov_b64 v[74:75], 0
    v_mov_b32 v108, v18
    v_mov_b32 v109, v18
    v_mov_b32 v110, v18
    v_mov_b32 v111, v18
    s_sleep 1
    global_load_dwordx2 v[84:85], v83, s[26:27] offset:0 sc1
    global_load_dwordx2 v[86:87], v83, s[26:27] offset:512 sc1
    global_load_dwordx2 v[88:89], v83, s[26:27] offset:1024 sc1
    global_load_dwordx2 v[90:91], v83, s[26:27] offset:1536 sc1
    s_mov_b32 s41, 2097152
L_pk_26:
    s_waitcnt vmcnt(0)
    v_bitop3_b32 v0, v84, v86, v88 bitop3:0x80
    v_bitop3_b32 v0, v0, v90, 1 bitop3:0x80
    v_cmp_eq_u32 vcc, 0, v0
    s_nop 4
    s_cbranch_vccz L_kg_27
    s_mov_b64 exec, vcc
    global_load_dwordx2 v[84:85], v83, s[26:27] offset:0 sc1
    global_load_dwordx2 v[86:87], v83, s[26:27] offset:512 sc1
    global_load_dwordx2 v[88:89], v83, s[26:27] offset:1024 sc1
    global_load_dwordx2 v[90:91], v83, s[26:27] offset:1536 sc1
    s_mov_b64 exec, -1
    s_sub_u32 s41, s41, 1
    s_cmp_eq_u32 s41, 0
    s_cbranch_scc1 L_end_7
    s_branch L_pk_26
L_kg_27:
    v_lshlrev_b32 v76, 16, v84
    v_and_b32 v77, 0xffff0000, v84
    v_lshlrev_b32 v78, 16, v85
    v_and_b32 v79, 0xffff0000, v85
    v_lshlrev_b32 v80, 16, v86
    v_and_b32 v81, 0xffff0000, v86
    v_lshlrev_b32 v82, 16, v87
    v_and_b32 v83, 0xffff0000, v87
    v_lshlrev_b32 v84, 16, v88
    v_and_b32 v85, 0xffff0000, v88
    v_lshlrev_b32 v86, 16, v89
    v_and_b32 v87, 0xffff0000, v89
    v_lshlrev_b32 v88, 16, v90
    v_and_b32 v89, 0xffff0000, v90
    v_lshlrev_b32 v90, 16, v91
    v_and_b32 v91, 0xffff0000, v91
    v_pk_add_f32 v[76:77], v[76:77], v[80:81]
    v_pk_add_f32 v[84:85], v[84:85], v[88:89]
    v_pk_add_f32 v[78:79], v[78:79], v[82:83]
    v_pk_add_f32 v[86:87], v[86:87], v[90:91]
    v_pk_add_f32 v[76:77], v[76:77], v[84:85]
    v_pk_add_f32 v[78:79], v[78:79], v[86:87]
    s_nop 1
    v_permlane32_swap_b32 v76, v78
    v_permlane32_swap_b32 v77, v79
    v_pk_add_f32 v[76:77], v[76:77], v[78:79]
    s_nop 1
    v_permlane16_swap_b32 v76, v77
    v_add_f32 v76, v76, v77
    s_nop 1
    v_add_f32_dpp v77, v76, v76 row_ror:8 row_mask:0xf bank_mask:0xf
    s_nop 1
    v_mov_b32_dpp v78, v77 quad_perm:[1,0,3,2] row_mask:0xf bank_mask:0xf
    v_cvt_pk_bf16_f32 v77, v77, v78
    v_min_u32 v77, -2, v77
    s_mov_b64 exec, s[42:43]
    global_store_dword v10, v77, s[24:25]
    global_store_dword v10, v11, s[22:23]
    s_mov_b64 exec, -1
    s_cmp_lg_u64 s[100:101], 0
    s_cbranch_scc1 L_p2_28
    s_mov_b32 s41, 2097152
L_fsp_29:
    global_load_dword v0, v16, s[34:35] sc1
    s_sub_u32 s41, s41, 1
    s_cmp_eq_u32 s41, 0
    s_cbranch_scc1 L_end_7
    s_waitcnt vmcnt(0)
    v_cmp_eq_u32 vcc, 0, v0
    s_nop 4
    s_cbranch_vccnz L_fsp_29
    s_add_u32 m0, s46, 32768
    s_nop 0
    global_load_lds_dwordx4 v1, s[30:31] offset:0 sc1
    global_load_lds_dwordx4 v1, s[30:31] offset:1024 sc1
    global_load_lds_dwordx4 v1, s[30:31] offset:2048 sc1
    global_load_lds_dwordx4 v1, s[30:31] offset:3072 sc1
L_p2_28:
    s_add_u32 s30, s30, 524288
    s_addc_u32 s31, s31, 0
    s_add_u32 s34, s34, 128
    s_addc_u32 s35, s35, 0
    ds_read_b128 v[76:79], v6 offset:10240
    ds_read_b128 v[80:83], v6 offset:11264
    ds_read_b128 v[84:87], v6 offset:12288
    ds_read_b128 v[88:91], v6 offset:13312
    s_sleep 2
    global_load_dwordx4 v[20:23], v12, s[24:25] offset:0 sc1
    global_load_dwordx4 v[24:27], v12, s[24:25] offset:1024 sc1
    s_mov_b32 s41, 2097152
L_pa_30:
    s_waitcnt vmcnt(0) lgkmcnt(0)
    v_max3_u32 v0, v20, v21, v22
    v_max3_u32 v0, v0, v23, v24
    v_max3_u32 v0, v0, v25, v26
    v_max_u32 v0, v0, v27
    v_cmp_eq_u32 vcc, -1, v0
    s_nop 4
    s_cbranch_vccz L_pg_31
    s_mov_b64 exec, vcc
    global_load_dwordx4 v[20:23], v12, s[24:25] offset:0 sc1
    global_load_dwordx4 v[24:27], v12, s[24:25] offset:1024 sc1
    s_mov_b64 exec, -1
    s_sub_u32 s41, s41, 1
    s_cmp_eq_u32 s41, 0
    s_cbranch_scc1 L_end_7
    s_branch L_pa_30
L_pg_31:
    ds_write_b128 v12, v[20:23] offset:0
    ds_write_b128 v12, v[24:27] offset:1024
    global_load_dword v19, v16, s[34:35] sc1
    v_smfmac_f32_16x16x64_bf16 v[52:55], v[20:23], v[28:35], v2
    v_smfmac_f32_16x16x64_bf16 v[56:59], v[20:23], v[36:43], v2
    v_smfmac_f32_16x16x64_bf16 v[60:63], v[20:23], v[44:51], v2
    v_smfmac_f32_16x16x64_bf16 v[64:67], v[20:23], v[92:99], v2
    s_waitcnt lgkmcnt(0)
    s_barrier
    ds_read_b128 v[28:31], v13 offset:0
    ds_read_b128 v[32:35], v13 offset:1024
    ds_read_b128 v[36:39], v14 offset:0
    ds_read_b128 v[40:43], v14 offset:1024
    ds_read_b128 v[44:47], v15 offset:0
    ds_read_b128 v[48:51], v15 offset:1024
    v_smfmac_f32_16x16x64_bf16 v[52:55], v[24:27], v[100:107], v2
    v_smfmac_f32_16x16x64_bf16 v[64:67], v[24:27], a[0:7], v2
    v_smfmac_f32_16x16x64_bf16 v[56:59], v[24:27], v[76:83], v2
    s_add_u32 m0, s46, 16384
    v_smfmac_f32_16x16x64_bf16 v[60:63], v[24:27], v[84:91], v2
    v_smfmac_f32_16x16x64_bf16 v[68:71], v[20:23], a[56:63], v2
    ds_read_b128 v[92:95], v1 offset:36864
    ds_read_b128 v[96:99], v1 offset:37888
    v_smfmac_f32_16x16x64_bf16 v[72:75], v[20:23], a[120:127], v2
    ds_read_b128 v[100:103], v1 offset:38912
    ds_read_b128 v[104:107], v1 offset:39936
    v_smfmac_f32_16x16x64_bf16 v[68:71], v[24:27], a[64:71], v2
    ds_read_b128 v[76:79], v1 offset:32768
    ds_read_b128 v[80:83], v1 offset:33792
    v_smfmac_f32_16x16x64_bf16 v[72:75], v[24:27], a[128:135], v2
    ds_read_b128 v[84:87], v1 offset:34816
    ds_read_b128 v[88:91], v1 offset:35840
    s_waitcnt lgkmcnt(13)
    v_smfmac_f32_16x16x64_bf16 v[52:55], v[28:31], v[112:119], v2
    v_smfmac_f32_16x16x64_bf16 v[56:59], v[28:31], v[160:167], v2
    v_smfmac_f32_16x16x64_bf16 v[60:63], v[28:31], v[208:215], v2
    v_smfmac_f32_16x16x64_bf16 v[64:67], v[28:31], a[8:15], v2
    s_waitcnt lgkmcnt(12)
    v_smfmac_f32_16x16x64_bf16 v[52:55], v[32:35], v[120:127], v2
    v_smfmac_f32_16x16x64_bf16 v[56:59], v[32:35], v[168:175], v2
    v_smfmac_f32_16x16x64_bf16 v[60:63], v[32:35], v[216:223], v2
    v_smfmac_f32_16x16x64_bf16 v[64:67], v[32:35], a[16:23], v2
    s_waitcnt lgkmcnt(11)
    v_smfmac_f32_16x16x64_bf16 v[52:55], v[36:39], v[128:135], v2
    v_smfmac_f32_16x16x64_bf16 v[56:59], v[36:39], v[176:183], v2
    v_smfmac_f32_16x16x64_bf16 v[60:63], v[36:39], v[224:231], v2
    v_smfmac_f32_16x16x64_bf16 v[64:67], v[36:39], a[24:31], v2
    s_waitcnt lgkmcnt(10)
    v_smfmac_f32_16x16x64_bf16 v[52:55], v[40:43], v[136:143], v2
    v_smfmac_f32_16x16x64_bf16 v[56:59], v[40:43], v[184:191], v2
    v_smfmac_f32_16x16x64_bf16 v[60:63], v[40:43], v[232:239], v2
    v_smfmac_f32_16x16x64_bf16 v[64:67], v[40:43], a[32:39], v2
    s_waitcnt lgkmcnt(9)
    v_smfmac_f32_16x16x64_bf16 v[52:55], v[44:47], v[144:151], v2
    v_smfmac_f32_16x16x64_bf16 v[56:59], v[44:47], v[192:199], v2
    v_smfmac_f32_16x16x64_bf16 v[60:63], v[44:47], v[240:247], v2
    v_smfmac_f32_16x16x64_bf16 v[64:67], v[44:47], a[40:47], v2
    s_waitcnt lgkmcnt(8)
    v_smfmac_f32_16x16x64_bf16 v[52:55], v[48:51], v[152:159], v2
    v_smfmac_f32_16x16x64_bf16 v[56:59], v[48:51], v[200:207], v2
    v_smfmac_f32_16x16x64_bf16 v[60:63], v[48:51], v[248:255], v2
    v_smfmac_f32_16x16x64_bf16 v[64:67], v[48:51], a[48:55], v2
    v_smfmac_f32_16x16x64_bf16 v[68:71], v[28:31], a[72:79], v2
    v_smfmac_f32_16x16x64_bf16 v[72:75], v[28:31], a[136:143], v2
    s_nop 3
    v_permlane32_swap_b32 v52, v56
    v_permlane32_swap_b32 v53, v57
    v_permlane32_swap_b32 v54, v58
    v_permlane32_swap_b32 v55, v59
    v_smfmac_f32_16x16x64_bf16 v[68:71], v[32:35], a[80:87], v2
    v_permlane32_swap_b32 v60, v64
    v_permlane32_swap_b32 v61, v65
    v_permlane32_swap_b32 v62, v66
    v_permlane32_swap_b32 v63, v67
    v_smfmac_f32_16x16x64_bf16 v[72:75], v[32:35], a[144:151], v2
    v_add_f32 v52, v52, v56
    v_add_f32 v53, v53, v57
    v_add_f32 v54, v54, v58
    v_add_f32 v55, v55, v59
    v_cvt_pk_bf16_f32 v56, v52, v53
    v_cvt_pk_bf16_f32 v57, v54, v55
    ds_write_b64 v3, v[56:57] offset:0
    v_smfmac_f32_16x16x64_bf16 v[68:71], v[36:39], a[88:95], v2
    v_add_f32 v60, v60, v64
    v_add_f32 v61, v61, v65
    v_add_f32 v62, v62, v66
    v_add_f32 v63, v63, v67
    v_cvt_pk_bf16_f32 v64, v60, v61
    v_cvt_pk_bf16_f32 v65, v62, v63
    ds_write_b64 v3, v[64:65] offset:2048
    v_smfmac_f32_16x16x64_bf16 v[72:75], v[36:39], a[152:159], v2
    s_waitcnt lgkmcnt(0)
    s_barrier
    ds_read_b64_tr_b16 v[20:21], v4 offset:0
    ds_read_b64_tr_b16 v[22:23], v4 offset:256
    ds_read_b64_tr_b16 v[52:53], v4 offset:2048
    ds_read_b64_tr_b16 v[54:55], v4 offset:2304
    v_smfmac_f32_16x16x64_bf16 v[68:71], v[40:43], a[96:103], v2
    ds_read_b64_tr_b16 v[24:25], v4 offset:512
    ds_read_b64_tr_b16 v[26:27], v4 offset:768
    ds_read_b64_tr_b16 v[56:57], v4 offset:2560
    ds_read_b64_tr_b16 v[58:59], v4 offset:2816
    s_waitcnt vmcnt(0)
    v_cmp_ne_u32 s[100:101], 0, v19
    v_smfmac_f32_16x16x64_bf16 v[72:75], v[40:43], a[160:167], v2
    ds_read_b64_tr_b16 v[28:29], v4 offset:1024
    ds_read_b64_tr_b16 v[30:31], v4 offset:1280
    ds_read_b64_tr_b16 v[36:37], v4 offset:3072
    ds_read_b64_tr_b16 v[38:39], v4 offset:3328
    v_smfmac_f32_16x16x64_bf16 v[68:71], v[44:47], a[104:111], v2
    ds_read_b64_tr_b16 v[32:33], v4 offset:1536
    ds_read_b64_tr_b16 v[34:35], v4 offset:1792
    ds_read_b64_tr_b16 v[40:41], v4 offset:3584
    v_smfmac_f32_16x16x64_bf16 v[72:75], v[44:47], a[168:175], v2
    s_mov_b64 exec, s[100:101]
    global_load_lds_dwordx4 v1, s[30:31] offset:0 sc1
    s_mov_b64 exec, -1
    s_mov_b64 exec, s[100:101]
    global_load_lds_dwordx4 v1, s[30:31] offset:1024 sc1
    s_mov_b64 exec, -1
    v_smfmac_f32_16x16x64_bf16 v[68:71], v[48:51], a[112:119], v2
    s_mov_b64 exec, s[100:101]
    global_load_lds_dwordx4 v1, s[30:31] offset:2048 sc1
    s_mov_b64 exec, -1
    s_mov_b64 exec, s[100:101]
    global_load_lds_dwordx4 v1, s[30:31] offset:3072 sc1
    s_mov_b64 exec, -1
    v_smfmac_f32_16x16x64_bf16 v[72:75], v[48:51], a[176:183], v2
    s_waitcnt lgkmcnt(11)
    ds_read_b64_tr_b16 v[42:43], v4 offset:3840
    v_mfma_f32_16x16x32_bf16 v[60:63], v[76:79], v[20:23], 0
    v_mfma_f32_16x16x32_bf16 v[64:67], v[92:95], v[20:23], 0
    v_mfma_f32_16x16x32_bf16 v[108:111], v[52:55], v[20:23], v[108:111]
    s_nop 2
    v_permlane32_swap_b32 v68, v72
    v_permlane32_swap_b32 v69, v73
    s_waitcnt lgkmcnt(8)
    v_mfma_f32_16x16x32_bf16 v[60:63], v[80:83], v[24:27], v[60:63]
    v_permlane32_swap_b32 v70, v74
    v_permlane32_swap_b32 v71, v75
    v_mfma_f32_16x16x32_bf16 v[64:67], v[96:99], v[24:27], v[64:67]
    v_add_f32 v68, v68, v72
    v_add_f32 v69, v69, v73
    v_mfma_f32_16x16x32_bf16 v[108:111], v[56:59], v[24:27], v[108:111]
    v_add_f32 v70, v70, v74
    v_add_f32 v71, v71, v75
    s_waitcnt lgkmcnt(4)
    v_mfma_f32_16x16x32_bf16 v[60:63], v[84:87], v[28:31], v[60:63]
    v_cvt_pk_bf16_f32 v72, v68, v69
    v_cvt_pk_bf16_f32 v73, v70, v71
    v_mfma_f32_16x16x32_bf16 v[64:67], v[100:103], v[28:31], v[64:67]
    v_min_u32 v72, -2, v72
    v_min_u32 v73, -2, v73
    v_mfma_f32_16x16x32_bf16 v[108:111], v[36:39], v[28:31], v[108:111]
    v_mov_b64 v[74:75], v[72:73]
    global_store_dwordx2 v9, v[72:73], s[32:33] sc1
    s_waitcnt lgkmcnt(0)
    v_mfma_f32_16x16x32_bf16 v[60:63], v[88:91], v[32:35], v[60:63]
    v_permlane32_swap_b32 v72, v74
    v_permlane32_swap_b32 v73, v75
    v_mfma_f32_16x16x32_bf16 v[64:67], v[104:107], v[32:35], v[64:67]
    v_mov_b32 v68, 0x3f803f80
    v_mov_b32 v69, 0x3f803f80
    v_mfma_f32_16x16x32_bf16 v[108:111], v[40:43], v[32:35], v[108:111]
    v_mov_b32 v70, 0x3f803f80
    v_mov_b32 v71, 0x3f803f80
    ds_read_b128 v[20:23], v12 offset:40960
    ds_read_b128 v[24:27], v12 offset:41984
    ds_read_b64_tr_b16 v[28:29], v17 offset:2048
    ds_read_b64_tr_b16 v[30:31], v17 offset:2304
    ds_read_b128 v[76:79], v6 offset:14336
    ds_read_b128 v[80:83], v6 offset:15360
    ds_read_b128 v[84:87], v6 offset:16384
    ds_read_b128 v[88:91], v6 offset:17408
    ds_read_b128 v[92:95], v6 offset:18432
    ds_read_b128 v[96:99], v6 offset:19456
    ds_read_b128 v[100:103], v6 offset:20480
    ds_read_b128 v[104:107], v6 offset:21504
    ds_read_b128 v[36:39], v6 offset:22528
    ds_read_b128 v[40:43], v6 offset:23552
    v_max3_f32 v32, v60, v61, v62
    v_max3_f32 v33, v63, v64, v65
    v_max3_f32 v32, v32, v66, v67
    v_max3_f32 v33, v33, v108, v109
    v_max3_f32 v32, v32, v110, v111
    v_max_f32 v32, v32, v33
    v_mov_b32 v33, v32
    s_nop 1
    v_permlane16_swap_b32 v33, v32
    v_max_f32 v32, v32, v33
    v_mov_b32 v33, v32
    s_nop 1
    v_permlane32_swap_b32 v33, v32
    v_max_f32 v32, v32, v33
    v_mul_f32 v32, s44, v32
    s_waitcnt lgkmcnt(10)
    v_min_u32 v28, -2, v28
    v_min_u32 v29, -2, v29
    v_min_u32 v30, -2, v30
    v_min_u32 v31, -2, v31
    global_store_dwordx4 v8, v[28:31], s[32:33] sc1
    v_pk_fma_f32 v[108:109], v[108:109], s[44:45], v[32:33] op_sel_hi:[1,1,0] neg_lo:[0,0,1] neg_hi:[0,0,1]
    v_pk_fma_f32 v[110:111], v[110:111], s[44:45], v[32:33] op_sel_hi:[1,1,0] neg_lo:[0,0,1] neg_hi:[0,0,1]
    v_pk_fma_f32 v[60:61], v[60:61], s[44:45], v[32:33] op_sel_hi:[1,1,0] neg_lo:[0,0,1] neg_hi:[0,0,1]
    v_pk_fma_f32 v[62:63], v[62:63], s[44:45], v[32:33] op_sel_hi:[1,1,0] neg_lo:[0,0,1] neg_hi:[0,0,1]
    v_pk_fma_f32 v[64:65], v[64:65], s[44:45], v[32:33] op_sel_hi:[1,1,0] neg_lo:[0,0,1] neg_hi:[0,0,1]
    v_pk_fma_f32 v[66:67], v[66:67], s[44:45], v[32:33] op_sel_hi:[1,1,0] neg_lo:[0,0,1] neg_hi:[0,0,1]
    v_exp_f32 v108, v108
    v_exp_f32 v109, v109
    v_exp_f32 v110, v110
    v_exp_f32 v111, v111
    v_exp_f32 v60, v60
    v_cvt_pk_bf16_f32 v44, v108, v109
    v_cvt_pk_bf16_f32 v45, v110, v111
    v_exp_f32 v61, v61
    v_exp_f32 v62, v62
    v_mfma_f32_16x16x16_bf16 v[32:35], v[68:69], v[44:45], 0
    v_mfma_f32_16x16x16_bf16 v[52:55], v[72:73], v[44:45], 0
    v_mfma_f32_16x16x16_bf16 v[56:59], v[74:75], v[44:45], 0
    v_exp_f32 v63, v63
    v_exp_f32 v64, v64
    v_exp_f32 v65, v65
    v_exp_f32 v66, v66
    v_exp_f32 v67, v67
    v_cvt_pk_bf16_f32 v48, v60, v61
    v_cvt_pk_bf16_f32 v49, v62, v63
    v_cvt_pk_bf16_f32 v50, v64, v65
    v_cvt_pk_bf16_f32 v51, v66, v67
    s_nop 1
    v_mfma_f32_16x16x32_bf16 v[32:35], v[68:71], v[48:51], v[32:35]
    v_mfma_f32_16x16x32_bf16 v[52:55], v[20:23], v[48:51], v[52:55]
    v_mfma_f32_16x16x32_bf16 v[56:59], v[24:27], v[48:51], v[56:59]
    s_nop 5
    v_rcp_f32 v32, v32
    v_mov_b64 v[60:61], 0
    v_mov_b64 v[62:63], 0
    v_pk_mul_f32 v[52:53], v[52:53], v[32:33] op_sel_hi:[1,0]
    v_pk_mul_f32 v[54:55], v[54:55], v[32:33] op_sel_hi:[1,0]
    v_cvt_pk_bf16_f32 v52, v52, v53
    v_cvt_pk_bf16_f32 v53, v54, v55
    ds_write2_b32 v5, v52, v53 offset0:0 offset1:32
    v_pk_mul_f32 v[56:57], v[56:57], v[32:33] op_sel_hi:[1,0]
    v_pk_mul_f32 v[58:59], v[58:59], v[32:33] op_sel_hi:[1,0]
    v_cvt_pk_bf16_f32 v56, v56, v57
    v_cvt_pk_bf16_f32 v57, v58, v59
    ds_write2_b32 v5, v56, v57 offset0:64 offset1:96
    v_mov_b64 v[64:65], 0
    v_mov_b64 v[66:67], 0
    v_mov_b64 v[44:45], 0
    v_mov_b64 v[46:47], 0
    v_mov_b64 v[48:49], 0
    v_mov_b64 v[50:51], 0
    s_waitcnt lgkmcnt(0)
    s_barrier
    ds_read_b128 v[20:23], v1 offset:12288
    ds_read_b128 v[24:27], v1 offset:13312
    ds_read_b128 v[52:55], v6 offset:24576
    ds_read_b128 v[56:59], v6 offset:25600
    s_add_u32 s32, s32, 131072
    s_addc_u32 s33, s33, 0
    v_mov_b64 v[68:69], 0
    v_mov_b64 v[70:71], 0
    v_mov_b64 v[72:73], 0
    v_mov_b64 v[74:75], 0
    v_mov_b64 v[32:33], 0
    v_mov_b64 v[34:35], 0
    v_mov_b64 v[28:29], 0
    v_mov_b64 v[30:31], 0
    s_cmp_ge_u32 s8, 62
    s_nop 0
    s_cbranch_scc1 L_rexit_22
    s_waitcnt lgkmcnt(3)
    v_smfmac_f32_16x16x64_bf16 v[28:31], v[20:23], a[184:191], v2
    v_smfmac_f32_16x16x64_bf16 v[32:35], v[20:23], a[192:199], v2
    v_smfmac_f32_16x16x64_bf16 v[44:47], v[20:23], a[200:207], v2
    v_smfmac_f32_16x16x64_bf16 v[48:51], v[20:23], a[208:215], v2
    s_waitcnt lgkmcnt(2)
    v_smfmac_f32_16x16x64_bf16 v[28:31], v[24:27], v[76:83], v2
    v_smfmac_f32_16x16x64_bf16 v[32:35], v[24:27], v[84:91], v2
    ds_read_b128 v[76:79], v6 offset:26624
    ds_read_b128 v[80:83], v6 offset:27648
    v_smfmac_f32_16x16x64_bf16 v[44:47], v[24:27], v[92:99], v2
    v_smfmac_f32_16x16x64_bf16 v[48:51], v[24:27], v[100:107], v2
    v_smfmac_f32_16x16x64_bf16 v[60:63], v[20:23], a[216:223], v2
    v_smfmac_f32_16x16x64_bf16 v[64:67], v[20:23], a[224:231], v2
    s_nop 1
    v_permlane32_swap_b32 v28, v32
    v_permlane32_swap_b32 v29, v33
    v_permlane32_swap_b32 v30, v34
    v_smfmac_f32_16x16x64_bf16 v[68:71], v[20:23], a[232:239], v2
    v_permlane32_swap_b32 v31, v35
    v_add_f32 v28, v28, v32
    v_add_f32 v29, v29, v33
    v_smfmac_f32_16x16x64_bf16 v[72:75], v[20:23], a[240:247], v2
    v_add_f32 v30, v30, v34
    v_add_f32 v31, v31, v35
    v_cvt_pk_bf16_f32 v28, v28, v29
    v_smfmac_f32_16x16x64_bf16 v[60:63], v[24:27], v[36:43], v2
    v_cvt_pk_bf16_f32 v29, v30, v31
    v_and_b32 v28, -2, v28
    global_store_dwordx2 v7, v[28:29], s[28:29]
    s_waitcnt lgkmcnt(2)
    v_smfmac_f32_16x16x64_bf16 v[64:67], v[24:27], v[52:59], v2
    v_permlane32_swap_b32 v44, v48
    v_permlane32_swap_b32 v45, v49
    v_permlane32_swap_b32 v46, v50
    v_permlane32_swap_b32 v47, v51
    v_smfmac_f32_16x16x64_bf16 v[72:75], v[24:27], a[248:255], v2
    v_add_f32 v44, v44, v48
    v_add_f32 v45, v45, v49
    v_add_f32 v46, v46, v50
    v_add_f32 v47, v47, v51
    s_waitcnt lgkmcnt(0)
    v_smfmac_f32_16x16x64_bf16 v[68:71], v[24:27], v[76:83], v2
    v_cvt_pk_bf16_f32 v44, v44, v45
    v_cvt_pk_bf16_f32 v45, v46, v47
    v_and_b32 v44, -2, v44
    global_store_dwordx2 v7, v[44:45], s[50:51]
    v_permlane32_swap_b32 v60, v64
    v_permlane32_swap_b32 v61, v65
    v_permlane32_swap_b32 v62, v66
    v_permlane32_swap_b32 v63, v67
    v_add_f32 v60, v60, v64
    v_add_f32 v61, v61, v65
    v_add_f32 v62, v62, v66
    v_add_f32 v63, v63, v67
    v_cvt_pk_bf16_f32 v60, v60, v61
    v_cvt_pk_bf16_f32 v61, v62, v63
    v_and_b32 v60, -2, v60
    global_store_dwordx2 v7, v[60:61], s[52:53]
    v_permlane32_swap_b32 v68, v72
    v_permlane32_swap_b32 v69, v73
    v_permlane32_swap_b32 v70, v74
    v_permlane32_swap_b32 v71, v75
    v_add_f32 v68, v68, v72
    v_add_f32 v69, v69, v73
    v_add_f32 v70, v70, v74
    v_add_f32 v71, v71, v75
    v_cvt_pk_bf16_f32 v68, v68, v69
    v_cvt_pk_bf16_f32 v69, v70, v71
    v_and_b32 v68, -2, v68
    global_store_dwordx2 v7, v[68:69], s[54:55]
    v_lshrrev_b32 v83, 1, v1
    ds_read_b128 v[28:31], v6 offset:0
    ds_read_b128 v[32:35], v6 offset:1024
    ds_read_b128 v[36:39], v6 offset:2048
    ds_read_b128 v[40:43], v6 offset:3072
    ds_read_b128 v[44:47], v6 offset:4096
    ds_read_b128 v[48:51], v6 offset:5120
    ds_read_b128 v[92:95], v6 offset:6144
    ds_read_b128 v[96:99], v6 offset:7168
    ds_read_b128 v[100:103], v6 offset:8192
    ds_read_b128 v[104:107], v6 offset:9216
    v_mov_b64 v[52:53], 0
    v_mov_b64 v[54:55], 0
    v_mov_b64 v[56:57], 0
    v_mov_b64 v[58:59], 0
    v_mov_b64 v[60:61], 0
    v_mov_b64 v[62:63], 0
    v_mov_b64 v[64:65], 0
    v_mov_b64 v[66:67], 0
    v_mov_b64 v[68:69], 0
    v_mov_b64 v[70:71], 0
    v_mov_b64 v[72:73], 0
    v_mov_b64 v[74:75], 0
    v_mov_b32 v108, v18
    v_mov_b32 v109, v18
    v_mov_b32 v110, v18
    v_mov_b32 v111, v18
    s_sleep 1
    global_load_dwordx2 v[84:85], v83, s[26:27] offset:0 sc1
    global_load_dwordx2 v[86:87], v83, s[26:27] offset:512 sc1
    global_load_dwordx2 v[88:89], v83, s[26:27] offset:1024 sc1
    global_load_dwordx2 v[90:91], v83, s[26:27] offset:1536 sc1
    s_mov_b32 s41, 2097152
L_pk_32:
    s_waitcnt vmcnt(0)
    v_or3_b32 v0, v84, v86, v88
    v_bitop3_b32 v0, v0, v90, 1 bitop3:0xa8
    v_cmp_ne_u32 vcc, 0, v0
    s_nop 4
    s_cbranch_vccz L_kg_33
    s_mov_b64 exec, vcc
    global_load_dwordx2 v[84:85], v83, s[26:27] offset:0 sc1
    global_load_dwordx2 v[86:87], v83, s[26:27] offset:512 sc1
    global_load_dwordx2 v[88:89], v83, s[26:27] offset:1024 sc1
    global_load_dwordx2 v[90:91], v83, s[26:27] offset:1536 sc1
    s_mov_b64 exec, -1
    s_sub_u32 s41, s41, 1
    s_cmp_eq_u32 s41, 0
    s_cbranch_scc1 L_end_7
    s_branch L_pk_32
L_kg_33:
    v_lshlrev_b32 v76, 16, v84
    v_and_b32 v77, 0xffff0000, v84
    v_lshlrev_b32 v78, 16, v85
    v_and_b32 v79, 0xffff0000, v85
    v_lshlrev_b32 v80, 16, v86
    v_and_b32 v81, 0xffff0000, v86
    v_lshlrev_b32 v82, 16, v87
    v_and_b32 v83, 0xffff0000, v87
    v_lshlrev_b32 v84, 16, v88
    v_and_b32 v85, 0xffff0000, v88
    v_lshlrev_b32 v86, 16, v89
    v_and_b32 v87, 0xffff0000, v89
    v_lshlrev_b32 v88, 16, v90
    v_and_b32 v89, 0xffff0000, v90
    v_lshlrev_b32 v90, 16, v91
    v_and_b32 v91, 0xffff0000, v91
    v_pk_add_f32 v[76:77], v[76:77], v[80:81]
    v_pk_add_f32 v[84:85], v[84:85], v[88:89]
    v_pk_add_f32 v[78:79], v[78:79], v[82:83]
    v_pk_add_f32 v[86:87], v[86:87], v[90:91]
    v_pk_add_f32 v[76:77], v[76:77], v[84:85]
    v_pk_add_f32 v[78:79], v[78:79], v[86:87]
    s_nop 1
    v_permlane32_swap_b32 v76, v78
    v_permlane32_swap_b32 v77, v79
    v_pk_add_f32 v[76:77], v[76:77], v[78:79]
    s_nop 1
    v_permlane16_swap_b32 v76, v77
    v_add_f32 v76, v76, v77
    s_nop 1
    v_add_f32_dpp v77, v76, v76 row_ror:8 row_mask:0xf bank_mask:0xf
    s_nop 1
    v_mov_b32_dpp v78, v77 quad_perm:[1,0,3,2] row_mask:0xf bank_mask:0xf
    v_cvt_pk_bf16_f32 v77, v77, v78
    v_min_u32 v77, -2, v77
    s_mov_b64 exec, s[42:43]
    global_store_dword v10, v77, s[22:23]
    global_store_dword v10, v11, s[24:25]
    s_mov_b64 exec, -1
    s_cmp_lg_u64 s[100:101], 0
    s_cbranch_scc1 L_p2_34
    s_mov_b32 s41, 2097152
L_fsp_35:
    global_load_dword v0, v16, s[34:35] sc1
    s_sub_u32 s41, s41, 1
    s_cmp_eq_u32 s41, 0
    s_cbranch_scc1 L_end_7
    s_waitcnt vmcnt(0)
    v_cmp_eq_u32 vcc, 0, v0
    s_nop 4
    s_cbranch_vccnz L_fsp_35
    s_add_u32 m0, s46, 16384
    s_nop 0
    global_load_lds_dwordx4 v1, s[30:31] offset:0 sc1
    global_load_lds_dwordx4 v1, s[30:31] offset:1024 sc1
    global_load_lds_dwordx4 v1, s[30:31] offset:2048 sc1
    global_load_lds_dwordx4 v1, s[30:31] offset:3072 sc1
L_p2_34:
    s_add_u32 s30, s30, 524288
    s_addc_u32 s31, s31, 0
    s_add_u32 s34, s34, 128
    s_addc_u32 s35, s35, 0
    ds_read_b128 v[76:79], v6 offset:10240
    ds_read_b128 v[80:83], v6 offset:11264
    ds_read_b128 v[84:87], v6 offset:12288
    ds_read_b128 v[88:91], v6 offset:13312
    s_sleep 2
    global_load_dwordx4 v[20:23], v12, s[22:23] offset:0 sc1
    global_load_dwordx4 v[24:27], v12, s[22:23] offset:1024 sc1
    s_add_u32 s8, s8, 2
    s_branch L_rstep_23
L_rexit_22:
    s_waitcnt vmcnt(0)
L_end_7:
    s_waitcnt vmcnt(0) lgkmcnt(0)
    s_endpgm
L_fast_x:
    s_sub_u32 s22, s6, 2
    s_lshr_b32 s26, s7, 2
    s_and_b32 s27, s7, 3
    s_mul_i32 s58, s26, 8320
    s_lshl_b32 s38, s27, 11
    s_add_u32 s58, s58, s38
    s_lshl_b32 s38, s9, 9
    s_add_u32 s58, s58, s38
    s_mov_b32 s44, 0x3e0293ee
    s_mov_b32 s45, 0x3e0293ee
    s_load_dwordx2 s[50:51], s[0:1], 0
    s_waitcnt lgkmcnt(0)
    s_load_dwordx2 s[12:13], s[0:1], 16
    s_load_dwordx2 s[14:15], s[0:1], 24
    s_load_dwordx2 s[16:17], s[0:1], 32
    s_load_dwordx2 s[18:19], s[0:1], 40
    v_lshrrev_b32 v1, 4, v0
    v_and_b32 v2, 15, v0
    v_lshlrev_b32 v3, 13, v1
    v_lshl_add_u32 v3, v2, 4, v3
    s_lshl_b32 s38, s7, 8
    v_add_u32 v3, s38, v3
    v_lshlrev_b32 v4, 10, v1
    v_lshl_add_u32 v4, v2, 4, v4
    s_lshr_b32 s38, s7, 2
    s_lshl_b32 s38, s38, 19
    s_and_b32 s39, s7, 3
    s_lshl_b32 s39, s39, 8
    s_add_u32 s38, s38, s39
    v_add_u32 v4, s38, v4
    v_and_b32 v5, 3, v1
    v_lshlrev_b32 v5, 5, v5
    v_bfe_u32 v6, v1, 3, 1
    v_lshlrev_b32 v6, 7, v6
    v_xor_b32 v5, v5, v6
    v_lshlrev_b32 v6, 4, v2
    v_xor_b32 v5, v5, v6
    v_lshl_add_u32 v5, v1, 8, v5
    v_add_u32 v5, 114688, v5
    v_and_b32 v6, 63, v0
    v_lshrrev_b32 v7, 4, v6
    v_bfe_u32 v8, v6, 2, 2
    v_and_b32 v9, 3, v6
    v_lshl_add_u32 v10, v7, 3, v8
    v_lshlrev_b32 v10, 8, v10
    v_add_u32 v10, 114688, v10
    v_lshlrev_b32 v8, 5, v8
    v_and_b32 v7, 1, v7
    v_lshlrev_b32 v7, 7, v7
    v_xor_b32 v8, v8, v7
    s_lshl_b32 s38, s9, 6
    v_lshlrev_b32 v12, 3, v9
    v_add_u32 v12, s38, v12
    v_xor_b32 v12, v12, v8
    v_add_u32 v6, v10, v12
    v_xor_b32 v12, 32, v12
    v_add_u32 v7, v10, v12
    v_lshlrev_b32 v12, 4, v9
    v_add_u32 v12, s38, v12
    v_xor_b32 v12, v12, v8
    v_add_u32 v13, v10, v12
    v_add_u32 v14, 8, v13
    v_and_b32 v8, 63, v0
    v_lshlrev_b32 v8, 4, v8
    s_mul_i32 s38, s9, 28672
    v_add_u32 v8, s38, v8
    s_waitcnt lgkmcnt(0)
    v_mov_b32 v11, v3
    global_load_dwordx4 v[16:19], v11, s[14:15]
    v_add_u32 v11, 131072, v3
    global_load_dwordx4 v[20:23], v11, s[14:15]
    v_add_u32 v11, 262144, v3
    global_load_dwordx4 v[24:27], v11, s[14:15]
    v_add_u32 v11, 393216, v3
    global_load_dwordx4 v[28:31], v11, s[14:15]
    v_add_u32 v11, 524288, v3
    global_load_dwordx4 v[32:35], v11, s[14:15]
    v_add_u32 v11, 655360, v3
    global_load_dwordx4 v[36:39], v11, s[14:15]
    v_add_u32 v11, 786432, v3
    global_load_dwordx4 v[40:43], v11, s[14:15]
    v_add_u32 v11, 917504, v3
    global_load_dwordx4 v[44:47], v11, s[14:15]
    v_add_u32 v11, 1048576, v3
    global_load_dwordx4 v[48:51], v11, s[14:15]
    v_add_u32 v11, 1179648, v3
    global_load_dwordx4 v[52:55], v11, s[14:15]
    v_add_u32 v11, 1310720, v3
    global_load_dwordx4 v[56:59], v11, s[14:15]
    v_add_u32 v11, 1441792, v3
    global_load_dwordx4 v[60:63], v11, s[14:15]
    v_add_u32 v11, 1572864, v3
    global_load_dwordx4 v[64:67], v11, s[14:15]
    v_add_u32 v11, 1703936, v3
    global_load_dwordx4 v[68:71], v11, s[14:15]
    v_add_u32 v11, 1835008, v3
    global_load_dwordx4 v[72:75], v11, s[14:15]
    v_add_u32 v11, 1966080, v3
    global_load_dwordx4 v[76:79], v11, s[14:15]
    v_add_u32 v11, 2097152, v3
    global_load_dwordx4 v[80:83], v11, s[14:15]
    v_add_u32 v11, 2228224, v3
    global_load_dwordx4 v[84:87], v11, s[14:15]
    v_add_u32 v11, 2359296, v3
    global_load_dwordx4 v[88:91], v11, s[14:15]
    v_add_u32 v11, 2490368, v3
    global_load_dwordx4 v[92:95], v11, s[14:15]
    v_mov_b32 v96, 0
    v_mov_b32 v97, 0
    v_mov_b32 v98, 0
    v_mov_b32 v99, 0
    s_mul_i32 s38, s7, 36864
    s_add_u32 s38, s38, 2097152
    v_lshlrev_b32 v100, 4, v0
    v_add_u32 v100, s38, v100
    global_store_dwordx4 v100, v[96:99], s[20:21]
    v_add_u32 v100, 4096, v100
    global_store_dwordx4 v100, v[96:99], s[20:21]
    v_add_u32 v100, 4096, v100
    global_store_dwordx4 v100, v[96:99], s[20:21]
    v_add_u32 v100, 4096, v100
    global_store_dwordx4 v100, v[96:99], s[20:21]
    v_add_u32 v100, 4096, v100
    global_store_dwordx4 v100, v[96:99], s[20:21]
    v_add_u32 v100, 4096, v100
    global_store_dwordx4 v100, v[96:99], s[20:21]
    v_add_u32 v100, 4096, v100
    global_store_dwordx4 v100, v[96:99], s[20:21]
    v_add_u32 v100, 4096, v100
    global_store_dwordx4 v100, v[96:99], s[20:21]
    v_add_u32 v100, 4096, v100
    global_store_dwordx4 v100, v[96:99], s[20:21]
    v_add_u32 v100, 4096, v100
    s_lshl_b32 s38, s7, 4
    s_add_u32 s38, s38, 983040
    v_mov_b32 v101, s38
    global_store_dwordx4 v101, v[96:99], s[20:21]
    s_waitcnt vmcnt(16)
    ds_write_b128 v5, v[16:19] offset:0
    ds_write_b128 v5, v[20:23] offset:4096
    ds_write_b128 v5, v[24:27] offset:8192
    ds_write_b128 v5, v[28:31] offset:12288
    s_waitcnt lgkmcnt(0)
    v_add_u32 v11, 2621440, v3
    global_load_dwordx4 v[16:19], v11, s[14:15]
    v_add_u32 v11, 2752512, v3
    global_load_dwordx4 v[20:23], v11, s[14:15]
    v_add_u32 v11, 2883584, v3
    global_load_dwordx4 v[24:27], v11, s[14:15]
    v_add_u32 v11, 3014656, v3
    global_load_dwordx4 v[28:31], v11, s[14:15]
    s_barrier
    ds_read_b64_tr_b16 v[240:241], v6 offset:0
    ds_read_b64_tr_b16 v[242:243], v6 offset:1024
    ds_read_b64_tr_b16 v[244:245], v6 offset:8192
    ds_read_b64_tr_b16 v[246:247], v6 offset:9216
    ds_read_b64_tr_b16 a[48:49], v7 offset:0
    ds_read_b64_tr_b16 a[50:51], v7 offset:1024
    ds_read_b64_tr_b16 a[52:53], v7 offset:8192
    ds_read_b64_tr_b16 a[54:55], v7 offset:9216
    s_waitcnt lgkmcnt(0)
    s_waitcnt vmcnt(16)
    ds_write_b128 v5, v[32:35] offset:16384
    ds_write_b128 v5, v[36:39] offset:20480
    ds_write_b128 v5, v[40:43] offset:24576
    ds_write_b128 v5, v[44:47] offset:28672
    s_waitcnt lgkmcnt(0)
    v_add_u32 v11, 3145728, v3
    global_load_dwordx4 v[32:35], v11, s[14:15]
    v_add_u32 v11, 3276800, v3
    global_load_dwordx4 v[36:39], v11, s[14:15]
    v_add_u32 v11, 3407872, v3
    global_load_dwordx4 v[40:43], v11, s[14:15]
    v_add_u32 v11, 3538944, v3
    global_load_dwordx4 v[44:47], v11, s[14:15]
    s_barrier
    ds_read_b64_tr_b16 v[248:249], v6 offset:16384
    ds_read_b64_tr_b16 v[250:251], v6 offset:17408
    ds_read_b64_tr_b16 v[252:253], v6 offset:24576
    ds_read_b64_tr_b16 v[254:255], v6 offset:25600
    ds_read_b64_tr_b16 a[56:57], v7 offset:16384
    ds_read_b64_tr_b16 a[58:59], v7 offset:17408
    ds_read_b64_tr_b16 a[60:61], v7 offset:24576
    ds_read_b64_tr_b16 a[62:63], v7 offset:25600
    s_waitcnt lgkmcnt(0)
    s_waitcnt vmcnt(16)
    ds_write_b128 v5, v[48:51] offset:0
    ds_write_b128 v5, v[52:55] offset:4096
    ds_write_b128 v5, v[56:59] offset:8192
    ds_write_b128 v5, v[60:63] offset:12288
    s_waitcnt lgkmcnt(0)
    v_add_u32 v11, 3670016, v3
    global_load_dwordx4 v[48:51], v11, s[14:15]
    v_add_u32 v11, 3801088, v3
    global_load_dwordx4 v[52:55], v11, s[14:15]
    v_add_u32 v11, 3932160, v3
    global_load_dwordx4 v[56:59], v11, s[14:15]
    v_add_u32 v11, 4063232, v3
    global_load_dwordx4 v[60:63], v11, s[14:15]
    s_barrier
    ds_read_b64_tr_b16 a[0:1], v6 offset:0
    ds_read_b64_tr_b16 a[2:3], v6 offset:1024
    ds_read_b64_tr_b16 a[4:5], v6 offset:8192
    ds_read_b64_tr_b16 a[6:7], v6 offset:9216
    ds_read_b64_tr_b16 a[64:65], v7 offset:0
    ds_read_b64_tr_b16 a[66:67], v7 offset:1024
    ds_read_b64_tr_b16 a[68:69], v7 offset:8192
    ds_read_b64_tr_b16 a[70:71], v7 offset:9216
    s_waitcnt lgkmcnt(0)
    s_waitcnt vmcnt(16)
    ds_write_b128 v5, v[64:67] offset:16384
    ds_write_b128 v5, v[68:71] offset:20480
    ds_write_b128 v5, v[72:75] offset:24576
    ds_write_b128 v5, v[76:79] offset:28672
    s_waitcnt lgkmcnt(0)
    v_mov_b32 v11, v3
    global_load_dwordx4 v[64:67], v11, s[16:17]
    v_add_u32 v11, 131072, v3
    global_load_dwordx4 v[68:71], v11, s[16:17]
    v_add_u32 v11, 262144, v3
    global_load_dwordx4 v[72:75], v11, s[16:17]
    v_add_u32 v11, 393216, v3
    global_load_dwordx4 v[76:79], v11, s[16:17]
    s_barrier
    ds_read_b64_tr_b16 a[8:9], v6 offset:16384
    ds_read_b64_tr_b16 a[10:11], v6 offset:17408
    ds_read_b64_tr_b16 a[12:13], v6 offset:24576
    ds_read_b64_tr_b16 a[14:15], v6 offset:25600
    ds_read_b64_tr_b16 a[72:73], v7 offset:16384
    ds_read_b64_tr_b16 a[74:75], v7 offset:17408
    ds_read_b64_tr_b16 a[76:77], v7 offset:24576
    ds_read_b64_tr_b16 a[78:79], v7 offset:25600
    s_waitcnt lgkmcnt(0)
    s_waitcnt vmcnt(16)
    ds_write_b128 v5, v[80:83] offset:0
    ds_write_b128 v5, v[84:87] offset:4096
    ds_write_b128 v5, v[88:91] offset:8192
    ds_write_b128 v5, v[92:95] offset:12288
    s_waitcnt lgkmcnt(0)
    v_add_u32 v11, 524288, v3
    global_load_dwordx4 v[80:83], v11, s[16:17]
    v_add_u32 v11, 655360, v3
    global_load_dwordx4 v[84:87], v11, s[16:17]
    v_add_u32 v11, 786432, v3
    global_load_dwordx4 v[88:91], v11, s[16:17]
    v_add_u32 v11, 917504, v3
    global_load_dwordx4 v[92:95], v11, s[16:17]
    s_barrier
    ds_read_b64_tr_b16 a[16:17], v6 offset:0
    ds_read_b64_tr_b16 a[18:19], v6 offset:1024
    ds_read_b64_tr_b16 a[20:21], v6 offset:8192
    ds_read_b64_tr_b16 a[22:23], v6 offset:9216
    ds_read_b64_tr_b16 a[80:81], v7 offset:0
    ds_read_b64_tr_b16 a[82:83], v7 offset:1024
    ds_read_b64_tr_b16 a[84:85], v7 offset:8192
    ds_read_b64_tr_b16 a[86:87], v7 offset:9216
    s_waitcnt lgkmcnt(0)
    s_waitcnt vmcnt(16)
    ds_write_b128 v5, v[16:19] offset:16384
    ds_write_b128 v5, v[20:23] offset:20480
    ds_write_b128 v5, v[24:27] offset:24576
    ds_write_b128 v5, v[28:31] offset:28672
    s_waitcnt lgkmcnt(0)
    v_add_u32 v11, 1048576, v3
    global_load_dwordx4 v[16:19], v11, s[16:17]
    v_add_u32 v11, 1179648, v3
    global_load_dwordx4 v[20:23], v11, s[16:17]
    v_add_u32 v11, 1310720, v3
    global_load_dwordx4 v[24:27], v11, s[16:17]
    v_add_u32 v11, 1441792, v3
    global_load_dwordx4 v[28:31], v11, s[16:17]
    s_barrier
    ds_read_b64_tr_b16 a[24:25], v6 offset:16384
    ds_read_b64_tr_b16 a[26:27], v6 offset:17408
    ds_read_b64_tr_b16 a[28:29], v6 offset:24576
    ds_read_b64_tr_b16 a[30:31], v6 offset:25600
    ds_read_b64_tr_b16 a[88:89], v7 offset:16384
    ds_read_b64_tr_b16 a[90:91], v7 offset:17408
    ds_read_b64_tr_b16 a[92:93], v7 offset:24576
    ds_read_b64_tr_b16 a[94:95], v7 offset:25600
    s_waitcnt lgkmcnt(0)
    s_lshl_b32 s38, s6, 2
    s_add_u32 s38, s38, 64
    s_cmp_lg_u32 s9, 0
    s_cbranch_scc1 L_arr_37
    v_mov_b32 v1, s38
    v_mov_b32 v2, 1
    s_mov_b64 exec, 1
    global_atomic_add v1, v2, s[10:11] sc1
    s_mov_b64 exec, -1
L_arr_37:
    s_waitcnt vmcnt(16)
    ds_write_b128 v5, v[32:35] offset:0
    ds_write_b128 v5, v[36:39] offset:4096
    ds_write_b128 v5, v[40:43] offset:8192
    ds_write_b128 v5, v[44:47] offset:12288
    s_waitcnt lgkmcnt(0)
    v_add_u32 v11, 1572864, v3
    global_load_dwordx4 v[32:35], v11, s[16:17]
    v_add_u32 v11, 1703936, v3
    global_load_dwordx4 v[36:39], v11, s[16:17]
    v_add_u32 v11, 1835008, v3
    global_load_dwordx4 v[40:43], v11, s[16:17]
    v_add_u32 v11, 1966080, v3
    global_load_dwordx4 v[44:47], v11, s[16:17]
    s_barrier
    ds_read_b64_tr_b16 a[32:33], v6 offset:0
    ds_read_b64_tr_b16 a[34:35], v6 offset:1024
    ds_read_b64_tr_b16 a[36:37], v6 offset:8192
    ds_read_b64_tr_b16 a[38:39], v6 offset:9216
    ds_read_b64_tr_b16 a[96:97], v7 offset:0
    ds_read_b64_tr_b16 a[98:99], v7 offset:1024
    ds_read_b64_tr_b16 a[100:101], v7 offset:8192
    ds_read_b64_tr_b16 a[102:103], v7 offset:9216
    s_waitcnt lgkmcnt(0)
    s_waitcnt vmcnt(16)
    ds_write_b128 v5, v[48:51] offset:16384
    ds_write_b128 v5, v[52:55] offset:20480
    ds_write_b128 v5, v[56:59] offset:24576
    ds_write_b128 v5, v[60:63] offset:28672
    s_waitcnt lgkmcnt(0)
    v_add_u32 v11, 2097152, v3
    global_load_dwordx4 v[48:51], v11, s[16:17]
    v_add_u32 v11, 2228224, v3
    global_load_dwordx4 v[52:55], v11, s[16:17]
    v_add_u32 v11, 2359296, v3
    global_load_dwordx4 v[56:59], v11, s[16:17]
    v_add_u32 v11, 2490368, v3
    global_load_dwordx4 v[60:63], v11, s[16:17]
    s_barrier
    ds_read_b64_tr_b16 a[40:41], v6 offset:16384
    ds_read_b64_tr_b16 a[42:43], v6 offset:17408
    ds_read_b64_tr_b16 a[44:45], v6 offset:24576
    ds_read_b64_tr_b16 a[46:47], v6 offset:25600
    ds_read_b64_tr_b16 a[104:105], v7 offset:16384
    ds_read_b64_tr_b16 a[106:107], v7 offset:17408
    ds_read_b64_tr_b16 a[108:109], v7 offset:24576
    ds_read_b64_tr_b16 a[110:111], v7 offset:25600
    s_waitcnt lgkmcnt(0)
    s_waitcnt vmcnt(16)
    ds_write_b128 v5, v[64:67] offset:0
    ds_write_b128 v5, v[68:71] offset:4096
    ds_write_b128 v5, v[72:75] offset:8192
    ds_write_b128 v5, v[76:79] offset:12288
    s_waitcnt lgkmcnt(0)
    v_add_u32 v11, 2621440, v3
    global_load_dwordx4 v[64:67], v11, s[16:17]
    v_add_u32 v11, 2752512, v3
    global_load_dwordx4 v[68:71], v11, s[16:17]
    v_add_u32 v11, 2883584, v3
    global_load_dwordx4 v[72:75], v11, s[16:17]
    v_add_u32 v11, 3014656, v3
    global_load_dwordx4 v[76:79], v11, s[16:17]
    s_barrier
    ds_read_b64_tr_b16 a[112:113], v6 offset:0
    ds_read_b64_tr_b16 a[114:115], v6 offset:1024
    ds_read_b64_tr_b16 a[116:117], v6 offset:8192
    ds_read_b64_tr_b16 a[118:119], v6 offset:9216
    ds_read_b64_tr_b16 a[176:177], v7 offset:0
    ds_read_b64_tr_b16 a[178:179], v7 offset:1024
    ds_read_b64_tr_b16 a[180:181], v7 offset:8192
    ds_read_b64_tr_b16 a[182:183], v7 offset:9216
    s_waitcnt lgkmcnt(0)
    s_waitcnt vmcnt(16)
    ds_write_b128 v5, v[80:83] offset:16384
    ds_write_b128 v5, v[84:87] offset:20480
    ds_write_b128 v5, v[88:91] offset:24576
    ds_write_b128 v5, v[92:95] offset:28672
    s_waitcnt lgkmcnt(0)
    v_add_u32 v11, 3145728, v3
    global_load_dwordx4 v[80:83], v11, s[16:17]
    v_add_u32 v11, 3276800, v3
    global_load_dwordx4 v[84:87], v11, s[16:17]
    v_add_u32 v11, 3407872, v3
    global_load_dwordx4 v[88:91], v11, s[16:17]
    v_add_u32 v11, 3538944, v3
    global_load_dwordx4 v[92:95], v11, s[16:17]
    s_barrier
    ds_read_b64_tr_b16 a[120:121], v6 offset:16384
    ds_read_b64_tr_b16 a[122:123], v6 offset:17408
    ds_read_b64_tr_b16 a[124:125], v6 offset:24576
    ds_read_b64_tr_b16 a[126:127], v6 offset:25600
    ds_read_b64_tr_b16 v[96:97], v7 offset:16384
    ds_read_b64_tr_b16 v[98:99], v7 offset:17408
    ds_read_b64_tr_b16 v[100:101], v7 offset:24576
    ds_read_b64_tr_b16 v[102:103], v7 offset:25600
    s_waitcnt lgkmcnt(0)
    ds_write_b128 v8, v[96:99] offset:0
    ds_write_b128 v8, v[100:103] offset:1024
    s_waitcnt lgkmcnt(0)
    s_waitcnt vmcnt(16)
    ds_write_b128 v5, v[16:19] offset:0
    ds_write_b128 v5, v[20:23] offset:4096
    ds_write_b128 v5, v[24:27] offset:8192
    ds_write_b128 v5, v[28:31] offset:12288
    s_waitcnt lgkmcnt(0)
    v_add_u32 v11, 3670016, v3
    global_load_dwordx4 v[16:19], v11, s[16:17]
    v_add_u32 v11, 3801088, v3
    global_load_dwordx4 v[20:23], v11, s[16:17]
    v_add_u32 v11, 3932160, v3
    global_load_dwordx4 v[24:27], v11, s[16:17]
    v_add_u32 v11, 4063232, v3
    global_load_dwordx4 v[28:31], v11, s[16:17]
    s_barrier
    ds_read_b64_tr_b16 a[128:129], v6 offset:0
    ds_read_b64_tr_b16 a[130:131], v6 offset:1024
    ds_read_b64_tr_b16 a[132:133], v6 offset:8192
    ds_read_b64_tr_b16 a[134:135], v6 offset:9216
    ds_read_b64_tr_b16 v[96:97], v7 offset:0
    ds_read_b64_tr_b16 v[98:99], v7 offset:1024
    ds_read_b64_tr_b16 v[100:101], v7 offset:8192
    ds_read_b64_tr_b16 v[102:103], v7 offset:9216
    s_waitcnt lgkmcnt(0)
    ds_write_b128 v8, v[96:99] offset:2048
    ds_write_b128 v8, v[100:103] offset:3072
    s_waitcnt lgkmcnt(0)
    s_waitcnt vmcnt(16)
    ds_write_b128 v5, v[32:35] offset:16384
    ds_write_b128 v5, v[36:39] offset:20480
    ds_write_b128 v5, v[40:43] offset:24576
    ds_write_b128 v5, v[44:47] offset:28672
    s_waitcnt lgkmcnt(0)
    v_mov_b32 v11, v3
    global_load_dwordx4 v[32:35], v11, s[12:13]
    v_add_u32 v11, 131072, v3
    global_load_dwordx4 v[36:39], v11, s[12:13]
    v_add_u32 v11, 262144, v3
    global_load_dwordx4 v[40:43], v11, s[12:13]
    v_add_u32 v11, 393216, v3
    global_load_dwordx4 v[44:47], v11, s[12:13]
    s_barrier
    ds_read_b64_tr_b16 a[136:137], v6 offset:16384
    ds_read_b64_tr_b16 a[138:139], v6 offset:17408
    ds_read_b64_tr_b16 a[140:141], v6 offset:24576
    ds_read_b64_tr_b16 a[142:143], v6 offset:25600
    ds_read_b64_tr_b16 v[96:97], v7 offset:16384
    ds_read_b64_tr_b16 v[98:99], v7 offset:17408
    ds_read_b64_tr_b16 v[100:101], v7 offset:24576
    ds_read_b64_tr_b16 v[102:103], v7 offset:25600
    s_waitcnt lgkmcnt(0)
    ds_write_b128 v8, v[96:99] offset:4096
    ds_write_b128 v8, v[100:103] offset:5120
    s_waitcnt lgkmcnt(0)
    s_waitcnt vmcnt(16)
    ds_write_b128 v5, v[48:51] offset:0
    ds_write_b128 v5, v[52:55] offset:4096
    ds_write_b128 v5, v[56:59] offset:8192
    ds_write_b128 v5, v[60:63] offset:12288
    s_waitcnt lgkmcnt(0)
    v_add_u32 v11, 524288, v3
    global_load_dwordx4 v[48:51], v11, s[12:13]
    v_add_u32 v11, 655360, v3
    global_load_dwordx4 v[52:55], v11, s[12:13]
    v_add_u32 v11, 786432, v3
    global_load_dwordx4 v[56:59], v11, s[12:13]
    v_add_u32 v11, 917504, v3
    global_load_dwordx4 v[60:63], v11, s[12:13]
    s_barrier
    ds_read_b64_tr_b16 a[144:145], v6 offset:0
    ds_read_b64_tr_b16 a[146:147], v6 offset:1024
    ds_read_b64_tr_b16 a[148:149], v6 offset:8192
    ds_read_b64_tr_b16 a[150:151], v6 offset:9216
    ds_read_b64_tr_b16 v[96:97], v7 offset:0
    ds_read_b64_tr_b16 v[98:99], v7 offset:1024
    ds_read_b64_tr_b16 v[100:101], v7 offset:8192
    ds_read_b64_tr_b16 v[102:103], v7 offset:9216
    s_waitcnt lgkmcnt(0)
    ds_write_b128 v8, v[96:99] offset:6144
    ds_write_b128 v8, v[100:103] offset:7168
    s_waitcnt lgkmcnt(0)
    s_cmp_lg_u32 s9, 0
    s_cbranch_scc1 L_rd_38
    v_lshlrev_b32 v1, 2, v0
    v_mov_b32 v2, 0
    global_atomic_add v104, v1, v2, s[10:11] sc0 sc1
    s_nop 0
L_rd_38:
    s_waitcnt vmcnt(16)
    ds_write_b128 v5, v[64:67] offset:16384
    ds_write_b128 v5, v[68:71] offset:20480
    ds_write_b128 v5, v[72:75] offset:24576
    ds_write_b128 v5, v[76:79] offset:28672
    s_waitcnt lgkmcnt(0)
    v_add_u32 v11, 1048576, v3
    global_load_dwordx4 v[64:67], v11, s[12:13]
    v_add_u32 v11, 1179648, v3
    global_load_dwordx4 v[68:71], v11, s[12:13]
    v_add_u32 v11, 1310720, v3
    global_load_dwordx4 v[72:75], v11, s[12:13]
    v_add_u32 v11, 1441792, v3
    global_load_dwordx4 v[76:79], v11, s[12:13]
    s_barrier
    ds_read_b64_tr_b16 a[152:153], v6 offset:16384
    ds_read_b64_tr_b16 a[154:155], v6 offset:17408
    ds_read_b64_tr_b16 a[156:157], v6 offset:24576
    ds_read_b64_tr_b16 a[158:159], v6 offset:25600
    ds_read_b64_tr_b16 v[96:97], v7 offset:16384
    ds_read_b64_tr_b16 v[98:99], v7 offset:17408
    ds_read_b64_tr_b16 v[100:101], v7 offset:24576
    ds_read_b64_tr_b16 v[102:103], v7 offset:25600
    s_waitcnt lgkmcnt(0)
    ds_write_b128 v8, v[96:99] offset:8192
    ds_write_b128 v8, v[100:103] offset:9216
    s_waitcnt lgkmcnt(0)
    s_waitcnt vmcnt(16)
    ds_write_b128 v5, v[80:83] offset:0
    ds_write_b128 v5, v[84:87] offset:4096
    ds_write_b128 v5, v[88:91] offset:8192
    ds_write_b128 v5, v[92:95] offset:12288
    s_waitcnt lgkmcnt(0)
    v_add_u32 v11, 1572864, v3
    global_load_dwordx4 v[80:83], v11, s[12:13]
    v_add_u32 v11, 1703936, v3
    global_load_dwordx4 v[84:87], v11, s[12:13]
    v_add_u32 v11, 1835008, v3
    global_load_dwordx4 v[88:91], v11, s[12:13]
    v_add_u32 v11, 1966080, v3
    global_load_dwordx4 v[92:95], v11, s[12:13]
    s_barrier
    ds_read_b64_tr_b16 a[160:161], v6 offset:0
    ds_read_b64_tr_b16 a[162:163], v6 offset:1024
    ds_read_b64_tr_b16 a[164:165], v6 offset:8192
    ds_read_b64_tr_b16 a[166:167], v6 offset:9216
    ds_read_b64_tr_b16 v[96:97], v7 offset:0
    ds_read_b64_tr_b16 v[98:99], v7 offset:1024
    ds_read_b64_tr_b16 v[100:101], v7 offset:8192
    ds_read_b64_tr_b16 v[102:103], v7 offset:9216
    s_waitcnt lgkmcnt(0)
    ds_write_b128 v8, v[96:99] offset:10240
    ds_write_b128 v8, v[100:103] offset:11264
    s_waitcnt lgkmcnt(0)
    s_waitcnt vmcnt(16)
    ds_write_b128 v5, v[16:19] offset:16384
    ds_write_b128 v5, v[20:23] offset:20480
    ds_write_b128 v5, v[24:27] offset:24576
    ds_write_b128 v5, v[28:31] offset:28672
    s_waitcnt lgkmcnt(0)
    v_add_u32 v11, 2097152, v3
    global_load_dwordx4 v[16:19], v11, s[12:13]
    v_add_u32 v11, 2228224, v3
    global_load_dwordx4 v[20:23], v11, s[12:13]
    v_add_u32 v11, 2359296, v3
    global_load_dwordx4 v[24:27], v11, s[12:13]
    v_add_u32 v11, 2490368, v3
    global_load_dwordx4 v[28:31], v11, s[12:13]
    s_barrier
    ds_read_b64_tr_b16 a[168:169], v6 offset:16384
    ds_read_b64_tr_b16 a[170:171], v6 offset:17408
    ds_read_b64_tr_b16 a[172:173], v6 offset:24576
    ds_read_b64_tr_b16 a[174:175], v6 offset:25600
    ds_read_b64_tr_b16 v[96:97], v7 offset:16384
    ds_read_b64_tr_b16 v[98:99], v7 offset:17408
    ds_read_b64_tr_b16 v[100:101], v7 offset:24576
    ds_read_b64_tr_b16 v[102:103], v7 offset:25600
    s_waitcnt lgkmcnt(0)
    ds_write_b128 v8, v[96:99] offset:12288
    ds_write_b128 v8, v[100:103] offset:13312
    s_waitcnt lgkmcnt(0)
    s_waitcnt vmcnt(16)
    ds_write_b128 v5, v[32:35] offset:0
    ds_write_b128 v5, v[36:39] offset:4096
    ds_write_b128 v5, v[40:43] offset:8192
    ds_write_b128 v5, v[44:47] offset:12288
    s_waitcnt lgkmcnt(0)
    v_add_u32 v11, 2621440, v3
    global_load_dwordx4 v[32:35], v11, s[12:13]
    v_add_u32 v11, 2752512, v3
    global_load_dwordx4 v[36:39], v11, s[12:13]
    v_add_u32 v11, 2883584, v3
    global_load_dwordx4 v[40:43], v11, s[12:13]
    v_add_u32 v11, 3014656, v3
    global_load_dwordx4 v[44:47], v11, s[12:13]
    s_barrier
    ds_read_b64_tr_b16 v[112:113], v6 offset:0
    ds_read_b64_tr_b16 v[114:115], v6 offset:1024
    ds_read_b64_tr_b16 v[116:117], v6 offset:8192
    ds_read_b64_tr_b16 v[118:119], v6 offset:9216
    ds_read_b64_tr_b16 v[176:177], v7 offset:0
    ds_read_b64_tr_b16 v[178:179], v7 offset:1024
    ds_read_b64_tr_b16 v[180:181], v7 offset:8192
    ds_read_b64_tr_b16 v[182:183], v7 offset:9216
    s_waitcnt lgkmcnt(0)
    s_waitcnt vmcnt(16)
    ds_write_b128 v5, v[48:51] offset:16384
    ds_write_b128 v5, v[52:55] offset:20480
    ds_write_b128 v5, v[56:59] offset:24576
    ds_write_b128 v5, v[60:63] offset:28672
    s_waitcnt lgkmcnt(0)
    v_add_u32 v11, 3145728, v3
    global_load_dwordx4 v[48:51], v11, s[12:13]
    v_add_u32 v11, 3276800, v3
    global_load_dwordx4 v[52:55], v11, s[12:13]
    v_add_u32 v11, 3407872, v3
    global_load_dwordx4 v[56:59], v11, s[12:13]
    v_add_u32 v11, 3538944, v3
    global_load_dwordx4 v[60:63], v11, s[12:13]
    s_barrier
    ds_read_b64_tr_b16 v[120:121], v6 offset:16384
    ds_read_b64_tr_b16 v[122:123], v6 offset:17408
    ds_read_b64_tr_b16 v[124:125], v6 offset:24576
    ds_read_b64_tr_b16 v[126:127], v6 offset:25600
    ds_read_b64_tr_b16 v[184:185], v7 offset:16384
    ds_read_b64_tr_b16 v[186:187], v7 offset:17408
    ds_read_b64_tr_b16 v[188:189], v7 offset:24576
    ds_read_b64_tr_b16 v[190:191], v7 offset:25600
    s_waitcnt lgkmcnt(0)
    s_waitcnt vmcnt(16)
    ds_write_b128 v5, v[64:67] offset:0
    ds_write_b128 v5, v[68:71] offset:4096
    ds_write_b128 v5, v[72:75] offset:8192
    ds_write_b128 v5, v[76:79] offset:12288
    s_waitcnt lgkmcnt(0)
    v_add_u32 v11, 3670016, v3
    global_load_dwordx4 v[64:67], v11, s[12:13]
    v_add_u32 v11, 3801088, v3
    global_load_dwordx4 v[68:71], v11, s[12:13]
    v_add_u32 v11, 3932160, v3
    global_load_dwordx4 v[72:75], v11, s[12:13]
    v_add_u32 v11, 4063232, v3
    global_load_dwordx4 v[76:79], v11, s[12:13]
    s_barrier
    ds_read_b64_tr_b16 v[128:129], v6 offset:0
    ds_read_b64_tr_b16 v[130:131], v6 offset:1024
    ds_read_b64_tr_b16 v[132:133], v6 offset:8192
    ds_read_b64_tr_b16 v[134:135], v6 offset:9216
    ds_read_b64_tr_b16 v[192:193], v7 offset:0
    ds_read_b64_tr_b16 v[194:195], v7 offset:1024
    ds_read_b64_tr_b16 v[196:197], v7 offset:8192
    ds_read_b64_tr_b16 v[198:199], v7 offset:9216
    s_waitcnt lgkmcnt(0)
    s_waitcnt vmcnt(16)
    ds_write_b128 v5, v[80:83] offset:16384
    ds_write_b128 v5, v[84:87] offset:20480
    ds_write_b128 v5, v[88:91] offset:24576
    ds_write_b128 v5, v[92:95] offset:28672
    s_waitcnt lgkmcnt(0)
    v_mov_b32 v11, v4
    global_load_dwordx4 v[80:83], v11, s[18:19]
    v_add_u32 v11, 16384, v4
    global_load_dwordx4 v[84:87], v11, s[18:19]
    v_add_u32 v11, 32768, v4
    global_load_dwordx4 v[88:91], v11, s[18:19]
    v_add_u32 v11, 49152, v4
    global_load_dwordx4 v[92:95], v11, s[18:19]
    s_barrier
    ds_read_b64_tr_b16 v[136:137], v6 offset:16384
    ds_read_b64_tr_b16 v[138:139], v6 offset:17408
    ds_read_b64_tr_b16 v[140:141], v6 offset:24576
    ds_read_b64_tr_b16 v[142:143], v6 offset:25600
    ds_read_b64_tr_b16 v[200:201], v7 offset:16384
    ds_read_b64_tr_b16 v[202:203], v7 offset:17408
    ds_read_b64_tr_b16 v[204:205], v7 offset:24576
    ds_read_b64_tr_b16 v[206:207], v7 offset:25600
    s_waitcnt lgkmcnt(0)
    s_waitcnt vmcnt(16)
    ds_write_b128 v5, v[16:19] offset:0
    ds_write_b128 v5, v[20:23] offset:4096
    ds_write_b128 v5, v[24:27] offset:8192
    ds_write_b128 v5, v[28:31] offset:12288
    s_waitcnt lgkmcnt(0)
    v_add_u32 v11, 65536, v4
    global_load_dwordx4 v[16:19], v11, s[18:19]
    v_add_u32 v11, 81920, v4
    global_load_dwordx4 v[20:23], v11, s[18:19]
    v_add_u32 v11, 98304, v4
    global_load_dwordx4 v[24:27], v11, s[18:19]
    v_add_u32 v11, 114688, v4
    global_load_dwordx4 v[28:31], v11, s[18:19]
    s_barrier
    ds_read_b64_tr_b16 v[144:145], v6 offset:0
    ds_read_b64_tr_b16 v[146:147], v6 offset:1024
    ds_read_b64_tr_b16 v[148:149], v6 offset:8192
    ds_read_b64_tr_b16 v[150:151], v6 offset:9216
    ds_read_b64_tr_b16 v[208:209], v7 offset:0
    ds_read_b64_tr_b16 v[210:211], v7 offset:1024
    ds_read_b64_tr_b16 v[212:213], v7 offset:8192
    ds_read_b64_tr_b16 v[214:215], v7 offset:9216
    s_waitcnt lgkmcnt(0)
    s_waitcnt vmcnt(16)
    ds_write_b128 v5, v[32:35] offset:16384
    ds_write_b128 v5, v[36:39] offset:20480
    ds_write_b128 v5, v[40:43] offset:24576
    ds_write_b128 v5, v[44:47] offset:28672
    s_waitcnt lgkmcnt(0)
    v_add_u32 v11, 131072, v4
    global_load_dwordx4 v[32:35], v11, s[18:19]
    v_add_u32 v11, 147456, v4
    global_load_dwordx4 v[36:39], v11, s[18:19]
    v_add_u32 v11, 163840, v4
    global_load_dwordx4 v[40:43], v11, s[18:19]
    v_add_u32 v11, 180224, v4
    global_load_dwordx4 v[44:47], v11, s[18:19]
    s_barrier
    ds_read_b64_tr_b16 v[152:153], v6 offset:16384
    ds_read_b64_tr_b16 v[154:155], v6 offset:17408
    ds_read_b64_tr_b16 v[156:157], v6 offset:24576
    ds_read_b64_tr_b16 v[158:159], v6 offset:25600
    ds_read_b64_tr_b16 v[216:217], v7 offset:16384
    ds_read_b64_tr_b16 v[218:219], v7 offset:17408
    ds_read_b64_tr_b16 v[220:221], v7 offset:24576
    ds_read_b64_tr_b16 v[222:223], v7 offset:25600
    s_waitcnt lgkmcnt(0)
    s_waitcnt vmcnt(16)
    ds_write_b128 v5, v[48:51] offset:0
    ds_write_b128 v5, v[52:55] offset:4096
    ds_write_b128 v5, v[56:59] offset:8192
    ds_write_b128 v5, v[60:63] offset:12288
    s_waitcnt lgkmcnt(0)
    v_add_u32 v11, 196608, v4
    global_load_dwordx4 v[48:51], v11, s[18:19]
    v_add_u32 v11, 212992, v4
    global_load_dwordx4 v[52:55], v11, s[18:19]
    v_add_u32 v11, 229376, v4
    global_load_dwordx4 v[56:59], v11, s[18:19]
    v_add_u32 v11, 245760, v4
    global_load_dwordx4 v[60:63], v11, s[18:19]
    s_barrier
    ds_read_b64_tr_b16 v[160:161], v6 offset:0
    ds_read_b64_tr_b16 v[162:163], v6 offset:1024
    ds_read_b64_tr_b16 v[164:165], v6 offset:8192
    ds_read_b64_tr_b16 v[166:167], v6 offset:9216
    ds_read_b64_tr_b16 v[224:225], v7 offset:0
    ds_read_b64_tr_b16 v[226:227], v7 offset:1024
    ds_read_b64_tr_b16 v[228:229], v7 offset:8192
    ds_read_b64_tr_b16 v[230:231], v7 offset:9216
    s_waitcnt lgkmcnt(0)
    s_waitcnt vmcnt(16)
    ds_write_b128 v5, v[64:67] offset:16384
    ds_write_b128 v5, v[68:71] offset:20480
    ds_write_b128 v5, v[72:75] offset:24576
    ds_write_b128 v5, v[76:79] offset:28672
    s_waitcnt lgkmcnt(0)
    v_add_u32 v11, 262144, v4
    global_load_dwordx4 v[64:67], v11, s[18:19]
    v_add_u32 v11, 278528, v4
    global_load_dwordx4 v[68:71], v11, s[18:19]
    v_add_u32 v11, 294912, v4
    global_load_dwordx4 v[72:75], v11, s[18:19]
    v_add_u32 v11, 311296, v4
    global_load_dwordx4 v[76:79], v11, s[18:19]
    s_barrier
    ds_read_b64_tr_b16 v[168:169], v6 offset:16384
    ds_read_b64_tr_b16 v[170:171], v6 offset:17408
    ds_read_b64_tr_b16 v[172:173], v6 offset:24576
    ds_read_b64_tr_b16 v[174:175], v6 offset:25600
    ds_read_b64_tr_b16 v[232:233], v7 offset:16384
    ds_read_b64_tr_b16 v[234:235], v7 offset:17408
    ds_read_b64_tr_b16 v[236:237], v7 offset:24576
    ds_read_b64_tr_b16 v[238:239], v7 offset:25600
    s_waitcnt lgkmcnt(0)
    s_waitcnt vmcnt(16)
    ds_write_b128 v5, v[80:83] offset:0
    ds_write_b128 v5, v[84:87] offset:4096
    ds_write_b128 v5, v[88:91] offset:8192
    ds_write_b128 v5, v[92:95] offset:12288
    s_waitcnt lgkmcnt(0)
    v_add_u32 v11, 327680, v4
    global_load_dwordx4 v[80:83], v11, s[18:19]
    v_add_u32 v11, 344064, v4
    global_load_dwordx4 v[84:87], v11, s[18:19]
    v_add_u32 v11, 360448, v4
    global_load_dwordx4 v[88:91], v11, s[18:19]
    v_add_u32 v11, 376832, v4
    global_load_dwordx4 v[92:95], v11, s[18:19]
    s_barrier
    ds_read_b64_tr_b16 a[184:185], v13 offset:0
    ds_read_b64_tr_b16 a[186:187], v13 offset:1024
    ds_read_b64_tr_b16 a[188:189], v13 offset:8192
    ds_read_b64_tr_b16 a[190:191], v13 offset:9216
    ds_read_b64_tr_b16 a[248:249], v14 offset:0
    ds_read_b64_tr_b16 a[250:251], v14 offset:1024
    ds_read_b64_tr_b16 a[252:253], v14 offset:8192
    ds_read_b64_tr_b16 a[254:255], v14 offset:9216
    s_waitcnt lgkmcnt(0)
    s_cmp_lg_u32 s9, 0
    s_cbranch_scc1 L_rd_39
    v_lshlrev_b32 v1, 2, v0
    v_mov_b32 v2, 0
    global_atomic_add v105, v1, v2, s[10:11] sc0 sc1
    s_nop 0
L_rd_39:
    s_waitcnt vmcnt(16)
    ds_write_b128 v5, v[16:19] offset:16384
    ds_write_b128 v5, v[20:23] offset:20480
    ds_write_b128 v5, v[24:27] offset:24576
    ds_write_b128 v5, v[28:31] offset:28672
    s_waitcnt lgkmcnt(0)
    v_add_u32 v11, 393216, v4
    global_load_dwordx4 v[16:19], v11, s[18:19]
    v_add_u32 v11, 409600, v4
    global_load_dwordx4 v[20:23], v11, s[18:19]
    v_add_u32 v11, 425984, v4
    global_load_dwordx4 v[24:27], v11, s[18:19]
    v_add_u32 v11, 442368, v4
    global_load_dwordx4 v[28:31], v11, s[18:19]
    s_barrier
    ds_read_b64_tr_b16 a[192:193], v13 offset:16384
    ds_read_b64_tr_b16 a[194:195], v13 offset:17408
    ds_read_b64_tr_b16 a[196:197], v13 offset:24576
    ds_read_b64_tr_b16 a[198:199], v13 offset:25600
    ds_read_b64_tr_b16 v[96:97], v14 offset:16384
    ds_read_b64_tr_b16 v[98:99], v14 offset:17408
    ds_read_b64_tr_b16 v[100:101], v14 offset:24576
    ds_read_b64_tr_b16 v[102:103], v14 offset:25600
    s_waitcnt lgkmcnt(0)
    ds_write_b128 v8, v[96:99] offset:14336
    ds_write_b128 v8, v[100:103] offset:15360
    s_waitcnt lgkmcnt(0)
    s_waitcnt vmcnt(16)
    ds_write_b128 v5, v[32:35] offset:0
    ds_write_b128 v5, v[36:39] offset:4096
    ds_write_b128 v5, v[40:43] offset:8192
    ds_write_b128 v5, v[44:47] offset:12288
    s_waitcnt lgkmcnt(0)
    v_add_u32 v11, 458752, v4
    global_load_dwordx4 v[32:35], v11, s[18:19]
    v_add_u32 v11, 475136, v4
    global_load_dwordx4 v[36:39], v11, s[18:19]
    v_add_u32 v11, 491520, v4
    global_load_dwordx4 v[40:43], v11, s[18:19]
    v_add_u32 v11, 507904, v4
    global_load_dwordx4 v[44:47], v11, s[18:19]
    s_barrier
    ds_read_b64_tr_b16 a[200:201], v13 offset:0
    ds_read_b64_tr_b16 a[202:203], v13 offset:1024
    ds_read_b64_tr_b16 a[204:205], v13 offset:8192
    ds_read_b64_tr_b16 a[206:207], v13 offset:9216
    ds_read_b64_tr_b16 v[96:97], v14 offset:0
    ds_read_b64_tr_b16 v[98:99], v14 offset:1024
    ds_read_b64_tr_b16 v[100:101], v14 offset:8192
    ds_read_b64_tr_b16 v[102:103], v14 offset:9216
    s_waitcnt lgkmcnt(0)
    ds_write_b128 v8, v[96:99] offset:16384
    ds_write_b128 v8, v[100:103] offset:17408
    s_waitcnt lgkmcnt(0)
    s_waitcnt vmcnt(16)
    ds_write_b128 v5, v[48:51] offset:16384
    ds_write_b128 v5, v[52:55] offset:20480
    ds_write_b128 v5, v[56:59] offset:24576
    ds_write_b128 v5, v[60:63] offset:28672
    s_waitcnt lgkmcnt(0)
    s_barrier
    ds_read_b64_tr_b16 a[208:209], v13 offset:16384
    ds_read_b64_tr_b16 a[210:211], v13 offset:17408
    ds_read_b64_tr_b16 a[212:213], v13 offset:24576
    ds_read_b64_tr_b16 a[214:215], v13 offset:25600
    ds_read_b64_tr_b16 v[96:97], v14 offset:16384
    ds_read_b64_tr_b16 v[98:99], v14 offset:17408
    ds_read_b64_tr_b16 v[100:101], v14 offset:24576
    ds_read_b64_tr_b16 v[102:103], v14 offset:25600
    s_waitcnt lgkmcnt(0)
    ds_write_b128 v8, v[96:99] offset:18432
    ds_write_b128 v8, v[100:103] offset:19456
    s_waitcnt lgkmcnt(0)
    s_waitcnt vmcnt(12)
    ds_write_b128 v5, v[64:67] offset:0
    ds_write_b128 v5, v[68:71] offset:4096
    ds_write_b128 v5, v[72:75] offset:8192
    ds_write_b128 v5, v[76:79] offset:12288
    s_waitcnt lgkmcnt(0)
    s_barrier
    ds_read_b64_tr_b16 a[216:217], v13 offset:0
    ds_read_b64_tr_b16 a[218:219], v13 offset:1024
    ds_read_b64_tr_b16 a[220:221], v13 offset:8192
    ds_read_b64_tr_b16 a[222:223], v13 offset:9216
    ds_read_b64_tr_b16 v[96:97], v14 offset:0
    ds_read_b64_tr_b16 v[98:99], v14 offset:1024
    ds_read_b64_tr_b16 v[100:101], v14 offset:8192
    ds_read_b64_tr_b16 v[102:103], v14 offset:9216
    s_waitcnt lgkmcnt(0)
    ds_write_b128 v8, v[96:99] offset:20480
    ds_write_b128 v8, v[100:103] offset:21504
    s_waitcnt lgkmcnt(0)
    s_waitcnt vmcnt(8)
    ds_write_b128 v5, v[80:83] offset:16384
    ds_write_b128 v5, v[84:87] offset:20480
    ds_write_b128 v5, v[88:91] offset:24576
    ds_write_b128 v5, v[92:95] offset:28672
    s_waitcnt lgkmcnt(0)
    s_barrier
    ds_read_b64_tr_b16 a[224:225], v13 offset:16384
    ds_read_b64_tr_b16 a[226:227], v13 offset:17408
    ds_read_b64_tr_b16 a[228:229], v13 offset:24576
    ds_read_b64_tr_b16 a[230:231], v13 offset:25600
    ds_read_b64_tr_b16 v[96:97], v14 offset:16384
    ds_read_b64_tr_b16 v[98:99], v14 offset:17408
    ds_read_b64_tr_b16 v[100:101], v14 offset:24576
    ds_read_b64_tr_b16 v[102:103], v14 offset:25600
    s_waitcnt lgkmcnt(0)
    ds_write_b128 v8, v[96:99] offset:22528
    ds_write_b128 v8, v[100:103] offset:23552
    s_waitcnt lgkmcnt(0)
    s_waitcnt vmcnt(4)
    ds_write_b128 v5, v[16:19] offset:0
    ds_write_b128 v5, v[20:23] offset:4096
    ds_write_b128 v5, v[24:27] offset:8192
    ds_write_b128 v5, v[28:31] offset:12288
    s_waitcnt lgkmcnt(0)
    s_barrier
    ds_read_b64_tr_b16 a[232:233], v13 offset:0
    ds_read_b64_tr_b16 a[234:235], v13 offset:1024
    ds_read_b64_tr_b16 a[236:237], v13 offset:8192
    ds_read_b64_tr_b16 a[238:239], v13 offset:9216
    ds_read_b64_tr_b16 v[96:97], v14 offset:0
    ds_read_b64_tr_b16 v[98:99], v14 offset:1024
    ds_read_b64_tr_b16 v[100:101], v14 offset:8192
    ds_read_b64_tr_b16 v[102:103], v14 offset:9216
    s_waitcnt lgkmcnt(0)
    ds_write_b128 v8, v[96:99] offset:24576
    ds_write_b128 v8, v[100:103] offset:25600
    s_waitcnt lgkmcnt(0)
    s_waitcnt vmcnt(0)
    ds_write_b128 v5, v[32:35] offset:16384
    ds_write_b128 v5, v[36:39] offset:20480
    ds_write_b128 v5, v[40:43] offset:24576
    ds_write_b128 v5, v[44:47] offset:28672
    s_waitcnt lgkmcnt(0)
    s_barrier
    ds_read_b64_tr_b16 a[240:241], v13 offset:16384
    ds_read_b64_tr_b16 a[242:243], v13 offset:17408
    ds_read_b64_tr_b16 a[244:245], v13 offset:24576
    ds_read_b64_tr_b16 a[246:247], v13 offset:25600
    ds_read_b64_tr_b16 v[96:97], v14 offset:16384
    ds_read_b64_tr_b16 v[98:99], v14 offset:17408
    ds_read_b64_tr_b16 v[100:101], v14 offset:24576
    ds_read_b64_tr_b16 v[102:103], v14 offset:25600
    s_waitcnt lgkmcnt(0)
    ds_write_b128 v8, v[96:99] offset:26624
    ds_write_b128 v8, v[100:103] offset:27648
    s_waitcnt lgkmcnt(0)
    s_cmp_lg_u32 s9, 0
    s_cbranch_scc1 L_ev_40
    s_waitcnt vmcnt(0)
    v_readlane_b32 s38, v104, 8
    v_cmp_eq_u32 vcc, 32, v105
    s_add_u32 s39, s6, 16
    s_lshl_b64 s[12:13], 1, s39
    s_or_b32 s12, s12, 255
    s_or_b32 s13, s13, 1
    v_mov_b32 v1, 161792
    s_nop 1
    s_andn2_b64 s[12:13], s[12:13], vcc
    s_cselect_b32 s39, 1, 0
    s_cmp_lg_u32 s38, 256
    s_cselect_b32 s39, 1, s39
    v_mov_b32 v2, s39
    ds_write_b32 v1, v2
    s_waitcnt lgkmcnt(0)
L_ev_40:
    s_barrier
    v_mov_b32 v16, 161792
    ds_read_b32 v17, v16
    s_waitcnt lgkmcnt(0)
    v_readfirstlane_b32 s38, v17
    s_barrier
    s_cmp_eq_u32 s38, 0
    s_nop 2
    s_cbranch_scc1 L_go_41
    s_cmp_lg_u32 s9, 0
    s_cbranch_scc1 L_wg_42
    v_and_b32 v16, 15, v0
    v_lshlrev_b32 v16, 2, v16
    v_mov_b32 v17, 0
    s_mov_b32 s41, 2097152
    s_mov_b64 exec, 0x1ff
L_wgp_43:
    global_atomic_add v18, v16, v17, s[10:11] sc0 sc1
    s_waitcnt vmcnt(0)
    v_readlane_b32 s38, v18, 8
    s_sub_u32 s41, s41, 1
    s_cmp_eq_u32 s41, 0
    s_nop 2
    s_cbranch_scc1 L_end_36
    s_cmp_lt_u32 s38, 256
    s_cbranch_scc1 L_wgp_43
    global_atomic_add v18, v16, v17, s[10:11] sc0 sc1
    s_waitcnt vmcnt(0)
    s_mov_b64 exec, 0xff
    v_cmp_ne_u32 vcc, 32, v18
    s_mov_b64 exec, -1
    s_nop 0
    v_mov_b32 v18, vcc_lo
    v_mov_b32 v16, 161792
    ds_write_b32 v16, v18
    s_waitcnt lgkmcnt(0)
L_wg_42:
    s_barrier
    v_mov_b32 v16, 161792
    ds_read_b32 v18, v16
    s_waitcnt lgkmcnt(0)
    v_readfirstlane_b32 s38, v18
    s_barrier
    s_cmp_lg_u32 s38, 0
    s_nop 2
    s_cbranch_scc1 L_safe_far_x
    s_lshl_b32 s39, s6, 2
    s_add_u32 s39, s39, 64
    v_mov_b32 v17, s39
    s_mov_b32 s41, 2097152
    s_nop 0
L_dw_44:
    global_load_dword v18, v17, s[10:11] sc1
    s_waitcnt vmcnt(0)
    v_readfirstlane_b32 s38, v18
    s_sub_u32 s41, s41, 1
    s_cmp_eq_u32 s41, 0
    s_nop 2
    s_cbranch_scc1 L_end_36
    s_cmp_lt_u32 s38, 32
    s_cbranch_scc1 L_dw_44
    v_mov_b32 v17, 128
    s_mov_b32 s41, 2097152
    s_nop 0
L_dw_45:
    global_load_dword v18, v17, s[10:11] sc1
    s_waitcnt vmcnt(0)
    v_readfirstlane_b32 s38, v18
    s_sub_u32 s41, s41, 1
    s_cmp_eq_u32 s41, 0
    s_nop 2
    s_cbranch_scc1 L_end_36
    s_cmp_lt_u32 s38, 32
    s_cbranch_scc1 L_dw_45
L_go_41:
    v_and_b32 v16, 63, v0
    v_lshlrev_b32 v1, 4, v16
    v_and_b32 v17, 15, v16
    v_lshrrev_b32 v18, 4, v16
    v_lshrrev_b32 v19, 5, v16
    v_and_b32 v20, 31, v16
    v_xor_b32 v20, v20, v19
    s_and_b32 s38, s9, 1
    s_lshl_b32 s38, s38, 3
    v_xor_b32 v20, s38, v20
    v_lshlrev_b32 v20, 4, v20
    v_lshl_add_u32 v20, v19, 10, v20
    s_lshl_b32 s38, s9, 13
    v_add_u32 v2, s38, v20
    v_xor_b32 v19, v17, v18
    v_lshlrev_b32 v19, 4, v19
    v_lshl_add_u32 v19, v17, 9, v19
    v_add_u32 v3, 114688, v19
    v_xor_b32 v4, 64, v3
    v_xor_b32 v5, 128, v3
    v_xor_b32 v6, 192, v3
    v_add_u32 v7, 114688, v1
    s_mul_i32 s38, s9, 28672
    v_add_u32 v8, s38, v1
    s_lshl_b32 s38, s9, 12
    v_add_u32 v9, s38, v1
    s_add_u32 s46, s38, 114688
    v_mul_u32_u24 v11, 35072, v18
    v_lshl_add_u32 v11, v17, 3, v11
    s_mul_i32 s38, s26, 2176
    s_lshl_b32 s39, s27, 9
    s_add_u32 s38, s38, s39
    s_lshl_b32 s39, s9, 7
    s_add_u32 s38, s38, s39
    v_add_u32 v11, s38, v11
    v_add_u32 v12, 17536, v11
    v_mov_b32 v13, -1
    v_mov_b32 v14, 0
    s_mov_b32 s23, -2
    s_mov_b32 s25, 0
    s_mov_b32 s59, 0
    s_add_u32 s56, s20, 984064
    s_addc_u32 s57, s21, 0
    s_add_u32 s100, s20, 984064
    s_addc_u32 s101, s21, 0
L_xw_46:
    s_mul_i32 s62, s23, 5
    s_add_u32 s62, s62, s22
    s_sub_u32 s63, s62, 15
    s_sub_u32 s12, s62, 5
    s_add_u32 s13, s62, 10
    s_add_u32 s14, s62, 5
    s_add_u32 s15, s63, 5
    s_bfe_u32 s36, s23, 0x10001
    s_xor_b32 s36, s36, 1
    s_and_b32 s38, s23, 1
    s_lshl_b32 s61, s38, 19
    s_add_u32 s61, s61, 1048576
    s_mul_i32 s37, s38, 589824
    s_add_u32 s37, s37, 2097152
    s_min_u32 s38, s62, s63
    s_cmp_ge_u32 s38, 64
    s_cbranch_scc1 L_g_47
    s_bitcmp1_b32 s25, 2
    s_cbranch_scc1 L_ka_48
    s_cmp_ge_u32 s62, 64
    s_cbranch_scc1 L_ka_48
    s_waitcnt vmcnt(0)
    s_barrier
    s_min_u32 s38, s62, 127
    s_lshl_b32 s38, s38, 19
    s_lshl_b32 s39, s7, 14
    s_add_u32 s38, s38, s39
    s_add_u32 s54, s4, s38
    s_addc_u32 s55, s5, 0
    s_add_u32 m0, s46, 0
    s_nop 0
    global_load_lds_dwordx4 v9, s[54:55] offset:0 sc1
    global_load_lds_dwordx4 v9, s[54:55] offset:1024 sc1
    global_load_lds_dwordx4 v9, s[54:55] offset:2048 sc1
    global_load_lds_dwordx4 v9, s[54:55] offset:3072 sc1
L_ka_48:
    s_bitcmp1_b32 s25, 3
    s_cbranch_scc1 L_ka_49
    s_cmp_ge_u32 s63, 64
    s_cbranch_scc1 L_ka_49
    s_waitcnt vmcnt(0)
    s_barrier
    s_min_u32 s38, s63, 127
    s_lshl_b32 s38, s38, 19
    s_lshl_b32 s39, s7, 14
    s_add_u32 s38, s38, s39
    s_add_u32 s38, s38, 33554432
    s_add_u32 s54, s4, s38
    s_addc_u32 s55, s5, 0
    s_add_u32 m0, s46, 32768
    s_nop 0
    global_load_lds_dwordx4 v9, s[54:55] offset:0 sc1
    global_load_lds_dwordx4 v9, s[54:55] offset:1024 sc1
    global_load_lds_dwordx4 v9, s[54:55] offset:2048 sc1
    global_load_lds_dwordx4 v9, s[54:55] offset:3072 sc1
L_ka_49:
    s_lshr_b32 s40, s9, 1
    s_cmp_eq_u32 s40, 0
    s_cselect_b32 s24, s62, s63
    s_cmp_ge_u32 s24, 64
    s_cbranch_scc1 L_as_50
    s_lshl_b32 s60, s40, 6
    s_add_u32 s60, s60, s24
    s_min_u32 s38, s60, 127
    s_lshl_b32 s38, s38, 18
    s_lshl_b32 s39, s7, 13
    s_add_u32 s38, s38, s39
    s_add_u32 s38, s38, 67108864
    s_add_u32 s30, s4, s38
    s_addc_u32 s31, s5, 0
    s_min_u32 s38, s60, 127
    s_lshl_b32 s38, s38, 17
    s_lshl_b32 s39, s7, 12
    s_add_u32 s38, s38, s39
    s_add_u32 s38, s38, 100663296
    s_add_u32 s34, s4, s38
    s_addc_u32 s35, s5, 0
    v_lshrrev_b32 v16, 4, v1
    v_lshrrev_b32 v18, 4, v16
    v_and_b32 v19, 7, v16
    v_lshlrev_b32 v19, 4, v19
    v_lshl_add_u32 v19, v18, 7, v19
    global_load_dwordx4 v[80:83], v19, s[34:35] offset:0 sc1
    global_load_dwordx4 v[84:87], v19, s[34:35] offset:512 sc1
    global_load_dwordx4 v[88:91], v19, s[34:35] offset:1024 sc1
    global_load_dwordx4 v[92:95], v19, s[34:35] offset:1536 sc1
    s_and_b32 s38, s9, 1
    s_lshl_b32 s39, s38, 12
    v_add_u32 v23, s39, v1
    global_load_dwordx4 v[64:67], v23, s[30:31] offset:0 sc1
    global_load_dwordx4 v[68:71], v23, s[30:31] offset:1024 sc1
    global_load_dwordx4 v[72:75], v23, s[30:31] offset:2048 sc1
    global_load_dwordx4 v[76:79], v23, s[30:31] offset:3072 sc1
    v_and_b32 v17, 15, v16
    s_lshl_b32 s39, s38, 4
    v_add_u32 v21, s39, v17
    v_lshlrev_b32 v24, 2, v18
    v_sub_u32 v21, v21, v24
    s_lshl_b32 s40, s40, 15
    v_add_u32 v61, s40, v7
    v_lshrrev_b32 v60, 3, v17
    v_lshlrev_b32 v60, 10, v60
    v_lshl_add_u32 v60, v18, 8, v60
    v_bfe_u32 v24, v17, 2, 1
    v_lshl_add_u32 v60, v24, 7, v60
    v_and_b32 v24, 3, v17
    v_lshl_add_u32 v60, v24, 4, v60
    s_add_u32 s40, s40, 122880
    v_add_u32 v60, s40, v60
    v_lshrrev_b32 v20, 2, v17
    v_lshlrev_b32 v20, 7, v20
    v_lshl_add_u32 v20, v24, 4, v20
    v_and_b32 v24, 1, v18
    v_lshl_add_u32 v20, v24, 3, v20
    v_add_u32 v62, 2048, v20
    v_mov_b32 v22, 0xff800000
    v_cmp_gt_u32 vcc, 2, v18
    s_nop 1
    v_cndmask_b32 v48, v22, v14, vcc
    v_cndmask_b32 v49, v22, v14, vcc
    v_cndmask_b32 v50, v22, v14, vcc
    v_cndmask_b32 v51, v22, v14, vcc
    v_cmp_le_i32 vcc, 0, v21
    s_nop 1
    v_cndmask_b32 v52, v22, v14, vcc
    v_cmp_le_i32 vcc, 1, v21
    s_nop 1
    v_cndmask_b32 v53, v22, v14, vcc
    v_cmp_le_i32 vcc, 2, v21
    s_nop 1
    v_cndmask_b32 v54, v22, v14, vcc
    v_cmp_le_i32 vcc, 3, v21
    s_nop 1
    v_cndmask_b32 v55, v22, v14, vcc
    v_cmp_le_i32 vcc, 16, v21
    s_nop 1
    v_cndmask_b32 v56, v22, v14, vcc
    v_cmp_le_i32 vcc, 17, v21
    s_nop 1
    v_cndmask_b32 v57, v22, v14, vcc
    v_cmp_le_i32 vcc, 18, v21
    s_nop 1
    v_cndmask_b32 v58, v22, v14, vcc
    v_cmp_le_i32 vcc, 19, v21
    s_nop 1
    v_cndmask_b32 v59, v22, v14, vcc
    v_mov_b32 v63, v19
    s_waitcnt vmcnt(0)
    s_barrier
    s_bitcmp1_b32 s59, 0
    s_cselect_b64 exec, 1, 0
    global_store_dword v14, v13, s[56:57] sc1
    s_mov_b64 exec, -1
    s_bitset0_b32 s59, 0
    ds_read_b128 v[16:19], v61 offset:0
    ds_read_b128 v[32:35], v61 offset:4096
    ds_read_b128 v[20:23], v61 offset:1024
    ds_read_b128 v[36:39], v61 offset:5120
    ds_read_b128 v[24:27], v61 offset:2048
    ds_read_b128 v[40:43], v61 offset:6144
    ds_read_b128 v[28:31], v61 offset:3072
    ds_read_b128 v[44:47], v61 offset:7168
    s_waitcnt lgkmcnt(6)
    v_mfma_f32_16x16x32_bf16 v[52:55], v[16:19], v[64:67], v[52:55]
    v_mfma_f32_16x16x32_bf16 v[56:59], v[32:35], v[64:67], v[56:59]
    s_waitcnt lgkmcnt(4)
    v_mfma_f32_16x16x32_bf16 v[52:55], v[20:23], v[68:71], v[52:55]
    v_mfma_f32_16x16x32_bf16 v[56:59], v[36:39], v[68:71], v[56:59]
    s_waitcnt lgkmcnt(2)
    v_mfma_f32_16x16x32_bf16 v[52:55], v[24:27], v[72:75], v[52:55]
    v_mfma_f32_16x16x32_bf16 v[56:59], v[40:43], v[72:75], v[56:59]
    s_waitcnt lgkmcnt(0)
    v_mfma_f32_16x16x32_bf16 v[52:55], v[28:31], v[76:79], v[52:55]
    v_mfma_f32_16x16x32_bf16 v[56:59], v[44:47], v[76:79], v[56:59]
    ds_read_b128 v[16:19], v60 offset:0
    ds_read_b128 v[20:23], v60 offset:64
    ds_read_b128 v[24:27], v60 offset:2048
    ds_read_b128 v[28:31], v60 offset:2112
    ds_read_b128 v[32:35], v60 offset:4096
    ds_read_b128 v[36:39], v60 offset:4160
    ds_read_b128 v[40:43], v60 offset:6144
    ds_read_b128 v[44:47], v60 offset:6208
    s_mov_b32 s41, 2097152
L_fw_52:
    v_max3_u32 v60, v80, v81, v82
    v_max3_u32 v61, v83, v84, v85
    v_max3_u32 v60, v60, v86, v87
    v_max3_u32 v61, v61, v88, v89
    v_max3_u32 v60, v60, v90, v91
    v_max3_u32 v61, v61, v92, v93
    v_max3_u32 v60, v60, v94, v95
    v_max_u32 v60, v60, v61
    v_cmp_eq_u32 vcc, -1, v60
    s_nop 4
    s_cbranch_vccz L_fg_53
    s_mov_b64 exec, vcc
    global_load_dwordx4 v[80:83], v63, s[34:35] offset:0 sc1
    global_load_dwordx4 v[84:87], v63, s[34:35] offset:512 sc1
    global_load_dwordx4 v[88:91], v63, s[34:35] offset:1024 sc1
    global_load_dwordx4 v[92:95], v63, s[34:35] offset:1536 sc1
    s_mov_b64 exec, -1
    s_sub_u32 s41, s41, 1
    s_cmp_eq_u32 s41, 0
    s_cbranch_scc1 L_end_36
    s_waitcnt vmcnt(0)
    s_branch L_fw_52
L_fg_53:
    global_load_dwordx2 v[96:97], v62, s[34:35] offset:0 sc1
    global_load_dwordx2 v[98:99], v62, s[34:35] offset:64 sc1
    global_load_dwordx2 v[100:101], v62, s[34:35] offset:512 sc1
    global_load_dwordx2 v[102:103], v62, s[34:35] offset:576 sc1
    global_load_dwordx2 v[104:105], v62, s[34:35] offset:1024 sc1
    global_load_dwordx2 v[106:107], v62, s[34:35] offset:1088 sc1
    global_load_dwordx2 v[108:109], v62, s[34:35] offset:1536 sc1
    global_load_dwordx2 v[110:111], v62, s[34:35] offset:1600 sc1
    v_mfma_f32_16x16x32_bf16 v[48:51], v[80:83], v[64:67], v[48:51]
    v_mfma_f32_16x16x32_bf16 v[48:51], v[84:87], v[68:71], v[48:51]
    v_mfma_f32_16x16x32_bf16 v[48:51], v[88:91], v[72:75], v[48:51]
    v_mfma_f32_16x16x32_bf16 v[48:51], v[92:95], v[76:79], v[48:51]
    v_max3_f32 v60, v52, v53, v54
    v_max3_f32 v61, v55, v56, v57
    v_max3_f32 v60, v60, v58, v59
    v_max_f32 v60, v60, v61
    s_nop 3
    v_max3_f32 v80, v60, v48, v49
    v_max3_f32 v80, v80, v50, v51
    v_mov_b32 v81, v80
    s_nop 1
    v_permlane16_swap_b32 v81, v80
    v_max_f32 v80, v80, v81
    v_mov_b32 v81, v80
    s_nop 1
    v_permlane32_swap_b32 v81, v80
    v_max_f32 v80, v80, v81
    v_mul_f32 v80, s44, v80
    v_pk_fma_f32 v[48:49], v[48:49], s[44:45], v[80:81] op_sel_hi:[1,1,0] neg_lo:[0,0,1] neg_hi:[0,0,1]
    v_pk_fma_f32 v[50:51], v[50:51], s[44:45], v[80:81] op_sel_hi:[1,1,0] neg_lo:[0,0,1] neg_hi:[0,0,1]
    v_pk_fma_f32 v[52:53], v[52:53], s[44:45], v[80:81] op_sel_hi:[1,1,0] neg_lo:[0,0,1] neg_hi:[0,0,1]
    v_pk_fma_f32 v[54:55], v[54:55], s[44:45], v[80:81] op_sel_hi:[1,1,0] neg_lo:[0,0,1] neg_hi:[0,0,1]
    v_pk_fma_f32 v[56:57], v[56:57], s[44:45], v[80:81] op_sel_hi:[1,1,0] neg_lo:[0,0,1] neg_hi:[0,0,1]
    v_pk_fma_f32 v[58:59], v[58:59], s[44:45], v[80:81] op_sel_hi:[1,1,0] neg_lo:[0,0,1] neg_hi:[0,0,1]
    v_exp_f32 v48, v48
    v_exp_f32 v49, v49
    v_exp_f32 v50, v50
    v_exp_f32 v51, v51
    v_exp_f32 v52, v52
    v_exp_f32 v53, v53
    v_exp_f32 v54, v54
    v_exp_f32 v55, v55
    v_exp_f32 v56, v56
    v_exp_f32 v57, v57
    v_exp_f32 v58, v58
    v_exp_f32 v59, v59
    v_pk_add_f32 v[80:81], v[48:49], v[50:51]
    v_pk_add_f32 v[82:83], v[52:53], v[54:55]
    v_pk_add_f32 v[84:85], v[56:57], v[58:59]
    v_pk_add_f32 v[80:81], v[80:81], v[82:83]
    v_pk_add_f32 v[80:81], v[80:81], v[84:85]
    v_add_f32 v80, v80, v81
    v_mov_b32 v81, v80
    s_nop 1
    v_permlane16_swap_b32 v81, v80
    v_add_f32 v80, v80, v81
    v_mov_b32 v81, v80
    s_nop 1
    v_permlane32_swap_b32 v81, v80
    v_add_f32 v80, v80, v81
    v_rcp_f32 v80, v80
    s_nop 0
    v_pk_mul_f32 v[48:49], v[48:49], v[80:81] op_sel_hi:[1,0]
    v_pk_mul_f32 v[50:51], v[50:51], v[80:81] op_sel_hi:[1,0]
    v_pk_mul_f32 v[52:53], v[52:53], v[80:81] op_sel_hi:[1,0]
    v_pk_mul_f32 v[54:55], v[54:55], v[80:81] op_sel_hi:[1,0]
    v_pk_mul_f32 v[56:57], v[56:57], v[80:81] op_sel_hi:[1,0]
    v_pk_mul_f32 v[58:59], v[58:59], v[80:81] op_sel_hi:[1,0]
    v_cvt_pk_bf16_f32 v48, v48, v49
    v_cvt_pk_bf16_f32 v49, v50, v51
    v_cvt_pk_bf16_f32 v52, v52, v53
    v_cvt_pk_bf16_f32 v53, v54, v55
    v_cvt_pk_bf16_f32 v54, v56, v57
    v_cvt_pk_bf16_f32 v55, v58, v59
    s_waitcnt lgkmcnt(0)
    s_nop 0
    v_mfma_f32_16x16x32_bf16 v[64:67], v[16:19], v[52:55], 0
    v_mfma_f32_16x16x32_bf16 v[68:71], v[20:23], v[52:55], 0
    v_mfma_f32_16x16x32_bf16 v[72:75], v[24:27], v[52:55], 0
    v_mfma_f32_16x16x32_bf16 v[76:79], v[28:31], v[52:55], 0
    v_mfma_f32_16x16x32_bf16 v[80:83], v[32:35], v[52:55], 0
    v_mfma_f32_16x16x32_bf16 v[84:87], v[36:39], v[52:55], 0
    v_mfma_f32_16x16x32_bf16 v[88:91], v[40:43], v[52:55], 0
    v_mfma_f32_16x16x32_bf16 v[92:95], v[44:47], v[52:55], 0
    s_mov_b32 s41, 2097152
    s_nop 6
L_vw_54:
    s_waitcnt vmcnt(0)
    v_max3_u32 v60, v96, v97, v98
    v_max3_u32 v61, v99, v100, v101
    v_max3_u32 v60, v60, v102, v103
    v_max3_u32 v61, v61, v104, v105
    v_max3_u32 v60, v60, v106, v107
    v_max3_u32 v61, v61, v108, v109
    v_max3_u32 v60, v60, v110, v111
    v_max_u32 v60, v60, v61
    v_cmp_eq_u32 vcc, -1, v60
    s_nop 4
    s_cbranch_vccz L_vg_55
    s_mov_b64 exec, vcc
    global_load_dwordx2 v[96:97], v62, s[34:35] offset:0 sc1
    global_load_dwordx2 v[98:99], v62, s[34:35] offset:64 sc1
    global_load_dwordx2 v[100:101], v62, s[34:35] offset:512 sc1
    global_load_dwordx2 v[102:103], v62, s[34:35] offset:576 sc1
    global_load_dwordx2 v[104:105], v62, s[34:35] offset:1024 sc1
    global_load_dwordx2 v[106:107], v62, s[34:35] offset:1088 sc1
    global_load_dwordx2 v[108:109], v62, s[34:35] offset:1536 sc1
    global_load_dwordx2 v[110:111], v62, s[34:35] offset:1600 sc1
    s_mov_b64 exec, -1
    s_sub_u32 s41, s41, 1
    s_cmp_eq_u32 s41, 0
    s_cbranch_scc1 L_end_36
    s_branch L_vw_54
L_vg_55:
    s_lshl_b32 s38, s7, 13
    s_and_b32 s39, s9, 1
    s_lshl_b32 s39, s39, 12
    s_add_u32 s38, s38, s39
    s_lshr_b32 s39, s9, 1
    s_lshl_b32 s39, s39, 18
    s_add_u32 s38, s38, s39
    s_add_u32 s38, s38, s61
    s_add_u32 s28, s20, s38
    s_addc_u32 s29, s21, 0
    v_mfma_f32_16x16x16_bf16 v[64:67], v[96:97], v[48:49], v[64:67]
    v_mfma_f32_16x16x16_bf16 v[68:71], v[98:99], v[48:49], v[68:71]
    v_mfma_f32_16x16x16_bf16 v[72:75], v[100:101], v[48:49], v[72:75]
    v_mfma_f32_16x16x16_bf16 v[76:79], v[102:103], v[48:49], v[76:79]
    v_mfma_f32_16x16x16_bf16 v[80:83], v[104:105], v[48:49], v[80:83]
    s_nop 3
    v_cvt_pk_bf16_f32 v64, v64, v65
    v_cvt_pk_bf16_f32 v65, v66, v67
    v_cvt_pk_bf16_f32 v66, v68, v69
    v_cvt_pk_bf16_f32 v67, v70, v71
    global_store_dwordx4 v1, v[64:67], s[28:29] offset:0
    v_mfma_f32_16x16x16_bf16 v[84:87], v[106:107], v[48:49], v[84:87]
    v_mfma_f32_16x16x16_bf16 v[88:91], v[108:109], v[48:49], v[88:91]
    v_cvt_pk_bf16_f32 v72, v72, v73
    v_cvt_pk_bf16_f32 v73, v74, v75
    v_cvt_pk_bf16_f32 v74, v76, v77
    v_cvt_pk_bf16_f32 v75, v78, v79
    global_store_dwordx4 v1, v[72:75], s[28:29] offset:1024
    v_mfma_f32_16x16x16_bf16 v[92:95], v[110:111], v[48:49], v[92:95]
    v_cvt_pk_bf16_f32 v80, v80, v81
    v_cvt_pk_bf16_f32 v81, v82, v83
    v_cvt_pk_bf16_f32 v82, v84, v85
    v_cvt_pk_bf16_f32 v83, v86, v87
    global_store_dwordx4 v1, v[80:83], s[28:29] offset:2048
    v_cvt_pk_bf16_f32 v88, v88, v89
    v_cvt_pk_bf16_f32 v89, v90, v91
    s_nop 0
    v_cvt_pk_bf16_f32 v90, v92, v93
    v_cvt_pk_bf16_f32 v91, v94, v95
    global_store_dwordx4 v1, v[88:91], s[28:29] offset:3072
    s_nop 1
    s_branch L_ad_51
L_as_50:
    s_waitcnt vmcnt(0)
    s_barrier
    s_bitcmp1_b32 s59, 0
    s_cselect_b64 exec, 1, 0
    global_store_dword v14, v13, s[56:57] sc1
    s_mov_b64 exec, -1
    s_bitset0_b32 s59, 0
L_ad_51:
    s_lshl_b32 s38, s7, 4
    s_lshl_b32 s39, s9, 2
    s_add_u32 s38, s38, s39
    s_add_u32 s38, s38, 983040
    v_mov_b32 v60, s38
    s_add_u32 s40, s23, 1
    v_mov_b32 v61, s40
    s_lshl_b32 s38, s26, 6
    s_add_u32 s38, s38, 983040
    v_bfe_u32 v62, v1, 4, 4
    v_lshlrev_b32 v62, 2, v62
    v_add_u32 v62, s38, v62
    s_waitcnt vmcnt(0)
    s_mov_b64 exec, 1
    global_store_dword v60, v61, s[20:21]
    s_mov_b64 exec, -1
    s_mov_b32 s41, 2097152
L_of_56:
    global_load_dword v63, v62, s[20:21] sc1
    s_sub_u32 s41, s41, 1
    s_cmp_eq_u32 s41, 0
    s_cbranch_scc1 L_end_36
    s_waitcnt vmcnt(0)
    v_cmp_gt_u32 vcc, s40, v63
    s_nop 4
    s_cbranch_vccnz L_of_56
    s_mov_b32 s25, 0
    s_cmp_lt_u32 s62, 64
    s_cbranch_scc1 L_tg_57
    s_sub_u32 s60, s63, 10
    s_lshl_b32 s38, s60, 7
    s_add_u32 s38, s38, 117465088
    v_bfe_u32 v16, v1, 4, 5
    v_lshlrev_b32 v16, 2, v16
    v_add_u32 v16, s38, v16
    s_mov_b32 s41, 2097152
    s_nop 0
L_pf_58:
    global_load_dword v17, v16, s[4:5] sc1
    s_sub_u32 s41, s41, 1
    s_cmp_eq_u32 s41, 0
    s_cbranch_scc1 L_end_36
    s_waitcnt vmcnt(0)
    v_cmp_eq_u32 vcc, 0, v17
    s_nop 4
    s_cbranch_vccnz L_pf_58
    s_lshl_b32 s38, s26, 15
    s_add_u32 s38, s38, s61
    s_add_u32 s38, s38, 278528
    s_add_u32 s54, s20, s38
    s_addc_u32 s55, s21, 0
    s_add_u32 m0, s46, 0
    s_nop 0
    global_load_lds_dwordx4 v9, s[54:55] offset:0 sc1
    global_load_lds_dwordx4 v9, s[54:55] offset:1024 sc1
    global_load_lds_dwordx4 v9, s[54:55] offset:2048 sc1
    global_load_lds_dwordx4 v9, s[54:55] offset:3072 sc1
L_tg_57:
    s_cmp_ge_u32 s62, 64
    s_cbranch_scc1 L_g_59
    s_lshl_b32 s38, s26, 15
    s_add_u32 s38, s38, s61
    s_add_u32 s38, s38, 0
    s_add_u32 s54, s20, s38
    s_addc_u32 s55, s21, 0
    s_add_u32 m0, s46, 0
    s_nop 0
    global_load_lds_dwordx4 v9, s[54:55] offset:0 sc1
    global_load_lds_dwordx4 v9, s[54:55] offset:1024 sc1
    global_load_lds_dwordx4 v9, s[54:55] offset:2048 sc1
    global_load_lds_dwordx4 v9, s[54:55] offset:3072 sc1
    s_lshl_b32 s38, s26, 15
    s_add_u32 s38, s38, s61
    s_add_u32 s38, s38, 16384
    s_add_u32 s54, s20, s38
    s_addc_u32 s55, s21, 0
    s_add_u32 m0, s46, 16384
    s_nop 0
    global_load_lds_dwordx4 v9, s[54:55] offset:0 sc1
    global_load_lds_dwordx4 v9, s[54:55] offset:1024 sc1
    global_load_lds_dwordx4 v9, s[54:55] offset:2048 sc1
    global_load_lds_dwordx4 v9, s[54:55] offset:3072 sc1
L_g_59:
    s_lshl_b32 s38, s26, 15
    s_add_u32 s38, s38, s61
    s_add_u32 s38, s38, 262144
    s_add_u32 s54, s20, s38
    s_addc_u32 s55, s21, 0
    s_add_u32 m0, s46, 32768
    s_nop 0
    global_load_lds_dwordx4 v9, s[54:55] offset:0 sc1
    global_load_lds_dwordx4 v9, s[54:55] offset:1024 sc1
    global_load_lds_dwordx4 v9, s[54:55] offset:2048 sc1
    global_load_lds_dwordx4 v9, s[54:55] offset:3072 sc1
    s_cmp_ge_u32 s62, 64
    s_cbranch_scc1 L_g_60
    s_waitcnt vmcnt(8)
    s_barrier
    ds_read_b128 v[64:67], v7 offset:0
    ds_read_b128 v[68:71], v7 offset:4096
    ds_read_b128 v[72:75], v7 offset:1024
    ds_read_b128 v[76:79], v7 offset:5120
    ds_read_b128 v[80:83], v7 offset:2048
    ds_read_b128 v[84:87], v7 offset:6144
    ds_read_b128 v[96:99], v8 offset:14336
    ds_read_b128 v[100:103], v8 offset:15360
    s_waitcnt lgkmcnt(6)
    v_mfma_f32_16x16x32_bf16 v[16:19], v[64:67], a[184:187], 0
    v_mfma_f32_16x16x32_bf16 v[20:23], v[68:71], a[184:187], 0
    v_mfma_f32_16x16x32_bf16 v[24:27], v[64:67], a[248:251], 0
    v_mfma_f32_16x16x32_bf16 v[28:31], v[68:71], a[248:251], 0
    ds_read_b128 v[64:67], v7 offset:3072
    ds_read_b128 v[68:71], v7 offset:7168
    s_waitcnt lgkmcnt(6)
    v_mfma_f32_16x16x32_bf16 v[16:19], v[72:75], a[188:191], v[16:19]
    v_mfma_f32_16x16x32_bf16 v[20:23], v[76:79], a[188:191], v[20:23]
    v_mfma_f32_16x16x32_bf16 v[24:27], v[72:75], a[252:255], v[24:27]
    v_mfma_f32_16x16x32_bf16 v[28:31], v[76:79], a[252:255], v[28:31]
    ds_read_b128 v[72:75], v7 offset:8192
    ds_read_b128 v[76:79], v7 offset:12288
    ds_read_b128 v[88:91], v8 offset:16384
    ds_read_b128 v[92:95], v8 offset:17408
    s_waitcnt lgkmcnt(8)
    s_waitcnt lgkmcnt(6)
    v_mfma_f32_16x16x32_bf16 v[16:19], v[80:83], a[192:195], v[16:19]
    v_mfma_f32_16x16x32_bf16 v[20:23], v[84:87], a[192:195], v[20:23]
    v_mfma_f32_16x16x32_bf16 v[24:27], v[80:83], v[96:99], v[24:27]
    v_mfma_f32_16x16x32_bf16 v[28:31], v[84:87], v[96:99], v[28:31]
    ds_read_b128 v[80:83], v7 offset:9216
    ds_read_b128 v[84:87], v7 offset:13312
    s_waitcnt lgkmcnt(6)
    v_mfma_f32_16x16x32_bf16 v[16:19], v[64:67], a[196:199], v[16:19]
    v_mfma_f32_16x16x32_bf16 v[20:23], v[68:71], a[196:199], v[20:23]
    v_mfma_f32_16x16x32_bf16 v[24:27], v[64:67], v[100:103], v[24:27]
    v_mfma_f32_16x16x32_bf16 v[28:31], v[68:71], v[100:103], v[28:31]
    ds_read_b128 v[64:67], v7 offset:10240
    ds_read_b128 v[68:71], v7 offset:14336
    ds_read_b128 v[96:99], v8 offset:18432
    ds_read_b128 v[100:103], v8 offset:19456
    s_waitcnt lgkmcnt(8)
    s_waitcnt lgkmcnt(6)
    v_mfma_f32_16x16x32_bf16 v[16:19], v[72:75], a[200:203], v[16:19]
    v_mfma_f32_16x16x32_bf16 v[20:23], v[76:79], a[200:203], v[20:23]
    v_mfma_f32_16x16x32_bf16 v[24:27], v[72:75], v[88:91], v[24:27]
    v_mfma_f32_16x16x32_bf16 v[28:31], v[76:79], v[88:91], v[28:31]
    ds_read_b128 v[72:75], v7 offset:11264
    ds_read_b128 v[76:79], v7 offset:15360
    s_waitcnt lgkmcnt(6)
    v_mfma_f32_16x16x32_bf16 v[16:19], v[80:83], a[204:207], v[16:19]
    v_mfma_f32_16x16x32_bf16 v[20:23], v[84:87], a[204:207], v[20:23]
    v_mfma_f32_16x16x32_bf16 v[24:27], v[80:83], v[92:95], v[24:27]
    v_mfma_f32_16x16x32_bf16 v[28:31], v[84:87], v[92:95], v[28:31]
    ds_read_b128 v[88:91], v8 offset:20480
    ds_read_b128 v[92:95], v8 offset:21504
    s_waitcnt lgkmcnt(6)
    s_waitcnt lgkmcnt(4)
    v_mfma_f32_16x16x32_bf16 v[16:19], v[64:67], a[208:211], v[16:19]
    v_mfma_f32_16x16x32_bf16 v[20:23], v[68:71], a[208:211], v[20:23]
    v_mfma_f32_16x16x32_bf16 v[24:27], v[64:67], v[96:99], v[24:27]
    v_mfma_f32_16x16x32_bf16 v[28:31], v[68:71], v[96:99], v[28:31]
    s_waitcnt lgkmcnt(2)
    s_waitcnt vmcnt(0)
    s_barrier
    ds_read_b128 v[80:83], v7 offset:16384
    ds_read_b128 v[84:87], v7 offset:20480
    ds_read_b128 v[64:67], v7 offset:17408
    ds_read_b128 v[68:71], v7 offset:21504
    v_mfma_f32_16x16x32_bf16 v[16:19], v[72:75], a[212:215], v[16:19]
    s_lshl_b32 s38, s26, 15
    s_add_u32 s38, s38, s61
    s_add_u32 s38, s38, 278528
    s_add_u32 s54, s20, s38
    s_addc_u32 s55, s21, 0
    v_mfma_f32_16x16x32_bf16 v[20:23], v[76:79], a[212:215], v[20:23]
    s_cmp_lt_u32 s63, 64
    s_cselect_b64 s[52:53], -1, 0
    v_mfma_f32_16x16x32_bf16 v[24:27], v[72:75], v[100:103], v[24:27]
    s_add_u32 m0, s46, 0
    v_mfma_f32_16x16x32_bf16 v[28:31], v[76:79], v[100:103], v[28:31]
    s_mov_b64 exec, s[52:53]
    global_load_lds_dwordx4 v9, s[54:55] offset:0 sc1
    s_mov_b64 exec, -1
    ds_read_b128 v[72:75], v7 offset:18432
    ds_read_b128 v[76:79], v7 offset:22528
    ds_read_b128 v[96:99], v8 offset:22528
    ds_read_b128 v[100:103], v8 offset:23552
    s_waitcnt lgkmcnt(6)
    v_mfma_f32_16x16x32_bf16 v[16:19], v[80:83], a[216:219], v[16:19]
    s_mov_b64 exec, s[52:53]
    global_load_lds_dwordx4 v9, s[54:55] offset:1024 sc1
    s_mov_b64 exec, -1
    v_mfma_f32_16x16x32_bf16 v[20:23], v[84:87], a[216:219], v[20:23]
    s_mov_b64 exec, s[52:53]
    global_load_lds_dwordx4 v9, s[54:55] offset:2048 sc1
    s_mov_b64 exec, -1
    v_mfma_f32_16x16x32_bf16 v[24:27], v[80:83], v[88:91], v[24:27]
    s_mov_b64 exec, s[52:53]
    global_load_lds_dwordx4 v9, s[54:55] offset:3072 sc1
    s_mov_b64 exec, -1
    v_mfma_f32_16x16x32_bf16 v[28:31], v[84:87], v[88:91], v[28:31]
    ds_read_b128 v[80:83], v7 offset:19456
    ds_read_b128 v[84:87], v7 offset:23552
    s_waitcnt lgkmcnt(6)
    v_mfma_f32_16x16x32_bf16 v[16:19], v[64:67], a[220:223], v[16:19]
    v_mfma_f32_16x16x32_bf16 v[20:23], v[68:71], a[220:223], v[20:23]
    v_mfma_f32_16x16x32_bf16 v[24:27], v[64:67], v[92:95], v[24:27]
    v_mfma_f32_16x16x32_bf16 v[28:31], v[68:71], v[92:95], v[28:31]
    ds_read_b128 v[64:67], v7 offset:24576
    ds_read_b128 v[68:71], v7 offset:28672
    ds_read_b128 v[88:91], v8 offset:24576
    ds_read_b128 v[92:95], v8 offset:25600
    s_waitcnt lgkmcnt(8)
    s_waitcnt lgkmcnt(6)
    v_mfma_f32_16x16x32_bf16 v[16:19], v[72:75], a[224:227], v[16:19]
    v_mfma_f32_16x16x32_bf16 v[20:23], v[76:79], a[224:227], v[20:23]
    v_mfma_f32_16x16x32_bf16 v[24:27], v[72:75], v[96:99], v[24:27]
    v_mfma_f32_16x16x32_bf16 v[28:31], v[76:79], v[96:99], v[28:31]
    ds_read_b128 v[72:75], v7 offset:25600
    ds_read_b128 v[76:79], v7 offset:29696
    s_waitcnt lgkmcnt(6)
    v_mfma_f32_16x16x32_bf16 v[16:19], v[80:83], a[228:231], v[16:19]
    v_mfma_f32_16x16x32_bf16 v[20:23], v[84:87], a[228:231], v[20:23]
    v_mfma_f32_16x16x32_bf16 v[24:27], v[80:83], v[100:103], v[24:27]
    v_mfma_f32_16x16x32_bf16 v[28:31], v[84:87], v[100:103], v[28:31]
    ds_read_b128 v[80:83], v7 offset:26624
    ds_read_b128 v[84:87], v7 offset:30720
    ds_read_b128 v[96:99], v8 offset:26624
    ds_read_b128 v[100:103], v8 offset:27648
    s_waitcnt lgkmcnt(8)
    s_waitcnt lgkmcnt(6)
    v_mfma_f32_16x16x32_bf16 v[16:19], v[64:67], a[232:235], v[16:19]
    v_mfma_f32_16x16x32_bf16 v[20:23], v[68:71], a[232:235], v[20:23]
    v_mfma_f32_16x16x32_bf16 v[24:27], v[64:67], v[88:91], v[24:27]
    v_mfma_f32_16x16x32_bf16 v[28:31], v[68:71], v[88:91], v[28:31]
    ds_read_b128 v[64:67], v7 offset:27648
    ds_read_b128 v[68:71], v7 offset:31744
    s_waitcnt lgkmcnt(6)
    v_mfma_f32_16x16x32_bf16 v[16:19], v[72:75], a[236:239], v[16:19]
    v_mfma_f32_16x16x32_bf16 v[20:23], v[76:79], a[236:239], v[20:23]
    v_mfma_f32_16x16x32_bf16 v[24:27], v[72:75], v[92:95], v[24:27]
    v_mfma_f32_16x16x32_bf16 v[28:31], v[76:79], v[92:95], v[28:31]
    s_waitcnt lgkmcnt(4)
    s_waitcnt lgkmcnt(2)
    v_mfma_f32_16x16x32_bf16 v[16:19], v[80:83], a[240:243], v[16:19]
    v_mfma_f32_16x16x32_bf16 v[20:23], v[84:87], a[240:243], v[20:23]
    v_mfma_f32_16x16x32_bf16 v[24:27], v[80:83], v[96:99], v[24:27]
    v_mfma_f32_16x16x32_bf16 v[28:31], v[84:87], v[96:99], v[28:31]
    s_waitcnt lgkmcnt(0)
    s_barrier
    v_mfma_f32_16x16x32_bf16 v[16:19], v[64:67], a[244:247], v[16:19]
    v_mfma_f32_16x16x32_bf16 v[20:23], v[68:71], a[244:247], v[20:23]
    v_mfma_f32_16x16x32_bf16 v[24:27], v[64:67], v[100:103], v[24:27]
    v_mfma_f32_16x16x32_bf16 v[28:31], v[68:71], v[100:103], v[28:31]
    s_add_u32 s38, s37, 0
    s_add_u32 s34, s20, s38
    s_addc_u32 s35, s21, 0
    s_add_u32 s32, s34, 140288
    s_addc_u32 s33, s35, 0
    s_sub_u32 s39, s23, 0
    s_bfe_u32 s39, s39, 0x10001
    s_xor_b32 s39, s39, 1
    v_cvt_pk_bf16_f32 v16, v16, v17
    v_cvt_pk_bf16_f32 v17, v24, v25
    v_cvt_pk_bf16_f32 v18, v18, v19
    v_cvt_pk_bf16_f32 v19, v26, v27
    v_and_or_b32 v16, v16, -2, s39
    global_store_dwordx2 v11, v[16:17], s[34:35]
    v_and_or_b32 v18, v18, -2, s39
    global_store_dwordx2 v12, v[18:19], s[34:35]
    v_cvt_pk_bf16_f32 v20, v20, v21
    v_cvt_pk_bf16_f32 v21, v28, v29
    v_cvt_pk_bf16_f32 v22, v22, v23
    v_cvt_pk_bf16_f32 v23, v30, v31
    v_and_or_b32 v20, v20, -2, s39
    global_store_dwordx2 v11, v[20:21], s[32:33]
    v_and_or_b32 v22, v22, -2, s39
    global_store_dwordx2 v12, v[22:23], s[32:33]
    s_nop 0
L_g_60:
    s_cmp_ge_u32 s63, 64
    s_cbranch_scc1 L_g_61
    s_cmp_lt_u32 s62, 64
    s_cbranch_scc1 L_wb_62
    s_waitcnt vmcnt(0)
    s_barrier
L_wb_62:
    v_mov_b32 v10, 0
    s_cmp_ge_u32 s12, 64
    s_nop 0
    s_cbranch_scc1 L_g_63
    s_lshl_b32 s38, s12, 7
    s_lshl_b32 s39, s9, 5
    s_add_u32 s38, s38, s39
    s_add_u32 s38, s38, 117473280
    v_bfe_u32 v15, v1, 4, 3
    v_lshlrev_b32 v15, 2, v15
    v_add_u32 v15, s38, v15
    global_load_dword v10, v15, s[4:5] sc1
    s_nop 0
L_g_63:
    ds_read_b128 v[64:67], v7 offset:32768
    ds_read_b128 v[68:71], v7 offset:36864
    ds_read_b128 v[72:75], v7 offset:33792
    ds_read_b128 v[76:79], v7 offset:37888
    ds_read_b128 v[80:83], v7 offset:34816
    ds_read_b128 v[84:87], v7 offset:38912
    ds_read_b128 v[96:99], v8 offset:14336
    ds_read_b128 v[100:103], v8 offset:15360
    s_waitcnt lgkmcnt(6)
    v_mfma_f32_16x16x32_bf16 v[16:19], v[64:67], a[184:187], 0
    v_mfma_f32_16x16x32_bf16 v[20:23], v[68:71], a[184:187], 0
    v_mfma_f32_16x16x32_bf16 v[24:27], v[64:67], a[248:251], 0
    v_mfma_f32_16x16x32_bf16 v[28:31], v[68:71], a[248:251], 0
    ds_read_b128 v[64:67], v7 offset:35840
    ds_read_b128 v[68:71], v7 offset:39936
    s_waitcnt lgkmcnt(6)
    v_mfma_f32_16x16x32_bf16 v[16:19], v[72:75], a[188:191], v[16:19]
    v_mfma_f32_16x16x32_bf16 v[20:23], v[76:79], a[188:191], v[20:23]
    v_mfma_f32_16x16x32_bf16 v[24:27], v[72:75], a[252:255], v[24:27]
    v_mfma_f32_16x16x32_bf16 v[28:31], v[76:79], a[252:255], v[28:31]
    ds_read_b128 v[72:75], v7 offset:40960
    ds_read_b128 v[76:79], v7 offset:45056
    ds_read_b128 v[88:91], v8 offset:16384
    ds_read_b128 v[92:95], v8 offset:17408
    s_waitcnt lgkmcnt(8)
    s_waitcnt lgkmcnt(6)
    v_mfma_f32_16x16x32_bf16 v[16:19], v[80:83], a[192:195], v[16:19]
    v_mfma_f32_16x16x32_bf16 v[20:23], v[84:87], a[192:195], v[20:23]
    v_mfma_f32_16x16x32_bf16 v[24:27], v[80:83], v[96:99], v[24:27]
    v_mfma_f32_16x16x32_bf16 v[28:31], v[84:87], v[96:99], v[28:31]
    ds_read_b128 v[80:83], v7 offset:41984
    ds_read_b128 v[84:87], v7 offset:46080
    s_waitcnt lgkmcnt(6)
    v_mfma_f32_16x16x32_bf16 v[16:19], v[64:67], a[196:199], v[16:19]
    v_mfma_f32_16x16x32_bf16 v[20:23], v[68:71], a[196:199], v[20:23]
    v_mfma_f32_16x16x32_bf16 v[24:27], v[64:67], v[100:103], v[24:27]
    v_mfma_f32_16x16x32_bf16 v[28:31], v[68:71], v[100:103], v[28:31]
    ds_read_b128 v[64:67], v7 offset:43008
    ds_read_b128 v[68:71], v7 offset:47104
    ds_read_b128 v[96:99], v8 offset:18432
    ds_read_b128 v[100:103], v8 offset:19456
    s_waitcnt lgkmcnt(8)
    s_waitcnt lgkmcnt(6)
    v_mfma_f32_16x16x32_bf16 v[16:19], v[72:75], a[200:203], v[16:19]
    v_mfma_f32_16x16x32_bf16 v[20:23], v[76:79], a[200:203], v[20:23]
    v_mfma_f32_16x16x32_bf16 v[24:27], v[72:75], v[88:91], v[24:27]
    v_mfma_f32_16x16x32_bf16 v[28:31], v[76:79], v[88:91], v[28:31]
    ds_read_b128 v[72:75], v7 offset:44032
    ds_read_b128 v[76:79], v7 offset:48128
    s_waitcnt lgkmcnt(6)
    v_mfma_f32_16x16x32_bf16 v[16:19], v[80:83], a[204:207], v[16:19]
    v_mfma_f32_16x16x32_bf16 v[20:23], v[84:87], a[204:207], v[20:23]
    v_mfma_f32_16x16x32_bf16 v[24:27], v[80:83], v[92:95], v[24:27]
    v_mfma_f32_16x16x32_bf16 v[28:31], v[84:87], v[92:95], v[28:31]
    ds_read_b128 v[88:91], v8 offset:20480
    ds_read_b128 v[92:95], v8 offset:21504
    s_waitcnt lgkmcnt(6)
    s_waitcnt lgkmcnt(4)
    v_mfma_f32_16x16x32_bf16 v[16:19], v[64:67], a[208:211], v[16:19]
    v_mfma_f32_16x16x32_bf16 v[20:23], v[68:71], a[208:211], v[20:23]
    v_mfma_f32_16x16x32_bf16 v[24:27], v[64:67], v[96:99], v[24:27]
    v_mfma_f32_16x16x32_bf16 v[28:31], v[68:71], v[96:99], v[28:31]
    s_waitcnt lgkmcnt(2)
    s_waitcnt vmcnt(0)
    s_barrier
    ds_read_b128 v[80:83], v7 offset:0
    ds_read_b128 v[84:87], v7 offset:4096
    ds_read_b128 v[64:67], v7 offset:1024
    ds_read_b128 v[68:71], v7 offset:5120
    v_mfma_f32_16x16x32_bf16 v[16:19], v[72:75], a[212:215], v[16:19]
    v_cmp_eq_u32 vcc, 0, v10
    v_mfma_f32_16x16x32_bf16 v[20:23], v[76:79], a[212:215], v[20:23]
    s_min_u32 s38, s12, 127
    s_lshl_b32 s38, s38, 15
    s_add_u32 s38, s38, 127926272
    s_add_u32 s16, s4, s38
    s_addc_u32 s17, s5, 0
    v_mfma_f32_16x16x32_bf16 v[24:27], v[72:75], v[100:103], v[24:27]
    s_cmp_eq_u64 vcc, 0
    s_cselect_b32 s38, 1, 0
    s_or_b32 s25, s25, s38
    v_mfma_f32_16x16x32_bf16 v[28:31], v[76:79], v[100:103], v[28:31]
    s_bitcmp1_b32 s25, 0
    s_cselect_b64 s[52:53], -1, 0
    ds_read_b128 v[72:75], v7 offset:2048
    ds_read_b128 v[76:79], v7 offset:6144
    ds_read_b128 v[96:99], v8 offset:22528
    ds_read_b128 v[100:103], v8 offset:23552
    s_waitcnt lgkmcnt(6)
    v_mfma_f32_16x16x32_bf16 v[16:19], v[80:83], a[216:219], v[16:19]
    s_add_u32 m0, s46, 16384
    v_mfma_f32_16x16x32_bf16 v[20:23], v[84:87], a[216:219], v[20:23]
    s_mov_b64 exec, s[52:53]
    global_load_lds_dwordx4 v2, s[16:17] offset:0 sc1
    s_mov_b64 exec, -1
    v_mfma_f32_16x16x32_bf16 v[24:27], v[80:83], v[88:91], v[24:27]
    s_add_u32 m0, s46, 17408
    v_xor_b32 v105, 2080, v2
    v_mfma_f32_16x16x32_bf16 v[28:31], v[84:87], v[88:91], v[28:31]
    s_mov_b64 exec, s[52:53]
    global_load_lds_dwordx4 v105, s[16:17] offset:0 sc1
    s_mov_b64 exec, -1
    ds_read_b128 v[80:83], v7 offset:3072
    ds_read_b128 v[84:87], v7 offset:7168
    s_waitcnt lgkmcnt(6)
    v_mfma_f32_16x16x32_bf16 v[16:19], v[64:67], a[220:223], v[16:19]
    s_add_u32 m0, s46, 18432
    v_xor_b32 v106, 4160, v2
    v_mfma_f32_16x16x32_bf16 v[20:23], v[68:71], a[220:223], v[20:23]
    s_mov_b64 exec, s[52:53]
    global_load_lds_dwordx4 v106, s[16:17] offset:0 sc1
    s_mov_b64 exec, -1
    v_mfma_f32_16x16x32_bf16 v[24:27], v[64:67], v[92:95], v[24:27]
    s_add_u32 m0, s46, 19456
    v_xor_b32 v107, 6240, v2
    v_mfma_f32_16x16x32_bf16 v[28:31], v[68:71], v[92:95], v[28:31]
    s_mov_b64 exec, s[52:53]
    global_load_lds_dwordx4 v107, s[16:17] offset:0 sc1
    s_mov_b64 exec, -1
    ds_read_b128 v[64:67], v7 offset:8192
    ds_read_b128 v[68:71], v7 offset:12288
    ds_read_b128 v[88:91], v8 offset:24576
    ds_read_b128 v[92:95], v8 offset:25600
    s_waitcnt lgkmcnt(8)
    s_waitcnt lgkmcnt(6)
    v_mfma_f32_16x16x32_bf16 v[16:19], v[72:75], a[224:227], v[16:19]
    s_add_u32 m0, s46, 32256
    v_mfma_f32_16x16x32_bf16 v[20:23], v[76:79], a[224:227], v[20:23]
    s_mov_b64 exec, s[52:53]
    global_load_lds_dwordx4 v2, s[16:17] offset:512 sc1
    s_mov_b64 exec, -1
    v_mfma_f32_16x16x32_bf16 v[24:27], v[72:75], v[96:99], v[24:27]
    s_add_u32 m0, s46, 33280
    v_xor_b32 v105, 2080, v2
    v_mfma_f32_16x16x32_bf16 v[28:31], v[76:79], v[96:99], v[28:31]
    s_mov_b64 exec, s[52:53]
    global_load_lds_dwordx4 v105, s[16:17] offset:512 sc1
    s_mov_b64 exec, -1
    ds_read_b128 v[72:75], v7 offset:9216
    ds_read_b128 v[76:79], v7 offset:13312
    s_waitcnt lgkmcnt(6)
    v_mfma_f32_16x16x32_bf16 v[16:19], v[80:83], a[228:231], v[16:19]
    s_add_u32 m0, s46, 34304
    v_xor_b32 v106, 4160, v2
    v_mfma_f32_16x16x32_bf16 v[20:23], v[84:87], a[228:231], v[20:23]
    s_mov_b64 exec, s[52:53]
    global_load_lds_dwordx4 v106, s[16:17] offset:512 sc1
    s_mov_b64 exec, -1
    v_mfma_f32_16x16x32_bf16 v[24:27], v[80:83], v[100:103], v[24:27]
    s_add_u32 m0, s46, 35328
    v_xor_b32 v107, 6240, v2
    v_mfma_f32_16x16x32_bf16 v[28:31], v[84:87], v[100:103], v[28:31]
    s_mov_b64 exec, s[52:53]
    global_load_lds_dwordx4 v107, s[16:17] offset:512 sc1
    s_mov_b64 exec, -1
    ds_read_b128 v[80:83], v7 offset:10240
    ds_read_b128 v[84:87], v7 offset:14336
    ds_read_b128 v[96:99], v8 offset:26624
    ds_read_b128 v[100:103], v8 offset:27648
    s_waitcnt lgkmcnt(8)
    s_waitcnt lgkmcnt(6)
    v_mfma_f32_16x16x32_bf16 v[16:19], v[64:67], a[232:235], v[16:19]
    v_mfma_f32_16x16x32_bf16 v[20:23], v[68:71], a[232:235], v[20:23]
    v_mfma_f32_16x16x32_bf16 v[24:27], v[64:67], v[88:91], v[24:27]
    v_mfma_f32_16x16x32_bf16 v[28:31], v[68:71], v[88:91], v[28:31]
    ds_read_b128 v[64:67], v7 offset:11264
    ds_read_b128 v[68:71], v7 offset:15360
    s_waitcnt lgkmcnt(6)
    v_mfma_f32_16x16x32_bf16 v[16:19], v[72:75], a[236:239], v[16:19]
    v_mfma_f32_16x16x32_bf16 v[20:23], v[76:79], a[236:239], v[20:23]
    v_mfma_f32_16x16x32_bf16 v[24:27], v[72:75], v[92:95], v[24:27]
    v_mfma_f32_16x16x32_bf16 v[28:31], v[76:79], v[92:95], v[28:31]
    s_waitcnt lgkmcnt(4)
    s_waitcnt lgkmcnt(2)
    v_mfma_f32_16x16x32_bf16 v[16:19], v[80:83], a[240:243], v[16:19]
    v_mfma_f32_16x16x32_bf16 v[20:23], v[84:87], a[240:243], v[20:23]
    v_mfma_f32_16x16x32_bf16 v[24:27], v[80:83], v[96:99], v[24:27]
    v_mfma_f32_16x16x32_bf16 v[28:31], v[84:87], v[96:99], v[28:31]
    s_waitcnt lgkmcnt(0)
    s_barrier
    v_mfma_f32_16x16x32_bf16 v[16:19], v[64:67], a[244:247], v[16:19]
    v_mfma_f32_16x16x32_bf16 v[20:23], v[68:71], a[244:247], v[20:23]
    v_mfma_f32_16x16x32_bf16 v[24:27], v[64:67], v[100:103], v[24:27]
    v_mfma_f32_16x16x32_bf16 v[28:31], v[68:71], v[100:103], v[28:31]
    s_add_u32 s38, s37, 294912
    s_add_u32 s34, s20, s38
    s_addc_u32 s35, s21, 0
    s_add_u32 s32, s34, 140288
    s_addc_u32 s33, s35, 0
    s_sub_u32 s39, s23, 3
    s_bfe_u32 s39, s39, 0x10001
    s_xor_b32 s39, s39, 1
    v_cvt_pk_bf16_f32 v16, v16, v17
    v_cvt_pk_bf16_f32 v17, v24, v25
    v_cvt_pk_bf16_f32 v18, v18, v19
    v_cvt_pk_bf16_f32 v19, v26, v27
    v_and_or_b32 v16, v16, -2, s39
    global_store_dwordx2 v11, v[16:17], s[34:35]
    v_and_or_b32 v18, v18, -2, s39
    global_store_dwordx2 v12, v[18:19], s[34:35]
    v_cvt_pk_bf16_f32 v20, v20, v21
    v_cvt_pk_bf16_f32 v21, v28, v29
    v_cvt_pk_bf16_f32 v22, v22, v23
    v_cvt_pk_bf16_f32 v23, v30, v31
    v_and_or_b32 v20, v20, -2, s39
    global_store_dwordx2 v11, v[20:21], s[32:33]
    v_and_or_b32 v22, v22, -2, s39
    global_store_dwordx2 v12, v[22:23], s[32:33]
    s_nop 0
L_g_61:
    s_lshr_b32 s40, s7, 4
    s_cmp_eq_u32 s40, 0
    s_cselect_b32 s24, s62, s63
    s_cmp_ge_u32 s24, 64
    s_cbranch_scc1 L_rd_64
    s_and_b32 s60, s7, 15
    s_mul_i32 s38, s60, 17536
    s_mul_i32 s39, s40, 294912
    s_add_u32 s38, s38, s39
    s_lshl_b32 s39, s9, 9
    s_add_u32 s38, s38, s39
    s_add_u32 s38, s38, s37
    s_add_u32 s28, s20, s38
    s_addc_u32 s29, s21, 0
    v_lshrrev_b32 v49, 1, v1
    v_add_u32 v50, 4352, v49
    v_add_u32 v51, 8704, v49
    v_add_u32 v52, 13056, v49
    global_load_dwordx2 v[32:33], v49, s[28:29] offset:0 sc1
    global_load_dwordx2 v[34:35], v49, s[28:29] offset:2176 sc1
    global_load_dwordx2 v[36:37], v50, s[28:29] offset:0 sc1
    global_load_dwordx2 v[38:39], v50, s[28:29] offset:2176 sc1
    global_load_dwordx2 v[40:41], v51, s[28:29] offset:0 sc1
    global_load_dwordx2 v[42:43], v51, s[28:29] offset:2176 sc1
    global_load_dwordx2 v[44:45], v52, s[28:29] offset:0 sc1
    global_load_dwordx2 v[46:47], v52, s[28:29] offset:2176 sc1
    s_lshl_b32 s60, s60, 1
    s_and_b32 s38, s9, 1
    s_add_u32 s60, s60, s38
    s_lshl_b32 s38, s24, 5
    s_add_u32 s60, s60, s38
    s_lshl_b32 s38, s60, 10
    s_add_u32 s30, s4, s38
    s_addc_u32 s31, s5, 0
    s_add_u32 s32, s50, s38
    s_addc_u32 s33, s51, 0
    s_add_u32 s34, s30, 130023424
    s_addc_u32 s35, s31, 0
    s_cmp_eq_u32 s40, 0
    s_cselect_b64 s[32:33], s[32:33], s[34:35]
    global_load_dwordx4 v[60:63], v1, s[32:33] sc1
    s_lshl_b32 s38, s40, 21
    s_add_u32 s30, s30, s38
    s_addc_u32 s31, s31, 0
    s_lshl_b32 s38, s40, 13
    s_lshl_b32 s39, s60, 2
    s_add_u32 s38, s38, s39
    s_add_u32 s38, s38, 117456896
    s_add_u32 s100, s4, s38
    s_addc_u32 s101, s5, 0
    v_lshrrev_b32 v48, 6, v1
    v_lshlrev_b32 v48, 5, v48
    v_bfe_u32 v64, v1, 4, 2
    v_lshl_add_u32 v48, v64, 2, v48
    s_lshl_b32 s38, s9, 9
    s_add_u32 s38, s38, 114688
    v_add_u32 v48, s38, v48
    s_lshl_b32 s38, s9, 11
    s_add_u32 s38, s38, 114688
    v_lshl_add_u32 v56, v1, 1, s38
    s_mul_i32 s40, s40, 3
    s_sub_u32 s40, s23, s40
    s_bfe_u32 s40, s40, 0x10001
    s_xor_b32 s40, s40, 1
    s_sub_u32 s40, 0, s40
    s_mov_b32 s41, 2097152
L_rp_66:
    s_waitcnt vmcnt(0)
    v_bitop3_b32 v64, v32, v34, s40 bitop3:0x7e
    v_bitop3_b32 v65, v36, v38, s40 bitop3:0x7e
    v_bitop3_b32 v66, v40, v42, s40 bitop3:0x7e
    v_bitop3_b32 v67, v44, v46, s40 bitop3:0x7e
    v_or3_b32 v64, v64, v65, v66
    v_bitop3_b32 v64, v64, v67, 1 bitop3:0xa8
    v_cmp_ne_u32 vcc, 0, v64
    s_nop 4
    s_cbranch_vccz L_rg_67
    s_mov_b64 exec, vcc
    global_load_dwordx2 v[32:33], v49, s[28:29] offset:0 sc1
    global_load_dwordx2 v[34:35], v49, s[28:29] offset:2176 sc1
    global_load_dwordx2 v[36:37], v50, s[28:29] offset:0 sc1
    global_load_dwordx2 v[38:39], v50, s[28:29] offset:2176 sc1
    global_load_dwordx2 v[40:41], v51, s[28:29] offset:0 sc1
    global_load_dwordx2 v[42:43], v51, s[28:29] offset:2176 sc1
    global_load_dwordx2 v[44:45], v52, s[28:29] offset:0 sc1
    global_load_dwordx2 v[46:47], v52, s[28:29] offset:2176 sc1
    s_mov_b64 exec, -1
    s_sub_u32 s41, s41, 1
    s_cmp_eq_u32 s41, 0
    s_cbranch_scc1 L_end_36
    s_branch L_rp_66
L_rg_67:
    v_lshlrev_b32 v16, 16, v32
    v_and_b32 v17, 0xffff0000, v32
    v_lshlrev_b32 v18, 16, v33
    v_and_b32 v19, 0xffff0000, v33
    v_lshlrev_b32 v20, 16, v34
    v_and_b32 v21, 0xffff0000, v34
    v_lshlrev_b32 v22, 16, v35
    v_and_b32 v23, 0xffff0000, v35
    v_lshlrev_b32 v24, 16, v36
    v_and_b32 v25, 0xffff0000, v36
    v_lshlrev_b32 v26, 16, v37
    v_and_b32 v27, 0xffff0000, v37
    v_lshlrev_b32 v28, 16, v38
    v_and_b32 v29, 0xffff0000, v38
    v_lshlrev_b32 v30, 16, v39
    v_and_b32 v31, 0xffff0000, v39
    v_lshlrev_b32 v32, 16, v40
    v_and_b32 v33, 0xffff0000, v40
    v_lshlrev_b32 v34, 16, v41
    v_and_b32 v35, 0xffff0000, v41
    v_lshlrev_b32 v36, 16, v42
    v_and_b32 v37, 0xffff0000, v42
    v_lshlrev_b32 v38, 16, v43
    v_and_b32 v39, 0xffff0000, v43
    v_pk_add_f32 v[16:17], v[16:17], v[32:33]
    v_pk_add_f32 v[18:19], v[18:19], v[34:35]
    v_pk_add_f32 v[20:21], v[20:21], v[36:37]
    v_pk_add_f32 v[22:23], v[22:23], v[38:39]
    v_lshlrev_b32 v32, 16, v44
    v_and_b32 v33, 0xffff0000, v44
    v_lshlrev_b32 v34, 16, v45
    v_and_b32 v35, 0xffff0000, v45
    v_lshlrev_b32 v36, 16, v46
    v_and_b32 v37, 0xffff0000, v46
    v_lshlrev_b32 v38, 16, v47
    v_and_b32 v39, 0xffff0000, v47
    v_pk_add_f32 v[24:25], v[24:25], v[32:33]
    v_pk_add_f32 v[26:27], v[26:27], v[34:35]
    v_pk_add_f32 v[28:29], v[28:29], v[36:37]
    v_pk_add_f32 v[30:31], v[30:31], v[38:39]
    v_pk_add_f32 v[16:17], v[16:17], v[24:25]
    v_pk_add_f32 v[18:19], v[18:19], v[26:27]
    v_pk_add_f32 v[20:21], v[20:21], v[28:29]
    v_pk_add_f32 v[22:23], v[22:23], v[30:31]
    v_pk_add_f32 v[16:17], v[16:17], v[20:21]
    v_pk_add_f32 v[18:19], v[18:19], v[22:23]
    ds_write2_b32 v48, v16, v18 offset0:0 offset1:4
    v_add_u32 v49, 2048, v48
    ds_write2_b32 v49, v17, v19 offset0:0 offset1:4
    s_waitcnt lgkmcnt(0)
    s_barrier
    s_cmp_ge_u32 s9, 2
    s_cbranch_scc1 L_re_65
    ds_read_b128 v[16:19], v56
    ds_read_b128 v[20:23], v56 offset:16
    s_waitcnt lgkmcnt(0)
    v_cvt_pk_bf16_f32 v40, v16, v17
    v_cvt_pk_bf16_f32 v41, v18, v19
    v_cvt_pk_bf16_f32 v42, v20, v21
    v_cvt_pk_bf16_f32 v43, v22, v23
    v_lshlrev_b32 v16, 16, v40
    v_and_b32 v17, 0xffff0000, v40
    v_lshlrev_b32 v18, 16, v41
    v_and_b32 v19, 0xffff0000, v41
    v_lshlrev_b32 v20, 16, v42
    v_and_b32 v21, 0xffff0000, v42
    v_lshlrev_b32 v22, 16, v43
    v_and_b32 v23, 0xffff0000, v43
    v_lshlrev_b32 v24, 16, v60
    v_and_b32 v25, 0xffff0000, v60
    v_lshlrev_b32 v26, 16, v61
    v_and_b32 v27, 0xffff0000, v61
    v_lshlrev_b32 v28, 16, v62
    v_and_b32 v29, 0xffff0000, v62
    v_lshlrev_b32 v30, 16, v63
    v_and_b32 v31, 0xffff0000, v63
    v_pk_add_f32 v[24:25], v[24:25], v[16:17]
    v_pk_add_f32 v[26:27], v[26:27], v[18:19]
    v_pk_add_f32 v[28:29], v[28:29], v[20:21]
    v_pk_add_f32 v[30:31], v[30:31], v[22:23]
    v_cvt_pk_bf16_f32 v64, v24, v25
    v_cvt_pk_bf16_f32 v65, v26, v27
    v_cvt_pk_bf16_f32 v66, v28, v29
    v_cvt_pk_bf16_f32 v67, v30, v31
    v_add_u32 v48, 123731968, v1
    global_store_dwordx4 v48, v[64:67], s[30:31] sc1
    v_lshlrev_b32 v24, 16, v64
    v_and_b32 v25, 0xffff0000, v64
    v_lshlrev_b32 v26, 16, v65
    v_and_b32 v27, 0xffff0000, v65
    v_lshlrev_b32 v28, 16, v66
    v_and_b32 v29, 0xffff0000, v66
    v_lshlrev_b32 v30, 16, v67
    v_and_b32 v31, 0xffff0000, v67
    v_pk_add_f32 v[32:33], v[24:25], v[26:27]
    v_pk_add_f32 v[34:35], v[28:29], v[30:31]
    v_pk_add_f32 v[32:33], v[32:33], v[34:35]
    v_add_f32 v44, v32, v33
    s_nop 1
    v_add_f32_dpp v45, v44, v44 quad_perm:[1,0,3,2] row_mask:0xf bank_mask:0xf
    s_nop 1
    v_add_f32_dpp v44, v45, v45 quad_perm:[2,3,0,1] row_mask:0xf bank_mask:0xf
    s_nop 1
    v_add_f32_dpp v45, v44, v44 row_half_mirror row_mask:0xf bank_mask:0xf
    s_nop 1
    v_add_f32_dpp v44, v45, v45 row_mirror row_mask:0xf bank_mask:0xf
    v_mov_b32 v45, v44
    s_nop 1
    v_permlane16_swap_b32 v45, v44
    v_add_f32 v44, v44, v45
    v_mov_b32 v45, v44
    s_nop 1
    v_permlane32_swap_b32 v45, v44
    v_add_f32 v44, v44, v45
    v_mul_f32 v44, 0x3b000000, v44
    v_pk_add_f32 v[32:33], v[24:25], v[44:45] op_sel_hi:[1,0] neg_lo:[0,1] neg_hi:[0,1]
    v_pk_add_f32 v[34:35], v[26:27], v[44:45] op_sel_hi:[1,0] neg_lo:[0,1] neg_hi:[0,1]
    v_pk_add_f32 v[36:37], v[28:29], v[44:45] op_sel_hi:[1,0] neg_lo:[0,1] neg_hi:[0,1]
    v_pk_add_f32 v[38:39], v[30:31], v[44:45] op_sel_hi:[1,0] neg_lo:[0,1] neg_hi:[0,1]
    v_pk_mul_f32 v[46:47], v[32:33], v[32:33]
    v_pk_fma_f32 v[46:47], v[34:35], v[34:35], v[46:47]
    v_pk_fma_f32 v[46:47], v[36:37], v[36:37], v[46:47]
    v_pk_fma_f32 v[46:47], v[38:39], v[38:39], v[46:47]
    v_add_f32 v46, v46, v47
    s_nop 1
    v_add_f32_dpp v47, v46, v46 quad_perm:[1,0,3,2] row_mask:0xf bank_mask:0xf
    s_nop 1
    v_add_f32_dpp v46, v47, v47 quad_perm:[2,3,0,1] row_mask:0xf bank_mask:0xf
    s_nop 1
    v_add_f32_dpp v47, v46, v46 row_half_mirror row_mask:0xf bank_mask:0xf
    s_nop 1
    v_add_f32_dpp v46, v47, v47 row_mirror row_mask:0xf bank_mask:0xf
    v_mov_b32 v47, v46
    s_nop 1
    v_permlane16_swap_b32 v47, v46
    v_add_f32 v46, v46, v47
    v_mov_b32 v47, v46
    s_nop 1
    v_permlane32_swap_b32 v47, v46
    v_add_f32 v46, v46, v47
    v_mul_f32 v46, 0x3b000000, v46
    v_cvt_pk_bf16_f32 v44, v44, v44
    v_and_b32 v44, 0xffff0000, v44
    v_cvt_pk_bf16_f32 v46, v46, v46
    v_and_b32 v46, 0xffff0000, v46
    v_add_f32 v46, 0x3727c5ac, v46
    v_cvt_pk_bf16_f32 v46, v46, v46
    v_and_b32 v46, 0xffff0000, v46
    v_sqrt_f32 v46, v46
    s_nop 0
    v_cvt_pk_bf16_f32 v46, v46, v46
    v_and_b32 v46, 0xffff0000, v46
    v_rcp_f32 v46, v46
    v_pk_add_f32 v[32:33], v[24:25], v[44:45] op_sel_hi:[1,0] neg_lo:[0,1] neg_hi:[0,1]
    v_pk_add_f32 v[34:35], v[26:27], v[44:45] op_sel_hi:[1,0] neg_lo:[0,1] neg_hi:[0,1]
    v_pk_add_f32 v[36:37], v[28:29], v[44:45] op_sel_hi:[1,0] neg_lo:[0,1] neg_hi:[0,1]
    v_pk_add_f32 v[38:39], v[30:31], v[44:45] op_sel_hi:[1,0] neg_lo:[0,1] neg_hi:[0,1]
    v_cvt_pk_bf16_f32 v40, v32, v33
    v_cvt_pk_bf16_f32 v41, v34, v35
    v_cvt_pk_bf16_f32 v42, v36, v37
    v_cvt_pk_bf16_f32 v43, v38, v39
    v_lshlrev_b32 v32, 16, v40
    v_and_b32 v33, 0xffff0000, v40
    v_lshlrev_b32 v34, 16, v41
    v_and_b32 v35, 0xffff0000, v41
    v_lshlrev_b32 v36, 16, v42
    v_and_b32 v37, 0xffff0000, v42
    v_lshlrev_b32 v38, 16, v43
    v_and_b32 v39, 0xffff0000, v43
    v_pk_mul_f32 v[32:33], v[32:33], v[46:47] op_sel_hi:[1,0]
    v_pk_mul_f32 v[34:35], v[34:35], v[46:47] op_sel_hi:[1,0]
    v_pk_mul_f32 v[36:37], v[36:37], v[46:47] op_sel_hi:[1,0]
    v_pk_mul_f32 v[38:39], v[38:39], v[46:47] op_sel_hi:[1,0]
    v_cvt_pk_bf16_f32 v40, v32, v33
    v_cvt_pk_bf16_f32 v41, v34, v35
    v_cvt_pk_bf16_f32 v42, v36, v37
    v_cvt_pk_bf16_f32 v43, v38, v39
    v_min_u32 v40, -2, v40
    v_add_u32 v50, 119537664, v1
    global_store_dwordx4 v50, v[40:43], s[30:31] sc1
    s_bitset1_b32 s59, 1
    s_nop 0
    s_branch L_re_65
L_rd_64:
    s_waitcnt vmcnt(0)
L_re_65:
L_g_47:
    s_cmp_ge_u32 s12, 64
    s_cbranch_scc1 L_g_68
    s_bitcmp1_b32 s25, 0
    s_cbranch_scc1 L_q1p_69
    s_lshl_b32 s38, s12, 7
    s_lshl_b32 s39, s9, 5
    s_add_u32 s38, s38, s39
    s_add_u32 s38, s38, 117473280
    v_bfe_u32 v15, v1, 4, 3
    v_lshlrev_b32 v15, 2, v15
    v_add_u32 v15, s38, v15
    s_waitcnt vmcnt(0)
    s_bitcmp1_b32 s59, 1
    s_cselect_b64 exec, 1, 0
    global_store_dword v14, v13, s[100:101] sc1
    s_mov_b64 exec, -1
    s_bitset0_b32 s59, 1
    s_mov_b32 s41, 2097152
L_pf_70:
    global_load_dword v10, v15, s[4:5] sc1
    s_sub_u32 s41, s41, 1
    s_cmp_eq_u32 s41, 0
    s_cbranch_scc1 L_end_36
    s_waitcnt vmcnt(0)
    v_cmp_eq_u32 vcc, 0, v10
    s_nop 4
    s_cbranch_vccnz L_pf_70
    s_min_u32 s38, s12, 127
    s_lshl_b32 s38, s38, 15
    s_add_u32 s38, s38, 127926272
    s_add_u32 s16, s4, s38
    s_addc_u32 s17, s5, 0
    s_add_u32 m0, s46, 16384
    s_nop 0
    global_load_lds_dwordx4 v2, s[16:17] offset:0 sc1
    s_add_u32 m0, s46, 17408
    v_xor_b32 v105, 2080, v2
    global_load_lds_dwordx4 v105, s[16:17] offset:0 sc1
    s_add_u32 m0, s46, 18432
    v_xor_b32 v106, 4160, v2
    global_load_lds_dwordx4 v106, s[16:17] offset:0 sc1
    s_add_u32 m0, s46, 19456
    v_xor_b32 v107, 6240, v2
    global_load_lds_dwordx4 v107, s[16:17] offset:0 sc1
    s_add_u32 m0, s46, 32256
    s_nop 0
    global_load_lds_dwordx4 v2, s[16:17] offset:512 sc1
    s_add_u32 m0, s46, 33280
    v_xor_b32 v105, 2080, v2
    global_load_lds_dwordx4 v105, s[16:17] offset:512 sc1
    s_add_u32 m0, s46, 34304
    v_xor_b32 v106, 4160, v2
    global_load_lds_dwordx4 v106, s[16:17] offset:512 sc1
    s_add_u32 m0, s46, 35328
    v_xor_b32 v107, 6240, v2
    global_load_lds_dwordx4 v107, s[16:17] offset:512 sc1
    s_waitcnt vmcnt(4)
L_q1p_69:
    s_barrier
    s_mov_b32 s24, s12
    ds_read_b128 v[64:67], v3 offset:16384
    ds_read_b128 v[68:71], v3 offset:24576
    ds_read_b128 v[72:75], v4 offset:16384
    ds_read_b128 v[76:79], v4 offset:24576
    ds_read_b128 v[80:83], v5 offset:16384
    ds_read_b128 v[84:87], v5 offset:24576
    ds_read_b128 v[96:99], v8 offset:0
    ds_read_b128 v[100:103], v8 offset:1024
    s_waitcnt lgkmcnt(6)
    v_mfma_f32_16x16x32_bf16 v[16:19], v[112:115], v[64:67], 0
    v_mfma_f32_16x16x32_bf16 v[20:23], v[112:115], v[68:71], 0
    v_mfma_f32_16x16x32_bf16 v[24:27], v[176:179], v[64:67], 0
    v_mfma_f32_16x16x32_bf16 v[28:31], v[176:179], v[68:71], 0
    v_mfma_f32_16x16x32_bf16 v[32:35], v[240:243], v[64:67], 0
    v_mfma_f32_16x16x32_bf16 v[36:39], v[240:243], v[68:71], 0
    v_mfma_f32_16x16x32_bf16 v[40:43], a[48:51], v[64:67], 0
    v_mfma_f32_16x16x32_bf16 v[44:47], a[48:51], v[68:71], 0
    v_mfma_f32_16x16x32_bf16 v[48:51], v[64:67], a[112:115], 0
    v_mfma_f32_16x16x32_bf16 v[52:55], v[68:71], a[112:115], 0
    v_mfma_f32_16x16x32_bf16 v[56:59], v[64:67], a[176:179], 0
    v_mfma_f32_16x16x32_bf16 v[60:63], v[68:71], a[176:179], 0
    ds_read_b128 v[64:67], v6 offset:16384
    ds_read_b128 v[68:71], v6 offset:24576
    s_waitcnt lgkmcnt(6)
    v_mfma_f32_16x16x32_bf16 v[16:19], v[116:119], v[72:75], v[16:19]
    v_mfma_f32_16x16x32_bf16 v[20:23], v[116:119], v[76:79], v[20:23]
    v_mfma_f32_16x16x32_bf16 v[24:27], v[180:183], v[72:75], v[24:27]
    v_mfma_f32_16x16x32_bf16 v[28:31], v[180:183], v[76:79], v[28:31]
    v_mfma_f32_16x16x32_bf16 v[32:35], v[244:247], v[72:75], v[32:35]
    v_mfma_f32_16x16x32_bf16 v[36:39], v[244:247], v[76:79], v[36:39]
    v_mfma_f32_16x16x32_bf16 v[40:43], a[52:55], v[72:75], v[40:43]
    v_mfma_f32_16x16x32_bf16 v[44:47], a[52:55], v[76:79], v[44:47]
    v_mfma_f32_16x16x32_bf16 v[48:51], v[72:75], a[116:119], v[48:51]
    v_mfma_f32_16x16x32_bf16 v[52:55], v[76:79], a[116:119], v[52:55]
    v_mfma_f32_16x16x32_bf16 v[56:59], v[72:75], a[180:183], v[56:59]
    v_mfma_f32_16x16x32_bf16 v[60:63], v[76:79], a[180:183], v[60:63]
    ds_read_b128 v[72:75], v3 offset:16640
    ds_read_b128 v[76:79], v3 offset:24832
    ds_read_b128 v[88:91], v8 offset:2048
    ds_read_b128 v[92:95], v8 offset:3072
    s_waitcnt lgkmcnt(8)
    s_waitcnt lgkmcnt(6)
    v_mfma_f32_16x16x32_bf16 v[16:19], v[120:123], v[80:83], v[16:19]
    v_mfma_f32_16x16x32_bf16 v[20:23], v[120:123], v[84:87], v[20:23]
    v_mfma_f32_16x16x32_bf16 v[24:27], v[184:187], v[80:83], v[24:27]
    v_mfma_f32_16x16x32_bf16 v[28:31], v[184:187], v[84:87], v[28:31]
    v_mfma_f32_16x16x32_bf16 v[32:35], v[248:251], v[80:83], v[32:35]
    v_mfma_f32_16x16x32_bf16 v[36:39], v[248:251], v[84:87], v[36:39]
    v_mfma_f32_16x16x32_bf16 v[40:43], a[56:59], v[80:83], v[40:43]
    v_mfma_f32_16x16x32_bf16 v[44:47], a[56:59], v[84:87], v[44:47]
    v_mfma_f32_16x16x32_bf16 v[48:51], v[80:83], a[120:123], v[48:51]
    v_mfma_f32_16x16x32_bf16 v[52:55], v[84:87], a[120:123], v[52:55]
    v_mfma_f32_16x16x32_bf16 v[56:59], v[80:83], v[96:99], v[56:59]
    v_mfma_f32_16x16x32_bf16 v[60:63], v[84:87], v[96:99], v[60:63]
    ds_read_b128 v[80:83], v4 offset:16640
    ds_read_b128 v[84:87], v4 offset:24832
    s_waitcnt lgkmcnt(6)
    v_mfma_f32_16x16x32_bf16 v[16:19], v[124:127], v[64:67], v[16:19]
    s_waitcnt vmcnt(0)
    v_mfma_f32_16x16x32_bf16 v[20:23], v[124:127], v[68:71], v[20:23]
    s_bitcmp1_b32 s59, 1
    s_cselect_b64 exec, 1, 0
    global_store_dword v14, v13, s[100:101] sc1
    s_mov_b64 exec, -1
    s_bitset0_b32 s59, 1
    v_mfma_f32_16x16x32_bf16 v[24:27], v[188:191], v[64:67], v[24:27]
    s_min_u32 s38, s13, 127
    s_lshl_b32 s38, s38, 15
    s_add_u32 s38, s38, 146800640
    s_add_u32 s16, s4, s38
    s_addc_u32 s17, s5, 0
    v_mfma_f32_16x16x32_bf16 v[28:31], v[188:191], v[68:71], v[28:31]
    s_cmp_lt_u32 s13, 64
    s_cselect_b32 s38, 2, 0
    s_or_b32 s25, s25, s38
    v_mfma_f32_16x16x32_bf16 v[32:35], v[252:255], v[64:67], v[32:35]
    s_bitcmp1_b32 s25, 1
    s_cselect_b64 s[52:53], -1, 0
    v_mfma_f32_16x16x32_bf16 v[36:39], v[252:255], v[68:71], v[36:39]
    s_add_u32 m0, s46, 0
    v_mfma_f32_16x16x32_bf16 v[40:43], a[60:63], v[64:67], v[40:43]
    s_mov_b64 exec, s[52:53]
    global_load_lds_dwordx4 v2, s[16:17] offset:0 sc1
    s_mov_b64 exec, -1
    v_mfma_f32_16x16x32_bf16 v[44:47], a[60:63], v[68:71], v[44:47]
    s_add_u32 m0, s46, 1024
    v_xor_b32 v105, 2080, v2
    v_mfma_f32_16x16x32_bf16 v[48:51], v[64:67], a[124:127], v[48:51]
    s_mov_b64 exec, s[52:53]
    global_load_lds_dwordx4 v105, s[16:17] offset:0 sc1
    s_mov_b64 exec, -1
    v_mfma_f32_16x16x32_bf16 v[52:55], v[68:71], a[124:127], v[52:55]
    s_add_u32 m0, s46, 2048
    v_xor_b32 v106, 4160, v2
    v_mfma_f32_16x16x32_bf16 v[56:59], v[64:67], v[100:103], v[56:59]
    s_mov_b64 exec, s[52:53]
    global_load_lds_dwordx4 v106, s[16:17] offset:0 sc1
    s_mov_b64 exec, -1
    v_mfma_f32_16x16x32_bf16 v[60:63], v[68:71], v[100:103], v[60:63]
    s_add_u32 m0, s46, 3072
    v_xor_b32 v107, 6240, v2
    ds_read_b128 v[64:67], v5 offset:16640
    ds_read_b128 v[68:71], v5 offset:24832
    ds_read_b128 v[96:99], v8 offset:4096
    ds_read_b128 v[100:103], v8 offset:5120
    s_waitcnt lgkmcnt(8)
    s_waitcnt lgkmcnt(6)
    v_mfma_f32_16x16x32_bf16 v[16:19], v[128:131], v[72:75], v[16:19]
    s_mov_b64 exec, s[52:53]
    global_load_lds_dwordx4 v107, s[16:17] offset:0 sc1
    s_mov_b64 exec, -1
    v_mfma_f32_16x16x32_bf16 v[20:23], v[128:131], v[76:79], v[20:23]
    v_mfma_f32_16x16x32_bf16 v[24:27], v[192:195], v[72:75], v[24:27]
    v_mfma_f32_16x16x32_bf16 v[28:31], v[192:195], v[76:79], v[28:31]
    v_mfma_f32_16x16x32_bf16 v[32:35], a[0:3], v[72:75], v[32:35]
    v_mfma_f32_16x16x32_bf16 v[36:39], a[0:3], v[76:79], v[36:39]
    v_mfma_f32_16x16x32_bf16 v[40:43], a[64:67], v[72:75], v[40:43]
    v_mfma_f32_16x16x32_bf16 v[44:47], a[64:67], v[76:79], v[44:47]
    v_mfma_f32_16x16x32_bf16 v[48:51], v[72:75], a[128:131], v[48:51]
    v_mfma_f32_16x16x32_bf16 v[52:55], v[76:79], a[128:131], v[52:55]
    v_mfma_f32_16x16x32_bf16 v[56:59], v[72:75], v[88:91], v[56:59]
    v_mfma_f32_16x16x32_bf16 v[60:63], v[76:79], v[88:91], v[60:63]
    ds_read_b128 v[72:75], v6 offset:16640
    ds_read_b128 v[76:79], v6 offset:24832
    s_waitcnt lgkmcnt(6)
    v_mfma_f32_16x16x32_bf16 v[16:19], v[132:135], v[80:83], v[16:19]
    v_mfma_f32_16x16x32_bf16 v[20:23], v[132:135], v[84:87], v[20:23]
    v_mfma_f32_16x16x32_bf16 v[24:27], v[196:199], v[80:83], v[24:27]
    v_mfma_f32_16x16x32_bf16 v[28:31], v[196:199], v[84:87], v[28:31]
    v_mfma_f32_16x16x32_bf16 v[32:35], a[4:7], v[80:83], v[32:35]
    v_mfma_f32_16x16x32_bf16 v[36:39], a[4:7], v[84:87], v[36:39]
    v_mfma_f32_16x16x32_bf16 v[40:43], a[68:71], v[80:83], v[40:43]
    v_mfma_f32_16x16x32_bf16 v[44:47], a[68:71], v[84:87], v[44:47]
    v_mfma_f32_16x16x32_bf16 v[48:51], v[80:83], a[132:135], v[48:51]
    v_mfma_f32_16x16x32_bf16 v[52:55], v[84:87], a[132:135], v[52:55]
    v_mfma_f32_16x16x32_bf16 v[56:59], v[80:83], v[92:95], v[56:59]
    v_mfma_f32_16x16x32_bf16 v[60:63], v[84:87], v[92:95], v[60:63]
    ds_read_b128 v[88:91], v8 offset:6144
    ds_read_b128 v[92:95], v8 offset:7168
    s_waitcnt lgkmcnt(6)
    s_waitcnt lgkmcnt(4)
    v_mfma_f32_16x16x32_bf16 v[16:19], v[136:139], v[64:67], v[16:19]
    v_mfma_f32_16x16x32_bf16 v[20:23], v[136:139], v[68:71], v[20:23]
    v_mfma_f32_16x16x32_bf16 v[24:27], v[200:203], v[64:67], v[24:27]
    v_mfma_f32_16x16x32_bf16 v[28:31], v[200:203], v[68:71], v[28:31]
    v_mfma_f32_16x16x32_bf16 v[32:35], a[8:11], v[64:67], v[32:35]
    v_mfma_f32_16x16x32_bf16 v[36:39], a[8:11], v[68:71], v[36:39]
    v_mfma_f32_16x16x32_bf16 v[40:43], a[72:75], v[64:67], v[40:43]
    v_mfma_f32_16x16x32_bf16 v[44:47], a[72:75], v[68:71], v[44:47]
    v_mfma_f32_16x16x32_bf16 v[48:51], v[64:67], a[136:139], v[48:51]
    v_mfma_f32_16x16x32_bf16 v[52:55], v[68:71], a[136:139], v[52:55]
    v_mfma_f32_16x16x32_bf16 v[56:59], v[64:67], v[96:99], v[56:59]
    v_mfma_f32_16x16x32_bf16 v[60:63], v[68:71], v[96:99], v[60:63]
    s_waitcnt lgkmcnt(2)
    s_waitcnt vmcnt(0)
    s_barrier
    ds_read_b128 v[80:83], v3 offset:32768
    ds_read_b128 v[84:87], v3 offset:40960
    ds_read_b128 v[64:67], v4 offset:32768
    ds_read_b128 v[68:71], v4 offset:40960
    v_mfma_f32_16x16x32_bf16 v[16:19], v[140:143], v[72:75], v[16:19]
    s_add_u32 m0, s46, 15872
    v_mfma_f32_16x16x32_bf16 v[20:23], v[140:143], v[76:79], v[20:23]
    s_mov_b64 exec, s[52:53]
    global_load_lds_dwordx4 v2, s[16:17] offset:512 sc1
    s_mov_b64 exec, -1
    v_mfma_f32_16x16x32_bf16 v[24:27], v[204:207], v[72:75], v[24:27]
    s_add_u32 m0, s46, 16896
    v_xor_b32 v105, 2080, v2
    v_mfma_f32_16x16x32_bf16 v[28:31], v[204:207], v[76:79], v[28:31]
    s_mov_b64 exec, s[52:53]
    global_load_lds_dwordx4 v105, s[16:17] offset:512 sc1
    s_mov_b64 exec, -1
    v_mfma_f32_16x16x32_bf16 v[32:35], a[12:15], v[72:75], v[32:35]
    s_add_u32 m0, s46, 17920
    v_xor_b32 v106, 4160, v2
    v_mfma_f32_16x16x32_bf16 v[36:39], a[12:15], v[76:79], v[36:39]
    s_mov_b64 exec, s[52:53]
    global_load_lds_dwordx4 v106, s[16:17] offset:512 sc1
    s_mov_b64 exec, -1
    v_mfma_f32_16x16x32_bf16 v[40:43], a[76:79], v[72:75], v[40:43]
    s_add_u32 m0, s46, 18944
    v_xor_b32 v107, 6240, v2
    v_mfma_f32_16x16x32_bf16 v[44:47], a[76:79], v[76:79], v[44:47]
    s_mov_b64 exec, s[52:53]
    global_load_lds_dwordx4 v107, s[16:17] offset:512 sc1
    s_mov_b64 exec, -1
    v_mfma_f32_16x16x32_bf16 v[48:51], v[72:75], a[140:143], v[48:51]
    v_mfma_f32_16x16x32_bf16 v[52:55], v[76:79], a[140:143], v[52:55]
    v_mfma_f32_16x16x32_bf16 v[56:59], v[72:75], v[100:103], v[56:59]
    v_mfma_f32_16x16x32_bf16 v[60:63], v[76:79], v[100:103], v[60:63]
    ds_read_b128 v[72:75], v5 offset:32768
    ds_read_b128 v[76:79], v5 offset:40960
    ds_read_b128 v[96:99], v8 offset:8192
    ds_read_b128 v[100:103], v8 offset:9216
    s_waitcnt lgkmcnt(6)
    v_mfma_f32_16x16x32_bf16 v[16:19], v[144:147], v[80:83], v[16:19]
    v_mfma_f32_16x16x32_bf16 v[20:23], v[144:147], v[84:87], v[20:23]
    v_mfma_f32_16x16x32_bf16 v[24:27], v[208:211], v[80:83], v[24:27]
    v_mfma_f32_16x16x32_bf16 v[28:31], v[208:211], v[84:87], v[28:31]
    v_mfma_f32_16x16x32_bf16 v[32:35], a[16:19], v[80:83], v[32:35]
    v_mfma_f32_16x16x32_bf16 v[36:39], a[16:19], v[84:87], v[36:39]
    v_mfma_f32_16x16x32_bf16 v[40:43], a[80:83], v[80:83], v[40:43]
    v_mfma_f32_16x16x32_bf16 v[44:47], a[80:83], v[84:87], v[44:47]
    v_mfma_f32_16x16x32_bf16 v[48:51], v[80:83], a[144:147], v[48:51]
    v_mfma_f32_16x16x32_bf16 v[52:55], v[84:87], a[144:147], v[52:55]
    v_mfma_f32_16x16x32_bf16 v[56:59], v[80:83], v[88:91], v[56:59]
    v_mfma_f32_16x16x32_bf16 v[60:63], v[84:87], v[88:91], v[60:63]
    ds_read_b128 v[80:83], v6 offset:32768
    ds_read_b128 v[84:87], v6 offset:40960
    s_waitcnt lgkmcnt(6)
    v_mfma_f32_16x16x32_bf16 v[16:19], v[148:151], v[64:67], v[16:19]
    v_mfma_f32_16x16x32_bf16 v[20:23], v[148:151], v[68:71], v[20:23]
    v_mfma_f32_16x16x32_bf16 v[24:27], v[212:215], v[64:67], v[24:27]
    v_mfma_f32_16x16x32_bf16 v[28:31], v[212:215], v[68:71], v[28:31]
    v_mfma_f32_16x16x32_bf16 v[32:35], a[20:23], v[64:67], v[32:35]
    v_mfma_f32_16x16x32_bf16 v[36:39], a[20:23], v[68:71], v[36:39]
    v_mfma_f32_16x16x32_bf16 v[40:43], a[84:87], v[64:67], v[40:43]
    v_mfma_f32_16x16x32_bf16 v[44:47], a[84:87], v[68:71], v[44:47]
    v_mfma_f32_16x16x32_bf16 v[48:51], v[64:67], a[148:151], v[48:51]
    v_mfma_f32_16x16x32_bf16 v[52:55], v[68:71], a[148:151], v[52:55]
    v_mfma_f32_16x16x32_bf16 v[56:59], v[64:67], v[92:95], v[56:59]
    v_mfma_f32_16x16x32_bf16 v[60:63], v[68:71], v[92:95], v[60:63]
    ds_read_b128 v[64:67], v3 offset:33024
    ds_read_b128 v[68:71], v3 offset:41216
    ds_read_b128 v[88:91], v8 offset:10240
    ds_read_b128 v[92:95], v8 offset:11264
    s_waitcnt lgkmcnt(8)
    s_waitcnt lgkmcnt(6)
    v_mfma_f32_16x16x32_bf16 v[16:19], v[152:155], v[72:75], v[16:19]
    v_mfma_f32_16x16x32_bf16 v[20:23], v[152:155], v[76:79], v[20:23]
    v_mfma_f32_16x16x32_bf16 v[24:27], v[216:219], v[72:75], v[24:27]
    v_mfma_f32_16x16x32_bf16 v[28:31], v[216:219], v[76:79], v[28:31]
    v_mfma_f32_16x16x32_bf16 v[32:35], a[24:27], v[72:75], v[32:35]
    v_mfma_f32_16x16x32_bf16 v[36:39], a[24:27], v[76:79], v[36:39]
    v_mfma_f32_16x16x32_bf16 v[40:43], a[88:91], v[72:75], v[40:43]
    v_mfma_f32_16x16x32_bf16 v[44:47], a[88:91], v[76:79], v[44:47]
    v_mfma_f32_16x16x32_bf16 v[48:51], v[72:75], a[152:155], v[48:51]
    v_mfma_f32_16x16x32_bf16 v[52:55], v[76:79], a[152:155], v[52:55]
    v_mfma_f32_16x16x32_bf16 v[56:59], v[72:75], v[96:99], v[56:59]
    v_mfma_f32_16x16x32_bf16 v[60:63], v[76:79], v[96:99], v[60:63]
    ds_read_b128 v[72:75], v4 offset:33024
    ds_read_b128 v[76:79], v4 offset:41216
    s_waitcnt lgkmcnt(6)
    v_mfma_f32_16x16x32_bf16 v[16:19], v[156:159], v[80:83], v[16:19]
    v_mfma_f32_16x16x32_bf16 v[20:23], v[156:159], v[84:87], v[20:23]
    v_mfma_f32_16x16x32_bf16 v[24:27], v[220:223], v[80:83], v[24:27]
    v_mfma_f32_16x16x32_bf16 v[28:31], v[220:223], v[84:87], v[28:31]
    v_mfma_f32_16x16x32_bf16 v[32:35], a[28:31], v[80:83], v[32:35]
    v_mfma_f32_16x16x32_bf16 v[36:39], a[28:31], v[84:87], v[36:39]
    v_mfma_f32_16x16x32_bf16 v[40:43], a[92:95], v[80:83], v[40:43]
    v_mfma_f32_16x16x32_bf16 v[44:47], a[92:95], v[84:87], v[44:47]
    v_mfma_f32_16x16x32_bf16 v[48:51], v[80:83], a[156:159], v[48:51]
    v_mfma_f32_16x16x32_bf16 v[52:55], v[84:87], a[156:159], v[52:55]
    v_mfma_f32_16x16x32_bf16 v[56:59], v[80:83], v[100:103], v[56:59]
    v_mfma_f32_16x16x32_bf16 v[60:63], v[84:87], v[100:103], v[60:63]
    ds_read_b128 v[80:83], v5 offset:33024
    ds_read_b128 v[84:87], v5 offset:41216
    ds_read_b128 v[96:99], v8 offset:12288
    ds_read_b128 v[100:103], v8 offset:13312
    s_waitcnt lgkmcnt(8)
    s_waitcnt lgkmcnt(6)
    v_mfma_f32_16x16x32_bf16 v[16:19], v[160:163], v[64:67], v[16:19]
    v_mfma_f32_16x16x32_bf16 v[20:23], v[160:163], v[68:71], v[20:23]
    v_mfma_f32_16x16x32_bf16 v[24:27], v[224:227], v[64:67], v[24:27]
    v_mfma_f32_16x16x32_bf16 v[28:31], v[224:227], v[68:71], v[28:31]
    v_mfma_f32_16x16x32_bf16 v[32:35], a[32:35], v[64:67], v[32:35]
    v_mfma_f32_16x16x32_bf16 v[36:39], a[32:35], v[68:71], v[36:39]
    v_mfma_f32_16x16x32_bf16 v[40:43], a[96:99], v[64:67], v[40:43]
    v_mfma_f32_16x16x32_bf16 v[44:47], a[96:99], v[68:71], v[44:47]
    v_mfma_f32_16x16x32_bf16 v[48:51], v[64:67], a[160:163], v[48:51]
    v_mfma_f32_16x16x32_bf16 v[52:55], v[68:71], a[160:163], v[52:55]
    v_mfma_f32_16x16x32_bf16 v[56:59], v[64:67], v[88:91], v[56:59]
    v_mfma_f32_16x16x32_bf16 v[60:63], v[68:71], v[88:91], v[60:63]
    ds_read_b128 v[64:67], v6 offset:33024
    ds_read_b128 v[68:71], v6 offset:41216
    s_waitcnt lgkmcnt(6)
    v_mfma_f32_16x16x32_bf16 v[16:19], v[164:167], v[72:75], v[16:19]
    v_mfma_f32_16x16x32_bf16 v[20:23], v[164:167], v[76:79], v[20:23]
    v_mfma_f32_16x16x32_bf16 v[24:27], v[228:231], v[72:75], v[24:27]
    v_mfma_f32_16x16x32_bf16 v[28:31], v[228:231], v[76:79], v[28:31]
    v_mfma_f32_16x16x32_bf16 v[32:35], a[36:39], v[72:75], v[32:35]
    v_mfma_f32_16x16x32_bf16 v[36:39], a[36:39], v[76:79], v[36:39]
    v_mfma_f32_16x16x32_bf16 v[40:43], a[100:103], v[72:75], v[40:43]
    v_mfma_f32_16x16x32_bf16 v[44:47], a[100:103], v[76:79], v[44:47]
    v_mfma_f32_16x16x32_bf16 v[48:51], v[72:75], a[164:167], v[48:51]
    v_mfma_f32_16x16x32_bf16 v[52:55], v[76:79], a[164:167], v[52:55]
    v_mfma_f32_16x16x32_bf16 v[56:59], v[72:75], v[92:95], v[56:59]
    v_mfma_f32_16x16x32_bf16 v[60:63], v[76:79], v[92:95], v[60:63]
    s_waitcnt lgkmcnt(4)
    s_waitcnt lgkmcnt(2)
    v_mfma_f32_16x16x32_bf16 v[16:19], v[168:171], v[80:83], v[16:19]
    v_mfma_f32_16x16x32_bf16 v[20:23], v[168:171], v[84:87], v[20:23]
    v_mfma_f32_16x16x32_bf16 v[24:27], v[232:235], v[80:83], v[24:27]
    v_mfma_f32_16x16x32_bf16 v[28:31], v[232:235], v[84:87], v[28:31]
    v_mfma_f32_16x16x32_bf16 v[32:35], a[40:43], v[80:83], v[32:35]
    v_mfma_f32_16x16x32_bf16 v[36:39], a[40:43], v[84:87], v[36:39]
    v_mfma_f32_16x16x32_bf16 v[40:43], a[104:107], v[80:83], v[40:43]
    v_mfma_f32_16x16x32_bf16 v[44:47], a[104:107], v[84:87], v[44:47]
    v_mfma_f32_16x16x32_bf16 v[48:51], v[80:83], a[168:171], v[48:51]
    v_mfma_f32_16x16x32_bf16 v[52:55], v[84:87], a[168:171], v[52:55]
    v_mfma_f32_16x16x32_bf16 v[56:59], v[80:83], v[96:99], v[56:59]
    v_mfma_f32_16x16x32_bf16 v[60:63], v[84:87], v[96:99], v[60:63]
    s_waitcnt lgkmcnt(0)
    s_barrier
    v_mfma_f32_16x16x32_bf16 v[16:19], v[172:175], v[64:67], v[16:19]
    v_mfma_f32_16x16x32_bf16 v[20:23], v[172:175], v[68:71], v[20:23]
    v_mfma_f32_16x16x32_bf16 v[24:27], v[236:239], v[64:67], v[24:27]
    v_mfma_f32_16x16x32_bf16 v[28:31], v[236:239], v[68:71], v[28:31]
    v_mfma_f32_16x16x32_bf16 v[32:35], a[44:47], v[64:67], v[32:35]
    v_mfma_f32_16x16x32_bf16 v[36:39], a[44:47], v[68:71], v[36:39]
    v_mfma_f32_16x16x32_bf16 v[40:43], a[108:111], v[64:67], v[40:43]
    v_mfma_f32_16x16x32_bf16 v[44:47], a[108:111], v[68:71], v[44:47]
    v_mfma_f32_16x16x32_bf16 v[48:51], v[64:67], a[172:175], v[48:51]
    v_mfma_f32_16x16x32_bf16 v[52:55], v[68:71], a[172:175], v[52:55]
    v_mfma_f32_16x16x32_bf16 v[56:59], v[64:67], v[100:103], v[56:59]
    v_mfma_f32_16x16x32_bf16 v[60:63], v[68:71], v[100:103], v[60:63]
    s_min_u32 s38, s24, 127
    s_lshl_b32 s38, s38, 19
    s_lshl_b32 s39, s7, 14
    s_add_u32 s38, s38, s39
    s_add_u32 s38, s38, 33554432
    s_add_u32 s28, s4, s38
    s_addc_u32 s29, s5, 0
    s_min_u32 s38, s24, 127
    s_lshl_b32 s38, s38, 18
    s_lshl_b32 s39, s7, 13
    s_add_u32 s38, s38, s39
    s_add_u32 s38, s38, 83886080
    s_add_u32 s30, s4, s38
    s_addc_u32 s31, s5, 0
    s_min_u32 s38, s24, 127
    s_lshl_b32 s38, s38, 7
    s_lshl_b32 s39, s7, 2
    s_add_u32 s38, s38, s39
    s_add_u32 s38, s38, 117448704
    s_add_u32 s56, s4, s38
    s_addc_u32 s57, s5, 0
    s_min_u32 s38, s24, 127
    s_lshl_b32 s38, s38, 17
    s_lshl_b32 s39, s7, 12
    s_add_u32 s38, s38, s39
    s_add_u32 s38, s38, 109051904
    s_add_u32 s32, s4, s38
    s_addc_u32 s33, s5, 0
    v_mov_b32 v92, -1
    v_mov_b32 v93, -1
    v_mov_b32 v94, -1
    v_mov_b32 v95, -1
    s_lshl_b32 s38, s9, 10
    v_add_u32 v88, s38, v1
    v_add_u32 v89, 4096, v88
    s_lshl_b32 s38, s9, 11
    s_add_u32 s38, s38, 8192
    v_add_u32 v90, s38, v1
    s_waitcnt vmcnt(0)
    global_store_dwordx4 v88, v[92:95], s[32:33] sc1
    v_cvt_pk_bf16_f32 v64, v32, v33
    v_cvt_pk_bf16_f32 v65, v34, v35
    v_cvt_pk_bf16_f32 v66, v40, v41
    v_cvt_pk_bf16_f32 v67, v42, v43
    global_store_dwordx4 v88, v[64:67], s[28:29] sc1
    v_cvt_pk_bf16_f32 v68, v36, v37
    v_cvt_pk_bf16_f32 v69, v38, v39
    v_cvt_pk_bf16_f32 v70, v44, v45
    v_cvt_pk_bf16_f32 v71, v46, v47
    global_store_dwordx4 v89, v[68:71], s[28:29] sc1
    v_cvt_pk_bf16_f32 v72, v48, v49
    v_cvt_pk_bf16_f32 v73, v50, v51
    v_cvt_pk_bf16_f32 v74, v52, v53
    v_cvt_pk_bf16_f32 v75, v54, v55
    global_store_dwordx4 v90, v[72:75], s[28:29] offset:0 sc1
    v_cvt_pk_bf16_f32 v76, v56, v57
    v_cvt_pk_bf16_f32 v77, v58, v59
    v_cvt_pk_bf16_f32 v78, v60, v61
    v_cvt_pk_bf16_f32 v79, v62, v63
    global_store_dwordx4 v90, v[76:79], s[28:29] offset:1024 sc1
    v_cvt_pk_bf16_f32 v80, v16, v17
    v_cvt_pk_bf16_f32 v81, v18, v19
    v_cvt_pk_bf16_f32 v82, v24, v25
    v_cvt_pk_bf16_f32 v83, v26, v27
    global_store_dwordx4 v88, v[80:83], s[30:31]
    v_cvt_pk_bf16_f32 v84, v20, v21
    v_cvt_pk_bf16_f32 v85, v22, v23
    v_cvt_pk_bf16_f32 v86, v28, v29
    v_cvt_pk_bf16_f32 v87, v30, v31
    global_store_dwordx4 v89, v[84:87], s[30:31]
    s_cmp_eq_u32 s9, 0
    s_cselect_b32 s38, 1, 0
    s_or_b32 s59, s59, s38
L_g_68:
    s_cmp_ge_u32 s13, 64
    s_cbranch_scc1 L_g_71
    s_bitcmp1_b32 s25, 1
    s_cbranch_scc1 L_cp_72
    s_barrier
    s_min_u32 s38, s13, 127
    s_lshl_b32 s38, s38, 15
    s_add_u32 s38, s38, 146800640
    s_add_u32 s16, s4, s38
    s_addc_u32 s17, s5, 0
    s_add_u32 m0, s46, 0
    s_nop 0
    global_load_lds_dwordx4 v2, s[16:17] offset:0 sc1
    s_add_u32 m0, s46, 1024
    v_xor_b32 v105, 2080, v2
    global_load_lds_dwordx4 v105, s[16:17] offset:0 sc1
    s_add_u32 m0, s46, 2048
    v_xor_b32 v106, 4160, v2
    global_load_lds_dwordx4 v106, s[16:17] offset:0 sc1
    s_add_u32 m0, s46, 3072
    v_xor_b32 v107, 6240, v2
    global_load_lds_dwordx4 v107, s[16:17] offset:0 sc1
    s_add_u32 m0, s46, 15872
    s_nop 0
    global_load_lds_dwordx4 v2, s[16:17] offset:512 sc1
    s_add_u32 m0, s46, 16896
    v_xor_b32 v105, 2080, v2
    global_load_lds_dwordx4 v105, s[16:17] offset:512 sc1
    s_add_u32 m0, s46, 17920
    v_xor_b32 v106, 4160, v2
    global_load_lds_dwordx4 v106, s[16:17] offset:512 sc1
    s_add_u32 m0, s46, 18944
    v_xor_b32 v107, 6240, v2
    global_load_lds_dwordx4 v107, s[16:17] offset:512 sc1
    s_waitcnt vmcnt(4)
L_cp_72:
    s_barrier
    s_mov_b32 s24, s13
    ds_read_b128 v[64:67], v3 offset:0
    ds_read_b128 v[68:71], v3 offset:8192
    ds_read_b128 v[72:75], v4 offset:0
    ds_read_b128 v[76:79], v4 offset:8192
    ds_read_b128 v[80:83], v5 offset:0
    ds_read_b128 v[84:87], v5 offset:8192
    ds_read_b128 v[96:99], v8 offset:0
    ds_read_b128 v[100:103], v8 offset:1024
    s_waitcnt lgkmcnt(6)
    v_mfma_f32_16x16x32_bf16 v[16:19], v[112:115], v[64:67], 0
    v_mfma_f32_16x16x32_bf16 v[20:23], v[112:115], v[68:71], 0
    v_mfma_f32_16x16x32_bf16 v[24:27], v[176:179], v[64:67], 0
    v_mfma_f32_16x16x32_bf16 v[28:31], v[176:179], v[68:71], 0
    v_mfma_f32_16x16x32_bf16 v[32:35], v[240:243], v[64:67], 0
    v_mfma_f32_16x16x32_bf16 v[36:39], v[240:243], v[68:71], 0
    v_mfma_f32_16x16x32_bf16 v[40:43], a[48:51], v[64:67], 0
    v_mfma_f32_16x16x32_bf16 v[44:47], a[48:51], v[68:71], 0
    v_mfma_f32_16x16x32_bf16 v[48:51], v[64:67], a[112:115], 0
    v_mfma_f32_16x16x32_bf16 v[52:55], v[68:71], a[112:115], 0
    v_mfma_f32_16x16x32_bf16 v[56:59], v[64:67], a[176:179], 0
    v_mfma_f32_16x16x32_bf16 v[60:63], v[68:71], a[176:179], 0
    ds_read_b128 v[64:67], v6 offset:0
    ds_read_b128 v[68:71], v6 offset:8192
    s_waitcnt lgkmcnt(6)
    v_mfma_f32_16x16x32_bf16 v[16:19], v[116:119], v[72:75], v[16:19]
    v_mfma_f32_16x16x32_bf16 v[20:23], v[116:119], v[76:79], v[20:23]
    v_mfma_f32_16x16x32_bf16 v[24:27], v[180:183], v[72:75], v[24:27]
    v_mfma_f32_16x16x32_bf16 v[28:31], v[180:183], v[76:79], v[28:31]
    v_mfma_f32_16x16x32_bf16 v[32:35], v[244:247], v[72:75], v[32:35]
    v_mfma_f32_16x16x32_bf16 v[36:39], v[244:247], v[76:79], v[36:39]
    v_mfma_f32_16x16x32_bf16 v[40:43], a[52:55], v[72:75], v[40:43]
    v_mfma_f32_16x16x32_bf16 v[44:47], a[52:55], v[76:79], v[44:47]
    v_mfma_f32_16x16x32_bf16 v[48:51], v[72:75], a[116:119], v[48:51]
    v_mfma_f32_16x16x32_bf16 v[52:55], v[76:79], a[116:119], v[52:55]
    v_mfma_f32_16x16x32_bf16 v[56:59], v[72:75], a[180:183], v[56:59]
    v_mfma_f32_16x16x32_bf16 v[60:63], v[76:79], a[180:183], v[60:63]
    ds_read_b128 v[72:75], v3 offset:256
    ds_read_b128 v[76:79], v3 offset:8448
    ds_read_b128 v[88:91], v8 offset:2048
    ds_read_b128 v[92:95], v8 offset:3072
    s_waitcnt lgkmcnt(8)
    s_waitcnt lgkmcnt(6)
    v_mfma_f32_16x16x32_bf16 v[16:19], v[120:123], v[80:83], v[16:19]
    v_mfma_f32_16x16x32_bf16 v[20:23], v[120:123], v[84:87], v[20:23]
    v_mfma_f32_16x16x32_bf16 v[24:27], v[184:187], v[80:83], v[24:27]
    v_mfma_f32_16x16x32_bf16 v[28:31], v[184:187], v[84:87], v[28:31]
    v_mfma_f32_16x16x32_bf16 v[32:35], v[248:251], v[80:83], v[32:35]
    v_mfma_f32_16x16x32_bf16 v[36:39], v[248:251], v[84:87], v[36:39]
    v_mfma_f32_16x16x32_bf16 v[40:43], a[56:59], v[80:83], v[40:43]
    v_mfma_f32_16x16x32_bf16 v[44:47], a[56:59], v[84:87], v[44:47]
    v_mfma_f32_16x16x32_bf16 v[48:51], v[80:83], a[120:123], v[48:51]
    v_mfma_f32_16x16x32_bf16 v[52:55], v[84:87], a[120:123], v[52:55]
    v_mfma_f32_16x16x32_bf16 v[56:59], v[80:83], v[96:99], v[56:59]
    v_mfma_f32_16x16x32_bf16 v[60:63], v[84:87], v[96:99], v[60:63]
    ds_read_b128 v[80:83], v4 offset:256
    ds_read_b128 v[84:87], v4 offset:8448
    s_waitcnt lgkmcnt(6)
    v_mfma_f32_16x16x32_bf16 v[16:19], v[124:127], v[64:67], v[16:19]
    v_mfma_f32_16x16x32_bf16 v[20:23], v[124:127], v[68:71], v[20:23]
    v_mfma_f32_16x16x32_bf16 v[24:27], v[188:191], v[64:67], v[24:27]
    v_mfma_f32_16x16x32_bf16 v[28:31], v[188:191], v[68:71], v[28:31]
    v_mfma_f32_16x16x32_bf16 v[32:35], v[252:255], v[64:67], v[32:35]
    v_mfma_f32_16x16x32_bf16 v[36:39], v[252:255], v[68:71], v[36:39]
    v_mfma_f32_16x16x32_bf16 v[40:43], a[60:63], v[64:67], v[40:43]
    v_mfma_f32_16x16x32_bf16 v[44:47], a[60:63], v[68:71], v[44:47]
    v_mfma_f32_16x16x32_bf16 v[48:51], v[64:67], a[124:127], v[48:51]
    v_mfma_f32_16x16x32_bf16 v[52:55], v[68:71], a[124:127], v[52:55]
    v_mfma_f32_16x16x32_bf16 v[56:59], v[64:67], v[100:103], v[56:59]
    v_mfma_f32_16x16x32_bf16 v[60:63], v[68:71], v[100:103], v[60:63]
    ds_read_b128 v[64:67], v5 offset:256
    ds_read_b128 v[68:71], v5 offset:8448
    ds_read_b128 v[96:99], v8 offset:4096
    ds_read_b128 v[100:103], v8 offset:5120
    s_waitcnt lgkmcnt(8)
    s_waitcnt lgkmcnt(6)
    v_mfma_f32_16x16x32_bf16 v[16:19], v[128:131], v[72:75], v[16:19]
    v_mfma_f32_16x16x32_bf16 v[20:23], v[128:131], v[76:79], v[20:23]
    v_mfma_f32_16x16x32_bf16 v[24:27], v[192:195], v[72:75], v[24:27]
    v_mfma_f32_16x16x32_bf16 v[28:31], v[192:195], v[76:79], v[28:31]
    v_mfma_f32_16x16x32_bf16 v[32:35], a[0:3], v[72:75], v[32:35]
    v_mfma_f32_16x16x32_bf16 v[36:39], a[0:3], v[76:79], v[36:39]
    v_mfma_f32_16x16x32_bf16 v[40:43], a[64:67], v[72:75], v[40:43]
    v_mfma_f32_16x16x32_bf16 v[44:47], a[64:67], v[76:79], v[44:47]
    v_mfma_f32_16x16x32_bf16 v[48:51], v[72:75], a[128:131], v[48:51]
    v_mfma_f32_16x16x32_bf16 v[52:55], v[76:79], a[128:131], v[52:55]
    v_mfma_f32_16x16x32_bf16 v[56:59], v[72:75], v[88:91], v[56:59]
    v_mfma_f32_16x16x32_bf16 v[60:63], v[76:79], v[88:91], v[60:63]
    ds_read_b128 v[72:75], v6 offset:256
    ds_read_b128 v[76:79], v6 offset:8448
    s_waitcnt lgkmcnt(6)
    v_mfma_f32_16x16x32_bf16 v[16:19], v[132:135], v[80:83], v[16:19]
    v_mfma_f32_16x16x32_bf16 v[20:23], v[132:135], v[84:87], v[20:23]
    v_mfma_f32_16x16x32_bf16 v[24:27], v[196:199], v[80:83], v[24:27]
    v_mfma_f32_16x16x32_bf16 v[28:31], v[196:199], v[84:87], v[28:31]
    v_mfma_f32_16x16x32_bf16 v[32:35], a[4:7], v[80:83], v[32:35]
    v_mfma_f32_16x16x32_bf16 v[36:39], a[4:7], v[84:87], v[36:39]
    v_mfma_f32_16x16x32_bf16 v[40:43], a[68:71], v[80:83], v[40:43]
    v_mfma_f32_16x16x32_bf16 v[44:47], a[68:71], v[84:87], v[44:47]
    v_mfma_f32_16x16x32_bf16 v[48:51], v[80:83], a[132:135], v[48:51]
    v_mfma_f32_16x16x32_bf16 v[52:55], v[84:87], a[132:135], v[52:55]
    v_mfma_f32_16x16x32_bf16 v[56:59], v[80:83], v[92:95], v[56:59]
    v_mfma_f32_16x16x32_bf16 v[60:63], v[84:87], v[92:95], v[60:63]
    ds_read_b128 v[88:91], v8 offset:6144
    ds_read_b128 v[92:95], v8 offset:7168
    s_waitcnt lgkmcnt(6)
    s_waitcnt lgkmcnt(4)
    v_mfma_f32_16x16x32_bf16 v[16:19], v[136:139], v[64:67], v[16:19]
    v_mfma_f32_16x16x32_bf16 v[20:23], v[136:139], v[68:71], v[20:23]
    v_mfma_f32_16x16x32_bf16 v[24:27], v[200:203], v[64:67], v[24:27]
    v_mfma_f32_16x16x32_bf16 v[28:31], v[200:203], v[68:71], v[28:31]
    v_mfma_f32_16x16x32_bf16 v[32:35], a[8:11], v[64:67], v[32:35]
    v_mfma_f32_16x16x32_bf16 v[36:39], a[8:11], v[68:71], v[36:39]
    v_mfma_f32_16x16x32_bf16 v[40:43], a[72:75], v[64:67], v[40:43]
    v_mfma_f32_16x16x32_bf16 v[44:47], a[72:75], v[68:71], v[44:47]
    v_mfma_f32_16x16x32_bf16 v[48:51], v[64:67], a[136:139], v[48:51]
    v_mfma_f32_16x16x32_bf16 v[52:55], v[68:71], a[136:139], v[52:55]
    v_mfma_f32_16x16x32_bf16 v[56:59], v[64:67], v[96:99], v[56:59]
    v_mfma_f32_16x16x32_bf16 v[60:63], v[68:71], v[96:99], v[60:63]
    s_waitcnt lgkmcnt(2)
    s_waitcnt vmcnt(0)
    s_barrier
    ds_read_b128 v[80:83], v3 offset:16384
    ds_read_b128 v[84:87], v3 offset:24576
    ds_read_b128 v[64:67], v4 offset:16384
    ds_read_b128 v[68:71], v4 offset:24576
    v_mfma_f32_16x16x32_bf16 v[16:19], v[140:143], v[72:75], v[16:19]
    s_bitcmp1_b32 s59, 0
    s_cselect_b64 exec, 1, 0
    global_store_dword v14, v13, s[56:57] sc1
    s_mov_b64 exec, -1
    s_bitset0_b32 s59, 0
    v_mfma_f32_16x16x32_bf16 v[20:23], v[140:143], v[76:79], v[20:23]
    s_bitcmp1_b32 s59, 1
    s_cselect_b64 exec, 1, 0
    global_store_dword v14, v13, s[100:101] sc1
    s_mov_b64 exec, -1
    s_bitset0_b32 s59, 1
    v_mfma_f32_16x16x32_bf16 v[24:27], v[204:207], v[72:75], v[24:27]
    s_cmp_lt_u32 s15, 64
    s_cselect_b32 s38, 8, 0
    s_or_b32 s25, s25, s38
    v_mfma_f32_16x16x32_bf16 v[28:31], v[204:207], v[76:79], v[28:31]
    s_bitcmp1_b32 s25, 3
    s_cselect_b64 s[52:53], -1, 0
    v_mfma_f32_16x16x32_bf16 v[32:35], a[12:15], v[72:75], v[32:35]
    s_min_u32 s38, s15, 127
    s_lshl_b32 s38, s38, 19
    s_lshl_b32 s39, s7, 14
    s_add_u32 s38, s38, s39
    s_add_u32 s38, s38, 33554432
    s_add_u32 s54, s4, s38
    s_addc_u32 s55, s5, 0
    v_mfma_f32_16x16x32_bf16 v[36:39], a[12:15], v[76:79], v[36:39]
    s_add_u32 m0, s46, 32768
    v_mfma_f32_16x16x32_bf16 v[40:43], a[76:79], v[72:75], v[40:43]
    s_mov_b64 exec, s[52:53]
    global_load_lds_dwordx4 v9, s[54:55] offset:0 sc1
    s_mov_b64 exec, -1
    v_mfma_f32_16x16x32_bf16 v[44:47], a[76:79], v[76:79], v[44:47]
    s_mov_b64 exec, s[52:53]
    global_load_lds_dwordx4 v9, s[54:55] offset:1024 sc1
    s_mov_b64 exec, -1
    v_mfma_f32_16x16x32_bf16 v[48:51], v[72:75], a[140:143], v[48:51]
    s_mov_b64 exec, s[52:53]
    global_load_lds_dwordx4 v9, s[54:55] offset:2048 sc1
    s_mov_b64 exec, -1
    v_mfma_f32_16x16x32_bf16 v[52:55], v[76:79], a[140:143], v[52:55]
    s_mov_b64 exec, s[52:53]
    global_load_lds_dwordx4 v9, s[54:55] offset:3072 sc1
    s_mov_b64 exec, -1
    v_mfma_f32_16x16x32_bf16 v[56:59], v[72:75], v[100:103], v[56:59]
    s_cmp_lt_u32 s14, 64
    s_cselect_b32 s38, 4, 0
    s_or_b32 s25, s25, s38
    v_mfma_f32_16x16x32_bf16 v[60:63], v[76:79], v[100:103], v[60:63]
    s_bitcmp1_b32 s25, 2
    s_cselect_b64 s[52:53], -1, 0
    ds_read_b128 v[72:75], v5 offset:16384
    ds_read_b128 v[76:79], v5 offset:24576
    ds_read_b128 v[96:99], v8 offset:8192
    ds_read_b128 v[100:103], v8 offset:9216
    s_waitcnt lgkmcnt(6)
    v_mfma_f32_16x16x32_bf16 v[16:19], v[144:147], v[80:83], v[16:19]
    s_min_u32 s38, s14, 127
    s_lshl_b32 s38, s38, 19
    s_lshl_b32 s39, s7, 14
    s_add_u32 s38, s38, s39
    s_add_u32 s54, s4, s38
    s_addc_u32 s55, s5, 0
    v_mfma_f32_16x16x32_bf16 v[20:23], v[144:147], v[84:87], v[20:23]
    s_add_u32 m0, s46, 0
    v_mfma_f32_16x16x32_bf16 v[24:27], v[208:211], v[80:83], v[24:27]
    s_mov_b64 exec, s[52:53]
    global_load_lds_dwordx4 v9, s[54:55] offset:0 sc1
    s_mov_b64 exec, -1
    v_mfma_f32_16x16x32_bf16 v[28:31], v[208:211], v[84:87], v[28:31]
    s_mov_b64 exec, s[52:53]
    global_load_lds_dwordx4 v9, s[54:55] offset:1024 sc1
    s_mov_b64 exec, -1
    v_mfma_f32_16x16x32_bf16 v[32:35], a[16:19], v[80:83], v[32:35]
    s_mov_b64 exec, s[52:53]
    global_load_lds_dwordx4 v9, s[54:55] offset:2048 sc1
    s_mov_b64 exec, -1
    v_mfma_f32_16x16x32_bf16 v[36:39], a[16:19], v[84:87], v[36:39]
    s_mov_b64 exec, s[52:53]
    global_load_lds_dwordx4 v9, s[54:55] offset:3072 sc1
    s_mov_b64 exec, -1
    v_mfma_f32_16x16x32_bf16 v[40:43], a[80:83], v[80:83], v[40:43]
    v_mfma_f32_16x16x32_bf16 v[44:47], a[80:83], v[84:87], v[44:47]
    v_mfma_f32_16x16x32_bf16 v[48:51], v[80:83], a[144:147], v[48:51]
    v_mfma_f32_16x16x32_bf16 v[52:55], v[84:87], a[144:147], v[52:55]
    v_mfma_f32_16x16x32_bf16 v[56:59], v[80:83], v[88:91], v[56:59]
    v_mfma_f32_16x16x32_bf16 v[60:63], v[84:87], v[88:91], v[60:63]
    ds_read_b128 v[80:83], v6 offset:16384
    ds_read_b128 v[84:87], v6 offset:24576
    s_waitcnt lgkmcnt(6)
    v_mfma_f32_16x16x32_bf16 v[16:19], v[148:151], v[64:67], v[16:19]
    v_mfma_f32_16x16x32_bf16 v[20:23], v[148:151], v[68:71], v[20:23]
    v_mfma_f32_16x16x32_bf16 v[24:27], v[212:215], v[64:67], v[24:27]
    v_mfma_f32_16x16x32_bf16 v[28:31], v[212:215], v[68:71], v[28:31]
    v_mfma_f32_16x16x32_bf16 v[32:35], a[20:23], v[64:67], v[32:35]
    v_mfma_f32_16x16x32_bf16 v[36:39], a[20:23], v[68:71], v[36:39]
    v_mfma_f32_16x16x32_bf16 v[40:43], a[84:87], v[64:67], v[40:43]
    v_mfma_f32_16x16x32_bf16 v[44:47], a[84:87], v[68:71], v[44:47]
    v_mfma_f32_16x16x32_bf16 v[48:51], v[64:67], a[148:151], v[48:51]
    v_mfma_f32_16x16x32_bf16 v[52:55], v[68:71], a[148:151], v[52:55]
    v_mfma_f32_16x16x32_bf16 v[56:59], v[64:67], v[92:95], v[56:59]
    v_mfma_f32_16x16x32_bf16 v[60:63], v[68:71], v[92:95], v[60:63]
    ds_read_b128 v[64:67], v3 offset:16640
    ds_read_b128 v[68:71], v3 offset:24832
    ds_read_b128 v[88:91], v8 offset:10240
    ds_read_b128 v[92:95], v8 offset:11264
    s_waitcnt lgkmcnt(8)
    s_waitcnt lgkmcnt(6)
    v_mfma_f32_16x16x32_bf16 v[16:19], v[152:155], v[72:75], v[16:19]
    v_mfma_f32_16x16x32_bf16 v[20:23], v[152:155], v[76:79], v[20:23]
    v_mfma_f32_16x16x32_bf16 v[24:27], v[216:219], v[72:75], v[24:27]
    v_mfma_f32_16x16x32_bf16 v[28:31], v[216:219], v[76:79], v[28:31]
    v_mfma_f32_16x16x32_bf16 v[32:35], a[24:27], v[72:75], v[32:35]
    v_mfma_f32_16x16x32_bf16 v[36:39], a[24:27], v[76:79], v[36:39]
    v_mfma_f32_16x16x32_bf16 v[40:43], a[88:91], v[72:75], v[40:43]
    v_mfma_f32_16x16x32_bf16 v[44:47], a[88:91], v[76:79], v[44:47]
    v_mfma_f32_16x16x32_bf16 v[48:51], v[72:75], a[152:155], v[48:51]
    v_mfma_f32_16x16x32_bf16 v[52:55], v[76:79], a[152:155], v[52:55]
    v_mfma_f32_16x16x32_bf16 v[56:59], v[72:75], v[96:99], v[56:59]
    v_mfma_f32_16x16x32_bf16 v[60:63], v[76:79], v[96:99], v[60:63]
    ds_read_b128 v[72:75], v4 offset:16640
    ds_read_b128 v[76:79], v4 offset:24832
    s_waitcnt lgkmcnt(6)
    v_mfma_f32_16x16x32_bf16 v[16:19], v[156:159], v[80:83], v[16:19]
    v_mfma_f32_16x16x32_bf16 v[20:23], v[156:159], v[84:87], v[20:23]
    v_mfma_f32_16x16x32_bf16 v[24:27], v[220:223], v[80:83], v[24:27]
    v_mfma_f32_16x16x32_bf16 v[28:31], v[220:223], v[84:87], v[28:31]
    v_mfma_f32_16x16x32_bf16 v[32:35], a[28:31], v[80:83], v[32:35]
    v_mfma_f32_16x16x32_bf16 v[36:39], a[28:31], v[84:87], v[36:39]
    v_mfma_f32_16x16x32_bf16 v[40:43], a[92:95], v[80:83], v[40:43]
    v_mfma_f32_16x16x32_bf16 v[44:47], a[92:95], v[84:87], v[44:47]
    v_mfma_f32_16x16x32_bf16 v[48:51], v[80:83], a[156:159], v[48:51]
    v_mfma_f32_16x16x32_bf16 v[52:55], v[84:87], a[156:159], v[52:55]
    v_mfma_f32_16x16x32_bf16 v[56:59], v[80:83], v[100:103], v[56:59]
    v_mfma_f32_16x16x32_bf16 v[60:63], v[84:87], v[100:103], v[60:63]
    ds_read_b128 v[80:83], v5 offset:16640
    ds_read_b128 v[84:87], v5 offset:24832
    ds_read_b128 v[96:99], v8 offset:12288
    ds_read_b128 v[100:103], v8 offset:13312
    s_waitcnt lgkmcnt(8)
    s_waitcnt lgkmcnt(6)
    v_mfma_f32_16x16x32_bf16 v[16:19], v[160:163], v[64:67], v[16:19]
    v_mfma_f32_16x16x32_bf16 v[20:23], v[160:163], v[68:71], v[20:23]
    v_mfma_f32_16x16x32_bf16 v[24:27], v[224:227], v[64:67], v[24:27]
    v_mfma_f32_16x16x32_bf16 v[28:31], v[224:227], v[68:71], v[28:31]
    v_mfma_f32_16x16x32_bf16 v[32:35], a[32:35], v[64:67], v[32:35]
    v_mfma_f32_16x16x32_bf16 v[36:39], a[32:35], v[68:71], v[36:39]
    v_mfma_f32_16x16x32_bf16 v[40:43], a[96:99], v[64:67], v[40:43]
    v_mfma_f32_16x16x32_bf16 v[44:47], a[96:99], v[68:71], v[44:47]
    v_mfma_f32_16x16x32_bf16 v[48:51], v[64:67], a[160:163], v[48:51]
    v_mfma_f32_16x16x32_bf16 v[52:55], v[68:71], a[160:163], v[52:55]
    v_mfma_f32_16x16x32_bf16 v[56:59], v[64:67], v[88:91], v[56:59]
    v_mfma_f32_16x16x32_bf16 v[60:63], v[68:71], v[88:91], v[60:63]
    ds_read_b128 v[64:67], v6 offset:16640
    ds_read_b128 v[68:71], v6 offset:24832
    s_waitcnt lgkmcnt(6)
    v_mfma_f32_16x16x32_bf16 v[16:19], v[164:167], v[72:75], v[16:19]
    v_mfma_f32_16x16x32_bf16 v[20:23], v[164:167], v[76:79], v[20:23]
    v_mfma_f32_16x16x32_bf16 v[24:27], v[228:231], v[72:75], v[24:27]
    v_mfma_f32_16x16x32_bf16 v[28:31], v[228:231], v[76:79], v[28:31]
    v_mfma_f32_16x16x32_bf16 v[32:35], a[36:39], v[72:75], v[32:35]
    v_mfma_f32_16x16x32_bf16 v[36:39], a[36:39], v[76:79], v[36:39]
    v_mfma_f32_16x16x32_bf16 v[40:43], a[100:103], v[72:75], v[40:43]
    v_mfma_f32_16x16x32_bf16 v[44:47], a[100:103], v[76:79], v[44:47]
    v_mfma_f32_16x16x32_bf16 v[48:51], v[72:75], a[164:167], v[48:51]
    v_mfma_f32_16x16x32_bf16 v[52:55], v[76:79], a[164:167], v[52:55]
    v_mfma_f32_16x16x32_bf16 v[56:59], v[72:75], v[92:95], v[56:59]
    v_mfma_f32_16x16x32_bf16 v[60:63], v[76:79], v[92:95], v[60:63]
    s_waitcnt lgkmcnt(4)
    s_waitcnt lgkmcnt(2)
    v_mfma_f32_16x16x32_bf16 v[16:19], v[168:171], v[80:83], v[16:19]
    v_mfma_f32_16x16x32_bf16 v[20:23], v[168:171], v[84:87], v[20:23]
    v_mfma_f32_16x16x32_bf16 v[24:27], v[232:235], v[80:83], v[24:27]
    v_mfma_f32_16x16x32_bf16 v[28:31], v[232:235], v[84:87], v[28:31]
    v_mfma_f32_16x16x32_bf16 v[32:35], a[40:43], v[80:83], v[32:35]
    v_mfma_f32_16x16x32_bf16 v[36:39], a[40:43], v[84:87], v[36:39]
    v_mfma_f32_16x16x32_bf16 v[40:43], a[104:107], v[80:83], v[40:43]
    v_mfma_f32_16x16x32_bf16 v[44:47], a[104:107], v[84:87], v[44:47]
    v_mfma_f32_16x16x32_bf16 v[48:51], v[80:83], a[168:171], v[48:51]
    v_mfma_f32_16x16x32_bf16 v[52:55], v[84:87], a[168:171], v[52:55]
    v_mfma_f32_16x16x32_bf16 v[56:59], v[80:83], v[96:99], v[56:59]
    v_mfma_f32_16x16x32_bf16 v[60:63], v[84:87], v[96:99], v[60:63]
    s_waitcnt lgkmcnt(0)
    s_barrier
    v_mfma_f32_16x16x32_bf16 v[16:19], v[172:175], v[64:67], v[16:19]
    v_mfma_f32_16x16x32_bf16 v[20:23], v[172:175], v[68:71], v[20:23]
    v_mfma_f32_16x16x32_bf16 v[24:27], v[236:239], v[64:67], v[24:27]
    v_mfma_f32_16x16x32_bf16 v[28:31], v[236:239], v[68:71], v[28:31]
    v_mfma_f32_16x16x32_bf16 v[32:35], a[44:47], v[64:67], v[32:35]
    v_mfma_f32_16x16x32_bf16 v[36:39], a[44:47], v[68:71], v[36:39]
    v_mfma_f32_16x16x32_bf16 v[40:43], a[108:111], v[64:67], v[40:43]
    v_mfma_f32_16x16x32_bf16 v[44:47], a[108:111], v[68:71], v[44:47]
    v_mfma_f32_16x16x32_bf16 v[48:51], v[64:67], a[172:175], v[48:51]
    v_mfma_f32_16x16x32_bf16 v[52:55], v[68:71], a[172:175], v[52:55]
    v_mfma_f32_16x16x32_bf16 v[56:59], v[64:67], v[100:103], v[56:59]
    v_mfma_f32_16x16x32_bf16 v[60:63], v[68:71], v[100:103], v[60:63]
    s_min_u32 s38, s24, 127
    s_lshl_b32 s38, s38, 19
    s_lshl_b32 s39, s7, 14
    s_add_u32 s38, s38, s39
    s_add_u32 s28, s4, s38
    s_addc_u32 s29, s5, 0
    s_min_u32 s38, s24, 127
    s_lshl_b32 s38, s38, 18
    s_lshl_b32 s39, s7, 13
    s_add_u32 s38, s38, s39
    s_add_u32 s38, s38, 67108864
    s_add_u32 s30, s4, s38
    s_addc_u32 s31, s5, 0
    s_min_u32 s38, s24, 127
    s_lshl_b32 s38, s38, 7
    s_lshl_b32 s39, s7, 2
    s_add_u32 s38, s38, s39
    s_add_u32 s38, s38, 117440512
    s_add_u32 s56, s4, s38
    s_addc_u32 s57, s5, 0
    s_min_u32 s38, s24, 127
    s_lshl_b32 s38, s38, 17
    s_lshl_b32 s39, s7, 12
    s_add_u32 s38, s38, s39
    s_add_u32 s38, s38, 100663296
    s_add_u32 s32, s4, s38
    s_addc_u32 s33, s5, 0
    v_mov_b32 v92, -1
    v_mov_b32 v93, -1
    v_mov_b32 v94, -1
    v_mov_b32 v95, -1
    s_lshl_b32 s38, s9, 10
    v_add_u32 v88, s38, v1
    v_add_u32 v89, 4096, v88
    s_lshl_b32 s38, s9, 11
    s_add_u32 s38, s38, 8192
    v_add_u32 v90, s38, v1
    s_waitcnt vmcnt(0)
    global_store_dwordx4 v88, v[92:95], s[32:33] sc1
    v_cvt_pk_bf16_f32 v64, v32, v33
    v_cvt_pk_bf16_f32 v65, v34, v35
    v_cvt_pk_bf16_f32 v66, v40, v41
    v_cvt_pk_bf16_f32 v67, v42, v43
    global_store_dwordx4 v88, v[64:67], s[28:29] sc1
    v_cvt_pk_bf16_f32 v68, v36, v37
    v_cvt_pk_bf16_f32 v69, v38, v39
    v_cvt_pk_bf16_f32 v70, v44, v45
    v_cvt_pk_bf16_f32 v71, v46, v47
    global_store_dwordx4 v89, v[68:71], s[28:29] sc1
    v_cvt_pk_bf16_f32 v72, v48, v49
    v_cvt_pk_bf16_f32 v73, v50, v51
    v_cvt_pk_bf16_f32 v74, v52, v53
    v_cvt_pk_bf16_f32 v75, v54, v55
    global_store_dwordx4 v90, v[72:75], s[28:29] offset:0 sc1
    v_cvt_pk_bf16_f32 v76, v56, v57
    v_cvt_pk_bf16_f32 v77, v58, v59
    v_cvt_pk_bf16_f32 v78, v60, v61
    v_cvt_pk_bf16_f32 v79, v62, v63
    global_store_dwordx4 v90, v[76:79], s[28:29] offset:1024 sc1
    v_cvt_pk_bf16_f32 v80, v16, v17
    v_cvt_pk_bf16_f32 v81, v18, v19
    v_cvt_pk_bf16_f32 v82, v24, v25
    v_cvt_pk_bf16_f32 v83, v26, v27
    global_store_dwordx4 v88, v[80:83], s[30:31]
    v_cvt_pk_bf16_f32 v84, v20, v21
    v_cvt_pk_bf16_f32 v85, v22, v23
    v_cvt_pk_bf16_f32 v86, v28, v29
    v_cvt_pk_bf16_f32 v87, v30, v31
    global_store_dwordx4 v89, v[84:87], s[30:31]
    s_cmp_eq_u32 s9, 0
    s_cselect_b32 s38, 1, 0
    s_or_b32 s59, s59, s38
    s_cmp_ge_i32 s23, -1
    s_cbranch_scc1 L_ce_73
    s_waitcnt vmcnt(0)
    s_barrier
    s_bitcmp1_b32 s59, 0
    s_cselect_b64 exec, 1, 0
    global_store_dword v14, v13, s[56:57] sc1
    s_mov_b64 exec, -1
    s_bitset0_b32 s59, 0
    s_branch L_ce_73
L_g_71:
    s_waitcnt vmcnt(0)
    s_bitcmp1_b32 s59, 1
    s_cselect_b64 exec, 1, 0
    global_store_dword v14, v13, s[100:101] sc1
    s_mov_b64 exec, -1
    s_bitset0_b32 s59, 1
    s_barrier
    s_bitcmp1_b32 s59, 0
    s_cselect_b64 exec, 1, 0
    global_store_dword v14, v13, s[56:57] sc1
    s_mov_b64 exec, -1
    s_bitset0_b32 s59, 0
L_ce_73:
    s_add_u32 s23, s23, 1
    s_cmp_lt_i32 s23, 16
    s_cbranch_scc0 L_xe_74
    s_branch L_xw_46
L_xe_74:
L_end_36:
    s_waitcnt vmcnt(0) lgkmcnt(0)
    s_endpgm
L_fast_f:
    s_lshr_b32 s22, s7, 3
    s_and_b32 s26, s7, 7
    s_and_b32 s27, s22, 1
    s_mul_i32 s58, s26, 8320
    s_lshl_b32 s38, s9, 9
    s_add_u32 s58, s58, s38
    s_mul_i32 s60, s22, 1179648
    s_cmp_eq_u32 s27, 0
    s_lshl_b32 s38, s27, 21
    s_add_u32 s61, s38, 119537664
    s_add_u32 s62, s38, 123731968
    s_lshl_b32 s38, s27, 13
    s_add_u32 s63, s38, 117456896
    s_load_dwordx2 s[52:53], s[0:1], 96
    s_load_dwordx2 s[54:55], s[0:1], 72
    s_load_dwordx2 s[56:57], s[0:1], 88
    s_waitcnt lgkmcnt(0)
    v_lshlrev_b32 v2, 4, v0
    v_mov_b32 v8, 0
    v_mov_b32 v9, 0
    v_mov_b32 v10, 0
    v_mov_b32 v11, 0
    s_mul_i32 s38, s26, 73728
    s_add_u32 s38, s38, s60
    v_add_u32 v3, s38, v2
    v_add_u32 v12, 0, v3
    global_store_dwordx4 v12, v[8:11], s[20:21]
    v_add_u32 v12, 4096, v3
    global_store_dwordx4 v12, v[8:11], s[20:21]
    v_add_u32 v12, 8192, v3
    global_store_dwordx4 v12, v[8:11], s[20:21]
    v_add_u32 v12, 12288, v3
    global_store_dwordx4 v12, v[8:11], s[20:21]
    v_add_u32 v12, 16384, v3
    global_store_dwordx4 v12, v[8:11], s[20:21]
    v_add_u32 v12, 20480, v3
    global_store_dwordx4 v12, v[8:11], s[20:21]
    v_add_u32 v12, 24576, v3
    global_store_dwordx4 v12, v[8:11], s[20:21]
    v_add_u32 v12, 28672, v3
    global_store_dwordx4 v12, v[8:11], s[20:21]
    v_add_u32 v12, 32768, v3
    global_store_dwordx4 v12, v[8:11], s[20:21]
    v_add_u32 v12, 36864, v3
    global_store_dwordx4 v12, v[8:11], s[20:21]
    v_add_u32 v12, 40960, v3
    global_store_dwordx4 v12, v[8:11], s[20:21]
    v_add_u32 v12, 45056, v3
    global_store_dwordx4 v12, v[8:11], s[20:21]
    v_add_u32 v12, 49152, v3
    global_store_dwordx4 v12, v[8:11], s[20:21]
    v_add_u32 v12, 53248, v3
    global_store_dwordx4 v12, v[8:11], s[20:21]
    v_add_u32 v12, 57344, v3
    global_store_dwordx4 v12, v[8:11], s[20:21]
    v_add_u32 v12, 61440, v3
    global_store_dwordx4 v12, v[8:11], s[20:21]
    v_add_u32 v12, 65536, v3
    global_store_dwordx4 v12, v[8:11], s[20:21]
    v_add_u32 v12, 69632, v3
    global_store_dwordx4 v12, v[8:11], s[20:21]
    v_add_u32 v12, 589824, v3
    global_store_dwordx4 v12, v[8:11], s[20:21]
    v_add_u32 v12, 593920, v3
    global_store_dwordx4 v12, v[8:11], s[20:21]
    v_add_u32 v12, 598016, v3
    global_store_dwordx4 v12, v[8:11], s[20:21]
    v_add_u32 v12, 602112, v3
    global_store_dwordx4 v12, v[8:11], s[20:21]
    v_add_u32 v12, 606208, v3
    global_store_dwordx4 v12, v[8:11], s[20:21]
    v_add_u32 v12, 610304, v3
    global_store_dwordx4 v12, v[8:11], s[20:21]
    v_add_u32 v12, 614400, v3
    global_store_dwordx4 v12, v[8:11], s[20:21]
    v_add_u32 v12, 618496, v3
    global_store_dwordx4 v12, v[8:11], s[20:21]
    v_add_u32 v12, 622592, v3
    global_store_dwordx4 v12, v[8:11], s[20:21]
    v_add_u32 v12, 626688, v3
    global_store_dwordx4 v12, v[8:11], s[20:21]
    v_add_u32 v12, 630784, v3
    global_store_dwordx4 v12, v[8:11], s[20:21]
    v_add_u32 v12, 634880, v3
    global_store_dwordx4 v12, v[8:11], s[20:21]
    v_add_u32 v12, 638976, v3
    global_store_dwordx4 v12, v[8:11], s[20:21]
    v_add_u32 v12, 643072, v3
    global_store_dwordx4 v12, v[8:11], s[20:21]
    v_add_u32 v12, 647168, v3
    global_store_dwordx4 v12, v[8:11], s[20:21]
    v_add_u32 v12, 651264, v3
    global_store_dwordx4 v12, v[8:11], s[20:21]
    v_add_u32 v12, 655360, v3
    global_store_dwordx4 v12, v[8:11], s[20:21]
    v_add_u32 v12, 659456, v3
    global_store_dwordx4 v12, v[8:11], s[20:21]
    s_waitcnt vmcnt(0)
    s_barrier
    s_lshl_b32 s38, s6, 2
    s_add_u32 s38, s38, 64
    s_cmp_lg_u32 s9, 0
    s_cbranch_scc1 L_arr_76
    v_mov_b32 v1, s38
    v_mov_b32 v2, 1
    s_mov_b64 exec, 1
    global_atomic_add v1, v2, s[10:11] sc1
    s_mov_b64 exec, -1
L_arr_76:
    s_sleep 127
    s_sleep 127
    v_and_b32 v16, 63, v0
    v_lshlrev_b32 v1, 4, v16
    v_and_b32 v17, 15, v16
    v_lshrrev_b32 v18, 4, v16
    s_and_b32 s38, s9, 1
    s_lshl_b32 s38, s38, 3
    v_xor_b32 v19, s38, v17
    v_lshlrev_b32 v19, 4, v19
    v_lshl_add_u32 v19, v16, 8, v19
    s_lshr_b32 s38, s9, 1
    s_lshl_b32 s38, s38, 14
    s_add_u32 s38, s38, 114688
    v_add_u32 v2, s38, v19
    v_xor_b32 v19, v17, v18
    v_lshlrev_b32 v19, 4, v19
    v_lshl_add_u32 v19, v18, 8, v19
    v_add_u32 v3, 114688, v19
    v_xor_b32 v4, 64, v3
    v_xor_b32 v5, 128, v3
    v_xor_b32 v6, 192, v3
    v_add_u32 v7, 114688, v1
    s_mul_i32 s38, s9, 28672
    v_add_u32 v8, s38, v1
    s_lshl_b32 s38, s9, 13
    v_add_u32 v9, s38, v1
    v_add_u32 v10, 4096, v9
    v_mul_u32_u24 v11, 66688, v18
    v_lshl_add_u32 v11, v17, 4, v11
    v_add_u32 v11, s58, v11
    v_add_u32 v12, 266752, v11
    v_mov_b32 v13, -1
    v_mov_b32 v14, 0
    s_load_dwordx2 s[28:29], s[0:1], 64
    s_load_dwordx2 s[30:31], s[0:1], 80
    s_mul_i32 s40, s9, 16384
    s_add_u32 s40, s40, 16384
    v_add_u32 v109, s40, v1
    v_lshrrev_b32 v110, 8, v1
    v_lshlrev_b32 v110, 8, v110
    v_bfe_u32 v108, v1, 6, 2
    v_lshl_add_u32 v110, v108, 5, v110
    v_bfe_u32 v108, v1, 4, 2
    v_lshl_add_u32 v110, v108, 3, v110
    v_add_u32 v110, s40, v110
    s_waitcnt lgkmcnt(0)
    v_mov_b32 v128, 0
    v_mov_b32 v129, 0
    v_mov_b32 v130, 0
    v_mov_b32 v131, 0
    s_add_u32 s39, s9, 0
    s_cmp_ge_u32 s39, 11
    s_cbranch_scc1 L_f1z_77
    s_mul_i32 s38, s26, 11
    s_add_u32 s38, s38, s39
    s_cmp_ge_u32 s38, 86
    s_cbranch_scc1 L_f1z_77
    s_lshl_b32 s38, s38, 5
    v_lshrrev_b32 v111, 8, v1
    v_lshlrev_b32 v111, 3, v111
    v_add_u32 v111, s38, v111
    global_load_dwordx2 v[80:81], v111, s[54:55]
    v_lshrrev_b32 v108, 5, v1
    v_mul_u32_u24 v108, 2752, v108
    v_and_b32 v111, 16, v1
    v_add_u32 v108, v108, v111
    v_add_u32 v108, s38, v108
    global_load_dwordx4 v[16:19], v108, s[28:29]
    v_add_u32 v108, 88064, v108
    global_load_dwordx4 v[20:23], v108, s[28:29]
    v_add_u32 v108, 88064, v108
    global_load_dwordx4 v[24:27], v108, s[28:29]
    v_add_u32 v108, 88064, v108
    global_load_dwordx4 v[28:31], v108, s[28:29]
    v_add_u32 v108, 88064, v108
    global_load_dwordx4 v[32:35], v108, s[28:29]
    v_add_u32 v108, 88064, v108
    global_load_dwordx4 v[36:39], v108, s[28:29]
    v_add_u32 v108, 88064, v108
    global_load_dwordx4 v[40:43], v108, s[28:29]
    v_add_u32 v108, 88064, v108
    global_load_dwordx4 v[44:47], v108, s[28:29]
    v_add_u32 v108, 88064, v108
    global_load_dwordx4 v[48:51], v108, s[28:29]
    v_add_u32 v108, 88064, v108
    global_load_dwordx4 v[52:55], v108, s[28:29]
    v_add_u32 v108, 88064, v108
    global_load_dwordx4 v[56:59], v108, s[28:29]
    v_add_u32 v108, 88064, v108
    global_load_dwordx4 v[60:63], v108, s[28:29]
    v_add_u32 v108, 88064, v108
    global_load_dwordx4 v[64:67], v108, s[28:29]
    v_add_u32 v108, 88064, v108
    global_load_dwordx4 v[68:71], v108, s[28:29]
    v_add_u32 v108, 88064, v108
    global_load_dwordx4 v[72:75], v108, s[28:29]
    v_add_u32 v108, 88064, v108
    global_load_dwordx4 v[76:79], v108, s[28:29]
    s_waitcnt vmcnt(0)
    ds_write_b128 v109, v[16:19] offset:0
    ds_write_b128 v109, v[20:23] offset:1024
    ds_write_b128 v109, v[24:27] offset:2048
    ds_write_b128 v109, v[28:31] offset:3072
    ds_write_b128 v109, v[32:35] offset:4096
    ds_write_b128 v109, v[36:39] offset:5120
    ds_write_b128 v109, v[40:43] offset:6144
    ds_write_b128 v109, v[44:47] offset:7168
    ds_write_b128 v109, v[48:51] offset:8192
    ds_write_b128 v109, v[52:55] offset:9216
    ds_write_b128 v109, v[56:59] offset:10240
    ds_write_b128 v109, v[60:63] offset:11264
    ds_write_b128 v109, v[64:67] offset:12288
    ds_write_b128 v109, v[68:71] offset:13312
    ds_write_b128 v109, v[72:75] offset:14336
    ds_write_b128 v109, v[76:79] offset:15360
    v_lshlrev_b32 v128, 16, v80
    v_and_b32 v129, 0xffff0000, v80
    v_lshlrev_b32 v130, 16, v81
    v_and_b32 v131, 0xffff0000, v81
    s_waitcnt lgkmcnt(0)
    ds_read_b64_tr_b16 a[0:1], v110 offset:0
    ds_read_b64_tr_b16 a[2:3], v110 offset:128
    ds_read_b64_tr_b16 a[4:5], v110 offset:1024
    ds_read_b64_tr_b16 a[6:7], v110 offset:1152
    ds_read_b64_tr_b16 a[8:9], v110 offset:2048
    ds_read_b64_tr_b16 a[10:11], v110 offset:2176
    ds_read_b64_tr_b16 a[12:13], v110 offset:3072
    ds_read_b64_tr_b16 a[14:15], v110 offset:3200
    ds_read_b64_tr_b16 a[16:17], v110 offset:4096
    ds_read_b64_tr_b16 a[18:19], v110 offset:4224
    ds_read_b64_tr_b16 a[20:21], v110 offset:5120
    ds_read_b64_tr_b16 a[22:23], v110 offset:5248
    ds_read_b64_tr_b16 a[24:25], v110 offset:6144
    ds_read_b64_tr_b16 a[26:27], v110 offset:6272
    ds_read_b64_tr_b16 a[28:29], v110 offset:7168
    ds_read_b64_tr_b16 a[30:31], v110 offset:7296
    ds_read_b64_tr_b16 a[32:33], v110 offset:8192
    ds_read_b64_tr_b16 a[34:35], v110 offset:8320
    ds_read_b64_tr_b16 a[36:37], v110 offset:9216
    ds_read_b64_tr_b16 a[38:39], v110 offset:9344
    ds_read_b64_tr_b16 a[40:41], v110 offset:10240
    ds_read_b64_tr_b16 a[42:43], v110 offset:10368
    ds_read_b64_tr_b16 a[44:45], v110 offset:11264
    ds_read_b64_tr_b16 a[46:47], v110 offset:11392
    ds_read_b64_tr_b16 a[48:49], v110 offset:12288
    ds_read_b64_tr_b16 a[50:51], v110 offset:12416
    ds_read_b64_tr_b16 a[52:53], v110 offset:13312
    ds_read_b64_tr_b16 a[54:55], v110 offset:13440
    ds_read_b64_tr_b16 a[56:57], v110 offset:14336
    ds_read_b64_tr_b16 a[58:59], v110 offset:14464
    ds_read_b64_tr_b16 a[60:61], v110 offset:15360
    ds_read_b64_tr_b16 a[62:63], v110 offset:15488
    s_waitcnt lgkmcnt(0)
    s_branch L_f1d_78
L_f1z_77:
    v_accvgpr_write_b32 a0, 0
    v_accvgpr_write_b32 a1, 0
    v_accvgpr_write_b32 a2, 0
    v_accvgpr_write_b32 a3, 0
    v_accvgpr_write_b32 a4, 0
    v_accvgpr_write_b32 a5, 0
    v_accvgpr_write_b32 a6, 0
    v_accvgpr_write_b32 a7, 0
    v_accvgpr_write_b32 a8, 0
    v_accvgpr_write_b32 a9, 0
    v_accvgpr_write_b32 a10, 0
    v_accvgpr_write_b32 a11, 0
    v_accvgpr_write_b32 a12, 0
    v_accvgpr_write_b32 a13, 0
    v_accvgpr_write_b32 a14, 0
    v_accvgpr_write_b32 a15, 0
    v_accvgpr_write_b32 a16, 0
    v_accvgpr_write_b32 a17, 0
    v_accvgpr_write_b32 a18, 0
    v_accvgpr_write_b32 a19, 0
    v_accvgpr_write_b32 a20, 0
    v_accvgpr_write_b32 a21, 0
    v_accvgpr_write_b32 a22, 0
    v_accvgpr_write_b32 a23, 0
    v_accvgpr_write_b32 a24, 0
    v_accvgpr_write_b32 a25, 0
    v_accvgpr_write_b32 a26, 0
    v_accvgpr_write_b32 a27, 0
    v_accvgpr_write_b32 a28, 0
    v_accvgpr_write_b32 a29, 0
    v_accvgpr_write_b32 a30, 0
    v_accvgpr_write_b32 a31, 0
    v_accvgpr_write_b32 a32, 0
    v_accvgpr_write_b32 a33, 0
    v_accvgpr_write_b32 a34, 0
    v_accvgpr_write_b32 a35, 0
    v_accvgpr_write_b32 a36, 0
    v_accvgpr_write_b32 a37, 0
    v_accvgpr_write_b32 a38, 0
    v_accvgpr_write_b32 a39, 0
    v_accvgpr_write_b32 a40, 0
    v_accvgpr_write_b32 a41, 0
    v_accvgpr_write_b32 a42, 0
    v_accvgpr_write_b32 a43, 0
    v_accvgpr_write_b32 a44, 0
    v_accvgpr_write_b32 a45, 0
    v_accvgpr_write_b32 a46, 0
    v_accvgpr_write_b32 a47, 0
    v_accvgpr_write_b32 a48, 0
    v_accvgpr_write_b32 a49, 0
    v_accvgpr_write_b32 a50, 0
    v_accvgpr_write_b32 a51, 0
    v_accvgpr_write_b32 a52, 0
    v_accvgpr_write_b32 a53, 0
    v_accvgpr_write_b32 a54, 0
    v_accvgpr_write_b32 a55, 0
    v_accvgpr_write_b32 a56, 0
    v_accvgpr_write_b32 a57, 0
    v_accvgpr_write_b32 a58, 0
    v_accvgpr_write_b32 a59, 0
    v_accvgpr_write_b32 a60, 0
    v_accvgpr_write_b32 a61, 0
    v_accvgpr_write_b32 a62, 0
    v_accvgpr_write_b32 a63, 0
    s_nop 1
L_f1d_78:
    v_mov_b32 v132, 0
    v_mov_b32 v133, 0
    v_mov_b32 v134, 0
    v_mov_b32 v135, 0
    s_add_u32 s39, s9, 4
    s_cmp_ge_u32 s39, 11
    s_cbranch_scc1 L_f1z_79
    s_mul_i32 s38, s26, 11
    s_add_u32 s38, s38, s39
    s_cmp_ge_u32 s38, 86
    s_cbranch_scc1 L_f1z_79
    s_lshl_b32 s38, s38, 5
    v_lshrrev_b32 v111, 8, v1
    v_lshlrev_b32 v111, 3, v111
    v_add_u32 v111, s38, v111
    global_load_dwordx2 v[80:81], v111, s[54:55]
    v_lshrrev_b32 v108, 5, v1
    v_mul_u32_u24 v108, 2752, v108
    v_and_b32 v111, 16, v1
    v_add_u32 v108, v108, v111
    v_add_u32 v108, s38, v108
    global_load_dwordx4 v[16:19], v108, s[28:29]
    v_add_u32 v108, 88064, v108
    global_load_dwordx4 v[20:23], v108, s[28:29]
    v_add_u32 v108, 88064, v108
    global_load_dwordx4 v[24:27], v108, s[28:29]
    v_add_u32 v108, 88064, v108
    global_load_dwordx4 v[28:31], v108, s[28:29]
    v_add_u32 v108, 88064, v108
    global_load_dwordx4 v[32:35], v108, s[28:29]
    v_add_u32 v108, 88064, v108
    global_load_dwordx4 v[36:39], v108, s[28:29]
    v_add_u32 v108, 88064, v108
    global_load_dwordx4 v[40:43], v108, s[28:29]
    v_add_u32 v108, 88064, v108
    global_load_dwordx4 v[44:47], v108, s[28:29]
    v_add_u32 v108, 88064, v108
    global_load_dwordx4 v[48:51], v108, s[28:29]
    v_add_u32 v108, 88064, v108
    global_load_dwordx4 v[52:55], v108, s[28:29]
    v_add_u32 v108, 88064, v108
    global_load_dwordx4 v[56:59], v108, s[28:29]
    v_add_u32 v108, 88064, v108
    global_load_dwordx4 v[60:63], v108, s[28:29]
    v_add_u32 v108, 88064, v108
    global_load_dwordx4 v[64:67], v108, s[28:29]
    v_add_u32 v108, 88064, v108
    global_load_dwordx4 v[68:71], v108, s[28:29]
    v_add_u32 v108, 88064, v108
    global_load_dwordx4 v[72:75], v108, s[28:29]
    v_add_u32 v108, 88064, v108
    global_load_dwordx4 v[76:79], v108, s[28:29]
    s_waitcnt vmcnt(0)
    ds_write_b128 v109, v[16:19] offset:0
    ds_write_b128 v109, v[20:23] offset:1024
    ds_write_b128 v109, v[24:27] offset:2048
    ds_write_b128 v109, v[28:31] offset:3072
    ds_write_b128 v109, v[32:35] offset:4096
    ds_write_b128 v109, v[36:39] offset:5120
    ds_write_b128 v109, v[40:43] offset:6144
    ds_write_b128 v109, v[44:47] offset:7168
    ds_write_b128 v109, v[48:51] offset:8192
    ds_write_b128 v109, v[52:55] offset:9216
    ds_write_b128 v109, v[56:59] offset:10240
    ds_write_b128 v109, v[60:63] offset:11264
    ds_write_b128 v109, v[64:67] offset:12288
    ds_write_b128 v109, v[68:71] offset:13312
    ds_write_b128 v109, v[72:75] offset:14336
    ds_write_b128 v109, v[76:79] offset:15360
    v_lshlrev_b32 v132, 16, v80
    v_and_b32 v133, 0xffff0000, v80
    v_lshlrev_b32 v134, 16, v81
    v_and_b32 v135, 0xffff0000, v81
    s_waitcnt lgkmcnt(0)
    ds_read_b64_tr_b16 a[64:65], v110 offset:0
    ds_read_b64_tr_b16 a[66:67], v110 offset:128
    ds_read_b64_tr_b16 a[68:69], v110 offset:1024
    ds_read_b64_tr_b16 a[70:71], v110 offset:1152
    ds_read_b64_tr_b16 a[72:73], v110 offset:2048
    ds_read_b64_tr_b16 a[74:75], v110 offset:2176
    ds_read_b64_tr_b16 a[76:77], v110 offset:3072
    ds_read_b64_tr_b16 a[78:79], v110 offset:3200
    ds_read_b64_tr_b16 a[80:81], v110 offset:4096
    ds_read_b64_tr_b16 a[82:83], v110 offset:4224
    ds_read_b64_tr_b16 a[84:85], v110 offset:5120
    ds_read_b64_tr_b16 a[86:87], v110 offset:5248
    ds_read_b64_tr_b16 a[88:89], v110 offset:6144
    ds_read_b64_tr_b16 a[90:91], v110 offset:6272
    ds_read_b64_tr_b16 a[92:93], v110 offset:7168
    ds_read_b64_tr_b16 a[94:95], v110 offset:7296
    ds_read_b64_tr_b16 a[96:97], v110 offset:8192
    ds_read_b64_tr_b16 a[98:99], v110 offset:8320
    ds_read_b64_tr_b16 a[100:101], v110 offset:9216
    ds_read_b64_tr_b16 a[102:103], v110 offset:9344
    ds_read_b64_tr_b16 a[104:105], v110 offset:10240
    ds_read_b64_tr_b16 a[106:107], v110 offset:10368
    ds_read_b64_tr_b16 a[108:109], v110 offset:11264
    ds_read_b64_tr_b16 a[110:111], v110 offset:11392
    ds_read_b64_tr_b16 a[112:113], v110 offset:12288
    ds_read_b64_tr_b16 a[114:115], v110 offset:12416
    ds_read_b64_tr_b16 a[116:117], v110 offset:13312
    ds_read_b64_tr_b16 a[118:119], v110 offset:13440
    ds_read_b64_tr_b16 a[120:121], v110 offset:14336
    ds_read_b64_tr_b16 a[122:123], v110 offset:14464
    ds_read_b64_tr_b16 a[124:125], v110 offset:15360
    ds_read_b64_tr_b16 a[126:127], v110 offset:15488
    s_waitcnt lgkmcnt(0)
    s_branch L_f1d_80
L_f1z_79:
    v_accvgpr_write_b32 a64, 0
    v_accvgpr_write_b32 a65, 0
    v_accvgpr_write_b32 a66, 0
    v_accvgpr_write_b32 a67, 0
    v_accvgpr_write_b32 a68, 0
    v_accvgpr_write_b32 a69, 0
    v_accvgpr_write_b32 a70, 0
    v_accvgpr_write_b32 a71, 0
    v_accvgpr_write_b32 a72, 0
    v_accvgpr_write_b32 a73, 0
    v_accvgpr_write_b32 a74, 0
    v_accvgpr_write_b32 a75, 0
    v_accvgpr_write_b32 a76, 0
    v_accvgpr_write_b32 a77, 0
    v_accvgpr_write_b32 a78, 0
    v_accvgpr_write_b32 a79, 0
    v_accvgpr_write_b32 a80, 0
    v_accvgpr_write_b32 a81, 0
    v_accvgpr_write_b32 a82, 0
    v_accvgpr_write_b32 a83, 0
    v_accvgpr_write_b32 a84, 0
    v_accvgpr_write_b32 a85, 0
    v_accvgpr_write_b32 a86, 0
    v_accvgpr_write_b32 a87, 0
    v_accvgpr_write_b32 a88, 0
    v_accvgpr_write_b32 a89, 0
    v_accvgpr_write_b32 a90, 0
    v_accvgpr_write_b32 a91, 0
    v_accvgpr_write_b32 a92, 0
    v_accvgpr_write_b32 a93, 0
    v_accvgpr_write_b32 a94, 0
    v_accvgpr_write_b32 a95, 0
    v_accvgpr_write_b32 a96, 0
    v_accvgpr_write_b32 a97, 0
    v_accvgpr_write_b32 a98, 0
    v_accvgpr_write_b32 a99, 0
    v_accvgpr_write_b32 a100, 0
    v_accvgpr_write_b32 a101, 0
    v_accvgpr_write_b32 a102, 0
    v_accvgpr_write_b32 a103, 0
    v_accvgpr_write_b32 a104, 0
    v_accvgpr_write_b32 a105, 0
    v_accvgpr_write_b32 a106, 0
    v_accvgpr_write_b32 a107, 0
    v_accvgpr_write_b32 a108, 0
    v_accvgpr_write_b32 a109, 0
    v_accvgpr_write_b32 a110, 0
    v_accvgpr_write_b32 a111, 0
    v_accvgpr_write_b32 a112, 0
    v_accvgpr_write_b32 a113, 0
    v_accvgpr_write_b32 a114, 0
    v_accvgpr_write_b32 a115, 0
    v_accvgpr_write_b32 a116, 0
    v_accvgpr_write_b32 a117, 0
    v_accvgpr_write_b32 a118, 0
    v_accvgpr_write_b32 a119, 0
    v_accvgpr_write_b32 a120, 0
    v_accvgpr_write_b32 a121, 0
    v_accvgpr_write_b32 a122, 0
    v_accvgpr_write_b32 a123, 0
    v_accvgpr_write_b32 a124, 0
    v_accvgpr_write_b32 a125, 0
    v_accvgpr_write_b32 a126, 0
    v_accvgpr_write_b32 a127, 0
    s_nop 1
L_f1d_80:
    v_mov_b32 v136, 0
    v_mov_b32 v137, 0
    v_mov_b32 v138, 0
    v_mov_b32 v139, 0
    s_add_u32 s39, s9, 8
    s_cmp_ge_u32 s39, 11
    s_cbranch_scc1 L_f1z_81
    s_mul_i32 s38, s26, 11
    s_add_u32 s38, s38, s39
    s_cmp_ge_u32 s38, 86
    s_cbranch_scc1 L_f1z_81
    s_lshl_b32 s38, s38, 5
    v_lshrrev_b32 v111, 8, v1
    v_lshlrev_b32 v111, 3, v111
    v_add_u32 v111, s38, v111
    global_load_dwordx2 v[80:81], v111, s[54:55]
    v_lshrrev_b32 v108, 5, v1
    v_mul_u32_u24 v108, 2752, v108
    v_and_b32 v111, 16, v1
    v_add_u32 v108, v108, v111
    v_add_u32 v108, s38, v108
    global_load_dwordx4 v[16:19], v108, s[28:29]
    v_add_u32 v108, 88064, v108
    global_load_dwordx4 v[20:23], v108, s[28:29]
    v_add_u32 v108, 88064, v108
    global_load_dwordx4 v[24:27], v108, s[28:29]
    v_add_u32 v108, 88064, v108
    global_load_dwordx4 v[28:31], v108, s[28:29]
    v_add_u32 v108, 88064, v108
    global_load_dwordx4 v[32:35], v108, s[28:29]
    v_add_u32 v108, 88064, v108
    global_load_dwordx4 v[36:39], v108, s[28:29]
    v_add_u32 v108, 88064, v108
    global_load_dwordx4 v[40:43], v108, s[28:29]
    v_add_u32 v108, 88064, v108
    global_load_dwordx4 v[44:47], v108, s[28:29]
    v_add_u32 v108, 88064, v108
    global_load_dwordx4 v[48:51], v108, s[28:29]
    v_add_u32 v108, 88064, v108
    global_load_dwordx4 v[52:55], v108, s[28:29]
    v_add_u32 v108, 88064, v108
    global_load_dwordx4 v[56:59], v108, s[28:29]
    v_add_u32 v108, 88064, v108
    global_load_dwordx4 v[60:63], v108, s[28:29]
    v_add_u32 v108, 88064, v108
    global_load_dwordx4 v[64:67], v108, s[28:29]
    v_add_u32 v108, 88064, v108
    global_load_dwordx4 v[68:71], v108, s[28:29]
    v_add_u32 v108, 88064, v108
    global_load_dwordx4 v[72:75], v108, s[28:29]
    v_add_u32 v108, 88064, v108
    global_load_dwordx4 v[76:79], v108, s[28:29]
    s_waitcnt vmcnt(0)
    ds_write_b128 v109, v[16:19] offset:0
    ds_write_b128 v109, v[20:23] offset:1024
    ds_write_b128 v109, v[24:27] offset:2048
    ds_write_b128 v109, v[28:31] offset:3072
    ds_write_b128 v109, v[32:35] offset:4096
    ds_write_b128 v109, v[36:39] offset:5120
    ds_write_b128 v109, v[40:43] offset:6144
    ds_write_b128 v109, v[44:47] offset:7168
    ds_write_b128 v109, v[48:51] offset:8192
    ds_write_b128 v109, v[52:55] offset:9216
    ds_write_b128 v109, v[56:59] offset:10240
    ds_write_b128 v109, v[60:63] offset:11264
    ds_write_b128 v109, v[64:67] offset:12288
    ds_write_b128 v109, v[68:71] offset:13312
    ds_write_b128 v109, v[72:75] offset:14336
    ds_write_b128 v109, v[76:79] offset:15360
    v_lshlrev_b32 v136, 16, v80
    v_and_b32 v137, 0xffff0000, v80
    v_lshlrev_b32 v138, 16, v81
    v_and_b32 v139, 0xffff0000, v81
    s_waitcnt lgkmcnt(0)
    ds_read_b64_tr_b16 a[128:129], v110 offset:0
    ds_read_b64_tr_b16 a[130:131], v110 offset:128
    ds_read_b64_tr_b16 a[132:133], v110 offset:1024
    ds_read_b64_tr_b16 a[134:135], v110 offset:1152
    ds_read_b64_tr_b16 a[136:137], v110 offset:2048
    ds_read_b64_tr_b16 a[138:139], v110 offset:2176
    ds_read_b64_tr_b16 a[140:141], v110 offset:3072
    ds_read_b64_tr_b16 a[142:143], v110 offset:3200
    ds_read_b64_tr_b16 a[144:145], v110 offset:4096
    ds_read_b64_tr_b16 a[146:147], v110 offset:4224
    ds_read_b64_tr_b16 a[148:149], v110 offset:5120
    ds_read_b64_tr_b16 a[150:151], v110 offset:5248
    ds_read_b64_tr_b16 a[152:153], v110 offset:6144
    ds_read_b64_tr_b16 a[154:155], v110 offset:6272
    ds_read_b64_tr_b16 a[156:157], v110 offset:7168
    ds_read_b64_tr_b16 a[158:159], v110 offset:7296
    ds_read_b64_tr_b16 a[160:161], v110 offset:8192
    ds_read_b64_tr_b16 a[162:163], v110 offset:8320
    ds_read_b64_tr_b16 a[164:165], v110 offset:9216
    ds_read_b64_tr_b16 a[166:167], v110 offset:9344
    ds_read_b64_tr_b16 a[168:169], v110 offset:10240
    ds_read_b64_tr_b16 a[170:171], v110 offset:10368
    ds_read_b64_tr_b16 a[172:173], v110 offset:11264
    ds_read_b64_tr_b16 a[174:175], v110 offset:11392
    ds_read_b64_tr_b16 a[176:177], v110 offset:12288
    ds_read_b64_tr_b16 a[178:179], v110 offset:12416
    ds_read_b64_tr_b16 a[180:181], v110 offset:13312
    ds_read_b64_tr_b16 a[182:183], v110 offset:13440
    ds_read_b64_tr_b16 a[184:185], v110 offset:14336
    ds_read_b64_tr_b16 a[186:187], v110 offset:14464
    ds_read_b64_tr_b16 a[188:189], v110 offset:15360
    ds_read_b64_tr_b16 a[190:191], v110 offset:15488
    s_waitcnt lgkmcnt(0)
    s_branch L_f1d_82
L_f1z_81:
    v_accvgpr_write_b32 a128, 0
    v_accvgpr_write_b32 a129, 0
    v_accvgpr_write_b32 a130, 0
    v_accvgpr_write_b32 a131, 0
    v_accvgpr_write_b32 a132, 0
    v_accvgpr_write_b32 a133, 0
    v_accvgpr_write_b32 a134, 0
    v_accvgpr_write_b32 a135, 0
    v_accvgpr_write_b32 a136, 0
    v_accvgpr_write_b32 a137, 0
    v_accvgpr_write_b32 a138, 0
    v_accvgpr_write_b32 a139, 0
    v_accvgpr_write_b32 a140, 0
    v_accvgpr_write_b32 a141, 0
    v_accvgpr_write_b32 a142, 0
    v_accvgpr_write_b32 a143, 0
    v_accvgpr_write_b32 a144, 0
    v_accvgpr_write_b32 a145, 0
    v_accvgpr_write_b32 a146, 0
    v_accvgpr_write_b32 a147, 0
    v_accvgpr_write_b32 a148, 0
    v_accvgpr_write_b32 a149, 0
    v_accvgpr_write_b32 a150, 0
    v_accvgpr_write_b32 a151, 0
    v_accvgpr_write_b32 a152, 0
    v_accvgpr_write_b32 a153, 0
    v_accvgpr_write_b32 a154, 0
    v_accvgpr_write_b32 a155, 0
    v_accvgpr_write_b32 a156, 0
    v_accvgpr_write_b32 a157, 0
    v_accvgpr_write_b32 a158, 0
    v_accvgpr_write_b32 a159, 0
    v_accvgpr_write_b32 a160, 0
    v_accvgpr_write_b32 a161, 0
    v_accvgpr_write_b32 a162, 0
    v_accvgpr_write_b32 a163, 0
    v_accvgpr_write_b32 a164, 0
    v_accvgpr_write_b32 a165, 0
    v_accvgpr_write_b32 a166, 0
    v_accvgpr_write_b32 a167, 0
    v_accvgpr_write_b32 a168, 0
    v_accvgpr_write_b32 a169, 0
    v_accvgpr_write_b32 a170, 0
    v_accvgpr_write_b32 a171, 0
    v_accvgpr_write_b32 a172, 0
    v_accvgpr_write_b32 a173, 0
    v_accvgpr_write_b32 a174, 0
    v_accvgpr_write_b32 a175, 0
    v_accvgpr_write_b32 a176, 0
    v_accvgpr_write_b32 a177, 0
    v_accvgpr_write_b32 a178, 0
    v_accvgpr_write_b32 a179, 0
    v_accvgpr_write_b32 a180, 0
    v_accvgpr_write_b32 a181, 0
    v_accvgpr_write_b32 a182, 0
    v_accvgpr_write_b32 a183, 0
    v_accvgpr_write_b32 a184, 0
    v_accvgpr_write_b32 a185, 0
    v_accvgpr_write_b32 a186, 0
    v_accvgpr_write_b32 a187, 0
    v_accvgpr_write_b32 a188, 0
    v_accvgpr_write_b32 a189, 0
    v_accvgpr_write_b32 a190, 0
    v_accvgpr_write_b32 a191, 0
    s_nop 1
L_f1d_82:
    v_lshrrev_b32 v110, 8, v1
    v_lshlrev_b32 v110, 8, v110
    v_bfe_u32 v108, v1, 6, 2
    v_lshl_add_u32 v110, v108, 6, v110
    v_bfe_u32 v108, v1, 4, 2
    v_lshl_add_u32 v110, v108, 4, v110
    v_add_u32 v110, s40, v110
    global_load_dwordx4 v[140:143], v1, s[56:57]
    v_lshrrev_b32 v108, 6, v1
    v_lshlrev_b32 v108, 10, v108
    v_and_b32 v111, 48, v1
    v_add_u32 v108, v108, v111
    s_mul_i32 s38, s26, 180224
    s_lshl_b32 s39, s9, 6
    s_add_u32 s38, s38, s39
    s_add_u32 s38, s38, 0
    v_add_u32 v108, s38, v108
    global_load_dwordx4 v[16:19], v108, s[30:31]
    v_add_u32 v108, 16384, v108
    global_load_dwordx4 v[20:23], v108, s[30:31]
    v_add_u32 v108, 16384, v108
    global_load_dwordx4 v[24:27], v108, s[30:31]
    v_add_u32 v108, 16384, v108
    global_load_dwordx4 v[28:31], v108, s[30:31]
    v_add_u32 v108, 16384, v108
    global_load_dwordx4 v[32:35], v108, s[30:31]
    v_add_u32 v108, 16384, v108
    global_load_dwordx4 v[36:39], v108, s[30:31]
    v_add_u32 v108, 16384, v108
    global_load_dwordx4 v[40:43], v108, s[30:31]
    v_add_u32 v108, 16384, v108
    global_load_dwordx4 v[44:47], v108, s[30:31]
    v_add_u32 v108, 16384, v108
    global_load_dwordx4 v[48:51], v108, s[30:31]
    v_add_u32 v108, 16384, v108
    v_mov_b32 v52, 0
    v_mov_b32 v53, 0
    v_mov_b32 v54, 0
    v_mov_b32 v55, 0
    v_mov_b32 v56, 0
    v_mov_b32 v57, 0
    v_mov_b32 v58, 0
    v_mov_b32 v59, 0
    s_cmp_eq_u32 s26, 7
    s_nop 0
    s_cbranch_scc1 L_f2z_83
    global_load_dwordx4 v[52:55], v108, s[30:31]
    v_add_u32 v108, 16384, v108
    global_load_dwordx4 v[56:59], v108, s[30:31]
    v_add_u32 v108, 16384, v108
    s_nop 1
L_f2z_83:
    s_waitcnt vmcnt(0)
    ds_write_b128 v109, v[16:19] offset:0
    ds_write_b128 v109, v[20:23] offset:1024
    ds_write_b128 v109, v[24:27] offset:2048
    ds_write_b128 v109, v[28:31] offset:3072
    ds_write_b128 v109, v[32:35] offset:4096
    ds_write_b128 v109, v[36:39] offset:5120
    ds_write_b128 v109, v[40:43] offset:6144
    ds_write_b128 v109, v[44:47] offset:7168
    ds_write_b128 v109, v[48:51] offset:8192
    ds_write_b128 v109, v[52:55] offset:9216
    ds_write_b128 v109, v[56:59] offset:10240
    s_waitcnt lgkmcnt(0)
    ds_read_b64_tr_b16 a[192:193], v110 offset:0
    ds_read_b64_tr_b16 a[194:195], v110 offset:1024
    ds_read_b64_tr_b16 a[196:197], v110 offset:8
    ds_read_b64_tr_b16 a[198:199], v110 offset:1032
    ds_read_b64_tr_b16 a[200:201], v110 offset:2048
    ds_read_b64_tr_b16 a[202:203], v110 offset:3072
    ds_read_b64_tr_b16 a[204:205], v110 offset:2056
    ds_read_b64_tr_b16 a[206:207], v110 offset:3080
    ds_read_b64_tr_b16 a[208:209], v110 offset:4096
    ds_read_b64_tr_b16 a[210:211], v110 offset:5120
    ds_read_b64_tr_b16 a[212:213], v110 offset:4104
    ds_read_b64_tr_b16 a[214:215], v110 offset:5128
    ds_read_b64_tr_b16 a[216:217], v110 offset:6144
    ds_read_b64_tr_b16 a[218:219], v110 offset:7168
    ds_read_b64_tr_b16 a[220:221], v110 offset:6152
    ds_read_b64_tr_b16 a[222:223], v110 offset:7176
    ds_read_b64_tr_b16 a[224:225], v110 offset:8192
    ds_read_b64_tr_b16 a[226:227], v110 offset:9216
    ds_read_b64_tr_b16 a[228:229], v110 offset:8200
    ds_read_b64_tr_b16 a[230:231], v110 offset:9224
    ds_read_b64_tr_b16 a[232:233], v110 offset:10240
    ds_read_b64_tr_b16 a[234:235], v110 offset:10248
    s_waitcnt lgkmcnt(0)
    v_lshrrev_b32 v108, 6, v1
    v_lshlrev_b32 v108, 10, v108
    v_and_b32 v111, 48, v1
    v_add_u32 v108, v108, v111
    s_mul_i32 s38, s26, 180224
    s_lshl_b32 s39, s9, 6
    s_add_u32 s38, s38, s39
    s_add_u32 s38, s38, 256
    v_add_u32 v108, s38, v108
    global_load_dwordx4 v[16:19], v108, s[30:31]
    v_add_u32 v108, 16384, v108
    global_load_dwordx4 v[20:23], v108, s[30:31]
    v_add_u32 v108, 16384, v108
    global_load_dwordx4 v[24:27], v108, s[30:31]
    v_add_u32 v108, 16384, v108
    global_load_dwordx4 v[28:31], v108, s[30:31]
    v_add_u32 v108, 16384, v108
    global_load_dwordx4 v[32:35], v108, s[30:31]
    v_add_u32 v108, 16384, v108
    global_load_dwordx4 v[36:39], v108, s[30:31]
    v_add_u32 v108, 16384, v108
    global_load_dwordx4 v[40:43], v108, s[30:31]
    v_add_u32 v108, 16384, v108
    global_load_dwordx4 v[44:47], v108, s[30:31]
    v_add_u32 v108, 16384, v108
    global_load_dwordx4 v[48:51], v108, s[30:31]
    v_add_u32 v108, 16384, v108
    v_mov_b32 v52, 0
    v_mov_b32 v53, 0
    v_mov_b32 v54, 0
    v_mov_b32 v55, 0
    v_mov_b32 v56, 0
    v_mov_b32 v57, 0
    v_mov_b32 v58, 0
    v_mov_b32 v59, 0
    s_cmp_eq_u32 s26, 7
    s_nop 0
    s_cbranch_scc1 L_f2z_84
    global_load_dwordx4 v[52:55], v108, s[30:31]
    v_add_u32 v108, 16384, v108
    global_load_dwordx4 v[56:59], v108, s[30:31]
    v_add_u32 v108, 16384, v108
    s_nop 1
L_f2z_84:
    s_waitcnt vmcnt(0)
    ds_write_b128 v109, v[16:19] offset:0
    ds_write_b128 v109, v[20:23] offset:1024
    ds_write_b128 v109, v[24:27] offset:2048
    ds_write_b128 v109, v[28:31] offset:3072
    ds_write_b128 v109, v[32:35] offset:4096
    ds_write_b128 v109, v[36:39] offset:5120
    ds_write_b128 v109, v[40:43] offset:6144
    ds_write_b128 v109, v[44:47] offset:7168
    ds_write_b128 v109, v[48:51] offset:8192
    ds_write_b128 v109, v[52:55] offset:9216
    ds_write_b128 v109, v[56:59] offset:10240
    s_waitcnt lgkmcnt(0)
    ds_read_b64_tr_b16 a[236:237], v110 offset:0
    ds_read_b64_tr_b16 a[238:239], v110 offset:1024
    ds_read_b64_tr_b16 a[240:241], v110 offset:8
    ds_read_b64_tr_b16 a[242:243], v110 offset:1032
    ds_read_b64_tr_b16 a[244:245], v110 offset:2048
    ds_read_b64_tr_b16 a[246:247], v110 offset:3072
    ds_read_b64_tr_b16 a[248:249], v110 offset:2056
    ds_read_b64_tr_b16 a[250:251], v110 offset:3080
    ds_read_b64_tr_b16 a[252:253], v110 offset:4096
    ds_read_b64_tr_b16 a[254:255], v110 offset:5120
    ds_read_b64_tr_b16 v[144:145], v110 offset:4104
    ds_read_b64_tr_b16 v[146:147], v110 offset:5128
    ds_read_b64_tr_b16 v[148:149], v110 offset:6144
    ds_read_b64_tr_b16 v[150:151], v110 offset:7168
    ds_read_b64_tr_b16 v[152:153], v110 offset:6152
    ds_read_b64_tr_b16 v[154:155], v110 offset:7176
    ds_read_b64_tr_b16 v[156:157], v110 offset:8192
    ds_read_b64_tr_b16 v[158:159], v110 offset:9216
    ds_read_b64_tr_b16 v[160:161], v110 offset:8200
    ds_read_b64_tr_b16 v[162:163], v110 offset:9224
    ds_read_b64_tr_b16 v[164:165], v110 offset:10240
    ds_read_b64_tr_b16 v[166:167], v110 offset:10248
    s_waitcnt lgkmcnt(0)
    v_lshrrev_b32 v108, 6, v1
    v_lshlrev_b32 v108, 10, v108
    v_and_b32 v111, 48, v1
    v_add_u32 v108, v108, v111
    s_mul_i32 s38, s26, 180224
    s_lshl_b32 s39, s9, 6
    s_add_u32 s38, s38, s39
    s_add_u32 s38, s38, 512
    v_add_u32 v108, s38, v108
    global_load_dwordx4 v[16:19], v108, s[30:31]
    v_add_u32 v108, 16384, v108
    global_load_dwordx4 v[20:23], v108, s[30:31]
    v_add_u32 v108, 16384, v108
    global_load_dwordx4 v[24:27], v108, s[30:31]
    v_add_u32 v108, 16384, v108
    global_load_dwordx4 v[28:31], v108, s[30:31]
    v_add_u32 v108, 16384, v108
    global_load_dwordx4 v[32:35], v108, s[30:31]
    v_add_u32 v108, 16384, v108
    global_load_dwordx4 v[36:39], v108, s[30:31]
    v_add_u32 v108, 16384, v108
    global_load_dwordx4 v[40:43], v108, s[30:31]
    v_add_u32 v108, 16384, v108
    global_load_dwordx4 v[44:47], v108, s[30:31]
    v_add_u32 v108, 16384, v108
    global_load_dwordx4 v[48:51], v108, s[30:31]
    v_add_u32 v108, 16384, v108
    v_mov_b32 v52, 0
    v_mov_b32 v53, 0
    v_mov_b32 v54, 0
    v_mov_b32 v55, 0
    v_mov_b32 v56, 0
    v_mov_b32 v57, 0
    v_mov_b32 v58, 0
    v_mov_b32 v59, 0
    s_cmp_eq_u32 s26, 7
    s_nop 0
    s_cbranch_scc1 L_f2z_85
    global_load_dwordx4 v[52:55], v108, s[30:31]
    v_add_u32 v108, 16384, v108
    global_load_dwordx4 v[56:59], v108, s[30:31]
    v_add_u32 v108, 16384, v108
    s_nop 1
L_f2z_85:
    s_waitcnt vmcnt(0)
    ds_write_b128 v109, v[16:19] offset:0
    ds_write_b128 v109, v[20:23] offset:1024
    ds_write_b128 v109, v[24:27] offset:2048
    ds_write_b128 v109, v[28:31] offset:3072
    ds_write_b128 v109, v[32:35] offset:4096
    ds_write_b128 v109, v[36:39] offset:5120
    ds_write_b128 v109, v[40:43] offset:6144
    ds_write_b128 v109, v[44:47] offset:7168
    ds_write_b128 v109, v[48:51] offset:8192
    ds_write_b128 v109, v[52:55] offset:9216
    ds_write_b128 v109, v[56:59] offset:10240
    s_waitcnt lgkmcnt(0)
    ds_read_b64_tr_b16 v[168:169], v110 offset:0
    ds_read_b64_tr_b16 v[170:171], v110 offset:1024
    ds_read_b64_tr_b16 v[172:173], v110 offset:8
    ds_read_b64_tr_b16 v[174:175], v110 offset:1032
    ds_read_b64_tr_b16 v[176:177], v110 offset:2048
    ds_read_b64_tr_b16 v[178:179], v110 offset:3072
    ds_read_b64_tr_b16 v[180:181], v110 offset:2056
    ds_read_b64_tr_b16 v[182:183], v110 offset:3080
    ds_read_b64_tr_b16 v[184:185], v110 offset:4096
    ds_read_b64_tr_b16 v[186:187], v110 offset:5120
    ds_read_b64_tr_b16 v[188:189], v110 offset:4104
    ds_read_b64_tr_b16 v[190:191], v110 offset:5128
    ds_read_b64_tr_b16 v[192:193], v110 offset:6144
    ds_read_b64_tr_b16 v[194:195], v110 offset:7168
    ds_read_b64_tr_b16 v[196:197], v110 offset:6152
    ds_read_b64_tr_b16 v[198:199], v110 offset:7176
    ds_read_b64_tr_b16 v[200:201], v110 offset:8192
    ds_read_b64_tr_b16 v[202:203], v110 offset:9216
    ds_read_b64_tr_b16 v[204:205], v110 offset:8200
    ds_read_b64_tr_b16 v[206:207], v110 offset:9224
    ds_read_b64_tr_b16 v[208:209], v110 offset:10240
    ds_read_b64_tr_b16 v[210:211], v110 offset:10248
    s_waitcnt lgkmcnt(0)
    v_lshrrev_b32 v108, 6, v1
    v_lshlrev_b32 v108, 10, v108
    v_and_b32 v111, 48, v1
    v_add_u32 v108, v108, v111
    s_mul_i32 s38, s26, 180224
    s_lshl_b32 s39, s9, 6
    s_add_u32 s38, s38, s39
    s_add_u32 s38, s38, 768
    v_add_u32 v108, s38, v108
    global_load_dwordx4 v[16:19], v108, s[30:31]
    v_add_u32 v108, 16384, v108
    global_load_dwordx4 v[20:23], v108, s[30:31]
    v_add_u32 v108, 16384, v108
    global_load_dwordx4 v[24:27], v108, s[30:31]
    v_add_u32 v108, 16384, v108
    global_load_dwordx4 v[28:31], v108, s[30:31]
    v_add_u32 v108, 16384, v108
    global_load_dwordx4 v[32:35], v108, s[30:31]
    v_add_u32 v108, 16384, v108
    global_load_dwordx4 v[36:39], v108, s[30:31]
    v_add_u32 v108, 16384, v108
    global_load_dwordx4 v[40:43], v108, s[30:31]
    v_add_u32 v108, 16384, v108
    global_load_dwordx4 v[44:47], v108, s[30:31]
    v_add_u32 v108, 16384, v108
    global_load_dwordx4 v[48:51], v108, s[30:31]
    v_add_u32 v108, 16384, v108
    v_mov_b32 v52, 0
    v_mov_b32 v53, 0
    v_mov_b32 v54, 0
    v_mov_b32 v55, 0
    v_mov_b32 v56, 0
    v_mov_b32 v57, 0
    v_mov_b32 v58, 0
    v_mov_b32 v59, 0
    s_cmp_eq_u32 s26, 7
    s_nop 0
    s_cbranch_scc1 L_f2z_86
    global_load_dwordx4 v[52:55], v108, s[30:31]
    v_add_u32 v108, 16384, v108
    global_load_dwordx4 v[56:59], v108, s[30:31]
    v_add_u32 v108, 16384, v108
    s_nop 1
L_f2z_86:
    s_waitcnt vmcnt(0)
    ds_write_b128 v109, v[16:19] offset:0
    ds_write_b128 v109, v[20:23] offset:1024
    ds_write_b128 v109, v[24:27] offset:2048
    ds_write_b128 v109, v[28:31] offset:3072
    ds_write_b128 v109, v[32:35] offset:4096
    ds_write_b128 v109, v[36:39] offset:5120
    ds_write_b128 v109, v[40:43] offset:6144
    ds_write_b128 v109, v[44:47] offset:7168
    ds_write_b128 v109, v[48:51] offset:8192
    ds_write_b128 v109, v[52:55] offset:9216
    ds_write_b128 v109, v[56:59] offset:10240
    s_waitcnt lgkmcnt(0)
    ds_read_b64_tr_b16 v[212:213], v110 offset:0
    ds_read_b64_tr_b16 v[214:215], v110 offset:1024
    ds_read_b64_tr_b16 v[216:217], v110 offset:8
    ds_read_b64_tr_b16 v[218:219], v110 offset:1032
    ds_read_b64_tr_b16 v[220:221], v110 offset:2048
    ds_read_b64_tr_b16 v[222:223], v110 offset:3072
    ds_read_b64_tr_b16 v[224:225], v110 offset:2056
    ds_read_b64_tr_b16 v[226:227], v110 offset:3080
    ds_read_b64_tr_b16 v[228:229], v110 offset:4096
    ds_read_b64_tr_b16 v[230:231], v110 offset:5120
    ds_read_b64_tr_b16 v[232:233], v110 offset:4104
    ds_read_b64_tr_b16 v[234:235], v110 offset:5128
    ds_read_b64_tr_b16 v[236:237], v110 offset:6144
    ds_read_b64_tr_b16 v[238:239], v110 offset:7168
    ds_read_b64_tr_b16 v[240:241], v110 offset:6152
    ds_read_b64_tr_b16 v[242:243], v110 offset:7176
    ds_read_b64_tr_b16 v[244:245], v110 offset:8192
    ds_read_b64_tr_b16 v[246:247], v110 offset:9216
    ds_read_b64_tr_b16 v[248:249], v110 offset:8200
    ds_read_b64_tr_b16 v[250:251], v110 offset:9224
    ds_read_b64_tr_b16 v[252:253], v110 offset:10240
    ds_read_b64_tr_b16 v[254:255], v110 offset:10248
    s_waitcnt lgkmcnt(0)
    s_barrier
    s_cmp_lg_u32 s9, 0
    s_cbranch_scc1 L_wg_88
    v_and_b32 v16, 15, v0
    v_lshlrev_b32 v16, 2, v16
    v_mov_b32 v17, 0
    s_mov_b32 s41, 2097152
    s_mov_b64 exec, 0x1ff
L_wgp_89:
    global_atomic_add v18, v16, v17, s[10:11] sc0 sc1
    s_waitcnt vmcnt(0)
    v_readlane_b32 s38, v18, 8
    s_sub_u32 s41, s41, 1
    s_cmp_eq_u32 s41, 0
    s_nop 2
    s_cbranch_scc1 L_end_75
    s_cmp_lt_u32 s38, 256
    s_cbranch_scc1 L_wgp_89
    global_atomic_add v18, v16, v17, s[10:11] sc0 sc1
    s_waitcnt vmcnt(0)
    s_mov_b64 exec, 0xff
    v_cmp_ne_u32 vcc, 32, v18
    s_mov_b64 exec, -1
    s_nop 0
    v_mov_b32 v18, vcc_lo
    v_mov_b32 v16, 161792
    ds_write_b32 v16, v18
    s_waitcnt lgkmcnt(0)
L_wg_88:
    s_barrier
    v_mov_b32 v16, 161792
    ds_read_b32 v18, v16
    s_waitcnt lgkmcnt(0)
    v_readfirstlane_b32 s38, v18
    s_barrier
    s_cmp_lg_u32 s38, 0
    s_nop 2
    s_cbranch_scc1 L_safe_far_f
    s_lshl_b32 s39, s6, 2
    s_add_u32 s39, s39, 64
    v_mov_b32 v17, s39
    s_mov_b32 s41, 2097152
    s_nop 0
L_dw_90:
    global_load_dword v18, v17, s[10:11] sc1
    s_waitcnt vmcnt(0)
    v_readfirstlane_b32 s38, v18
    s_sub_u32 s41, s41, 1
    s_cmp_eq_u32 s41, 0
    s_nop 2
    s_cbranch_scc1 L_end_75
    s_cmp_lt_u32 s38, 32
    s_cbranch_scc1 L_dw_90
L_go_87:
    v_mov_b32 v8, -1
    v_lshrrev_b32 v12, 8, v1
    v_mul_u32_u24 v11, 35072, v12
    v_and_b32 v12, 0xf0, v1
    v_add_u32 v11, v11, v12
    s_mul_i32 s38, s26, 2176
    s_lshl_b32 s39, s9, 8
    s_add_u32 s38, s38, s39
    v_add_u32 v11, s38, v11
    v_add_u32 v12, 17536, v11
    s_mov_b32 s18, 0
    v_bfe_u32 v16, v1, 4, 4
    v_lshrrev_b32 v17, 8, v1
    v_xor_b32 v17, v17, v16
    v_lshlrev_b32 v17, 4, v17
    v_lshl_add_u32 v17, v16, 10, v17
    v_add_u32 v3, 114688, v17
    v_xor_b32 v4, 64, v3
    v_xor_b32 v5, 128, v3
    v_xor_b32 v6, 192, v3
    s_and_b32 s38, s9, 1
    s_lshl_b32 s38, s38, 7
    v_xor_b32 v2, s38, v9
    s_mov_b32 s44, 0xbdd2d3e8
    s_mov_b32 s45, 0xbdd2d3e8
    s_lshl_b32 s46, s9, 13
    s_add_u32 s46, s46, 114688
    s_mov_b64 s[50:51], 0
    s_mov_b64 s[100:101], 0
    v_mov_b32 v15, 117481472
    s_mov_b32 s23, 0
    s_lshr_b32 s61, s22, 1
    s_lshl_b32 s38, s27, 6
    s_add_u32 s61, s61, s38
L_fj_91:
    s_and_b32 s24, s61, 63
    s_lshr_b32 s27, s61, 6
    s_lshl_b32 s38, s27, 21
    s_add_u32 s62, s38, 123731968
    s_cmp_ge_u32 s61, 116
    s_cselect_b32 s38, 4, 2
    s_add_u32 s63, s61, s38
    s_lshr_b32 s38, s61, 1
    s_cmp_eq_u32 s38, 31
    s_cselect_b32 s38, 54, 0
    s_add_u32 s63, s63, s38
    s_and_b32 s25, s23, 1
    s_mul_i32 s25, s25, 589824
    s_add_u32 s25, s25, s60
    s_bfe_u32 s36, s23, 0x10001
    s_xor_b32 s36, s36, 1
    s_cmp_lg_u64 s[50:51], 0
    s_cbranch_scc1 L_fpf_92
    s_waitcnt vmcnt(0)
    s_mov_b64 exec, s[100:101]
    global_store_dword v15, v8, s[4:5] sc1
    s_mov_b64 exec, -1
    s_mov_b64 s[100:101], 0
    s_lshl_b32 s38, s61, 7
    s_add_u32 s38, s38, 117456896
    s_lshl_b32 s39, s9, 5
    s_add_u32 s38, s38, s39
    v_bfe_u32 v79, v1, 4, 3
    v_lshlrev_b32 v79, 2, v79
    v_add_u32 v79, s38, v79
    s_mov_b32 s41, 2097152
    s_nop 0
L_pf_93:
    global_load_dword v76, v79, s[4:5] sc1
    s_sub_u32 s41, s41, 1
    s_cmp_eq_u32 s41, 0
    s_cbranch_scc1 L_end_75
    s_waitcnt vmcnt(0)
    v_cmp_eq_u32 vcc, 0, v76
    s_nop 4
    s_cbranch_vccnz L_pf_93
    s_lshl_b32 s38, s61, 15
    s_add_u32 s38, s38, 119537664
    s_add_u32 s28, s4, s38
    s_addc_u32 s29, s5, 0
    s_add_u32 m0, s46, 0
    s_nop 0
    global_load_lds_dwordx4 v2, s[28:29] offset:0 sc1
    v_xor_b32 v113, 16, v2
    global_load_lds_dwordx4 v113, s[28:29] offset:1024 sc1
    v_xor_b32 v114, 32, v2
    global_load_lds_dwordx4 v114, s[28:29] offset:2048 sc1
    v_xor_b32 v115, 48, v2
    global_load_lds_dwordx4 v115, s[28:29] offset:3072 sc1
    s_add_u32 m0, s46, 4096
    v_xor_b32 v116, 4160, v2
    global_load_lds_dwordx4 v116, s[28:29] offset:0 sc1
    v_xor_b32 v117, 4176, v2
    global_load_lds_dwordx4 v117, s[28:29] offset:1024 sc1
    v_xor_b32 v118, 4192, v2
    global_load_lds_dwordx4 v118, s[28:29] offset:2048 sc1
    v_xor_b32 v119, 4208, v2
    global_load_lds_dwordx4 v119, s[28:29] offset:3072 sc1
    s_waitcnt vmcnt(0)
L_fpf_92:
    s_cmp_eq_u32 s18, 0
    s_cbranch_scc1 L_f2c_94
    s_waitcnt vmcnt(1)
    s_mov_b32 s18, 0
L_f2c_94:
    s_barrier
    v_mov_b32 v74, 0xc0135761
    v_mov_b32 v77, 1.0
    v_lshrrev_b32 v78, 1, v1
    s_lshl_b32 s38, s9, 9
    v_add_u32 v75, s38, v78
    v_mov_b32 v76, 0
    ds_read_b128 v[28:31], v3 offset:0
    ds_read_b128 v[32:35], v4 offset:0
    ds_read_b128 v[36:39], v5 offset:0
    ds_read_b128 v[40:43], v6 offset:0
    s_waitcnt lgkmcnt(3)
    v_mfma_f32_16x16x32_bf16 v[16:19], a[0:3], v[28:31], 0
    v_mfma_f32_16x16x32_bf16 v[20:23], a[64:67], v[28:31], 0
    v_mfma_f32_16x16x32_bf16 v[24:27], a[128:131], v[28:31], 0
    ds_read_b128 v[28:31], v3 offset:256
    s_waitcnt lgkmcnt(3)
    v_mfma_f32_16x16x32_bf16 v[16:19], a[4:7], v[32:35], v[16:19]
    v_mfma_f32_16x16x32_bf16 v[20:23], a[68:71], v[32:35], v[20:23]
    v_mfma_f32_16x16x32_bf16 v[24:27], a[132:135], v[32:35], v[24:27]
    ds_read_b128 v[32:35], v4 offset:256
    s_waitcnt lgkmcnt(3)
    v_mfma_f32_16x16x32_bf16 v[16:19], a[8:11], v[36:39], v[16:19]
    v_mfma_f32_16x16x32_bf16 v[20:23], a[72:75], v[36:39], v[20:23]
    v_mfma_f32_16x16x32_bf16 v[24:27], a[136:139], v[36:39], v[24:27]
    ds_read_b128 v[36:39], v5 offset:256
    s_waitcnt lgkmcnt(3)
    v_mfma_f32_16x16x32_bf16 v[16:19], a[12:15], v[40:43], v[16:19]
    v_mfma_f32_16x16x32_bf16 v[20:23], a[76:79], v[40:43], v[20:23]
    v_mfma_f32_16x16x32_bf16 v[24:27], a[140:143], v[40:43], v[24:27]
    ds_read_b128 v[40:43], v6 offset:256
    s_waitcnt lgkmcnt(3)
    v_mfma_f32_16x16x32_bf16 v[16:19], a[16:19], v[28:31], v[16:19]
    v_mfma_f32_16x16x32_bf16 v[20:23], a[80:83], v[28:31], v[20:23]
    v_mfma_f32_16x16x32_bf16 v[24:27], a[144:147], v[28:31], v[24:27]
    ds_read_b128 v[28:31], v3 offset:512
    s_waitcnt lgkmcnt(3)
    v_mfma_f32_16x16x32_bf16 v[16:19], a[20:23], v[32:35], v[16:19]
    v_mfma_f32_16x16x32_bf16 v[20:23], a[84:87], v[32:35], v[20:23]
    v_mfma_f32_16x16x32_bf16 v[24:27], a[148:151], v[32:35], v[24:27]
    ds_read_b128 v[32:35], v4 offset:512
    s_waitcnt lgkmcnt(3)
    v_mfma_f32_16x16x32_bf16 v[16:19], a[24:27], v[36:39], v[16:19]
    v_mfma_f32_16x16x32_bf16 v[20:23], a[88:91], v[36:39], v[20:23]
    v_mfma_f32_16x16x32_bf16 v[24:27], a[152:155], v[36:39], v[24:27]
    ds_read_b128 v[36:39], v5 offset:512
    s_waitcnt lgkmcnt(3)
    v_mfma_f32_16x16x32_bf16 v[16:19], a[28:31], v[40:43], v[16:19]
    v_mfma_f32_16x16x32_bf16 v[20:23], a[92:95], v[40:43], v[20:23]
    v_mfma_f32_16x16x32_bf16 v[24:27], a[156:159], v[40:43], v[24:27]
    ds_read_b128 v[40:43], v6 offset:512
    s_waitcnt lgkmcnt(3)
    v_mfma_f32_16x16x32_bf16 v[16:19], a[32:35], v[28:31], v[16:19]
    v_mfma_f32_16x16x32_bf16 v[20:23], a[96:99], v[28:31], v[20:23]
    v_mfma_f32_16x16x32_bf16 v[24:27], a[160:163], v[28:31], v[24:27]
    ds_read_b128 v[28:31], v3 offset:768
    s_waitcnt lgkmcnt(3)
    v_mfma_f32_16x16x32_bf16 v[16:19], a[36:39], v[32:35], v[16:19]
    v_mfma_f32_16x16x32_bf16 v[20:23], a[100:103], v[32:35], v[20:23]
    v_mfma_f32_16x16x32_bf16 v[24:27], a[164:167], v[32:35], v[24:27]
    ds_read_b128 v[32:35], v4 offset:768
    s_waitcnt lgkmcnt(3)
    v_mfma_f32_16x16x32_bf16 v[16:19], a[40:43], v[36:39], v[16:19]
    v_mfma_f32_16x16x32_bf16 v[20:23], a[104:107], v[36:39], v[20:23]
    v_mfma_f32_16x16x32_bf16 v[24:27], a[168:171], v[36:39], v[24:27]
    s_waitcnt vmcnt(0)
    s_mov_b64 exec, s[100:101]
    global_store_dword v15, v8, s[4:5] sc1
    s_mov_b64 exec, -1
    s_mov_b64 s[100:101], 0
    s_lshl_b32 s39, s26, 1
    s_and_b32 s38, s9, 1
    s_add_u32 s39, s39, s38
    s_lshr_b32 s38, s9, 1
    s_lshl_b32 s38, s38, 4
    s_add_u32 s39, s39, s38
    s_lshl_b32 s38, s24, 5
    s_add_u32 s39, s39, s38
    s_lshl_b32 s38, s39, 10
    s_add_u32 s30, s4, s38
    s_addc_u32 s31, s5, 0
    s_add_u32 s32, s52, s38
    s_addc_u32 s33, s53, 0
    ds_read_b128 v[36:39], v5 offset:768
    s_waitcnt lgkmcnt(3)
    v_mfma_f32_16x16x32_bf16 v[16:19], a[44:47], v[40:43], v[16:19]
    v_mfma_f32_16x16x32_bf16 v[20:23], a[108:111], v[40:43], v[20:23]
    v_mfma_f32_16x16x32_bf16 v[24:27], a[172:175], v[40:43], v[24:27]
    v_add_u32 v112, s62, v1
    global_load_dwordx4 v[124:127], v112, s[30:31] sc1
    s_lshl_b32 s39, s39, 2
    v_mov_b32 v15, s39
    v_add_u32 v15, 117473280, v15
    ds_read_b128 v[40:43], v6 offset:768
    s_waitcnt lgkmcnt(3)
    v_mfma_f32_16x16x32_bf16 v[16:19], a[48:51], v[28:31], v[16:19]
    v_mfma_f32_16x16x32_bf16 v[20:23], a[112:115], v[28:31], v[20:23]
    v_mfma_f32_16x16x32_bf16 v[24:27], a[176:179], v[28:31], v[24:27]
    s_lshl_b32 s38, s63, 7
    s_add_u32 s38, s38, 117456896
    s_lshl_b32 s39, s9, 5
    s_add_u32 s38, s38, s39
    v_bfe_u32 v79, v1, 4, 3
    v_lshlrev_b32 v79, 2, v79
    v_add_u32 v79, s38, v79
    ds_read_b128 v[28:31], v3 offset:16384
    s_waitcnt lgkmcnt(3)
    v_mfma_f32_16x16x32_bf16 v[16:19], a[52:55], v[32:35], v[16:19]
    v_mfma_f32_16x16x32_bf16 v[20:23], a[116:119], v[32:35], v[20:23]
    v_mfma_f32_16x16x32_bf16 v[24:27], a[180:183], v[32:35], v[24:27]
    s_lshl_b32 s38, s63, 15
    s_add_u32 s38, s38, 119537664
    s_add_u32 s28, s4, s38
    s_addc_u32 s29, s5, 0
    s_add_u32 s34, s20, s25
    s_addc_u32 s35, s21, 0
    ds_read_b128 v[32:35], v4 offset:16384
    s_waitcnt lgkmcnt(3)
    v_mfma_f32_16x16x32_bf16 v[16:19], a[56:59], v[36:39], v[16:19]
    v_mfma_f32_16x16x32_bf16 v[20:23], a[120:123], v[36:39], v[20:23]
    v_mfma_f32_16x16x32_bf16 v[24:27], a[184:187], v[36:39], v[24:27]
    s_add_u32 s12, s34, 140288
    s_addc_u32 s13, s35, 0
    s_lshr_b32 s38, s9, 1
    s_lshl_b32 s38, s38, 3
    s_add_u32 s38, s38, s26
    s_mul_i32 s38, s38, 17536
    s_and_b32 s39, s9, 1
    s_lshl_b32 s39, s39, 10
    s_add_u32 s38, s38, s39
    s_add_u32 s14, s34, s38
    s_addc_u32 s15, s35, 0
    ds_read_b128 v[36:39], v5 offset:16384
    s_waitcnt lgkmcnt(3)
    v_mfma_f32_16x16x32_bf16 v[16:19], a[60:63], v[40:43], v[16:19]
    v_mfma_f32_16x16x32_bf16 v[20:23], a[124:127], v[40:43], v[20:23]
    v_mfma_f32_16x16x32_bf16 v[24:27], a[188:191], v[40:43], v[24:27]
    ds_read_b128 v[40:43], v6 offset:16384
    s_waitcnt lgkmcnt(3)
    v_mfma_f32_16x16x32_bf16 v[44:47], a[0:3], v[28:31], 0
    v_mfma_f32_16x16x32_bf16 v[48:51], a[64:67], v[28:31], 0
    v_mfma_f32_16x16x32_bf16 v[52:55], a[128:131], v[28:31], 0
    s_nop 0
    v_cvt_pk_bf16_f32 v68, v16, v17
    v_cvt_pk_bf16_f32 v69, v18, v19
    v_lshlrev_b32 v16, 16, v68
    ds_read_b128 v[28:31], v3 offset:16640
    s_waitcnt lgkmcnt(3)
    v_mfma_f32_16x16x32_bf16 v[44:47], a[4:7], v[32:35], v[44:47]
    v_and_b32 v17, 0xffff0000, v68
    v_lshlrev_b32 v18, 16, v69
    v_and_b32 v19, 0xffff0000, v69
    v_add_f32 v16, v16, v128
    v_mfma_f32_16x16x32_bf16 v[48:51], a[68:71], v[32:35], v[48:51]
    v_add_f32 v17, v17, v129
    v_add_f32 v18, v18, v130
    v_add_f32 v19, v19, v131
    v_mfma_f32_16x16x32_bf16 v[52:55], a[132:135], v[32:35], v[52:55]
    v_cvt_pk_bf16_f32 v68, v16, v17
    v_cvt_pk_bf16_f32 v69, v18, v19
    v_lshlrev_b32 v16, 16, v68
    v_and_b32 v17, 0xffff0000, v68
    ds_read_b128 v[32:35], v4 offset:16640
    s_waitcnt lgkmcnt(3)
    v_mfma_f32_16x16x32_bf16 v[44:47], a[8:11], v[36:39], v[44:47]
    v_lshlrev_b32 v18, 16, v69
    v_and_b32 v19, 0xffff0000, v69
    v_cvt_pk_bf16_f32 v70, v20, v21
    v_mfma_f32_16x16x32_bf16 v[48:51], a[72:75], v[36:39], v[48:51]
    v_cvt_pk_bf16_f32 v71, v22, v23
    v_lshlrev_b32 v20, 16, v70
    v_and_b32 v21, 0xffff0000, v70
    v_lshlrev_b32 v22, 16, v71
    v_mfma_f32_16x16x32_bf16 v[52:55], a[136:139], v[36:39], v[52:55]
    v_and_b32 v23, 0xffff0000, v71
    v_add_f32 v20, v20, v132
    v_add_f32 v21, v21, v133
    ds_read_b128 v[36:39], v5 offset:16640
    s_waitcnt lgkmcnt(3)
    v_mfma_f32_16x16x32_bf16 v[44:47], a[12:15], v[40:43], v[44:47]
    v_add_f32 v22, v22, v134
    v_add_f32 v23, v23, v135
    v_cvt_pk_bf16_f32 v70, v20, v21
    v_cvt_pk_bf16_f32 v71, v22, v23
    v_mfma_f32_16x16x32_bf16 v[48:51], a[76:79], v[40:43], v[48:51]
    v_lshlrev_b32 v20, 16, v70
    v_and_b32 v21, 0xffff0000, v70
    v_lshlrev_b32 v22, 16, v71
    v_mfma_f32_16x16x32_bf16 v[52:55], a[140:143], v[40:43], v[52:55]
    v_and_b32 v23, 0xffff0000, v71
    v_cvt_pk_bf16_f32 v72, v24, v25
    v_cvt_pk_bf16_f32 v73, v26, v27
    v_lshlrev_b32 v24, 16, v72
    ds_read_b128 v[40:43], v6 offset:16640
    s_waitcnt lgkmcnt(3)
    v_mfma_f32_16x16x32_bf16 v[44:47], a[16:19], v[28:31], v[44:47]
    v_and_b32 v25, 0xffff0000, v72
    v_lshlrev_b32 v26, 16, v73
    v_and_b32 v27, 0xffff0000, v73
    v_mfma_f32_16x16x32_bf16 v[48:51], a[80:83], v[28:31], v[48:51]
    v_add_f32 v24, v24, v136
    v_add_f32 v25, v25, v137
    v_add_f32 v26, v26, v138
    v_add_f32 v27, v27, v139
    v_mfma_f32_16x16x32_bf16 v[52:55], a[144:147], v[28:31], v[52:55]
    v_cvt_pk_bf16_f32 v72, v24, v25
    v_cvt_pk_bf16_f32 v73, v26, v27
    v_lshlrev_b32 v24, 16, v72
    ds_read_b128 v[28:31], v3 offset:16896
    s_waitcnt lgkmcnt(3)
    v_mfma_f32_16x16x32_bf16 v[44:47], a[20:23], v[32:35], v[44:47]
    v_and_b32 v25, 0xffff0000, v72
    v_lshlrev_b32 v26, 16, v73
    v_and_b32 v27, 0xffff0000, v73
    v_mul_f32 v56, v16, v16
    v_mfma_f32_16x16x32_bf16 v[48:51], a[84:87], v[32:35], v[48:51]
    v_mul_f32 v57, v17, v17
    v_mul_f32 v58, v18, v18
    v_mul_f32 v59, v19, v19
    v_mfma_f32_16x16x32_bf16 v[52:55], a[148:151], v[32:35], v[52:55]
    v_mul_f32 v60, v20, v20
    v_mul_f32 v61, v21, v21
    v_mul_f32 v62, v22, v22
    v_mul_f32 v63, v23, v23
    ds_read_b128 v[32:35], v4 offset:16896
    s_waitcnt lgkmcnt(3)
    v_mfma_f32_16x16x32_bf16 v[44:47], a[24:27], v[36:39], v[44:47]
    v_mul_f32 v64, v24, v24
    v_mul_f32 v65, v25, v25
    v_mul_f32 v66, v26, v26
    v_mfma_f32_16x16x32_bf16 v[48:51], a[88:91], v[36:39], v[48:51]
    v_mul_f32 v67, v27, v27
    v_fma_f32 v56, v56, s44, v74
    v_fma_f32 v57, v57, s44, v74
    v_fma_f32 v58, v58, s44, v74
    v_mfma_f32_16x16x32_bf16 v[52:55], a[152:155], v[36:39], v[52:55]
    v_fma_f32 v59, v59, s44, v74
    v_fma_f32 v60, v60, s44, v74
    v_fma_f32 v61, v61, s44, v74
    ds_read_b128 v[36:39], v5 offset:16896
    s_waitcnt lgkmcnt(3)
    v_mfma_f32_16x16x32_bf16 v[44:47], a[28:31], v[40:43], v[44:47]
    v_fma_f32 v62, v62, s44, v74
    v_fma_f32 v63, v63, s44, v74
    v_fma_f32 v64, v64, s44, v74
    v_fma_f32 v65, v65, s44, v74
    v_mfma_f32_16x16x32_bf16 v[48:51], a[92:95], v[40:43], v[48:51]
    v_fma_f32 v66, v66, s44, v74
    v_fma_f32 v67, v67, s44, v74
    v_mul_f32 v56, v56, v16
    v_mfma_f32_16x16x32_bf16 v[52:55], a[156:159], v[40:43], v[52:55]
    v_mul_f32 v57, v57, v17
    v_mul_f32 v58, v58, v18
    v_mul_f32 v59, v59, v19
    v_mul_f32 v60, v60, v20
    ds_read_b128 v[40:43], v6 offset:16896
    s_waitcnt lgkmcnt(3)
    v_mfma_f32_16x16x32_bf16 v[44:47], a[32:35], v[28:31], v[44:47]
    v_mul_f32 v61, v61, v21
    v_mul_f32 v62, v62, v22
    v_mul_f32 v63, v63, v23
    v_mfma_f32_16x16x32_bf16 v[48:51], a[96:99], v[28:31], v[48:51]
    v_mul_f32 v64, v64, v24
    v_mul_f32 v65, v65, v25
    v_mul_f32 v66, v66, v26
    v_mul_f32 v67, v67, v27
    v_mfma_f32_16x16x32_bf16 v[52:55], a[160:163], v[28:31], v[52:55]
    v_exp_f32 v56, v56
    ds_read_b128 v[28:31], v3 offset:17152
    s_waitcnt lgkmcnt(3)
    v_mfma_f32_16x16x32_bf16 v[44:47], a[36:39], v[32:35], v[44:47]
    v_exp_f32 v57, v57
    v_exp_f32 v58, v58
    v_mfma_f32_16x16x32_bf16 v[48:51], a[100:103], v[32:35], v[48:51]
    v_exp_f32 v59, v59
    v_exp_f32 v60, v60
    v_mfma_f32_16x16x32_bf16 v[52:55], a[164:167], v[32:35], v[52:55]
    v_exp_f32 v61, v61
    v_exp_f32 v62, v62
    ds_read_b128 v[32:35], v4 offset:17152
    s_waitcnt lgkmcnt(3)
    v_mfma_f32_16x16x32_bf16 v[44:47], a[40:43], v[36:39], v[44:47]
    v_exp_f32 v63, v63
    v_mfma_f32_16x16x32_bf16 v[48:51], a[104:107], v[36:39], v[48:51]
    v_exp_f32 v64, v64
    v_exp_f32 v65, v65
    v_mfma_f32_16x16x32_bf16 v[52:55], a[168:171], v[36:39], v[52:55]
    v_exp_f32 v66, v66
    v_exp_f32 v67, v67
    ds_read_b128 v[36:39], v5 offset:17152
    s_waitcnt lgkmcnt(3)
    v_mfma_f32_16x16x32_bf16 v[44:47], a[44:47], v[40:43], v[44:47]
    v_add_f32 v56, 1.0, v56
    v_add_f32 v57, 1.0, v57
    v_add_f32 v58, 1.0, v58
    v_add_f32 v59, 1.0, v59
    v_mfma_f32_16x16x32_bf16 v[48:51], a[108:111], v[40:43], v[48:51]
    v_add_f32 v60, 1.0, v60
    v_add_f32 v61, 1.0, v61
    v_add_f32 v62, 1.0, v62
    v_mfma_f32_16x16x32_bf16 v[52:55], a[172:175], v[40:43], v[52:55]
    v_add_f32 v63, 1.0, v63
    v_add_f32 v64, 1.0, v64
    v_add_f32 v65, 1.0, v65
    v_add_f32 v66, 1.0, v66
    ds_read_b128 v[40:43], v6 offset:17152
    s_waitcnt lgkmcnt(3)
    v_mfma_f32_16x16x32_bf16 v[44:47], a[48:51], v[28:31], v[44:47]
    v_add_f32 v67, 1.0, v67
    v_rcp_f32 v56, v56
    v_mfma_f32_16x16x32_bf16 v[48:51], a[112:115], v[28:31], v[48:51]
    v_rcp_f32 v57, v57
    v_rcp_f32 v58, v58
    v_mfma_f32_16x16x32_bf16 v[52:55], a[176:179], v[28:31], v[52:55]
    v_rcp_f32 v59, v59
    s_waitcnt lgkmcnt(2)
    v_mfma_f32_16x16x32_bf16 v[44:47], a[52:55], v[32:35], v[44:47]
    v_rcp_f32 v60, v60
    v_rcp_f32 v61, v61
    v_mfma_f32_16x16x32_bf16 v[48:51], a[116:119], v[32:35], v[48:51]
    v_rcp_f32 v62, v62
    v_rcp_f32 v63, v63
    v_mfma_f32_16x16x32_bf16 v[52:55], a[180:183], v[32:35], v[52:55]
    v_rcp_f32 v64, v64
    v_rcp_f32 v65, v65
    s_waitcnt lgkmcnt(1)
    v_mfma_f32_16x16x32_bf16 v[44:47], a[56:59], v[36:39], v[44:47]
    v_rcp_f32 v66, v66
    v_mfma_f32_16x16x32_bf16 v[48:51], a[120:123], v[36:39], v[48:51]
    v_rcp_f32 v67, v67
    v_mul_f32 v56, v56, v16
    v_mul_f32 v57, v57, v17
    v_mul_f32 v58, v58, v18
    v_mfma_f32_16x16x32_bf16 v[52:55], a[184:187], v[36:39], v[52:55]
    v_mul_f32 v59, v59, v19
    v_mul_f32 v60, v60, v20
    v_mul_f32 v61, v61, v21
    s_waitcnt lgkmcnt(0)
    v_mfma_f32_16x16x32_bf16 v[44:47], a[60:63], v[40:43], v[44:47]
    v_mul_f32 v62, v62, v22
    v_mul_f32 v63, v63, v23
    v_mul_f32 v64, v64, v24
    v_mul_f32 v65, v65, v25
    v_mfma_f32_16x16x32_bf16 v[48:51], a[124:127], v[40:43], v[48:51]
    v_mul_f32 v66, v66, v26
    v_mul_f32 v67, v67, v27
    v_cvt_pk_bf16_f32 v68, v56, v57
    v_mfma_f32_16x16x32_bf16 v[52:55], a[188:191], v[40:43], v[52:55]
    v_cvt_pk_bf16_f32 v69, v58, v59
    v_cvt_pk_bf16_f32 v70, v60, v61
    v_cvt_pk_bf16_f32 v71, v62, v63
    v_cvt_pk_bf16_f32 v72, v64, v65
    v_cvt_pk_bf16_f32 v73, v66, v67
    ds_write_b64 v75, v[68:69] offset:0
    ds_write_b64 v75, v[70:71] offset:2048
    ds_write_b64 v75, v[72:73] offset:4096
    s_waitcnt lgkmcnt(0)
    s_barrier
    ds_read2st64_b64 v[16:19], v78 offset0:0 offset1:1
    ds_read2st64_b64 v[20:23], v78 offset0:2 offset1:3
    ds_read2st64_b64 v[24:27], v78 offset0:4 offset1:5
    ds_read2st64_b64 v[28:31], v78 offset0:6 offset1:7
    ds_read2st64_b64 v[32:35], v78 offset0:8 offset1:9
    ds_read_b64 v[36:37], v78 offset:5120
    global_load_dword v76, v79, s[4:5] sc1
    v_cvt_pk_bf16_f32 v68, v44, v45
    v_cvt_pk_bf16_f32 v69, v46, v47
    v_lshlrev_b32 v44, 16, v68
    v_and_b32 v45, 0xffff0000, v68
    v_lshlrev_b32 v46, 16, v69
    v_and_b32 v47, 0xffff0000, v69
    v_add_f32 v44, v44, v128
    v_add_f32 v45, v45, v129
    v_add_f32 v46, v46, v130
    v_add_f32 v47, v47, v131
    v_cvt_pk_bf16_f32 v68, v44, v45
    v_cvt_pk_bf16_f32 v69, v46, v47
    v_lshlrev_b32 v44, 16, v68
    v_and_b32 v45, 0xffff0000, v68
    v_lshlrev_b32 v46, 16, v69
    v_and_b32 v47, 0xffff0000, v69
    v_cvt_pk_bf16_f32 v70, v48, v49
    v_cvt_pk_bf16_f32 v71, v50, v51
    v_lshlrev_b32 v48, 16, v70
    v_and_b32 v49, 0xffff0000, v70
    v_lshlrev_b32 v50, 16, v71
    v_and_b32 v51, 0xffff0000, v71
    v_add_f32 v48, v48, v132
    v_add_f32 v49, v49, v133
    s_waitcnt lgkmcnt(5)
    v_mfma_f32_16x16x32_bf16 v[80:83], v[16:19], a[192:195], 0
    v_add_f32 v50, v50, v134
    v_add_f32 v51, v51, v135
    v_cvt_pk_bf16_f32 v70, v48, v49
    v_mfma_f32_16x16x32_bf16 v[84:87], v[16:19], a[196:199], 0
    v_cvt_pk_bf16_f32 v71, v50, v51
    v_lshlrev_b32 v48, 16, v70
    v_and_b32 v49, 0xffff0000, v70
    v_mfma_f32_16x16x32_bf16 v[88:91], v[16:19], a[236:239], 0
    v_lshlrev_b32 v50, 16, v71
    v_and_b32 v51, 0xffff0000, v71
    v_cvt_pk_bf16_f32 v72, v52, v53
    v_mfma_f32_16x16x32_bf16 v[92:95], v[16:19], a[240:243], 0
    v_cvt_pk_bf16_f32 v73, v54, v55
    v_lshlrev_b32 v52, 16, v72
    v_and_b32 v53, 0xffff0000, v72
    s_waitcnt lgkmcnt(4)
    v_mfma_f32_16x16x32_bf16 v[80:83], v[20:23], a[200:203], v[80:83]
    v_lshlrev_b32 v54, 16, v73
    v_and_b32 v55, 0xffff0000, v73
    v_add_f32 v52, v52, v136
    v_mfma_f32_16x16x32_bf16 v[84:87], v[20:23], a[204:207], v[84:87]
    v_add_f32 v53, v53, v137
    v_add_f32 v54, v54, v138
    v_add_f32 v55, v55, v139
    v_mfma_f32_16x16x32_bf16 v[88:91], v[20:23], a[244:247], v[88:91]
    v_cvt_pk_bf16_f32 v72, v52, v53
    v_cvt_pk_bf16_f32 v73, v54, v55
    v_lshlrev_b32 v52, 16, v72
    v_mfma_f32_16x16x32_bf16 v[92:95], v[20:23], a[248:251], v[92:95]
    v_and_b32 v53, 0xffff0000, v72
    v_lshlrev_b32 v54, 16, v73
    v_and_b32 v55, 0xffff0000, v73
    s_waitcnt lgkmcnt(3)
    v_mfma_f32_16x16x32_bf16 v[80:83], v[24:27], a[208:211], v[80:83]
    v_mul_f32 v56, v44, v44
    v_mul_f32 v57, v45, v45
    v_mul_f32 v58, v46, v46
    v_mfma_f32_16x16x32_bf16 v[84:87], v[24:27], a[212:215], v[84:87]
    v_mul_f32 v59, v47, v47
    v_mul_f32 v60, v48, v48
    v_mul_f32 v61, v49, v49
    v_mfma_f32_16x16x32_bf16 v[88:91], v[24:27], a[252:255], v[88:91]
    v_mul_f32 v62, v50, v50
    v_mul_f32 v63, v51, v51
    v_mul_f32 v64, v52, v52
    v_mfma_f32_16x16x32_bf16 v[92:95], v[24:27], v[144:147], v[92:95]
    v_mul_f32 v65, v53, v53
    v_mul_f32 v66, v54, v54
    v_mul_f32 v67, v55, v55
    s_waitcnt lgkmcnt(2)
    v_mfma_f32_16x16x32_bf16 v[80:83], v[28:31], a[216:219], v[80:83]
    v_fma_f32 v56, v56, s44, v74
    v_fma_f32 v57, v57, s44, v74
    v_fma_f32 v58, v58, s44, v74
    v_mfma_f32_16x16x32_bf16 v[84:87], v[28:31], a[220:223], v[84:87]
    v_fma_f32 v59, v59, s44, v74
    v_fma_f32 v60, v60, s44, v74
    v_fma_f32 v61, v61, s44, v74
    v_mfma_f32_16x16x32_bf16 v[88:91], v[28:31], v[148:151], v[88:91]
    v_fma_f32 v62, v62, s44, v74
    v_fma_f32 v63, v63, s44, v74
    v_fma_f32 v64, v64, s44, v74
    v_mfma_f32_16x16x32_bf16 v[92:95], v[28:31], v[152:155], v[92:95]
    v_fma_f32 v65, v65, s44, v74
    v_fma_f32 v66, v66, s44, v74
    v_fma_f32 v67, v67, s44, v74
    s_waitcnt lgkmcnt(1)
    v_mfma_f32_16x16x32_bf16 v[80:83], v[32:35], a[224:227], v[80:83]
    v_mul_f32 v56, v56, v44
    v_mul_f32 v57, v57, v45
    v_mul_f32 v58, v58, v46
    v_mfma_f32_16x16x32_bf16 v[84:87], v[32:35], a[228:231], v[84:87]
    v_mul_f32 v59, v59, v47
    v_mul_f32 v60, v60, v48
    v_mul_f32 v61, v61, v49
    v_mfma_f32_16x16x32_bf16 v[88:91], v[32:35], v[156:159], v[88:91]
    v_mul_f32 v62, v62, v50
    v_mul_f32 v63, v63, v51
    v_mul_f32 v64, v64, v52
    v_mfma_f32_16x16x32_bf16 v[92:95], v[32:35], v[160:163], v[92:95]
    v_mul_f32 v65, v65, v53
    v_mul_f32 v66, v66, v54
    v_mul_f32 v67, v67, v55
    s_waitcnt lgkmcnt(0)
    v_mfma_f32_16x16x16_bf16 v[80:83], v[36:37], a[232:233], v[80:83]
    v_exp_f32 v56, v56
    v_mfma_f32_16x16x16_bf16 v[84:87], v[36:37], a[234:235], v[84:87]
    v_exp_f32 v57, v57
    v_exp_f32 v58, v58
    v_mfma_f32_16x16x16_bf16 v[88:91], v[36:37], v[164:165], v[88:91]
    v_exp_f32 v59, v59
    v_mfma_f32_16x16x16_bf16 v[92:95], v[36:37], v[166:167], v[92:95]
    v_exp_f32 v60, v60
    v_exp_f32 v61, v61
    v_mfma_f32_16x16x32_bf16 v[96:99], v[16:19], v[168:171], 0
    v_exp_f32 v62, v62
    v_mfma_f32_16x16x32_bf16 v[100:103], v[16:19], v[172:175], 0
    v_exp_f32 v63, v63
    v_exp_f32 v64, v64
    v_mfma_f32_16x16x32_bf16 v[104:107], v[16:19], v[212:215], 0
    v_exp_f32 v65, v65
    v_cvt_pk_bf16_f32 v80, v80, v81
    v_cvt_pk_bf16_f32 v81, v84, v85
    v_mfma_f32_16x16x32_bf16 v[108:111], v[16:19], v[216:219], 0
    v_exp_f32 v66, v66
    v_exp_f32 v67, v67
    v_mfma_f32_16x16x32_bf16 v[96:99], v[20:23], v[176:179], v[96:99]
    v_add_f32 v56, 1.0, v56
    v_add_f32 v57, 1.0, v57
    v_add_f32 v58, 1.0, v58
    v_mfma_f32_16x16x32_bf16 v[100:103], v[20:23], v[180:183], v[100:103]
    v_add_f32 v59, 1.0, v59
    v_add_f32 v60, 1.0, v60
    v_add_f32 v61, 1.0, v61
    v_mfma_f32_16x16x32_bf16 v[104:107], v[20:23], v[220:223], v[104:107]
    v_add_f32 v62, 1.0, v62
    v_add_f32 v63, 1.0, v63
    v_add_f32 v64, 1.0, v64
    v_cvt_pk_bf16_f32 v84, v82, v83
    v_cvt_pk_bf16_f32 v82, v88, v89
    v_mfma_f32_16x16x32_bf16 v[108:111], v[20:23], v[224:227], v[108:111]
    v_add_f32 v65, 1.0, v65
    v_add_f32 v66, 1.0, v66
    v_add_f32 v67, 1.0, v67
    v_mfma_f32_16x16x32_bf16 v[96:99], v[24:27], v[184:187], v[96:99]
    v_rcp_f32 v56, v56
    v_mfma_f32_16x16x32_bf16 v[100:103], v[24:27], v[188:191], v[100:103]
    v_rcp_f32 v57, v57
    v_rcp_f32 v58, v58
    v_mfma_f32_16x16x32_bf16 v[104:107], v[24:27], v[228:231], v[104:107]
    v_rcp_f32 v59, v59
    v_cvt_pk_bf16_f32 v83, v92, v93
    v_and_or_b32 v80, v80, -2, s36
    v_mfma_f32_16x16x32_bf16 v[108:111], v[24:27], v[232:235], v[108:111]
    v_rcp_f32 v60, v60
    v_rcp_f32 v61, v61
    v_mfma_f32_16x16x32_bf16 v[96:99], v[28:31], v[192:195], v[96:99]
    v_rcp_f32 v62, v62
    v_mfma_f32_16x16x32_bf16 v[100:103], v[28:31], v[196:199], v[100:103]
    v_rcp_f32 v63, v63
    v_rcp_f32 v64, v64
    v_mfma_f32_16x16x32_bf16 v[104:107], v[28:31], v[236:239], v[104:107]
    v_rcp_f32 v65, v65
    global_store_dwordx4 v11, v[80:83], s[34:35] offset:0
    v_cvt_pk_bf16_f32 v85, v86, v87
    v_mfma_f32_16x16x32_bf16 v[108:111], v[28:31], v[240:243], v[108:111]
    v_rcp_f32 v66, v66
    v_rcp_f32 v67, v67
    v_mfma_f32_16x16x32_bf16 v[96:99], v[32:35], v[200:203], v[96:99]
    v_mul_f32 v56, v56, v44
    v_mul_f32 v57, v57, v45
    v_mul_f32 v58, v58, v46
    v_mfma_f32_16x16x32_bf16 v[100:103], v[32:35], v[204:207], v[100:103]
    v_mul_f32 v59, v59, v47
    v_mul_f32 v60, v60, v48
    v_mul_f32 v61, v61, v49
    v_mfma_f32_16x16x32_bf16 v[104:107], v[32:35], v[244:247], v[104:107]
    v_mul_f32 v62, v62, v50
    v_mul_f32 v63, v63, v51
    v_mul_f32 v64, v64, v52
    v_cvt_pk_bf16_f32 v86, v90, v91
    v_cvt_pk_bf16_f32 v87, v94, v95
    v_mfma_f32_16x16x32_bf16 v[108:111], v[32:35], v[248:251], v[108:111]
    v_mul_f32 v65, v65, v53
    v_mul_f32 v66, v66, v54
    v_mul_f32 v67, v67, v55
    v_mfma_f32_16x16x16_bf16 v[96:99], v[36:37], v[208:209], v[96:99]
    v_cvt_pk_bf16_f32 v68, v56, v57
    v_cvt_pk_bf16_f32 v69, v58, v59
    v_cvt_pk_bf16_f32 v70, v60, v61
    v_mfma_f32_16x16x16_bf16 v[100:103], v[36:37], v[210:211], v[100:103]
    v_cvt_pk_bf16_f32 v71, v62, v63
    v_cvt_pk_bf16_f32 v72, v64, v65
    v_cvt_pk_bf16_f32 v73, v66, v67
    v_mfma_f32_16x16x16_bf16 v[104:107], v[36:37], v[252:253], v[104:107]
    v_and_or_b32 v84, v84, -2, s36
    global_store_dwordx4 v12, v[84:87], s[34:35] offset:0
    v_mfma_f32_16x16x16_bf16 v[108:111], v[36:37], v[254:255], v[108:111]
    ds_write_b64 v75, v[68:69] offset:6144
    ds_write_b64 v75, v[70:71] offset:8192
    ds_write_b64 v75, v[72:73] offset:10240
    s_waitcnt lgkmcnt(0)
    s_barrier
    v_cmp_eq_u32 vcc, 0, v76
    ds_read2st64_b64 v[16:19], v78 offset0:12 offset1:13
    ds_read2st64_b64 v[20:23], v78 offset0:14 offset1:15
    ds_read2st64_b64 v[24:27], v78 offset0:16 offset1:17
    ds_read2st64_b64 v[28:31], v78 offset0:18 offset1:19
    ds_read2st64_b64 v[32:35], v78 offset0:20 offset1:21
    ds_read_b64 v[36:37], v78 offset:11264
    s_cmp_eq_u64 vcc, 0
    s_cselect_b64 s[50:51], -1, 0
    s_waitcnt lgkmcnt(5)
    v_mfma_f32_16x16x32_bf16 v[40:43], v[16:19], a[192:195], 0
    v_mfma_f32_16x16x32_bf16 v[44:47], v[16:19], a[196:199], 0
    v_mfma_f32_16x16x32_bf16 v[48:51], v[16:19], a[236:239], 0
    v_cvt_pk_bf16_f32 v96, v96, v97
    v_cvt_pk_bf16_f32 v97, v100, v101
    v_mfma_f32_16x16x32_bf16 v[52:55], v[16:19], a[240:243], 0
    s_waitcnt lgkmcnt(4)
    v_mfma_f32_16x16x32_bf16 v[40:43], v[20:23], a[200:203], v[40:43]
    v_mfma_f32_16x16x32_bf16 v[44:47], v[20:23], a[204:207], v[44:47]
    v_mfma_f32_16x16x32_bf16 v[48:51], v[20:23], a[244:247], v[48:51]
    v_cvt_pk_bf16_f32 v100, v98, v99
    v_cvt_pk_bf16_f32 v98, v104, v105
    v_mfma_f32_16x16x32_bf16 v[52:55], v[20:23], a[248:251], v[52:55]
    s_waitcnt lgkmcnt(3)
    v_mfma_f32_16x16x32_bf16 v[40:43], v[24:27], a[208:211], v[40:43]
    s_add_u32 m0, s46, 0
    v_mfma_f32_16x16x32_bf16 v[44:47], v[24:27], a[212:215], v[44:47]
    s_mov_b64 exec, s[50:51]
    global_load_lds_dwordx4 v2, s[28:29] offset:0 sc1
    s_mov_b64 exec, -1
    v_mfma_f32_16x16x32_bf16 v[48:51], v[24:27], a[252:255], v[48:51]
    v_xor_b32 v113, 16, v2
    v_cvt_pk_bf16_f32 v99, v108, v109
    v_and_or_b32 v96, v96, -2, s36
    v_mfma_f32_16x16x32_bf16 v[52:55], v[24:27], v[144:147], v[52:55]
    s_mov_b64 exec, s[50:51]
    global_load_lds_dwordx4 v113, s[28:29] offset:1024 sc1
    s_mov_b64 exec, -1
    s_waitcnt lgkmcnt(2)
    v_mfma_f32_16x16x32_bf16 v[40:43], v[28:31], a[216:219], v[40:43]
    v_xor_b32 v114, 32, v2
    v_mfma_f32_16x16x32_bf16 v[44:47], v[28:31], a[220:223], v[44:47]
    s_mov_b64 exec, s[50:51]
    global_load_lds_dwordx4 v114, s[28:29] offset:2048 sc1
    s_mov_b64 exec, -1
    v_mfma_f32_16x16x32_bf16 v[48:51], v[28:31], v[148:151], v[48:51]
    v_xor_b32 v115, 48, v2
    global_store_dwordx4 v11, v[96:99], s[34:35] offset:1024
    v_cvt_pk_bf16_f32 v101, v102, v103
    v_mfma_f32_16x16x32_bf16 v[52:55], v[28:31], v[152:155], v[52:55]
    s_mov_b64 exec, s[50:51]
    global_load_lds_dwordx4 v115, s[28:29] offset:3072 sc1
    s_mov_b64 exec, -1
    s_waitcnt lgkmcnt(1)
    v_mfma_f32_16x16x32_bf16 v[40:43], v[32:35], a[224:227], v[40:43]
    s_add_u32 m0, s46, 4096
    v_mfma_f32_16x16x32_bf16 v[44:47], v[32:35], a[228:231], v[44:47]
    v_xor_b32 v116, 4160, v2
    v_mfma_f32_16x16x32_bf16 v[48:51], v[32:35], v[156:159], v[48:51]
    s_mov_b64 exec, s[50:51]
    global_load_lds_dwordx4 v116, s[28:29] offset:0 sc1
    s_mov_b64 exec, -1
    v_cvt_pk_bf16_f32 v102, v106, v107
    v_cvt_pk_bf16_f32 v103, v110, v111
    v_mfma_f32_16x16x32_bf16 v[52:55], v[32:35], v[160:163], v[52:55]
    v_xor_b32 v117, 4176, v2
    s_waitcnt lgkmcnt(0)
    v_mfma_f32_16x16x16_bf16 v[40:43], v[36:37], a[232:233], v[40:43]
    s_mov_b64 exec, s[50:51]
    global_load_lds_dwordx4 v117, s[28:29] offset:1024 sc1
    s_mov_b64 exec, -1
    v_mfma_f32_16x16x16_bf16 v[44:47], v[36:37], a[234:235], v[44:47]
    v_xor_b32 v118, 4192, v2
    v_mfma_f32_16x16x16_bf16 v[48:51], v[36:37], v[164:165], v[48:51]
    s_mov_b64 exec, s[50:51]
    global_load_lds_dwordx4 v118, s[28:29] offset:2048 sc1
    s_mov_b64 exec, -1
    v_and_or_b32 v100, v100, -2, s36
    global_store_dwordx4 v12, v[100:103], s[34:35] offset:1024
    v_mfma_f32_16x16x16_bf16 v[52:55], v[36:37], v[166:167], v[52:55]
    v_xor_b32 v119, 4208, v2
    v_mfma_f32_16x16x32_bf16 v[56:59], v[16:19], v[168:171], 0
    s_mov_b64 exec, s[50:51]
    global_load_lds_dwordx4 v119, s[28:29] offset:3072 sc1
    s_mov_b64 exec, -1
    v_mfma_f32_16x16x32_bf16 v[60:63], v[16:19], v[172:175], 0
    v_mfma_f32_16x16x32_bf16 v[64:67], v[16:19], v[212:215], 0
    v_cvt_pk_bf16_f32 v40, v40, v41
    v_cvt_pk_bf16_f32 v41, v44, v45
    v_mfma_f32_16x16x32_bf16 v[68:71], v[16:19], v[216:219], 0
    v_mfma_f32_16x16x32_bf16 v[56:59], v[20:23], v[176:179], v[56:59]
    v_mfma_f32_16x16x32_bf16 v[60:63], v[20:23], v[180:183], v[60:63]
    v_mfma_f32_16x16x32_bf16 v[64:67], v[20:23], v[220:223], v[64:67]
    v_cvt_pk_bf16_f32 v44, v42, v43
    v_cvt_pk_bf16_f32 v42, v48, v49
    v_mfma_f32_16x16x32_bf16 v[68:71], v[20:23], v[224:227], v[68:71]
    v_mfma_f32_16x16x32_bf16 v[56:59], v[24:27], v[184:187], v[56:59]
    v_mfma_f32_16x16x32_bf16 v[60:63], v[24:27], v[188:191], v[60:63]
    v_mfma_f32_16x16x32_bf16 v[64:67], v[24:27], v[228:231], v[64:67]
    v_cvt_pk_bf16_f32 v43, v52, v53
    v_and_or_b32 v40, v40, -2, s36
    v_mfma_f32_16x16x32_bf16 v[68:71], v[24:27], v[232:235], v[68:71]
    v_mfma_f32_16x16x32_bf16 v[56:59], v[28:31], v[192:195], v[56:59]
    v_mfma_f32_16x16x32_bf16 v[60:63], v[28:31], v[196:199], v[60:63]
    v_mfma_f32_16x16x32_bf16 v[64:67], v[28:31], v[236:239], v[64:67]
    global_store_dwordx4 v11, v[40:43], s[12:13] offset:0
    v_cvt_pk_bf16_f32 v45, v46, v47
    v_mfma_f32_16x16x32_bf16 v[68:71], v[28:31], v[240:243], v[68:71]
    v_mfma_f32_16x16x32_bf16 v[56:59], v[32:35], v[200:203], v[56:59]
    v_mfma_f32_16x16x32_bf16 v[60:63], v[32:35], v[204:207], v[60:63]
    v_mfma_f32_16x16x32_bf16 v[64:67], v[32:35], v[244:247], v[64:67]
    v_cvt_pk_bf16_f32 v46, v50, v51
    v_cvt_pk_bf16_f32 v47, v54, v55
    v_mfma_f32_16x16x32_bf16 v[68:71], v[32:35], v[248:251], v[68:71]
    v_mfma_f32_16x16x16_bf16 v[56:59], v[36:37], v[208:209], v[56:59]
    v_mfma_f32_16x16x16_bf16 v[60:63], v[36:37], v[210:211], v[60:63]
    v_mfma_f32_16x16x16_bf16 v[64:67], v[36:37], v[252:253], v[64:67]
    v_and_or_b32 v44, v44, -2, s36
    global_store_dwordx4 v12, v[44:47], s[12:13] offset:0
    v_mfma_f32_16x16x16_bf16 v[68:71], v[36:37], v[254:255], v[68:71]
    s_nop 2
    v_cvt_pk_bf16_f32 v56, v56, v57
    v_cvt_pk_bf16_f32 v57, v60, v61
    v_cvt_pk_bf16_f32 v60, v58, v59
    v_cvt_pk_bf16_f32 v58, v64, v65
    s_nop 0
    v_cvt_pk_bf16_f32 v59, v68, v69
    v_and_or_b32 v56, v56, -2, s36
    global_store_dwordx4 v11, v[56:59], s[12:13] offset:1024
    v_cvt_pk_bf16_f32 v61, v62, v63
    v_cvt_pk_bf16_f32 v62, v66, v67
    v_cvt_pk_bf16_f32 v63, v70, v71
    v_and_or_b32 v60, v60, -2, s36
    global_store_dwordx4 v12, v[60:63], s[12:13] offset:1024
    global_load_dword v76, v79, s[4:5] sc1
    s_mov_b64 s[16:17], s[14:15]
    global_load_dwordx4 v[16:19], v1, s[16:17] sc1
    s_add_u32 s16, s16, 2176
    s_addc_u32 s17, s17, 0
    global_load_dwordx4 v[20:23], v1, s[16:17] sc1
    s_add_u32 s16, s16, 2176
    s_addc_u32 s17, s17, 0
    global_load_dwordx4 v[24:27], v1, s[16:17] sc1
    s_add_u32 s16, s16, 2176
    s_addc_u32 s17, s17, 0
    global_load_dwordx4 v[28:31], v1, s[16:17] sc1
    s_add_u32 s16, s16, 2176
    s_addc_u32 s17, s17, 0
    global_load_dwordx4 v[32:35], v1, s[16:17] sc1
    s_add_u32 s16, s16, 2176
    s_addc_u32 s17, s17, 0
    global_load_dwordx4 v[36:39], v1, s[16:17] sc1
    s_add_u32 s16, s16, 2176
    s_addc_u32 s17, s17, 0
    global_load_dwordx4 v[40:43], v1, s[16:17] sc1
    s_add_u32 s16, s16, 2176
    s_addc_u32 s17, s17, 0
    global_load_dwordx4 v[44:47], v1, s[16:17] sc1
    v_lshrrev_b32 v48, 6, v1
    v_lshlrev_b32 v48, 5, v48
    v_bfe_u32 v52, v1, 4, 2
    v_lshl_add_u32 v48, v52, 2, v48
    s_lshr_b32 s38, s9, 1
    s_lshl_b32 s38, s38, 12
    s_and_b32 s39, s9, 1
    s_lshl_b32 s39, s39, 10
    s_add_u32 s38, s38, s39
    s_add_u32 s38, s38, 147456
    v_add_u32 v48, s38, v48
    v_add_u32 v49, 2048, v48
    s_lshl_b32 s38, s9, 11
    s_add_u32 s38, s38, 147456
    v_lshl_add_u32 v50, v1, 1, s38
    s_sub_u32 s40, 0, s36
    s_mov_b32 s41, 2097152
L_rp_95:
    s_waitcnt vmcnt(7)
    v_lshlrev_b32 v80, 16, v16
    v_and_b32 v81, 0xffff0000, v16
    v_lshlrev_b32 v82, 16, v17
    v_and_b32 v83, 0xffff0000, v17
    v_lshlrev_b32 v84, 16, v18
    v_and_b32 v85, 0xffff0000, v18
    v_lshlrev_b32 v86, 16, v19
    v_and_b32 v87, 0xffff0000, v19
    s_waitcnt vmcnt(6)
    v_lshlrev_b32 v88, 16, v20
    v_and_b32 v89, 0xffff0000, v20
    v_lshlrev_b32 v90, 16, v21
    v_and_b32 v91, 0xffff0000, v21
    v_lshlrev_b32 v92, 16, v22
    v_and_b32 v93, 0xffff0000, v22
    v_lshlrev_b32 v94, 16, v23
    v_and_b32 v95, 0xffff0000, v23
    v_pk_add_f32 v[80:81], v[80:81], v[88:89]
    v_pk_add_f32 v[82:83], v[82:83], v[90:91]
    v_pk_add_f32 v[84:85], v[84:85], v[92:93]
    v_pk_add_f32 v[86:87], v[86:87], v[94:95]
    v_bitop3_b32 v52, v16, v20, s40 bitop3:0x7e
    s_waitcnt vmcnt(5)
    v_lshlrev_b32 v88, 16, v24
    v_and_b32 v89, 0xffff0000, v24
    v_lshlrev_b32 v90, 16, v25
    v_and_b32 v91, 0xffff0000, v25
    v_lshlrev_b32 v92, 16, v26
    v_and_b32 v93, 0xffff0000, v26
    v_lshlrev_b32 v94, 16, v27
    v_and_b32 v95, 0xffff0000, v27
    v_pk_add_f32 v[80:81], v[80:81], v[88:89]
    v_pk_add_f32 v[82:83], v[82:83], v[90:91]
    v_pk_add_f32 v[84:85], v[84:85], v[92:93]
    v_pk_add_f32 v[86:87], v[86:87], v[94:95]
    s_waitcnt vmcnt(4)
    v_lshlrev_b32 v88, 16, v28
    v_and_b32 v89, 0xffff0000, v28
    v_lshlrev_b32 v90, 16, v29
    v_and_b32 v91, 0xffff0000, v29
    v_lshlrev_b32 v92, 16, v30
    v_and_b32 v93, 0xffff0000, v30
    v_lshlrev_b32 v94, 16, v31
    v_and_b32 v95, 0xffff0000, v31
    v_pk_add_f32 v[80:81], v[80:81], v[88:89]
    v_pk_add_f32 v[82:83], v[82:83], v[90:91]
    v_pk_add_f32 v[84:85], v[84:85], v[92:93]
    v_pk_add_f32 v[86:87], v[86:87], v[94:95]
    v_bitop3_b32 v53, v24, v28, s40 bitop3:0x7e
    s_waitcnt vmcnt(3)
    v_lshlrev_b32 v88, 16, v32
    v_and_b32 v89, 0xffff0000, v32
    v_lshlrev_b32 v90, 16, v33
    v_and_b32 v91, 0xffff0000, v33
    v_lshlrev_b32 v92, 16, v34
    v_and_b32 v93, 0xffff0000, v34
    v_lshlrev_b32 v94, 16, v35
    v_and_b32 v95, 0xffff0000, v35
    v_pk_add_f32 v[80:81], v[80:81], v[88:89]
    v_pk_add_f32 v[82:83], v[82:83], v[90:91]
    v_pk_add_f32 v[84:85], v[84:85], v[92:93]
    v_pk_add_f32 v[86:87], v[86:87], v[94:95]
    s_waitcnt vmcnt(2)
    v_lshlrev_b32 v88, 16, v36
    v_and_b32 v89, 0xffff0000, v36
    v_lshlrev_b32 v90, 16, v37
    v_and_b32 v91, 0xffff0000, v37
    v_lshlrev_b32 v92, 16, v38
    v_and_b32 v93, 0xffff0000, v38
    v_lshlrev_b32 v94, 16, v39
    v_and_b32 v95, 0xffff0000, v39
    v_pk_add_f32 v[80:81], v[80:81], v[88:89]
    v_pk_add_f32 v[82:83], v[82:83], v[90:91]
    v_pk_add_f32 v[84:85], v[84:85], v[92:93]
    v_pk_add_f32 v[86:87], v[86:87], v[94:95]
    v_bitop3_b32 v54, v32, v36, s40 bitop3:0x7e
    s_waitcnt vmcnt(1)
    v_lshlrev_b32 v88, 16, v40
    v_and_b32 v89, 0xffff0000, v40
    v_lshlrev_b32 v90, 16, v41
    v_and_b32 v91, 0xffff0000, v41
    v_lshlrev_b32 v92, 16, v42
    v_and_b32 v93, 0xffff0000, v42
    v_lshlrev_b32 v94, 16, v43
    v_and_b32 v95, 0xffff0000, v43
    v_pk_add_f32 v[80:81], v[80:81], v[88:89]
    v_pk_add_f32 v[82:83], v[82:83], v[90:91]
    v_pk_add_f32 v[84:85], v[84:85], v[92:93]
    v_pk_add_f32 v[86:87], v[86:87], v[94:95]
    s_waitcnt vmcnt(0)
    v_lshlrev_b32 v88, 16, v44
    v_and_b32 v89, 0xffff0000, v44
    v_lshlrev_b32 v90, 16, v45
    v_and_b32 v91, 0xffff0000, v45
    v_lshlrev_b32 v92, 16, v46
    v_and_b32 v93, 0xffff0000, v46
    v_lshlrev_b32 v94, 16, v47
    v_and_b32 v95, 0xffff0000, v47
    v_pk_add_f32 v[80:81], v[80:81], v[88:89]
    v_pk_add_f32 v[82:83], v[82:83], v[90:91]
    v_pk_add_f32 v[84:85], v[84:85], v[92:93]
    v_pk_add_f32 v[86:87], v[86:87], v[94:95]
    v_bitop3_b32 v55, v40, v44, s40 bitop3:0x7e
    v_or3_b32 v52, v52, v53, v54
    v_bitop3_b32 v52, v52, v55, 1 bitop3:0xa8
    v_cmp_ne_u32 vcc, 0, v52
    s_nop 4
    s_cbranch_vccz L_rg_96
    s_mov_b64 exec, vcc
    s_mov_b64 s[16:17], s[14:15]
    global_load_dwordx4 v[16:19], v1, s[16:17] sc1
    s_add_u32 s16, s16, 2176
    s_addc_u32 s17, s17, 0
    global_load_dwordx4 v[20:23], v1, s[16:17] sc1
    s_add_u32 s16, s16, 2176
    s_addc_u32 s17, s17, 0
    global_load_dwordx4 v[24:27], v1, s[16:17] sc1
    s_add_u32 s16, s16, 2176
    s_addc_u32 s17, s17, 0
    global_load_dwordx4 v[28:31], v1, s[16:17] sc1
    s_add_u32 s16, s16, 2176
    s_addc_u32 s17, s17, 0
    global_load_dwordx4 v[32:35], v1, s[16:17] sc1
    s_add_u32 s16, s16, 2176
    s_addc_u32 s17, s17, 0
    global_load_dwordx4 v[36:39], v1, s[16:17] sc1
    s_add_u32 s16, s16, 2176
    s_addc_u32 s17, s17, 0
    global_load_dwordx4 v[40:43], v1, s[16:17] sc1
    s_add_u32 s16, s16, 2176
    s_addc_u32 s17, s17, 0
    global_load_dwordx4 v[44:47], v1, s[16:17] sc1
    s_mov_b64 exec, -1
    s_sub_u32 s41, s41, 1
    s_cmp_eq_u32 s41, 0
    s_cbranch_scc1 L_end_75
    s_branch L_rp_95
L_rg_96:
    v_cmp_eq_u32 vcc, 0, v76
    ds_write2_b32 v48, v80, v82 offset0:0 offset1:4
    ds_write2_b32 v48, v84, v86 offset0:128 offset1:132
    ds_write2_b32 v49, v81, v83 offset0:0 offset1:4
    ds_write2_b32 v49, v85, v87 offset0:128 offset1:132
    s_nop 1
    s_or_b64 vcc, vcc, s[50:51]
    s_cbranch_scc1 L_f2s_97
    s_add_u32 m0, s46, 0
    s_nop 0
    global_load_lds_dwordx4 v2, s[28:29] offset:0 sc1
    v_xor_b32 v113, 16, v2
    global_load_lds_dwordx4 v113, s[28:29] offset:1024 sc1
    v_xor_b32 v114, 32, v2
    global_load_lds_dwordx4 v114, s[28:29] offset:2048 sc1
    v_xor_b32 v115, 48, v2
    global_load_lds_dwordx4 v115, s[28:29] offset:3072 sc1
    s_add_u32 m0, s46, 4096
    v_xor_b32 v116, 4160, v2
    global_load_lds_dwordx4 v116, s[28:29] offset:0 sc1
    v_xor_b32 v117, 4176, v2
    global_load_lds_dwordx4 v117, s[28:29] offset:1024 sc1
    v_xor_b32 v118, 4192, v2
    global_load_lds_dwordx4 v118, s[28:29] offset:2048 sc1
    v_xor_b32 v119, 4208, v2
    global_load_lds_dwordx4 v119, s[28:29] offset:3072 sc1
    s_mov_b64 s[50:51], -1
    s_mov_b32 s18, 1
L_f2s_97:
    s_waitcnt lgkmcnt(0)
    s_barrier
    ds_read_b128 v[16:19], v50
    ds_read_b128 v[20:23], v50 offset:16
    s_waitcnt lgkmcnt(0)
    v_cvt_pk_bf16_f32 v40, v16, v17
    v_cvt_pk_bf16_f32 v41, v18, v19
    v_cvt_pk_bf16_f32 v42, v20, v21
    v_cvt_pk_bf16_f32 v43, v22, v23
    v_lshlrev_b32 v16, 16, v40
    v_and_b32 v17, 0xffff0000, v40
    v_lshlrev_b32 v18, 16, v41
    v_and_b32 v19, 0xffff0000, v41
    v_lshlrev_b32 v20, 16, v42
    v_and_b32 v21, 0xffff0000, v42
    v_lshlrev_b32 v22, 16, v43
    v_and_b32 v23, 0xffff0000, v43
    v_lshlrev_b32 v24, 16, v140
    v_and_b32 v25, 0xffff0000, v140
    v_lshlrev_b32 v26, 16, v141
    v_and_b32 v27, 0xffff0000, v141
    v_lshlrev_b32 v28, 16, v142
    v_and_b32 v29, 0xffff0000, v142
    v_lshlrev_b32 v30, 16, v143
    v_and_b32 v31, 0xffff0000, v143
    v_pk_add_f32 v[16:17], v[16:17], v[24:25]
    v_pk_add_f32 v[18:19], v[18:19], v[26:27]
    v_pk_add_f32 v[20:21], v[20:21], v[28:29]
    v_pk_add_f32 v[22:23], v[22:23], v[30:31]
    v_cvt_pk_bf16_f32 v40, v16, v17
    v_cvt_pk_bf16_f32 v41, v18, v19
    v_cvt_pk_bf16_f32 v42, v20, v21
    v_cvt_pk_bf16_f32 v43, v22, v23
    v_lshlrev_b32 v16, 16, v40
    v_and_b32 v17, 0xffff0000, v40
    v_lshlrev_b32 v18, 16, v41
    v_and_b32 v19, 0xffff0000, v41
    v_lshlrev_b32 v20, 16, v42
    v_and_b32 v21, 0xffff0000, v42
    v_lshlrev_b32 v22, 16, v43
    v_and_b32 v23, 0xffff0000, v43
    v_lshlrev_b32 v24, 16, v124
    v_and_b32 v25, 0xffff0000, v124
    v_lshlrev_b32 v26, 16, v125
    v_and_b32 v27, 0xffff0000, v125
    v_lshlrev_b32 v28, 16, v126
    v_and_b32 v29, 0xffff0000, v126
    v_lshlrev_b32 v30, 16, v127
    v_and_b32 v31, 0xffff0000, v127
    v_pk_add_f32 v[24:25], v[24:25], v[16:17]
    v_pk_add_f32 v[26:27], v[26:27], v[18:19]
    v_pk_add_f32 v[28:29], v[28:29], v[20:21]
    v_pk_add_f32 v[30:31], v[30:31], v[22:23]
    v_cvt_pk_bf16_f32 v48, v24, v25
    v_cvt_pk_bf16_f32 v49, v26, v27
    v_cvt_pk_bf16_f32 v50, v28, v29
    v_cvt_pk_bf16_f32 v51, v30, v31
    s_cmp_lg_u32 s27, 0
    s_nop 0
    s_cbranch_scc1 L_fl1_98
    v_add_u32 v80, 130023424, v1
    global_store_dwordx4 v80, v[48:51], s[30:31] sc1
    v_lshlrev_b32 v24, 16, v48
    v_and_b32 v25, 0xffff0000, v48
    v_lshlrev_b32 v26, 16, v49
    v_and_b32 v27, 0xffff0000, v49
    v_lshlrev_b32 v28, 16, v50
    v_and_b32 v29, 0xffff0000, v50
    v_lshlrev_b32 v30, 16, v51
    v_and_b32 v31, 0xffff0000, v51
    v_pk_add_f32 v[32:33], v[24:25], v[26:27]
    v_pk_add_f32 v[34:35], v[28:29], v[30:31]
    v_pk_add_f32 v[32:33], v[32:33], v[34:35]
    v_add_f32 v44, v32, v33
    s_nop 1
    v_add_f32_dpp v45, v44, v44 quad_perm:[1,0,3,2] row_mask:0xf bank_mask:0xf
    s_nop 1
    v_add_f32_dpp v44, v45, v45 quad_perm:[2,3,0,1] row_mask:0xf bank_mask:0xf
    s_nop 1
    v_add_f32_dpp v45, v44, v44 row_half_mirror row_mask:0xf bank_mask:0xf
    s_nop 1
    v_add_f32_dpp v44, v45, v45 row_mirror row_mask:0xf bank_mask:0xf
    v_mov_b32 v45, v44
    s_nop 1
    v_permlane16_swap_b32 v45, v44
    v_add_f32 v44, v44, v45
    v_mov_b32 v45, v44
    s_nop 1
    v_permlane32_swap_b32 v45, v44
    v_add_f32 v44, v44, v45
    v_mul_f32 v44, 0x3b000000, v44
    v_pk_add_f32 v[32:33], v[24:25], v[44:45] op_sel_hi:[1,0] neg_lo:[0,1] neg_hi:[0,1]
    v_pk_add_f32 v[34:35], v[26:27], v[44:45] op_sel_hi:[1,0] neg_lo:[0,1] neg_hi:[0,1]
    v_pk_add_f32 v[36:37], v[28:29], v[44:45] op_sel_hi:[1,0] neg_lo:[0,1] neg_hi:[0,1]
    v_pk_add_f32 v[38:39], v[30:31], v[44:45] op_sel_hi:[1,0] neg_lo:[0,1] neg_hi:[0,1]
    v_pk_mul_f32 v[46:47], v[32:33], v[32:33]
    v_pk_fma_f32 v[46:47], v[34:35], v[34:35], v[46:47]
    v_pk_fma_f32 v[46:47], v[36:37], v[36:37], v[46:47]
    v_pk_fma_f32 v[46:47], v[38:39], v[38:39], v[46:47]
    v_add_f32 v46, v46, v47
    s_nop 1
    v_add_f32_dpp v47, v46, v46 quad_perm:[1,0,3,2] row_mask:0xf bank_mask:0xf
    s_nop 1
    v_add_f32_dpp v46, v47, v47 quad_perm:[2,3,0,1] row_mask:0xf bank_mask:0xf
    s_nop 1
    v_add_f32_dpp v47, v46, v46 row_half_mirror row_mask:0xf bank_mask:0xf
    s_nop 1
    v_add_f32_dpp v46, v47, v47 row_mirror row_mask:0xf bank_mask:0xf
    v_mov_b32 v47, v46
    s_nop 1
    v_permlane16_swap_b32 v47, v46
    v_add_f32 v46, v46, v47
    v_mov_b32 v47, v46
    s_nop 1
    v_permlane32_swap_b32 v47, v46
    v_add_f32 v46, v46, v47
    v_mul_f32 v46, 0x3b000000, v46
    v_cvt_pk_bf16_f32 v44, v44, v44
    v_and_b32 v44, 0xffff0000, v44
    v_cvt_pk_bf16_f32 v46, v46, v46
    v_and_b32 v46, 0xffff0000, v46
    v_add_f32 v46, 0x3727c5ac, v46
    v_cvt_pk_bf16_f32 v46, v46, v46
    v_and_b32 v46, 0xffff0000, v46
    v_sqrt_f32 v46, v46
    s_nop 0
    v_cvt_pk_bf16_f32 v46, v46, v46
    v_and_b32 v46, 0xffff0000, v46
    v_rcp_f32 v46, v46
    v_pk_add_f32 v[32:33], v[24:25], v[44:45] op_sel_hi:[1,0] neg_lo:[0,1] neg_hi:[0,1]
    v_pk_add_f32 v[34:35], v[26:27], v[44:45] op_sel_hi:[1,0] neg_lo:[0,1] neg_hi:[0,1]
    v_pk_add_f32 v[36:37], v[28:29], v[44:45] op_sel_hi:[1,0] neg_lo:[0,1] neg_hi:[0,1]
    v_pk_add_f32 v[38:39], v[30:31], v[44:45] op_sel_hi:[1,0] neg_lo:[0,1] neg_hi:[0,1]
    v_cvt_pk_bf16_f32 v40, v32, v33
    v_cvt_pk_bf16_f32 v41, v34, v35
    v_cvt_pk_bf16_f32 v42, v36, v37
    v_cvt_pk_bf16_f32 v43, v38, v39
    v_lshlrev_b32 v32, 16, v40
    v_and_b32 v33, 0xffff0000, v40
    v_lshlrev_b32 v34, 16, v41
    v_and_b32 v35, 0xffff0000, v41
    v_lshlrev_b32 v36, 16, v42
    v_and_b32 v37, 0xffff0000, v42
    v_lshlrev_b32 v38, 16, v43
    v_and_b32 v39, 0xffff0000, v43
    v_pk_mul_f32 v[32:33], v[32:33], v[46:47] op_sel_hi:[1,0]
    v_pk_mul_f32 v[34:35], v[34:35], v[46:47] op_sel_hi:[1,0]
    v_pk_mul_f32 v[36:37], v[36:37], v[46:47] op_sel_hi:[1,0]
    v_pk_mul_f32 v[38:39], v[38:39], v[46:47] op_sel_hi:[1,0]
    v_cvt_pk_bf16_f32 v40, v32, v33
    v_cvt_pk_bf16_f32 v41, v34, v35
    v_cvt_pk_bf16_f32 v42, v36, v37
    v_cvt_pk_bf16_f32 v43, v38, v39
    v_min_u32 v40, -2, v40
    v_add_u32 v81, 127926272, v1
    global_store_dwordx4 v81, v[40:43], s[30:31] sc1
    s_mov_b64 s[100:101], 1
    s_nop 0
    s_branch L_fl2_99
L_fl1_98:
    global_store_dwordx4 v1, v[48:51], s[32:33]
    s_nop 1
L_fl2_99:
    s_add_u32 s23, s23, 1
    s_mov_b32 s61, s63
    s_cmp_lt_u32 s61, 128
    s_cbranch_scc1 L_fj_91
    s_waitcnt vmcnt(0)
    s_mov_b64 exec, s[100:101]
    global_store_dword v15, v8, s[4:5] sc1
    s_mov_b64 exec, -1
    s_mov_b64 s[100:101], 0
L_end_75:
    s_waitcnt vmcnt(0) lgkmcnt(0)
    s_endpgm
L_safe_far_x:
L_safe_far_f:
L_safe:
    s_waitcnt vmcnt(0) lgkmcnt(0)
    s_cmp_lg_u32 s9, 0
    s_cbranch_scc1 L_sg_100
    v_mov_b32 v1, 36
    v_mov_b32 v2, 1
    s_mov_b64 exec, 1
    global_atomic_add v3, v1, v2, s[10:11] sc0 sc1
    s_mov_b64 exec, -1
    s_waitcnt vmcnt(0)
    s_mov_b64 exec, 1
    v_mov_b32 v1, 161792
    ds_write_b32 v1, v3
    s_waitcnt lgkmcnt(0)
    s_mov_b64 exec, -1
L_sg_100:
    s_barrier
    v_mov_b32 v1, 161792
    ds_read_b32 v2, v1
    s_waitcnt lgkmcnt(0)
    v_readfirstlane_b32 s47, v2
    s_barrier
    s_lshr_b32 s6, s47, 5
    s_and_b32 s7, s47, 31
    s_lshl_b32 s38, s6, 23
    s_add_u32 s38, s38, 201326592
    s_add_u32 s20, s4, s38
    s_addc_u32 s21, s5, 0
    s_cmp_eq_u32 s6, 7
    s_cbranch_scc1 L_safe_f
    s_cmp_ge_u32 s6, 2
    s_cbranch_scc1 L_safe_x
    s_cmp_lg_u32 s6, 1
    s_cbranch_scc1 L_xn0_102
    s_load_dwordx2 s[14:15], s[0:1], 0
    s_add_u32 s16, s4, 146800640
    s_addc_u32 s17, s5, 0
    v_lshlrev_b32 v12, 4, v0
    s_lshl_b32 s38, s7, 12
    v_add_u32 v12, s38, v12
    s_mov_b32 s40, 0
    s_waitcnt lgkmcnt(0)
L_xnl_103:
    v_add_u32 v4, 0, v12
    global_load_dwordx4 v[16:19], v4, s[14:15]
    v_add_u32 v5, 131072, v12
    global_load_dwordx4 v[20:23], v5, s[14:15]
    v_add_u32 v6, 262144, v12
    global_load_dwordx4 v[24:27], v6, s[14:15]
    v_add_u32 v7, 393216, v12
    global_load_dwordx4 v[28:31], v7, s[14:15]
    s_waitcnt vmcnt(3)
    v_lshlrev_b32 v32, 16, v16
    v_and_b32 v33, 0xffff0000, v16
    v_lshlrev_b32 v34, 16, v17
    v_and_b32 v35, 0xffff0000, v17
    v_lshlrev_b32 v36, 16, v18
    v_and_b32 v37, 0xffff0000, v18
    v_lshlrev_b32 v38, 16, v19
    v_and_b32 v39, 0xffff0000, v19
    v_pk_add_f32 v[40:41], v[32:33], v[34:35]
    v_pk_add_f32 v[42:43], v[36:37], v[38:39]
    v_pk_add_f32 v[40:41], v[40:41], v[42:43]
    v_add_f32 v64, v40, v41
    s_nop 1
    v_add_f32_dpp v65, v64, v64 quad_perm:[1,0,3,2] row_mask:0xf bank_mask:0xf
    s_nop 1
    v_add_f32_dpp v64, v65, v65 quad_perm:[2,3,0,1] row_mask:0xf bank_mask:0xf
    s_nop 1
    v_add_f32_dpp v65, v64, v64 row_half_mirror row_mask:0xf bank_mask:0xf
    s_nop 1
    v_add_f32_dpp v64, v65, v65 row_mirror row_mask:0xf bank_mask:0xf
    v_mov_b32 v65, v64
    s_nop 1
    v_permlane16_swap_b32 v65, v64
    v_add_f32 v64, v64, v65
    v_mov_b32 v65, v64
    s_nop 1
    v_permlane32_swap_b32 v65, v64
    v_add_f32 v64, v64, v65
    v_mul_f32 v64, 0x3b000000, v64
    v_pk_add_f32 v[40:41], v[32:33], v[64:65] op_sel_hi:[1,0] neg_lo:[0,1] neg_hi:[0,1]
    v_pk_add_f32 v[42:43], v[34:35], v[64:65] op_sel_hi:[1,0] neg_lo:[0,1] neg_hi:[0,1]
    v_pk_add_f32 v[44:45], v[36:37], v[64:65] op_sel_hi:[1,0] neg_lo:[0,1] neg_hi:[0,1]
    v_pk_add_f32 v[46:47], v[38:39], v[64:65] op_sel_hi:[1,0] neg_lo:[0,1] neg_hi:[0,1]
    v_pk_mul_f32 v[66:67], v[40:41], v[40:41]
    v_pk_fma_f32 v[66:67], v[42:43], v[42:43], v[66:67]
    v_pk_fma_f32 v[66:67], v[44:45], v[44:45], v[66:67]
    v_pk_fma_f32 v[66:67], v[46:47], v[46:47], v[66:67]
    v_add_f32 v66, v66, v67
    s_nop 1
    v_add_f32_dpp v67, v66, v66 quad_perm:[1,0,3,2] row_mask:0xf bank_mask:0xf
    s_nop 1
    v_add_f32_dpp v66, v67, v67 quad_perm:[2,3,0,1] row_mask:0xf bank_mask:0xf
    s_nop 1
    v_add_f32_dpp v67, v66, v66 row_half_mirror row_mask:0xf bank_mask:0xf
    s_nop 1
    v_add_f32_dpp v66, v67, v67 row_mirror row_mask:0xf bank_mask:0xf
    v_mov_b32 v67, v66
    s_nop 1
    v_permlane16_swap_b32 v67, v66
    v_add_f32 v66, v66, v67
    v_mov_b32 v67, v66
    s_nop 1
    v_permlane32_swap_b32 v67, v66
    v_add_f32 v66, v66, v67
    v_mul_f32 v66, 0x3b000000, v66
    v_cvt_pk_bf16_f32 v64, v64, v64
    v_and_b32 v64, 0xffff0000, v64
    v_cvt_pk_bf16_f32 v66, v66, v66
    v_and_b32 v66, 0xffff0000, v66
    v_add_f32 v66, 0x3727c5ac, v66
    v_cvt_pk_bf16_f32 v66, v66, v66
    v_and_b32 v66, 0xffff0000, v66
    v_sqrt_f32 v66, v66
    s_nop 0
    v_cvt_pk_bf16_f32 v66, v66, v66
    v_and_b32 v66, 0xffff0000, v66
    v_rcp_f32 v66, v66
    v_pk_add_f32 v[40:41], v[32:33], v[64:65] op_sel_hi:[1,0] neg_lo:[0,1] neg_hi:[0,1]
    v_pk_add_f32 v[42:43], v[34:35], v[64:65] op_sel_hi:[1,0] neg_lo:[0,1] neg_hi:[0,1]
    v_pk_add_f32 v[44:45], v[36:37], v[64:65] op_sel_hi:[1,0] neg_lo:[0,1] neg_hi:[0,1]
    v_pk_add_f32 v[46:47], v[38:39], v[64:65] op_sel_hi:[1,0] neg_lo:[0,1] neg_hi:[0,1]
    v_cvt_pk_bf16_f32 v48, v40, v41
    v_cvt_pk_bf16_f32 v49, v42, v43
    v_cvt_pk_bf16_f32 v50, v44, v45
    v_cvt_pk_bf16_f32 v51, v46, v47
    v_lshlrev_b32 v40, 16, v48
    v_and_b32 v41, 0xffff0000, v48
    v_lshlrev_b32 v42, 16, v49
    v_and_b32 v43, 0xffff0000, v49
    v_lshlrev_b32 v44, 16, v50
    v_and_b32 v45, 0xffff0000, v50
    v_lshlrev_b32 v46, 16, v51
    v_and_b32 v47, 0xffff0000, v51
    v_pk_mul_f32 v[40:41], v[40:41], v[66:67] op_sel_hi:[1,0]
    v_pk_mul_f32 v[42:43], v[42:43], v[66:67] op_sel_hi:[1,0]
    v_pk_mul_f32 v[44:45], v[44:45], v[66:67] op_sel_hi:[1,0]
    v_pk_mul_f32 v[46:47], v[46:47], v[66:67] op_sel_hi:[1,0]
    v_cvt_pk_bf16_f32 v48, v40, v41
    v_cvt_pk_bf16_f32 v49, v42, v43
    v_cvt_pk_bf16_f32 v50, v44, v45
    v_cvt_pk_bf16_f32 v51, v46, v47
    v_min_u32 v48, -2, v48
    global_store_dwordx4 v4, v[48:51], s[16:17] sc1
    s_waitcnt vmcnt(3)
    v_lshlrev_b32 v32, 16, v20
    v_and_b32 v33, 0xffff0000, v20
    v_lshlrev_b32 v34, 16, v21
    v_and_b32 v35, 0xffff0000, v21
    v_lshlrev_b32 v36, 16, v22
    v_and_b32 v37, 0xffff0000, v22
    v_lshlrev_b32 v38, 16, v23
    v_and_b32 v39, 0xffff0000, v23
    v_pk_add_f32 v[40:41], v[32:33], v[34:35]
    v_pk_add_f32 v[42:43], v[36:37], v[38:39]
    v_pk_add_f32 v[40:41], v[40:41], v[42:43]
    v_add_f32 v64, v40, v41
    s_nop 1
    v_add_f32_dpp v65, v64, v64 quad_perm:[1,0,3,2] row_mask:0xf bank_mask:0xf
    s_nop 1
    v_add_f32_dpp v64, v65, v65 quad_perm:[2,3,0,1] row_mask:0xf bank_mask:0xf
    s_nop 1
    v_add_f32_dpp v65, v64, v64 row_half_mirror row_mask:0xf bank_mask:0xf
    s_nop 1
    v_add_f32_dpp v64, v65, v65 row_mirror row_mask:0xf bank_mask:0xf
    v_mov_b32 v65, v64
    s_nop 1
    v_permlane16_swap_b32 v65, v64
    v_add_f32 v64, v64, v65
    v_mov_b32 v65, v64
    s_nop 1
    v_permlane32_swap_b32 v65, v64
    v_add_f32 v64, v64, v65
    v_mul_f32 v64, 0x3b000000, v64
    v_pk_add_f32 v[40:41], v[32:33], v[64:65] op_sel_hi:[1,0] neg_lo:[0,1] neg_hi:[0,1]
    v_pk_add_f32 v[42:43], v[34:35], v[64:65] op_sel_hi:[1,0] neg_lo:[0,1] neg_hi:[0,1]
    v_pk_add_f32 v[44:45], v[36:37], v[64:65] op_sel_hi:[1,0] neg_lo:[0,1] neg_hi:[0,1]
    v_pk_add_f32 v[46:47], v[38:39], v[64:65] op_sel_hi:[1,0] neg_lo:[0,1] neg_hi:[0,1]
    v_pk_mul_f32 v[66:67], v[40:41], v[40:41]
    v_pk_fma_f32 v[66:67], v[42:43], v[42:43], v[66:67]
    v_pk_fma_f32 v[66:67], v[44:45], v[44:45], v[66:67]
    v_pk_fma_f32 v[66:67], v[46:47], v[46:47], v[66:67]
    v_add_f32 v66, v66, v67
    s_nop 1
    v_add_f32_dpp v67, v66, v66 quad_perm:[1,0,3,2] row_mask:0xf bank_mask:0xf
    s_nop 1
    v_add_f32_dpp v66, v67, v67 quad_perm:[2,3,0,1] row_mask:0xf bank_mask:0xf
    s_nop 1
    v_add_f32_dpp v67, v66, v66 row_half_mirror row_mask:0xf bank_mask:0xf
    s_nop 1
    v_add_f32_dpp v66, v67, v67 row_mirror row_mask:0xf bank_mask:0xf
    v_mov_b32 v67, v66
    s_nop 1
    v_permlane16_swap_b32 v67, v66
    v_add_f32 v66, v66, v67
    v_mov_b32 v67, v66
    s_nop 1
    v_permlane32_swap_b32 v67, v66
    v_add_f32 v66, v66, v67
    v_mul_f32 v66, 0x3b000000, v66
    v_cvt_pk_bf16_f32 v64, v64, v64
    v_and_b32 v64, 0xffff0000, v64
    v_cvt_pk_bf16_f32 v66, v66, v66
    v_and_b32 v66, 0xffff0000, v66
    v_add_f32 v66, 0x3727c5ac, v66
    v_cvt_pk_bf16_f32 v66, v66, v66
    v_and_b32 v66, 0xffff0000, v66
    v_sqrt_f32 v66, v66
    s_nop 0
    v_cvt_pk_bf16_f32 v66, v66, v66
    v_and_b32 v66, 0xffff0000, v66
    v_rcp_f32 v66, v66
    v_pk_add_f32 v[40:41], v[32:33], v[64:65] op_sel_hi:[1,0] neg_lo:[0,1] neg_hi:[0,1]
    v_pk_add_f32 v[42:43], v[34:35], v[64:65] op_sel_hi:[1,0] neg_lo:[0,1] neg_hi:[0,1]
    v_pk_add_f32 v[44:45], v[36:37], v[64:65] op_sel_hi:[1,0] neg_lo:[0,1] neg_hi:[0,1]
    v_pk_add_f32 v[46:47], v[38:39], v[64:65] op_sel_hi:[1,0] neg_lo:[0,1] neg_hi:[0,1]
    v_cvt_pk_bf16_f32 v52, v40, v41
    v_cvt_pk_bf16_f32 v53, v42, v43
    v_cvt_pk_bf16_f32 v54, v44, v45
    v_cvt_pk_bf16_f32 v55, v46, v47
    v_lshlrev_b32 v40, 16, v52
    v_and_b32 v41, 0xffff0000, v52
    v_lshlrev_b32 v42, 16, v53
    v_and_b32 v43, 0xffff0000, v53
    v_lshlrev_b32 v44, 16, v54
    v_and_b32 v45, 0xffff0000, v54
    v_lshlrev_b32 v46, 16, v55
    v_and_b32 v47, 0xffff0000, v55
    v_pk_mul_f32 v[40:41], v[40:41], v[66:67] op_sel_hi:[1,0]
    v_pk_mul_f32 v[42:43], v[42:43], v[66:67] op_sel_hi:[1,0]
    v_pk_mul_f32 v[44:45], v[44:45], v[66:67] op_sel_hi:[1,0]
    v_pk_mul_f32 v[46:47], v[46:47], v[66:67] op_sel_hi:[1,0]
    v_cvt_pk_bf16_f32 v52, v40, v41
    v_cvt_pk_bf16_f32 v53, v42, v43
    v_cvt_pk_bf16_f32 v54, v44, v45
    v_cvt_pk_bf16_f32 v55, v46, v47
    v_min_u32 v52, -2, v52
    global_store_dwordx4 v5, v[52:55], s[16:17] sc1
    s_waitcnt vmcnt(3)
    v_lshlrev_b32 v32, 16, v24
    v_and_b32 v33, 0xffff0000, v24
    v_lshlrev_b32 v34, 16, v25
    v_and_b32 v35, 0xffff0000, v25
    v_lshlrev_b32 v36, 16, v26
    v_and_b32 v37, 0xffff0000, v26
    v_lshlrev_b32 v38, 16, v27
    v_and_b32 v39, 0xffff0000, v27
    v_pk_add_f32 v[40:41], v[32:33], v[34:35]
    v_pk_add_f32 v[42:43], v[36:37], v[38:39]
    v_pk_add_f32 v[40:41], v[40:41], v[42:43]
    v_add_f32 v64, v40, v41
    s_nop 1
    v_add_f32_dpp v65, v64, v64 quad_perm:[1,0,3,2] row_mask:0xf bank_mask:0xf
    s_nop 1
    v_add_f32_dpp v64, v65, v65 quad_perm:[2,3,0,1] row_mask:0xf bank_mask:0xf
    s_nop 1
    v_add_f32_dpp v65, v64, v64 row_half_mirror row_mask:0xf bank_mask:0xf
    s_nop 1
    v_add_f32_dpp v64, v65, v65 row_mirror row_mask:0xf bank_mask:0xf
    v_mov_b32 v65, v64
    s_nop 1
    v_permlane16_swap_b32 v65, v64
    v_add_f32 v64, v64, v65
    v_mov_b32 v65, v64
    s_nop 1
    v_permlane32_swap_b32 v65, v64
    v_add_f32 v64, v64, v65
    v_mul_f32 v64, 0x3b000000, v64
    v_pk_add_f32 v[40:41], v[32:33], v[64:65] op_sel_hi:[1,0] neg_lo:[0,1] neg_hi:[0,1]
    v_pk_add_f32 v[42:43], v[34:35], v[64:65] op_sel_hi:[1,0] neg_lo:[0,1] neg_hi:[0,1]
    v_pk_add_f32 v[44:45], v[36:37], v[64:65] op_sel_hi:[1,0] neg_lo:[0,1] neg_hi:[0,1]
    v_pk_add_f32 v[46:47], v[38:39], v[64:65] op_sel_hi:[1,0] neg_lo:[0,1] neg_hi:[0,1]
    v_pk_mul_f32 v[66:67], v[40:41], v[40:41]
    v_pk_fma_f32 v[66:67], v[42:43], v[42:43], v[66:67]
    v_pk_fma_f32 v[66:67], v[44:45], v[44:45], v[66:67]
    v_pk_fma_f32 v[66:67], v[46:47], v[46:47], v[66:67]
    v_add_f32 v66, v66, v67
    s_nop 1
    v_add_f32_dpp v67, v66, v66 quad_perm:[1,0,3,2] row_mask:0xf bank_mask:0xf
    s_nop 1
    v_add_f32_dpp v66, v67, v67 quad_perm:[2,3,0,1] row_mask:0xf bank_mask:0xf
    s_nop 1
    v_add_f32_dpp v67, v66, v66 row_half_mirror row_mask:0xf bank_mask:0xf
    s_nop 1
    v_add_f32_dpp v66, v67, v67 row_mirror row_mask:0xf bank_mask:0xf
    v_mov_b32 v67, v66
    s_nop 1
    v_permlane16_swap_b32 v67, v66
    v_add_f32 v66, v66, v67
    v_mov_b32 v67, v66
    s_nop 1
    v_permlane32_swap_b32 v67, v66
    v_add_f32 v66, v66, v67
    v_mul_f32 v66, 0x3b000000, v66
    v_cvt_pk_bf16_f32 v64, v64, v64
    v_and_b32 v64, 0xffff0000, v64
    v_cvt_pk_bf16_f32 v66, v66, v66
    v_and_b32 v66, 0xffff0000, v66
    v_add_f32 v66, 0x3727c5ac, v66
    v_cvt_pk_bf16_f32 v66, v66, v66
    v_and_b32 v66, 0xffff0000, v66
    v_sqrt_f32 v66, v66
    s_nop 0
    v_cvt_pk_bf16_f32 v66, v66, v66
    v_and_b32 v66, 0xffff0000, v66
    v_rcp_f32 v66, v66
    v_pk_add_f32 v[40:41], v[32:33], v[64:65] op_sel_hi:[1,0] neg_lo:[0,1] neg_hi:[0,1]
    v_pk_add_f32 v[42:43], v[34:35], v[64:65] op_sel_hi:[1,0] neg_lo:[0,1] neg_hi:[0,1]
    v_pk_add_f32 v[44:45], v[36:37], v[64:65] op_sel_hi:[1,0] neg_lo:[0,1] neg_hi:[0,1]
    v_pk_add_f32 v[46:47], v[38:39], v[64:65] op_sel_hi:[1,0] neg_lo:[0,1] neg_hi:[0,1]
    v_cvt_pk_bf16_f32 v56, v40, v41
    v_cvt_pk_bf16_f32 v57, v42, v43
    v_cvt_pk_bf16_f32 v58, v44, v45
    v_cvt_pk_bf16_f32 v59, v46, v47
    v_lshlrev_b32 v40, 16, v56
    v_and_b32 v41, 0xffff0000, v56
    v_lshlrev_b32 v42, 16, v57
    v_and_b32 v43, 0xffff0000, v57
    v_lshlrev_b32 v44, 16, v58
    v_and_b32 v45, 0xffff0000, v58
    v_lshlrev_b32 v46, 16, v59
    v_and_b32 v47, 0xffff0000, v59
    v_pk_mul_f32 v[40:41], v[40:41], v[66:67] op_sel_hi:[1,0]
    v_pk_mul_f32 v[42:43], v[42:43], v[66:67] op_sel_hi:[1,0]
    v_pk_mul_f32 v[44:45], v[44:45], v[66:67] op_sel_hi:[1,0]
    v_pk_mul_f32 v[46:47], v[46:47], v[66:67] op_sel_hi:[1,0]
    v_cvt_pk_bf16_f32 v56, v40, v41
    v_cvt_pk_bf16_f32 v57, v42, v43
    v_cvt_pk_bf16_f32 v58, v44, v45
    v_cvt_pk_bf16_f32 v59, v46, v47
    v_min_u32 v56, -2, v56
    global_store_dwordx4 v6, v[56:59], s[16:17] sc1
    s_waitcnt vmcnt(3)
    v_lshlrev_b32 v32, 16, v28
    v_and_b32 v33, 0xffff0000, v28
    v_lshlrev_b32 v34, 16, v29
    v_and_b32 v35, 0xffff0000, v29
    v_lshlrev_b32 v36, 16, v30
    v_and_b32 v37, 0xffff0000, v30
    v_lshlrev_b32 v38, 16, v31
    v_and_b32 v39, 0xffff0000, v31
    v_pk_add_f32 v[40:41], v[32:33], v[34:35]
    v_pk_add_f32 v[42:43], v[36:37], v[38:39]
    v_pk_add_f32 v[40:41], v[40:41], v[42:43]
    v_add_f32 v64, v40, v41
    s_nop 1
    v_add_f32_dpp v65, v64, v64 quad_perm:[1,0,3,2] row_mask:0xf bank_mask:0xf
    s_nop 1
    v_add_f32_dpp v64, v65, v65 quad_perm:[2,3,0,1] row_mask:0xf bank_mask:0xf
    s_nop 1
    v_add_f32_dpp v65, v64, v64 row_half_mirror row_mask:0xf bank_mask:0xf
    s_nop 1
    v_add_f32_dpp v64, v65, v65 row_mirror row_mask:0xf bank_mask:0xf
    v_mov_b32 v65, v64
    s_nop 1
    v_permlane16_swap_b32 v65, v64
    v_add_f32 v64, v64, v65
    v_mov_b32 v65, v64
    s_nop 1
    v_permlane32_swap_b32 v65, v64
    v_add_f32 v64, v64, v65
    v_mul_f32 v64, 0x3b000000, v64
    v_pk_add_f32 v[40:41], v[32:33], v[64:65] op_sel_hi:[1,0] neg_lo:[0,1] neg_hi:[0,1]
    v_pk_add_f32 v[42:43], v[34:35], v[64:65] op_sel_hi:[1,0] neg_lo:[0,1] neg_hi:[0,1]
    v_pk_add_f32 v[44:45], v[36:37], v[64:65] op_sel_hi:[1,0] neg_lo:[0,1] neg_hi:[0,1]
    v_pk_add_f32 v[46:47], v[38:39], v[64:65] op_sel_hi:[1,0] neg_lo:[0,1] neg_hi:[0,1]
    v_pk_mul_f32 v[66:67], v[40:41], v[40:41]
    v_pk_fma_f32 v[66:67], v[42:43], v[42:43], v[66:67]
    v_pk_fma_f32 v[66:67], v[44:45], v[44:45], v[66:67]
    v_pk_fma_f32 v[66:67], v[46:47], v[46:47], v[66:67]
    v_add_f32 v66, v66, v67
    s_nop 1
    v_add_f32_dpp v67, v66, v66 quad_perm:[1,0,3,2] row_mask:0xf bank_mask:0xf
    s_nop 1
    v_add_f32_dpp v66, v67, v67 quad_perm:[2,3,0,1] row_mask:0xf bank_mask:0xf
    s_nop 1
    v_add_f32_dpp v67, v66, v66 row_half_mirror row_mask:0xf bank_mask:0xf
    s_nop 1
    v_add_f32_dpp v66, v67, v67 row_mirror row_mask:0xf bank_mask:0xf
    v_mov_b32 v67, v66
    s_nop 1
    v_permlane16_swap_b32 v67, v66
    v_add_f32 v66, v66, v67
    v_mov_b32 v67, v66
    s_nop 1
    v_permlane32_swap_b32 v67, v66
    v_add_f32 v66, v66, v67
    v_mul_f32 v66, 0x3b000000, v66
    v_cvt_pk_bf16_f32 v64, v64, v64
    v_and_b32 v64, 0xffff0000, v64
    v_cvt_pk_bf16_f32 v66, v66, v66
    v_and_b32 v66, 0xffff0000, v66
    v_add_f32 v66, 0x3727c5ac, v66
    v_cvt_pk_bf16_f32 v66, v66, v66
    v_and_b32 v66, 0xffff0000, v66
    v_sqrt_f32 v66, v66
    s_nop 0
    v_cvt_pk_bf16_f32 v66, v66, v66
    v_and_b32 v66, 0xffff0000, v66
    v_rcp_f32 v66, v66
    v_pk_add_f32 v[40:41], v[32:33], v[64:65] op_sel_hi:[1,0] neg_lo:[0,1] neg_hi:[0,1]
    v_pk_add_f32 v[42:43], v[34:35], v[64:65] op_sel_hi:[1,0] neg_lo:[0,1] neg_hi:[0,1]
    v_pk_add_f32 v[44:45], v[36:37], v[64:65] op_sel_hi:[1,0] neg_lo:[0,1] neg_hi:[0,1]
    v_pk_add_f32 v[46:47], v[38:39], v[64:65] op_sel_hi:[1,0] neg_lo:[0,1] neg_hi:[0,1]
    v_cvt_pk_bf16_f32 v60, v40, v41
    v_cvt_pk_bf16_f32 v61, v42, v43
    v_cvt_pk_bf16_f32 v62, v44, v45
    v_cvt_pk_bf16_f32 v63, v46, v47
    v_lshlrev_b32 v40, 16, v60
    v_and_b32 v41, 0xffff0000, v60
    v_lshlrev_b32 v42, 16, v61
    v_and_b32 v43, 0xffff0000, v61
    v_lshlrev_b32 v44, 16, v62
    v_and_b32 v45, 0xffff0000, v62
    v_lshlrev_b32 v46, 16, v63
    v_and_b32 v47, 0xffff0000, v63
    v_pk_mul_f32 v[40:41], v[40:41], v[66:67] op_sel_hi:[1,0]
    v_pk_mul_f32 v[42:43], v[42:43], v[66:67] op_sel_hi:[1,0]
    v_pk_mul_f32 v[44:45], v[44:45], v[66:67] op_sel_hi:[1,0]
    v_pk_mul_f32 v[46:47], v[46:47], v[66:67] op_sel_hi:[1,0]
    v_cvt_pk_bf16_f32 v60, v40, v41
    v_cvt_pk_bf16_f32 v61, v42, v43
    v_cvt_pk_bf16_f32 v62, v44, v45
    v_cvt_pk_bf16_f32 v63, v46, v47
    v_min_u32 v60, -2, v60
    global_store_dwordx4 v7, v[60:63], s[16:17] sc1
    v_add_u32 v12, 524288, v12
    s_add_u32 s40, s40, 1
    s_cmp_lt_u32 s40, 4
    s_cbranch_scc1 L_xnl_103
    s_waitcnt vmcnt(0)
    s_barrier
    s_cmp_lg_u32 s9, 0
    s_cbranch_scc1 L_arr_104
    v_mov_b32 v1, 132
    v_mov_b32 v2, 1
    s_mov_b64 exec, 1
    global_atomic_add v1, v2, s[10:11] sc1
    s_mov_b64 exec, -1
L_arr_104:
    s_sleep 127
    s_sleep 127
L_xn0_102:
    s_lshl_b32 s46, s9, 12
    s_lshl_b32 s38, s6, 25
    s_lshl_b32 s39, s7, 14
    s_add_u32 s38, s38, s39
    s_add_u32 s38, s38, s46
    s_add_u32 s30, s4, s38
    s_addc_u32 s31, s5, 0
    s_lshl_b32 s38, s6, 23
    s_lshl_b32 s39, s7, 12
    s_add_u32 s38, s38, s39
    s_add_u32 s38, s38, 100663296
    s_add_u32 s32, s4, s38
    s_addc_u32 s33, s5, 0
    s_lshl_b32 s38, s6, 13
    s_lshl_b32 s39, s7, 2
    s_add_u32 s38, s38, s39
    s_add_u32 s39, s38, 117440512
    s_add_u32 s34, s4, s39
    s_addc_u32 s35, s5, 0
    s_lshl_b32 s38, s38, 2
    s_lshl_b32 s39, s9, 2
    s_add_u32 s38, s38, s39
    s_add_u32 s39, s38, 117506048
    s_add_u32 s36, s4, s39
    s_addc_u32 s37, s5, 0
    s_mov_b64 s[56:57], 0
    s_add_u32 s22, s20, 0
    s_addc_u32 s23, s21, 0
    s_add_u32 s24, s20, 8192
    s_addc_u32 s25, s21, 0
    s_add_u32 s28, s20, 65536
    s_addc_u32 s29, s21, 0
    s_add_u32 s50, s20, 98304
    s_addc_u32 s51, s21, 0
    s_add_u32 s52, s20, 131072
    s_addc_u32 s53, s21, 0
    s_add_u32 s54, s20, 163840
    s_addc_u32 s55, s21, 0
    s_lshl_b32 s38, s7, 14
    s_add_u32 s38, s38, s46
    s_add_u32 s26, s28, s38
    s_addc_u32 s27, s29, 0
    s_mov_b32 s42, 0x00550055
    s_mov_b32 s43, 0x00550055
    s_mov_b32 s44, 0x3e0293ee
    s_mov_b32 s45, 0x3e0293ee
    s_cmp_lg_u32 s9, 0
    s_cbranch_scc1 L_minit_105
    s_load_dwordx2 s[12:13], s[0:1], 8
    v_bfe_u32 v17, v0, 2, 3
    v_lshlrev_b32 v17, 10, v17
    v_and_b32 v18, 3, v0
    v_lshl_add_u32 v17, v18, 3, v17
    v_lshrrev_b32 v18, 5, v0
    v_lshl_add_u32 v17, v18, 2, v17
    s_lshl_b32 s38, s7, 5
    v_add_u32 v17, s38, v17
    s_waitcnt lgkmcnt(0)
    global_load_dword v107, v17, s[12:13]
L_minit_105:
    s_load_dwordx2 s[12:13], s[0:1], 16
    s_load_dwordx2 s[14:15], s[0:1], 24
    s_load_dwordx2 s[16:17], s[0:1], 32
    s_load_dwordx2 s[18:19], s[0:1], 40
    v_lshrrev_b32 v1, 4, v0
    v_and_b32 v2, 15, v0
    v_lshlrev_b32 v3, 13, v1
    v_lshl_add_u32 v3, v2, 4, v3
    s_lshl_b32 s38, s7, 8
    v_add_u32 v3, s38, v3
    v_lshlrev_b32 v4, 10, v1
    v_lshrrev_b32 v5, 2, v2
    v_lshl_add_u32 v4, v5, 8, v4
    v_and_b32 v5, 3, v2
    v_lshl_add_u32 v4, v5, 4, v4
    s_lshl_b32 s38, s7, 17
    v_add_u32 v4, s38, v4
    v_and_b32 v5, 3, v1
    v_lshlrev_b32 v5, 5, v5
    v_bfe_u32 v6, v1, 3, 1
    v_lshlrev_b32 v6, 7, v6
    v_xor_b32 v5, v5, v6
    v_lshlrev_b32 v6, 4, v2
    v_xor_b32 v5, v5, v6
    v_lshl_add_u32 v5, v1, 8, v5
    v_add_u32 v5, 16384, v5
    v_and_b32 v6, 63, v0
    v_lshrrev_b32 v7, 4, v6
    v_bfe_u32 v8, v6, 2, 2
    v_and_b32 v9, 3, v6
    v_lshl_add_u32 v10, v7, 3, v8
    v_lshlrev_b32 v10, 8, v10
    v_add_u32 v10, 16384, v10
    v_lshlrev_b32 v8, 5, v8
    v_and_b32 v7, 1, v7
    v_lshlrev_b32 v7, 7, v7
    v_xor_b32 v8, v8, v7
    s_lshl_b32 s38, s9, 6
    v_lshlrev_b32 v12, 3, v9
    v_add_u32 v12, s38, v12
    v_xor_b32 v12, v12, v8
    v_add_u32 v6, v10, v12
    v_xor_b32 v12, 32, v12
    v_add_u32 v7, v10, v12
    v_and_b32 v8, 63, v0
    v_lshlrev_b32 v8, 4, v8
    s_mul_i32 s38, s9, 28672
    s_add_u32 s38, s38, 49152
    v_add_u32 v8, s38, v8
    v_lshrrev_b32 v15, 2, v2
    v_lshlrev_b32 v15, 20, v15
    s_waitcnt lgkmcnt(0)
    v_add_u32 v11, 0, v15
    v_and_b32 v11, 0x3fffff, v11
    v_add_u32 v11, v11, v3
    global_load_dwordx4 v[16:19], v11, s[14:15]
    v_add_u32 v11, 0, v15
    v_and_b32 v11, 0x3fffff, v11
    v_add_u32 v11, v11, v3
    v_add_u32 v11, 131072, v11
    global_load_dwordx4 v[20:23], v11, s[14:15]
    v_add_u32 v11, 0, v15
    v_and_b32 v11, 0x3fffff, v11
    v_add_u32 v11, v11, v3
    v_add_u32 v11, 262144, v11
    global_load_dwordx4 v[24:27], v11, s[14:15]
    v_add_u32 v11, 0, v15
    v_and_b32 v11, 0x3fffff, v11
    v_add_u32 v11, v11, v3
    v_add_u32 v11, 393216, v11
    global_load_dwordx4 v[28:31], v11, s[14:15]
    v_add_u32 v11, 524288, v15
    v_and_b32 v11, 0x3fffff, v11
    v_add_u32 v11, v11, v3
    global_load_dwordx4 v[32:35], v11, s[14:15]
    v_add_u32 v11, 524288, v15
    v_and_b32 v11, 0x3fffff, v11
    v_add_u32 v11, v11, v3
    v_add_u32 v11, 131072, v11
    global_load_dwordx4 v[36:39], v11, s[14:15]
    v_add_u32 v11, 524288, v15
    v_and_b32 v11, 0x3fffff, v11
    v_add_u32 v11, v11, v3
    v_add_u32 v11, 262144, v11
    global_load_dwordx4 v[40:43], v11, s[14:15]
    v_add_u32 v11, 524288, v15
    v_and_b32 v11, 0x3fffff, v11
    v_add_u32 v11, v11, v3
    v_add_u32 v11, 393216, v11
    global_load_dwordx4 v[44:47], v11, s[14:15]
    v_add_u32 v11, 1048576, v15
    v_and_b32 v11, 0x3fffff, v11
    v_add_u32 v11, v11, v3
    global_load_dwordx4 v[48:51], v11, s[14:15]
    v_add_u32 v11, 1048576, v15
    v_and_b32 v11, 0x3fffff, v11
    v_add_u32 v11, v11, v3
    v_add_u32 v11, 131072, v11
    global_load_dwordx4 v[52:55], v11, s[14:15]
    v_add_u32 v11, 1048576, v15
    v_and_b32 v11, 0x3fffff, v11
    v_add_u32 v11, v11, v3
    v_add_u32 v11, 262144, v11
    global_load_dwordx4 v[56:59], v11, s[14:15]
    v_add_u32 v11, 1048576, v15
    v_and_b32 v11, 0x3fffff, v11
    v_add_u32 v11, v11, v3
    v_add_u32 v11, 393216, v11
    global_load_dwordx4 v[60:63], v11, s[14:15]
    v_add_u32 v11, 1572864, v15
    v_and_b32 v11, 0x3fffff, v11
    v_add_u32 v11, v11, v3
    global_load_dwordx4 v[64:67], v11, s[14:15]
    v_add_u32 v11, 1572864, v15
    v_and_b32 v11, 0x3fffff, v11
    v_add_u32 v11, v11, v3
    v_add_u32 v11, 131072, v11
    global_load_dwordx4 v[68:71], v11, s[14:15]
    v_add_u32 v11, 1572864, v15
    v_and_b32 v11, 0x3fffff, v11
    v_add_u32 v11, v11, v3
    v_add_u32 v11, 262144, v11
    global_load_dwordx4 v[72:75], v11, s[14:15]
    v_add_u32 v11, 1572864, v15
    v_and_b32 v11, 0x3fffff, v11
    v_add_u32 v11, v11, v3
    v_add_u32 v11, 393216, v11
    global_load_dwordx4 v[76:79], v11, s[14:15]
    v_add_u32 v11, 2097152, v15
    v_and_b32 v11, 0x3fffff, v11
    v_add_u32 v11, v11, v3
    global_load_dwordx4 v[80:83], v11, s[14:15]
    v_add_u32 v11, 2097152, v15
    v_and_b32 v11, 0x3fffff, v11
    v_add_u32 v11, v11, v3
    v_add_u32 v11, 131072, v11
    global_load_dwordx4 v[84:87], v11, s[14:15]
    v_add_u32 v11, 2097152, v15
    v_and_b32 v11, 0x3fffff, v11
    v_add_u32 v11, v11, v3
    v_add_u32 v11, 262144, v11
    global_load_dwordx4 v[88:91], v11, s[14:15]
    v_add_u32 v11, 2097152, v15
    v_and_b32 v11, 0x3fffff, v11
    v_add_u32 v11, v11, v3
    v_add_u32 v11, 393216, v11
    global_load_dwordx4 v[92:95], v11, s[14:15]
    v_and_b32 v100, 63, v0
    v_lshlrev_b32 v101, 4, v100
    v_mov_b32 v96, 0
    v_mov_b32 v97, 0
    v_mov_b32 v98, 0
    v_mov_b32 v99, 0
    s_cmp_lg_u32 s9, 0
    s_nop 0
    s_cbranch_scc1 L_minit_106
    s_lshl_b32 s38, s7, 8
    v_lshlrev_b32 v102, 2, v100
    v_add_u32 v102, s38, v102
    v_mov_b32 v103, -1
    s_waitcnt vmcnt(20)
    v_min_u32 v107, -2, v107
    global_store_dword v102, v103, s[24:25] sc1
    global_store_dword v102, v107, s[22:23] sc1
L_minit_106:
    global_store_dwordx4 v101, v[96:99], s[26:27] offset:0 sc1
    global_store_dwordx4 v101, v[96:99], s[26:27] offset:1024 sc1
    s_waitcnt vmcnt(16)
    ds_write_b128 v5, v[16:19] offset:0
    ds_write_b128 v5, v[20:23] offset:4096
    ds_write_b128 v5, v[24:27] offset:8192
    ds_write_b128 v5, v[28:31] offset:12288
    s_waitcnt lgkmcnt(0)
    v_add_u32 v11, 2621440, v15
    v_and_b32 v11, 0x3fffff, v11
    v_add_u32 v11, v11, v3
    global_load_dwordx4 v[16:19], v11, s[14:15]
    v_add_u32 v11, 2621440, v15
    v_and_b32 v11, 0x3fffff, v11
    v_add_u32 v11, v11, v3
    v_add_u32 v11, 131072, v11
    global_load_dwordx4 v[20:23], v11, s[14:15]
    v_add_u32 v11, 2621440, v15
    v_and_b32 v11, 0x3fffff, v11
    v_add_u32 v11, v11, v3
    v_add_u32 v11, 262144, v11
    global_load_dwordx4 v[24:27], v11, s[14:15]
    v_add_u32 v11, 2621440, v15
    v_and_b32 v11, 0x3fffff, v11
    v_add_u32 v11, v11, v3
    v_add_u32 v11, 393216, v11
    global_load_dwordx4 v[28:31], v11, s[14:15]
    s_barrier
    ds_read_b64_tr_b16 v[96:97], v6 offset:0
    ds_read_b64_tr_b16 v[98:99], v6 offset:1024
    ds_read_b64_tr_b16 v[100:101], v6 offset:8192
    ds_read_b64_tr_b16 v[102:103], v6 offset:9216
    s_waitcnt lgkmcnt(0)
    ds_write_b128 v8, v[96:99] offset:4096
    ds_write_b128 v8, v[100:103] offset:5120
    ds_read_b64_tr_b16 v[96:97], v7 offset:0
    ds_read_b64_tr_b16 v[98:99], v7 offset:1024
    ds_read_b64_tr_b16 v[100:101], v7 offset:8192
    ds_read_b64_tr_b16 v[102:103], v7 offset:9216
    s_waitcnt lgkmcnt(0)
    ds_write_b128 v8, v[96:99] offset:6144
    ds_write_b128 v8, v[100:103] offset:7168
    s_waitcnt lgkmcnt(0)
    s_waitcnt vmcnt(16)
    ds_write_b128 v5, v[32:35] offset:16384
    ds_write_b128 v5, v[36:39] offset:20480
    ds_write_b128 v5, v[40:43] offset:24576
    ds_write_b128 v5, v[44:47] offset:28672
    s_waitcnt lgkmcnt(0)
    v_add_u32 v11, 3145728, v15
    v_and_b32 v11, 0x3fffff, v11
    v_add_u32 v11, v11, v3
    global_load_dwordx4 v[32:35], v11, s[14:15]
    v_add_u32 v11, 3145728, v15
    v_and_b32 v11, 0x3fffff, v11
    v_add_u32 v11, v11, v3
    v_add_u32 v11, 131072, v11
    global_load_dwordx4 v[36:39], v11, s[14:15]
    v_add_u32 v11, 3145728, v15
    v_and_b32 v11, 0x3fffff, v11
    v_add_u32 v11, v11, v3
    v_add_u32 v11, 262144, v11
    global_load_dwordx4 v[40:43], v11, s[14:15]
    v_add_u32 v11, 3145728, v15
    v_and_b32 v11, 0x3fffff, v11
    v_add_u32 v11, v11, v3
    v_add_u32 v11, 393216, v11
    global_load_dwordx4 v[44:47], v11, s[14:15]
    s_barrier
    ds_read_b64_tr_b16 v[96:97], v6 offset:16384
    ds_read_b64_tr_b16 v[98:99], v6 offset:17408
    ds_read_b64_tr_b16 v[100:101], v6 offset:24576
    ds_read_b64_tr_b16 v[102:103], v6 offset:25600
    s_waitcnt lgkmcnt(0)
    ds_write_b128 v8, v[96:99] offset:12288
    ds_write_b128 v8, v[100:103] offset:13312
    ds_read_b64_tr_b16 a[0:1], v7 offset:16384
    ds_read_b64_tr_b16 a[2:3], v7 offset:17408
    ds_read_b64_tr_b16 a[4:5], v7 offset:24576
    ds_read_b64_tr_b16 a[6:7], v7 offset:25600
    s_waitcnt lgkmcnt(0)
    s_waitcnt vmcnt(16)
    ds_write_b128 v5, v[48:51] offset:0
    ds_write_b128 v5, v[52:55] offset:4096
    ds_write_b128 v5, v[56:59] offset:8192
    ds_write_b128 v5, v[60:63] offset:12288
    s_waitcnt lgkmcnt(0)
    v_add_u32 v11, 3670016, v15
    v_and_b32 v11, 0x3fffff, v11
    v_add_u32 v11, v11, v3
    global_load_dwordx4 v[48:51], v11, s[14:15]
    v_add_u32 v11, 3670016, v15
    v_and_b32 v11, 0x3fffff, v11
    v_add_u32 v11, v11, v3
    v_add_u32 v11, 131072, v11
    global_load_dwordx4 v[52:55], v11, s[14:15]
    v_add_u32 v11, 3670016, v15
    v_and_b32 v11, 0x3fffff, v11
    v_add_u32 v11, v11, v3
    v_add_u32 v11, 262144, v11
    global_load_dwordx4 v[56:59], v11, s[14:15]
    v_add_u32 v11, 3670016, v15
    v_and_b32 v11, 0x3fffff, v11
    v_add_u32 v11, v11, v3
    v_add_u32 v11, 393216, v11
    global_load_dwordx4 v[60:63], v11, s[14:15]
    s_barrier
    ds_read_b64_tr_b16 v[208:209], v6 offset:0
    ds_read_b64_tr_b16 v[210:211], v6 offset:1024
    ds_read_b64_tr_b16 v[212:213], v6 offset:8192
    ds_read_b64_tr_b16 v[214:215], v6 offset:9216
    ds_read_b64_tr_b16 a[8:9], v7 offset:0
    ds_read_b64_tr_b16 a[10:11], v7 offset:1024
    ds_read_b64_tr_b16 a[12:13], v7 offset:8192
    ds_read_b64_tr_b16 a[14:15], v7 offset:9216
    s_waitcnt lgkmcnt(0)
    s_waitcnt vmcnt(16)
    ds_write_b128 v5, v[64:67] offset:16384
    ds_write_b128 v5, v[68:71] offset:20480
    ds_write_b128 v5, v[72:75] offset:24576
    ds_write_b128 v5, v[76:79] offset:28672
    s_waitcnt lgkmcnt(0)
    v_add_u32 v11, 0, v15
    v_and_b32 v11, 0x3fffff, v11
    v_add_u32 v11, v11, v3
    global_load_dwordx4 v[64:67], v11, s[16:17]
    v_add_u32 v11, 0, v15
    v_and_b32 v11, 0x3fffff, v11
    v_add_u32 v11, v11, v3
    v_add_u32 v11, 131072, v11
    global_load_dwordx4 v[68:71], v11, s[16:17]
    v_add_u32 v11, 0, v15
    v_and_b32 v11, 0x3fffff, v11
    v_add_u32 v11, v11, v3
    v_add_u32 v11, 262144, v11
    global_load_dwordx4 v[72:75], v11, s[16:17]
    v_add_u32 v11, 0, v15
    v_and_b32 v11, 0x3fffff, v11
    v_add_u32 v11, v11, v3
    v_add_u32 v11, 393216, v11
    global_load_dwordx4 v[76:79], v11, s[16:17]
    s_barrier
    ds_read_b64_tr_b16 v[216:217], v6 offset:16384
    ds_read_b64_tr_b16 v[218:219], v6 offset:17408
    ds_read_b64_tr_b16 v[220:221], v6 offset:24576
    ds_read_b64_tr_b16 v[222:223], v6 offset:25600
    ds_read_b64_tr_b16 a[16:17], v7 offset:16384
    ds_read_b64_tr_b16 a[18:19], v7 offset:17408
    ds_read_b64_tr_b16 a[20:21], v7 offset:24576
    ds_read_b64_tr_b16 a[22:23], v7 offset:25600
    s_waitcnt lgkmcnt(0)
    s_waitcnt vmcnt(16)
    ds_write_b128 v5, v[80:83] offset:0
    ds_write_b128 v5, v[84:87] offset:4096
    ds_write_b128 v5, v[88:91] offset:8192
    ds_write_b128 v5, v[92:95] offset:12288
    s_waitcnt lgkmcnt(0)
    v_add_u32 v11, 524288, v15
    v_and_b32 v11, 0x3fffff, v11
    v_add_u32 v11, v11, v3
    global_load_dwordx4 v[80:83], v11, s[16:17]
    v_add_u32 v11, 524288, v15
    v_and_b32 v11, 0x3fffff, v11
    v_add_u32 v11, v11, v3
    v_add_u32 v11, 131072, v11
    global_load_dwordx4 v[84:87], v11, s[16:17]
    v_add_u32 v11, 524288, v15
    v_and_b32 v11, 0x3fffff, v11
    v_add_u32 v11, v11, v3
    v_add_u32 v11, 262144, v11
    global_load_dwordx4 v[88:91], v11, s[16:17]
    v_add_u32 v11, 524288, v15
    v_and_b32 v11, 0x3fffff, v11
    v_add_u32 v11, v11, v3
    v_add_u32 v11, 393216, v11
    global_load_dwordx4 v[92:95], v11, s[16:17]
    s_barrier
    ds_read_b64_tr_b16 v[224:225], v6 offset:0
    ds_read_b64_tr_b16 v[226:227], v6 offset:1024
    ds_read_b64_tr_b16 v[228:229], v6 offset:8192
    ds_read_b64_tr_b16 v[230:231], v6 offset:9216
    ds_read_b64_tr_b16 a[24:25], v7 offset:0
    ds_read_b64_tr_b16 a[26:27], v7 offset:1024
    ds_read_b64_tr_b16 a[28:29], v7 offset:8192
    ds_read_b64_tr_b16 a[30:31], v7 offset:9216
    s_waitcnt lgkmcnt(0)
    s_waitcnt vmcnt(16)
    ds_write_b128 v5, v[16:19] offset:16384
    ds_write_b128 v5, v[20:23] offset:20480
    ds_write_b128 v5, v[24:27] offset:24576
    ds_write_b128 v5, v[28:31] offset:28672
    s_waitcnt lgkmcnt(0)
    v_add_u32 v11, 1048576, v15
    v_and_b32 v11, 0x3fffff, v11
    v_add_u32 v11, v11, v3
    global_load_dwordx4 v[16:19], v11, s[16:17]
    v_add_u32 v11, 1048576, v15
    v_and_b32 v11, 0x3fffff, v11
    v_add_u32 v11, v11, v3
    v_add_u32 v11, 131072, v11
    global_load_dwordx4 v[20:23], v11, s[16:17]
    v_add_u32 v11, 1048576, v15
    v_and_b32 v11, 0x3fffff, v11
    v_add_u32 v11, v11, v3
    v_add_u32 v11, 262144, v11
    global_load_dwordx4 v[24:27], v11, s[16:17]
    v_add_u32 v11, 1048576, v15
    v_and_b32 v11, 0x3fffff, v11
    v_add_u32 v11, v11, v3
    v_add_u32 v11, 393216, v11
    global_load_dwordx4 v[28:31], v11, s[16:17]
    s_barrier
    ds_read_b64_tr_b16 v[232:233], v6 offset:16384
    ds_read_b64_tr_b16 v[234:235], v6 offset:17408
    ds_read_b64_tr_b16 v[236:237], v6 offset:24576
    ds_read_b64_tr_b16 v[238:239], v6 offset:25600
    ds_read_b64_tr_b16 a[32:33], v7 offset:16384
    ds_read_b64_tr_b16 a[34:35], v7 offset:17408
    ds_read_b64_tr_b16 a[36:37], v7 offset:24576
    ds_read_b64_tr_b16 a[38:39], v7 offset:25600
    s_waitcnt lgkmcnt(0)
    s_lshl_b32 s38, s6, 2
    s_add_u32 s38, s38, 96
    s_cmp_lg_u32 s9, 0
    s_cbranch_scc1 L_arr_107
    v_mov_b32 v1, s38
    v_mov_b32 v2, 1
    s_mov_b64 exec, 1
    global_atomic_add v1, v2, s[10:11] sc1
    s_mov_b64 exec, -1
L_arr_107:
    s_waitcnt vmcnt(16)
    ds_write_b128 v5, v[32:35] offset:0
    ds_write_b128 v5, v[36:39] offset:4096
    ds_write_b128 v5, v[40:43] offset:8192
    ds_write_b128 v5, v[44:47] offset:12288
    s_waitcnt lgkmcnt(0)
    v_add_u32 v11, 1572864, v15
    v_and_b32 v11, 0x3fffff, v11
    v_add_u32 v11, v11, v3
    global_load_dwordx4 v[32:35], v11, s[16:17]
    v_add_u32 v11, 1572864, v15
    v_and_b32 v11, 0x3fffff, v11
    v_add_u32 v11, v11, v3
    v_add_u32 v11, 131072, v11
    global_load_dwordx4 v[36:39], v11, s[16:17]
    v_add_u32 v11, 1572864, v15
    v_and_b32 v11, 0x3fffff, v11
    v_add_u32 v11, v11, v3
    v_add_u32 v11, 262144, v11
    global_load_dwordx4 v[40:43], v11, s[16:17]
    v_add_u32 v11, 1572864, v15
    v_and_b32 v11, 0x3fffff, v11
    v_add_u32 v11, v11, v3
    v_add_u32 v11, 393216, v11
    global_load_dwordx4 v[44:47], v11, s[16:17]
    s_barrier
    ds_read_b64_tr_b16 v[240:241], v6 offset:0
    ds_read_b64_tr_b16 v[242:243], v6 offset:1024
    ds_read_b64_tr_b16 v[244:245], v6 offset:8192
    ds_read_b64_tr_b16 v[246:247], v6 offset:9216
    ds_read_b64_tr_b16 a[40:41], v7 offset:0
    ds_read_b64_tr_b16 a[42:43], v7 offset:1024
    ds_read_b64_tr_b16 a[44:45], v7 offset:8192
    ds_read_b64_tr_b16 a[46:47], v7 offset:9216
    s_waitcnt lgkmcnt(0)
    s_waitcnt vmcnt(16)
    ds_write_b128 v5, v[48:51] offset:16384
    ds_write_b128 v5, v[52:55] offset:20480
    ds_write_b128 v5, v[56:59] offset:24576
    ds_write_b128 v5, v[60:63] offset:28672
    s_waitcnt lgkmcnt(0)
    v_add_u32 v11, 2097152, v15
    v_and_b32 v11, 0x3fffff, v11
    v_add_u32 v11, v11, v3
    global_load_dwordx4 v[48:51], v11, s[16:17]
    v_add_u32 v11, 2097152, v15
    v_and_b32 v11, 0x3fffff, v11
    v_add_u32 v11, v11, v3
    v_add_u32 v11, 131072, v11
    global_load_dwordx4 v[52:55], v11, s[16:17]
    v_add_u32 v11, 2097152, v15
    v_and_b32 v11, 0x3fffff, v11
    v_add_u32 v11, v11, v3
    v_add_u32 v11, 262144, v11
    global_load_dwordx4 v[56:59], v11, s[16:17]
    v_add_u32 v11, 2097152, v15
    v_and_b32 v11, 0x3fffff, v11
    v_add_u32 v11, v11, v3
    v_add_u32 v11, 393216, v11
    global_load_dwordx4 v[60:63], v11, s[16:17]
    s_barrier
    ds_read_b64_tr_b16 v[248:249], v6 offset:16384
    ds_read_b64_tr_b16 v[250:251], v6 offset:17408
    ds_read_b64_tr_b16 v[252:253], v6 offset:24576
    ds_read_b64_tr_b16 v[254:255], v6 offset:25600
    ds_read_b64_tr_b16 a[48:49], v7 offset:16384
    ds_read_b64_tr_b16 a[50:51], v7 offset:17408
    ds_read_b64_tr_b16 a[52:53], v7 offset:24576
    ds_read_b64_tr_b16 a[54:55], v7 offset:25600
    s_waitcnt lgkmcnt(0)
    s_waitcnt vmcnt(16)
    ds_write_b128 v5, v[64:67] offset:0
    ds_write_b128 v5, v[68:71] offset:4096
    ds_write_b128 v5, v[72:75] offset:8192
    ds_write_b128 v5, v[76:79] offset:12288
    s_waitcnt lgkmcnt(0)
    v_add_u32 v11, 2621440, v15
    v_and_b32 v11, 0x3fffff, v11
    v_add_u32 v11, v11, v3
    global_load_dwordx4 v[64:67], v11, s[16:17]
    v_add_u32 v11, 2621440, v15
    v_and_b32 v11, 0x3fffff, v11
    v_add_u32 v11, v11, v3
    v_add_u32 v11, 131072, v11
    global_load_dwordx4 v[68:71], v11, s[16:17]
    v_add_u32 v11, 2621440, v15
    v_and_b32 v11, 0x3fffff, v11
    v_add_u32 v11, v11, v3
    v_add_u32 v11, 262144, v11
    global_load_dwordx4 v[72:75], v11, s[16:17]
    v_add_u32 v11, 2621440, v15
    v_and_b32 v11, 0x3fffff, v11
    v_add_u32 v11, v11, v3
    v_add_u32 v11, 393216, v11
    global_load_dwordx4 v[76:79], v11, s[16:17]
    s_barrier
    ds_read_b64_tr_b16 a[56:57], v6 offset:0
    ds_read_b64_tr_b16 a[58:59], v6 offset:1024
    ds_read_b64_tr_b16 a[60:61], v6 offset:8192
    ds_read_b64_tr_b16 a[62:63], v6 offset:9216
    ds_read_b64_tr_b16 a[120:121], v7 offset:0
    ds_read_b64_tr_b16 a[122:123], v7 offset:1024
    ds_read_b64_tr_b16 a[124:125], v7 offset:8192
    ds_read_b64_tr_b16 a[126:127], v7 offset:9216
    s_waitcnt lgkmcnt(0)
    s_waitcnt vmcnt(16)
    ds_write_b128 v5, v[80:83] offset:16384
    ds_write_b128 v5, v[84:87] offset:20480
    ds_write_b128 v5, v[88:91] offset:24576
    ds_write_b128 v5, v[92:95] offset:28672
    s_waitcnt lgkmcnt(0)
    v_add_u32 v11, 3145728, v15
    v_and_b32 v11, 0x3fffff, v11
    v_add_u32 v11, v11, v3
    global_load_dwordx4 v[80:83], v11, s[16:17]
    v_add_u32 v11, 3145728, v15
    v_and_b32 v11, 0x3fffff, v11
    v_add_u32 v11, v11, v3
    v_add_u32 v11, 131072, v11
    global_load_dwordx4 v[84:87], v11, s[16:17]
    v_add_u32 v11, 3145728, v15
    v_and_b32 v11, 0x3fffff, v11
    v_add_u32 v11, v11, v3
    v_add_u32 v11, 262144, v11
    global_load_dwordx4 v[88:91], v11, s[16:17]
    v_add_u32 v11, 3145728, v15
    v_and_b32 v11, 0x3fffff, v11
    v_add_u32 v11, v11, v3
    v_add_u32 v11, 393216, v11
    global_load_dwordx4 v[92:95], v11, s[16:17]
    s_barrier
    ds_read_b64_tr_b16 a[64:65], v6 offset:16384
    ds_read_b64_tr_b16 a[66:67], v6 offset:17408
    ds_read_b64_tr_b16 a[68:69], v6 offset:24576
    ds_read_b64_tr_b16 a[70:71], v6 offset:25600
    ds_read_b64_tr_b16 a[128:129], v7 offset:16384
    ds_read_b64_tr_b16 a[130:131], v7 offset:17408
    ds_read_b64_tr_b16 a[132:133], v7 offset:24576
    ds_read_b64_tr_b16 a[134:135], v7 offset:25600
    s_waitcnt lgkmcnt(0)
    s_waitcnt vmcnt(16)
    ds_write_b128 v5, v[16:19] offset:0
    ds_write_b128 v5, v[20:23] offset:4096
    ds_write_b128 v5, v[24:27] offset:8192
    ds_write_b128 v5, v[28:31] offset:12288
    s_waitcnt lgkmcnt(0)
    v_add_u32 v11, 3670016, v15
    v_and_b32 v11, 0x3fffff, v11
    v_add_u32 v11, v11, v3
    global_load_dwordx4 v[16:19], v11, s[16:17]
    v_add_u32 v11, 3670016, v15
    v_and_b32 v11, 0x3fffff, v11
    v_add_u32 v11, v11, v3
    v_add_u32 v11, 131072, v11
    global_load_dwordx4 v[20:23], v11, s[16:17]
    v_add_u32 v11, 3670016, v15
    v_and_b32 v11, 0x3fffff, v11
    v_add_u32 v11, v11, v3
    v_add_u32 v11, 262144, v11
    global_load_dwordx4 v[24:27], v11, s[16:17]
    v_add_u32 v11, 3670016, v15
    v_and_b32 v11, 0x3fffff, v11
    v_add_u32 v11, v11, v3
    v_add_u32 v11, 393216, v11
    global_load_dwordx4 v[28:31], v11, s[16:17]
    s_barrier
    ds_read_b64_tr_b16 a[72:73], v6 offset:0
    ds_read_b64_tr_b16 a[74:75], v6 offset:1024
    ds_read_b64_tr_b16 a[76:77], v6 offset:8192
    ds_read_b64_tr_b16 a[78:79], v6 offset:9216
    ds_read_b64_tr_b16 a[136:137], v7 offset:0
    ds_read_b64_tr_b16 a[138:139], v7 offset:1024
    ds_read_b64_tr_b16 a[140:141], v7 offset:8192
    ds_read_b64_tr_b16 a[142:143], v7 offset:9216
    s_waitcnt lgkmcnt(0)
    s_waitcnt vmcnt(16)
    ds_write_b128 v5, v[32:35] offset:16384
    ds_write_b128 v5, v[36:39] offset:20480
    ds_write_b128 v5, v[40:43] offset:24576
    ds_write_b128 v5, v[44:47] offset:28672
    s_waitcnt lgkmcnt(0)
    v_add_u32 v11, 0, v15
    v_and_b32 v11, 0x3fffff, v11
    v_add_u32 v11, v11, v3
    global_load_dwordx4 v[32:35], v11, s[12:13]
    v_add_u32 v11, 0, v15
    v_and_b32 v11, 0x3fffff, v11
    v_add_u32 v11, v11, v3
    v_add_u32 v11, 131072, v11
    global_load_dwordx4 v[36:39], v11, s[12:13]
    v_add_u32 v11, 0, v15
    v_and_b32 v11, 0x3fffff, v11
    v_add_u32 v11, v11, v3
    v_add_u32 v11, 262144, v11
    global_load_dwordx4 v[40:43], v11, s[12:13]
    v_add_u32 v11, 0, v15
    v_and_b32 v11, 0x3fffff, v11
    v_add_u32 v11, v11, v3
    v_add_u32 v11, 393216, v11
    global_load_dwordx4 v[44:47], v11, s[12:13]
    s_barrier
    ds_read_b64_tr_b16 a[80:81], v6 offset:16384
    ds_read_b64_tr_b16 a[82:83], v6 offset:17408
    ds_read_b64_tr_b16 a[84:85], v6 offset:24576
    ds_read_b64_tr_b16 a[86:87], v6 offset:25600
    ds_read_b64_tr_b16 a[144:145], v7 offset:16384
    ds_read_b64_tr_b16 a[146:147], v7 offset:17408
    ds_read_b64_tr_b16 a[148:149], v7 offset:24576
    ds_read_b64_tr_b16 a[150:151], v7 offset:25600
    s_waitcnt lgkmcnt(0)
    s_waitcnt vmcnt(16)
    ds_write_b128 v5, v[48:51] offset:0
    ds_write_b128 v5, v[52:55] offset:4096
    ds_write_b128 v5, v[56:59] offset:8192
    ds_write_b128 v5, v[60:63] offset:12288
    s_waitcnt lgkmcnt(0)
    v_add_u32 v11, 524288, v15
    v_and_b32 v11, 0x3fffff, v11
    v_add_u32 v11, v11, v3
    global_load_dwordx4 v[48:51], v11, s[12:13]
    v_add_u32 v11, 524288, v15
    v_and_b32 v11, 0x3fffff, v11
    v_add_u32 v11, v11, v3
    v_add_u32 v11, 131072, v11
    global_load_dwordx4 v[52:55], v11, s[12:13]
    v_add_u32 v11, 524288, v15
    v_and_b32 v11, 0x3fffff, v11
    v_add_u32 v11, v11, v3
    v_add_u32 v11, 262144, v11
    global_load_dwordx4 v[56:59], v11, s[12:13]
    v_add_u32 v11, 524288, v15
    v_and_b32 v11, 0x3fffff, v11
    v_add_u32 v11, v11, v3
    v_add_u32 v11, 393216, v11
    global_load_dwordx4 v[60:63], v11, s[12:13]
    s_barrier
    ds_read_b64_tr_b16 a[88:89], v6 offset:0
    ds_read_b64_tr_b16 a[90:91], v6 offset:1024
    ds_read_b64_tr_b16 a[92:93], v6 offset:8192
    ds_read_b64_tr_b16 a[94:95], v6 offset:9216
    ds_read_b64_tr_b16 a[152:153], v7 offset:0
    ds_read_b64_tr_b16 a[154:155], v7 offset:1024
    ds_read_b64_tr_b16 a[156:157], v7 offset:8192
    ds_read_b64_tr_b16 a[158:159], v7 offset:9216
    s_waitcnt lgkmcnt(0)
    s_cmp_lg_u32 s9, 0
    s_cbranch_scc1 L_rd_108
    v_lshlrev_b32 v1, 2, v0
    v_mov_b32 v2, 0
    global_atomic_add v104, v1, v2, s[10:11] sc0 sc1
    s_nop 0
L_rd_108:
    s_waitcnt vmcnt(16)
    ds_write_b128 v5, v[64:67] offset:16384
    ds_write_b128 v5, v[68:71] offset:20480
    ds_write_b128 v5, v[72:75] offset:24576
    ds_write_b128 v5, v[76:79] offset:28672
    s_waitcnt lgkmcnt(0)
    v_add_u32 v11, 1048576, v15
    v_and_b32 v11, 0x3fffff, v11
    v_add_u32 v11, v11, v3
    global_load_dwordx4 v[64:67], v11, s[12:13]
    v_add_u32 v11, 1048576, v15
    v_and_b32 v11, 0x3fffff, v11
    v_add_u32 v11, v11, v3
    v_add_u32 v11, 131072, v11
    global_load_dwordx4 v[68:71], v11, s[12:13]
    v_add_u32 v11, 1048576, v15
    v_and_b32 v11, 0x3fffff, v11
    v_add_u32 v11, v11, v3
    v_add_u32 v11, 262144, v11
    global_load_dwordx4 v[72:75], v11, s[12:13]
    v_add_u32 v11, 1048576, v15
    v_and_b32 v11, 0x3fffff, v11
    v_add_u32 v11, v11, v3
    v_add_u32 v11, 393216, v11
    global_load_dwordx4 v[76:79], v11, s[12:13]
    s_barrier
    ds_read_b64_tr_b16 a[96:97], v6 offset:16384
    ds_read_b64_tr_b16 a[98:99], v6 offset:17408
    ds_read_b64_tr_b16 a[100:101], v6 offset:24576
    ds_read_b64_tr_b16 a[102:103], v6 offset:25600
    ds_read_b64_tr_b16 a[160:161], v7 offset:16384
    ds_read_b64_tr_b16 a[162:163], v7 offset:17408
    ds_read_b64_tr_b16 a[164:165], v7 offset:24576
    ds_read_b64_tr_b16 a[166:167], v7 offset:25600
    s_waitcnt lgkmcnt(0)
    s_waitcnt vmcnt(16)
    ds_write_b128 v5, v[80:83] offset:0
    ds_write_b128 v5, v[84:87] offset:4096
    ds_write_b128 v5, v[88:91] offset:8192
    ds_write_b128 v5, v[92:95] offset:12288
    s_waitcnt lgkmcnt(0)
    v_add_u32 v11, 1572864, v15
    v_and_b32 v11, 0x3fffff, v11
    v_add_u32 v11, v11, v3
    global_load_dwordx4 v[80:83], v11, s[12:13]
    v_add_u32 v11, 1572864, v15
    v_and_b32 v11, 0x3fffff, v11
    v_add_u32 v11, v11, v3
    v_add_u32 v11, 131072, v11
    global_load_dwordx4 v[84:87], v11, s[12:13]
    v_add_u32 v11, 1572864, v15
    v_and_b32 v11, 0x3fffff, v11
    v_add_u32 v11, v11, v3
    v_add_u32 v11, 262144, v11
    global_load_dwordx4 v[88:91], v11, s[12:13]
    v_add_u32 v11, 1572864, v15
    v_and_b32 v11, 0x3fffff, v11
    v_add_u32 v11, v11, v3
    v_add_u32 v11, 393216, v11
    global_load_dwordx4 v[92:95], v11, s[12:13]
    s_barrier
    ds_read_b64_tr_b16 a[104:105], v6 offset:0
    ds_read_b64_tr_b16 a[106:107], v6 offset:1024
    ds_read_b64_tr_b16 a[108:109], v6 offset:8192
    ds_read_b64_tr_b16 a[110:111], v6 offset:9216
    ds_read_b64_tr_b16 a[168:169], v7 offset:0
    ds_read_b64_tr_b16 a[170:171], v7 offset:1024
    ds_read_b64_tr_b16 a[172:173], v7 offset:8192
    ds_read_b64_tr_b16 a[174:175], v7 offset:9216
    s_waitcnt lgkmcnt(0)
    s_waitcnt vmcnt(16)
    ds_write_b128 v5, v[16:19] offset:16384
    ds_write_b128 v5, v[20:23] offset:20480
    ds_write_b128 v5, v[24:27] offset:24576
    ds_write_b128 v5, v[28:31] offset:28672
    s_waitcnt lgkmcnt(0)
    v_add_u32 v11, 2097152, v15
    v_and_b32 v11, 0x3fffff, v11
    v_add_u32 v11, v11, v3
    global_load_dwordx4 v[16:19], v11, s[12:13]
    v_add_u32 v11, 2097152, v15
    v_and_b32 v11, 0x3fffff, v11
    v_add_u32 v11, v11, v3
    v_add_u32 v11, 131072, v11
    global_load_dwordx4 v[20:23], v11, s[12:13]
    v_add_u32 v11, 2097152, v15
    v_and_b32 v11, 0x3fffff, v11
    v_add_u32 v11, v11, v3
    v_add_u32 v11, 262144, v11
    global_load_dwordx4 v[24:27], v11, s[12:13]
    v_add_u32 v11, 2097152, v15
    v_and_b32 v11, 0x3fffff, v11
    v_add_u32 v11, v11, v3
    v_add_u32 v11, 393216, v11
    global_load_dwordx4 v[28:31], v11, s[12:13]
    s_barrier
    ds_read_b64_tr_b16 a[112:113], v6 offset:16384
    ds_read_b64_tr_b16 a[114:115], v6 offset:17408
    ds_read_b64_tr_b16 a[116:117], v6 offset:24576
    ds_read_b64_tr_b16 a[118:119], v6 offset:25600
    ds_read_b64_tr_b16 a[176:177], v7 offset:16384
    ds_read_b64_tr_b16 a[178:179], v7 offset:17408
    ds_read_b64_tr_b16 a[180:181], v7 offset:24576
    ds_read_b64_tr_b16 a[182:183], v7 offset:25600
    s_waitcnt lgkmcnt(0)
    s_waitcnt vmcnt(16)
    ds_write_b128 v5, v[32:35] offset:0
    ds_write_b128 v5, v[36:39] offset:4096
    ds_write_b128 v5, v[40:43] offset:8192
    ds_write_b128 v5, v[44:47] offset:12288
    s_waitcnt lgkmcnt(0)
    v_add_u32 v11, 2621440, v15
    v_and_b32 v11, 0x3fffff, v11
    v_add_u32 v11, v11, v3
    global_load_dwordx4 v[32:35], v11, s[12:13]
    v_add_u32 v11, 2621440, v15
    v_and_b32 v11, 0x3fffff, v11
    v_add_u32 v11, v11, v3
    v_add_u32 v11, 131072, v11
    global_load_dwordx4 v[36:39], v11, s[12:13]
    v_add_u32 v11, 2621440, v15
    v_and_b32 v11, 0x3fffff, v11
    v_add_u32 v11, v11, v3
    v_add_u32 v11, 262144, v11
    global_load_dwordx4 v[40:43], v11, s[12:13]
    v_add_u32 v11, 2621440, v15
    v_and_b32 v11, 0x3fffff, v11
    v_add_u32 v11, v11, v3
    v_add_u32 v11, 393216, v11
    global_load_dwordx4 v[44:47], v11, s[12:13]
    s_barrier
    ds_read_b64_tr_b16 v[96:97], v6 offset:0
    ds_read_b64_tr_b16 v[98:99], v6 offset:1024
    ds_read_b64_tr_b16 v[100:101], v6 offset:8192
    ds_read_b64_tr_b16 v[102:103], v6 offset:9216
    s_waitcnt lgkmcnt(0)
    ds_write_b128 v8, v[96:99] offset:0
    ds_write_b128 v8, v[100:103] offset:1024
    ds_read_b64_tr_b16 v[96:97], v7 offset:0
    ds_read_b64_tr_b16 v[98:99], v7 offset:1024
    ds_read_b64_tr_b16 v[100:101], v7 offset:8192
    ds_read_b64_tr_b16 v[102:103], v7 offset:9216
    s_waitcnt lgkmcnt(0)
    ds_write_b128 v8, v[96:99] offset:2048
    ds_write_b128 v8, v[100:103] offset:3072
    s_waitcnt lgkmcnt(0)
    s_waitcnt vmcnt(16)
    ds_write_b128 v5, v[48:51] offset:16384
    ds_write_b128 v5, v[52:55] offset:20480
    ds_write_b128 v5, v[56:59] offset:24576
    ds_write_b128 v5, v[60:63] offset:28672
    s_waitcnt lgkmcnt(0)
    v_add_u32 v11, 3145728, v15
    v_and_b32 v11, 0x3fffff, v11
    v_add_u32 v11, v11, v3
    global_load_dwordx4 v[48:51], v11, s[12:13]
    v_add_u32 v11, 3145728, v15
    v_and_b32 v11, 0x3fffff, v11
    v_add_u32 v11, v11, v3
    v_add_u32 v11, 131072, v11
    global_load_dwordx4 v[52:55], v11, s[12:13]
    v_add_u32 v11, 3145728, v15
    v_and_b32 v11, 0x3fffff, v11
    v_add_u32 v11, v11, v3
    v_add_u32 v11, 262144, v11
    global_load_dwordx4 v[56:59], v11, s[12:13]
    v_add_u32 v11, 3145728, v15
    v_and_b32 v11, 0x3fffff, v11
    v_add_u32 v11, v11, v3
    v_add_u32 v11, 393216, v11
    global_load_dwordx4 v[60:63], v11, s[12:13]
    s_barrier
    ds_read_b64_tr_b16 v[96:97], v6 offset:16384
    ds_read_b64_tr_b16 v[98:99], v6 offset:17408
    ds_read_b64_tr_b16 v[100:101], v6 offset:24576
    ds_read_b64_tr_b16 v[102:103], v6 offset:25600
    s_waitcnt lgkmcnt(0)
    ds_write_b128 v8, v[96:99] offset:8192
    ds_write_b128 v8, v[100:103] offset:9216
    ds_read_b64_tr_b16 v[96:97], v7 offset:16384
    ds_read_b64_tr_b16 v[98:99], v7 offset:17408
    ds_read_b64_tr_b16 v[100:101], v7 offset:24576
    ds_read_b64_tr_b16 v[102:103], v7 offset:25600
    s_waitcnt lgkmcnt(0)
    ds_write_b128 v8, v[96:99] offset:10240
    ds_write_b128 v8, v[100:103] offset:11264
    s_waitcnt lgkmcnt(0)
    s_waitcnt vmcnt(16)
    ds_write_b128 v5, v[64:67] offset:0
    ds_write_b128 v5, v[68:71] offset:4096
    ds_write_b128 v5, v[72:75] offset:8192
    ds_write_b128 v5, v[76:79] offset:12288
    s_waitcnt lgkmcnt(0)
    v_add_u32 v11, 3670016, v15
    v_and_b32 v11, 0x3fffff, v11
    v_add_u32 v11, v11, v3
    global_load_dwordx4 v[64:67], v11, s[12:13]
    v_add_u32 v11, 3670016, v15
    v_and_b32 v11, 0x3fffff, v11
    v_add_u32 v11, v11, v3
    v_add_u32 v11, 131072, v11
    global_load_dwordx4 v[68:71], v11, s[12:13]
    v_add_u32 v11, 3670016, v15
    v_and_b32 v11, 0x3fffff, v11
    v_add_u32 v11, v11, v3
    v_add_u32 v11, 262144, v11
    global_load_dwordx4 v[72:75], v11, s[12:13]
    v_add_u32 v11, 3670016, v15
    v_and_b32 v11, 0x3fffff, v11
    v_add_u32 v11, v11, v3
    v_add_u32 v11, 393216, v11
    global_load_dwordx4 v[76:79], v11, s[12:13]
    s_barrier
    ds_read_b64_tr_b16 v[112:113], v6 offset:0
    ds_read_b64_tr_b16 v[114:115], v6 offset:1024
    ds_read_b64_tr_b16 v[116:117], v6 offset:8192
    ds_read_b64_tr_b16 v[118:119], v6 offset:9216
    ds_read_b64_tr_b16 v[160:161], v7 offset:0
    ds_read_b64_tr_b16 v[162:163], v7 offset:1024
    ds_read_b64_tr_b16 v[164:165], v7 offset:8192
    ds_read_b64_tr_b16 v[166:167], v7 offset:9216
    s_waitcnt lgkmcnt(0)
    s_waitcnt vmcnt(16)
    ds_write_b128 v5, v[80:83] offset:16384
    ds_write_b128 v5, v[84:87] offset:20480
    ds_write_b128 v5, v[88:91] offset:24576
    ds_write_b128 v5, v[92:95] offset:28672
    s_waitcnt lgkmcnt(0)
    v_mov_b32 v11, v4
    global_load_dwordx4 v[80:83], v11, s[18:19]
    v_add_u32 v11, 16384, v4
    global_load_dwordx4 v[84:87], v11, s[18:19]
    v_add_u32 v11, 32768, v4
    global_load_dwordx4 v[88:91], v11, s[18:19]
    v_add_u32 v11, 49152, v4
    global_load_dwordx4 v[92:95], v11, s[18:19]
    s_barrier
    ds_read_b64_tr_b16 v[120:121], v6 offset:16384
    ds_read_b64_tr_b16 v[122:123], v6 offset:17408
    ds_read_b64_tr_b16 v[124:125], v6 offset:24576
    ds_read_b64_tr_b16 v[126:127], v6 offset:25600
    ds_read_b64_tr_b16 v[168:169], v7 offset:16384
    ds_read_b64_tr_b16 v[170:171], v7 offset:17408
    ds_read_b64_tr_b16 v[172:173], v7 offset:24576
    ds_read_b64_tr_b16 v[174:175], v7 offset:25600
    s_waitcnt lgkmcnt(0)
    s_waitcnt vmcnt(16)
    ds_write_b128 v5, v[16:19] offset:0
    ds_write_b128 v5, v[20:23] offset:4096
    ds_write_b128 v5, v[24:27] offset:8192
    ds_write_b128 v5, v[28:31] offset:12288
    s_waitcnt lgkmcnt(0)
    v_add_u32 v11, 64, v4
    global_load_dwordx4 v[16:19], v11, s[18:19]
    v_add_u32 v11, 16448, v4
    global_load_dwordx4 v[20:23], v11, s[18:19]
    v_add_u32 v11, 32832, v4
    global_load_dwordx4 v[24:27], v11, s[18:19]
    v_add_u32 v11, 49216, v4
    global_load_dwordx4 v[28:31], v11, s[18:19]
    s_barrier
    ds_read_b64_tr_b16 v[128:129], v6 offset:0
    ds_read_b64_tr_b16 v[130:131], v6 offset:1024
    ds_read_b64_tr_b16 v[132:133], v6 offset:8192
    ds_read_b64_tr_b16 v[134:135], v6 offset:9216
    ds_read_b64_tr_b16 v[176:177], v7 offset:0
    ds_read_b64_tr_b16 v[178:179], v7 offset:1024
    ds_read_b64_tr_b16 v[180:181], v7 offset:8192
    ds_read_b64_tr_b16 v[182:183], v7 offset:9216
    s_waitcnt lgkmcnt(0)
    s_waitcnt vmcnt(16)
    ds_write_b128 v5, v[32:35] offset:16384
    ds_write_b128 v5, v[36:39] offset:20480
    ds_write_b128 v5, v[40:43] offset:24576
    ds_write_b128 v5, v[44:47] offset:28672
    s_waitcnt lgkmcnt(0)
    v_add_u32 v11, 128, v4
    global_load_dwordx4 v[32:35], v11, s[18:19]
    v_add_u32 v11, 16512, v4
    global_load_dwordx4 v[36:39], v11, s[18:19]
    v_add_u32 v11, 32896, v4
    global_load_dwordx4 v[40:43], v11, s[18:19]
    v_add_u32 v11, 49280, v4
    global_load_dwordx4 v[44:47], v11, s[18:19]
    s_barrier
    ds_read_b64_tr_b16 v[136:137], v6 offset:16384
    ds_read_b64_tr_b16 v[138:139], v6 offset:17408
    ds_read_b64_tr_b16 v[140:141], v6 offset:24576
    ds_read_b64_tr_b16 v[142:143], v6 offset:25600
    ds_read_b64_tr_b16 v[184:185], v7 offset:16384
    ds_read_b64_tr_b16 v[186:187], v7 offset:17408
    ds_read_b64_tr_b16 v[188:189], v7 offset:24576
    ds_read_b64_tr_b16 v[190:191], v7 offset:25600
    s_waitcnt lgkmcnt(0)
    s_waitcnt vmcnt(16)
    ds_write_b128 v5, v[48:51] offset:0
    ds_write_b128 v5, v[52:55] offset:4096
    ds_write_b128 v5, v[56:59] offset:8192
    ds_write_b128 v5, v[60:63] offset:12288
    s_waitcnt lgkmcnt(0)
    v_add_u32 v11, 192, v4
    global_load_dwordx4 v[48:51], v11, s[18:19]
    v_add_u32 v11, 16576, v4
    global_load_dwordx4 v[52:55], v11, s[18:19]
    v_add_u32 v11, 32960, v4
    global_load_dwordx4 v[56:59], v11, s[18:19]
    v_add_u32 v11, 49344, v4
    global_load_dwordx4 v[60:63], v11, s[18:19]
    s_barrier
    ds_read_b64_tr_b16 v[144:145], v6 offset:0
    ds_read_b64_tr_b16 v[146:147], v6 offset:1024
    ds_read_b64_tr_b16 v[148:149], v6 offset:8192
    ds_read_b64_tr_b16 v[150:151], v6 offset:9216
    ds_read_b64_tr_b16 v[192:193], v7 offset:0
    ds_read_b64_tr_b16 v[194:195], v7 offset:1024
    ds_read_b64_tr_b16 v[196:197], v7 offset:8192
    ds_read_b64_tr_b16 v[198:199], v7 offset:9216
    s_waitcnt lgkmcnt(0)
    s_waitcnt vmcnt(16)
    ds_write_b128 v5, v[64:67] offset:16384
    ds_write_b128 v5, v[68:71] offset:20480
    ds_write_b128 v5, v[72:75] offset:24576
    ds_write_b128 v5, v[76:79] offset:28672
    s_waitcnt lgkmcnt(0)
    v_add_u32 v11, 65536, v4
    global_load_dwordx4 v[64:67], v11, s[18:19]
    v_add_u32 v11, 81920, v4
    global_load_dwordx4 v[68:71], v11, s[18:19]
    v_add_u32 v11, 98304, v4
    global_load_dwordx4 v[72:75], v11, s[18:19]
    v_add_u32 v11, 114688, v4
    global_load_dwordx4 v[76:79], v11, s[18:19]
    s_barrier
    ds_read_b64_tr_b16 v[152:153], v6 offset:16384
    ds_read_b64_tr_b16 v[154:155], v6 offset:17408
    ds_read_b64_tr_b16 v[156:157], v6 offset:24576
    ds_read_b64_tr_b16 v[158:159], v6 offset:25600
    ds_read_b64_tr_b16 v[200:201], v7 offset:16384
    ds_read_b64_tr_b16 v[202:203], v7 offset:17408
    ds_read_b64_tr_b16 v[204:205], v7 offset:24576
    ds_read_b64_tr_b16 v[206:207], v7 offset:25600
    s_waitcnt lgkmcnt(0)
    s_waitcnt vmcnt(16)
    ds_write_b128 v5, v[80:83] offset:0
    ds_write_b128 v5, v[84:87] offset:4096
    ds_write_b128 v5, v[88:91] offset:8192
    ds_write_b128 v5, v[92:95] offset:12288
    s_waitcnt lgkmcnt(0)
    v_add_u32 v11, 65600, v4
    global_load_dwordx4 v[80:83], v11, s[18:19]
    v_add_u32 v11, 81984, v4
    global_load_dwordx4 v[84:87], v11, s[18:19]
    v_add_u32 v11, 98368, v4
    global_load_dwordx4 v[88:91], v11, s[18:19]
    v_add_u32 v11, 114752, v4
    global_load_dwordx4 v[92:95], v11, s[18:19]
    s_barrier
    ds_read_b64_tr_b16 a[184:185], v6 offset:0
    ds_read_b64_tr_b16 a[186:187], v6 offset:1024
    ds_read_b64_tr_b16 a[188:189], v6 offset:8192
    ds_read_b64_tr_b16 a[190:191], v6 offset:9216
    ds_read_b64_tr_b16 a[192:193], v7 offset:0
    ds_read_b64_tr_b16 a[194:195], v7 offset:1024
    ds_read_b64_tr_b16 a[196:197], v7 offset:8192
    ds_read_b64_tr_b16 a[198:199], v7 offset:9216
    s_waitcnt lgkmcnt(0)
    s_cmp_lg_u32 s9, 0
    s_cbranch_scc1 L_rd_109
    v_lshlrev_b32 v1, 2, v0
    v_mov_b32 v2, 0
    global_atomic_add v105, v1, v2, s[10:11] sc0 sc1
    s_nop 0
L_rd_109:
    s_waitcnt vmcnt(16)
    ds_write_b128 v5, v[16:19] offset:16384
    ds_write_b128 v5, v[20:23] offset:20480
    ds_write_b128 v5, v[24:27] offset:24576
    ds_write_b128 v5, v[28:31] offset:28672
    s_waitcnt lgkmcnt(0)
    v_add_u32 v11, 65664, v4
    global_load_dwordx4 v[16:19], v11, s[18:19]
    v_add_u32 v11, 82048, v4
    global_load_dwordx4 v[20:23], v11, s[18:19]
    v_add_u32 v11, 98432, v4
    global_load_dwordx4 v[24:27], v11, s[18:19]
    v_add_u32 v11, 114816, v4
    global_load_dwordx4 v[28:31], v11, s[18:19]
    s_barrier
    ds_read_b64_tr_b16 a[200:201], v6 offset:16384
    ds_read_b64_tr_b16 a[202:203], v6 offset:17408
    ds_read_b64_tr_b16 a[204:205], v6 offset:24576
    ds_read_b64_tr_b16 a[206:207], v6 offset:25600
    ds_read_b64_tr_b16 a[208:209], v7 offset:16384
    ds_read_b64_tr_b16 a[210:211], v7 offset:17408
    ds_read_b64_tr_b16 a[212:213], v7 offset:24576
    ds_read_b64_tr_b16 a[214:215], v7 offset:25600
    s_waitcnt lgkmcnt(0)
    s_waitcnt vmcnt(16)
    ds_write_b128 v5, v[32:35] offset:0
    ds_write_b128 v5, v[36:39] offset:4096
    ds_write_b128 v5, v[40:43] offset:8192
    ds_write_b128 v5, v[44:47] offset:12288
    s_waitcnt lgkmcnt(0)
    v_add_u32 v11, 65728, v4
    global_load_dwordx4 v[32:35], v11, s[18:19]
    v_add_u32 v11, 82112, v4
    global_load_dwordx4 v[36:39], v11, s[18:19]
    v_add_u32 v11, 98496, v4
    global_load_dwordx4 v[40:43], v11, s[18:19]
    v_add_u32 v11, 114880, v4
    global_load_dwordx4 v[44:47], v11, s[18:19]
    s_barrier
    ds_read_b64_tr_b16 a[216:217], v6 offset:0
    ds_read_b64_tr_b16 a[218:219], v6 offset:1024
    ds_read_b64_tr_b16 a[220:221], v6 offset:8192
    ds_read_b64_tr_b16 a[222:223], v6 offset:9216
    ds_read_b64_tr_b16 a[224:225], v7 offset:0
    ds_read_b64_tr_b16 a[226:227], v7 offset:1024
    ds_read_b64_tr_b16 a[228:229], v7 offset:8192
    ds_read_b64_tr_b16 a[230:231], v7 offset:9216
    s_waitcnt lgkmcnt(0)
    s_waitcnt vmcnt(16)
    ds_write_b128 v5, v[48:51] offset:16384
    ds_write_b128 v5, v[52:55] offset:20480
    ds_write_b128 v5, v[56:59] offset:24576
    ds_write_b128 v5, v[60:63] offset:28672
    s_waitcnt lgkmcnt(0)
    s_barrier
    ds_read_b64_tr_b16 a[232:233], v6 offset:16384
    ds_read_b64_tr_b16 a[234:235], v6 offset:17408
    ds_read_b64_tr_b16 a[236:237], v6 offset:24576
    ds_read_b64_tr_b16 a[238:239], v6 offset:25600
    ds_read_b64_tr_b16 a[240:241], v7 offset:16384
    ds_read_b64_tr_b16 a[242:243], v7 offset:17408
    ds_read_b64_tr_b16 a[244:245], v7 offset:24576
    ds_read_b64_tr_b16 a[246:247], v7 offset:25600
    s_waitcnt lgkmcnt(0)
    s_waitcnt vmcnt(12)
    ds_write_b128 v5, v[64:67] offset:0
    ds_write_b128 v5, v[68:71] offset:4096
    ds_write_b128 v5, v[72:75] offset:8192
    ds_write_b128 v5, v[76:79] offset:12288
    s_waitcnt lgkmcnt(0)
    s_barrier
    ds_read_b64_tr_b16 v[96:97], v6 offset:0
    ds_read_b64_tr_b16 v[98:99], v6 offset:1024
    ds_read_b64_tr_b16 v[100:101], v6 offset:8192
    ds_read_b64_tr_b16 v[102:103], v6 offset:9216
    s_waitcnt lgkmcnt(0)
    ds_write_b128 v8, v[96:99] offset:14336
    ds_write_b128 v8, v[100:103] offset:15360
    ds_read_b64_tr_b16 v[96:97], v7 offset:0
    ds_read_b64_tr_b16 v[98:99], v7 offset:1024
    ds_read_b64_tr_b16 v[100:101], v7 offset:8192
    ds_read_b64_tr_b16 v[102:103], v7 offset:9216
    s_waitcnt lgkmcnt(0)
    ds_write_b128 v8, v[96:99] offset:16384
    ds_write_b128 v8, v[100:103] offset:17408
    s_waitcnt lgkmcnt(0)
    s_waitcnt vmcnt(8)
    ds_write_b128 v5, v[80:83] offset:16384
    ds_write_b128 v5, v[84:87] offset:20480
    ds_write_b128 v5, v[88:91] offset:24576
    ds_write_b128 v5, v[92:95] offset:28672
    s_waitcnt lgkmcnt(0)
    s_barrier
    ds_read_b64_tr_b16 v[96:97], v6 offset:16384
    ds_read_b64_tr_b16 v[98:99], v6 offset:17408
    ds_read_b64_tr_b16 v[100:101], v6 offset:24576
    ds_read_b64_tr_b16 v[102:103], v6 offset:25600
    s_waitcnt lgkmcnt(0)
    ds_write_b128 v8, v[96:99] offset:18432
    ds_write_b128 v8, v[100:103] offset:19456
    ds_read_b64_tr_b16 v[96:97], v7 offset:16384
    ds_read_b64_tr_b16 v[98:99], v7 offset:17408
    ds_read_b64_tr_b16 v[100:101], v7 offset:24576
    ds_read_b64_tr_b16 v[102:103], v7 offset:25600
    s_waitcnt lgkmcnt(0)
    ds_write_b128 v8, v[96:99] offset:20480
    ds_write_b128 v8, v[100:103] offset:21504
    s_waitcnt lgkmcnt(0)
    s_waitcnt vmcnt(4)
    ds_write_b128 v5, v[16:19] offset:0
    ds_write_b128 v5, v[20:23] offset:4096
    ds_write_b128 v5, v[24:27] offset:8192
    ds_write_b128 v5, v[28:31] offset:12288
    s_waitcnt lgkmcnt(0)
    s_barrier
    ds_read_b64_tr_b16 v[96:97], v6 offset:0
    ds_read_b64_tr_b16 v[98:99], v6 offset:1024
    ds_read_b64_tr_b16 v[100:101], v6 offset:8192
    ds_read_b64_tr_b16 v[102:103], v6 offset:9216
    s_waitcnt lgkmcnt(0)
    ds_write_b128 v8, v[96:99] offset:22528
    ds_write_b128 v8, v[100:103] offset:23552
    ds_read_b64_tr_b16 v[96:97], v7 offset:0
    ds_read_b64_tr_b16 v[98:99], v7 offset:1024
    ds_read_b64_tr_b16 v[100:101], v7 offset:8192
    ds_read_b64_tr_b16 v[102:103], v7 offset:9216
    s_waitcnt lgkmcnt(0)
    ds_write_b128 v8, v[96:99] offset:24576
    ds_write_b128 v8, v[100:103] offset:25600
    s_waitcnt lgkmcnt(0)
    s_waitcnt vmcnt(0)
    ds_write_b128 v5, v[32:35] offset:16384
    ds_write_b128 v5, v[36:39] offset:20480
    ds_write_b128 v5, v[40:43] offset:24576
    ds_write_b128 v5, v[44:47] offset:28672
    s_waitcnt lgkmcnt(0)
    s_barrier
    ds_read_b64_tr_b16 v[96:97], v6 offset:16384
    ds_read_b64_tr_b16 v[98:99], v6 offset:17408
    ds_read_b64_tr_b16 v[100:101], v6 offset:24576
    ds_read_b64_tr_b16 v[102:103], v6 offset:25600
    s_waitcnt lgkmcnt(0)
    ds_write_b128 v8, v[96:99] offset:26624
    ds_write_b128 v8, v[100:103] offset:27648
    ds_read_b64_tr_b16 a[248:249], v7 offset:16384
    ds_read_b64_tr_b16 a[250:251], v7 offset:17408
    ds_read_b64_tr_b16 a[252:253], v7 offset:24576
    ds_read_b64_tr_b16 a[254:255], v7 offset:25600
    s_waitcnt lgkmcnt(0)
    s_cmp_lg_u32 s9, 0
    s_cbranch_scc1 L_ev_110
    s_waitcnt vmcnt(0)
    v_readlane_b32 s38, v104, 8
    v_cmp_eq_u32 vcc, 32, v105
    s_add_u32 s39, s6, 24
    s_lshl_b64 s[12:13], 1, s39
    s_or_b32 s12, s12, 0
    v_mov_b32 v1, 14336
    s_nop 1
    s_andn2_b64 s[12:13], s[12:13], vcc
    s_cselect_b32 s39, 1, 0
    v_mov_b32 v2, s39
    ds_write_b32 v1, v2
    s_waitcnt lgkmcnt(0)
L_ev_110:
    s_barrier
    v_mov_b32 v16, 14336
    ds_read_b32 v17, v16
    s_waitcnt lgkmcnt(0)
    v_readfirstlane_b32 s38, v17
    s_barrier
    s_cmp_eq_u32 s38, 0
    s_nop 2
    s_cbranch_scc1 L_go_111
    s_lshl_b32 s39, s6, 2
    s_add_u32 s39, s39, 96
    v_mov_b32 v17, s39
    s_mov_b32 s41, 2097152
    s_nop 0
L_dw_112:
    global_load_dword v18, v17, s[10:11] sc1
    s_waitcnt vmcnt(0)
    v_readfirstlane_b32 s38, v18
    s_sub_u32 s41, s41, 1
    s_cmp_eq_u32 s41, 0
    s_nop 2
    s_cbranch_scc1 L_end_101
    s_cmp_lt_u32 s38, 32
    s_cbranch_scc1 L_dw_112
L_go_111:
    v_and_b32 v20, 63, v0
    v_lshlrev_b32 v1, 4, v20
    v_mov_b32 v11, -1
    v_mov_b32 v16, 0
    v_mov_b32 v21, 0xff800000
    v_cmp_le_u32 vcc, 32, v20
    s_nop 1
    v_cndmask_b32 v18, v16, v21, vcc
    v_bfe_u32 v21, v20, 1, 1
    v_lshlrev_b32 v10, 7, v21
    v_bfe_u32 v21, v20, 2, 1
    v_lshl_add_u32 v10, v21, 6, v10
    v_lshrrev_b32 v21, 4, v20
    v_lshl_add_u32 v10, v21, 4, v10
    s_lshl_b32 s38, s7, 8
    s_lshl_b32 s39, s9, 2
    s_add_u32 s38, s38, s39
    v_add_u32 v10, s38, v10
    v_and_b32 v21, 8, v20
    v_cmp_ne_u32 vcc, 0, v21
    v_mov_b32 v21, 0x4444
    v_mov_b32 v22, 0xeeee
    v_cndmask_b32 v2, v21, v22, vcc
    s_lshl_b32 s38, s9, 11
    v_add_u32 v12, s38, v1
    s_add_u32 s38, s9, 1
    s_and_b32 s38, s38, 3
    s_lshl_b32 s38, s38, 11
    v_add_u32 v13, s38, v1
    s_add_u32 s38, s9, 2
    s_and_b32 s38, s38, 3
    s_lshl_b32 s38, s38, 11
    v_add_u32 v14, s38, v1
    s_add_u32 s38, s9, 3
    s_and_b32 s38, s38, 3
    s_lshl_b32 s38, s38, 11
    v_add_u32 v15, s38, v1
    v_lshrrev_b32 v21, 5, v20
    v_lshlrev_b32 v21, 4, v21
    v_and_b32 v22, 15, v20
    v_add_u32 v21, v21, v22
    v_lshlrev_b32 v21, 4, v21
    v_bfe_u32 v22, v20, 4, 1
    v_lshl_add_u32 v21, v22, 3, v21
    s_lshl_b32 s38, s9, 9
    v_add_u32 v21, s38, v21
    v_add_u32 v3, 8192, v21
    v_add_u32 v9, 2048, v21
    v_lshrrev_b32 v21, 4, v20
    v_lshlrev_b32 v21, 2, v21
    v_bfe_u32 v22, v20, 2, 2
    v_add_u32 v21, v21, v22
    v_lshlrev_b32 v21, 4, v21
    v_and_b32 v22, 1, v20
    v_lshl_add_u32 v21, v22, 3, v21
    v_add_u32 v4, 8192, v21
    s_lshl_b32 s38, s9, 9
    v_add_u32 v17, s38, v4
    v_and_b32 v21, 7, v20
    v_lshlrev_b32 v21, 4, v21
    v_lshrrev_b32 v22, 4, v20
    v_lshl_add_u32 v21, v22, 2, v21
    s_lshl_b32 s38, s9, 9
    s_add_u32 s38, s38, 12288
    v_add_u32 v5, s38, v21
    s_mul_i32 s38, s9, 28672
    s_add_u32 s38, s38, 49152
    v_add_u32 v6, s38, v1
    v_lshrrev_b32 v21, 5, v20
    v_lshlrev_b32 v21, 14, v21
    v_bfe_u32 v22, v20, 2, 2
    v_lshl_add_u32 v21, v22, 12, v21
    v_bfe_u32 v22, v20, 4, 1
    v_lshl_add_u32 v21, v22, 5, v21
    v_and_b32 v22, 3, v20
    v_lshl_add_u32 v21, v22, 3, v21
    s_lshl_b32 s38, s9, 17
    s_lshl_b32 s39, s7, 6
    s_add_u32 s38, s38, s39
    v_add_u32 v7, s38, v21
    v_lshrrev_b32 v21, 4, v20
    v_lshlrev_b32 v21, 7, v21
    v_and_b32 v22, 7, v20
    v_lshl_add_u32 v21, v22, 4, v21
    s_lshl_b32 s38, s9, 9
    v_add_u32 v8, s38, v21
    s_mov_b32 s41, 2097152
    s_nop 0
L_fsp_113:
    global_load_dword v0, v16, s[34:35] sc1
    s_sub_u32 s41, s41, 1
    s_cmp_eq_u32 s41, 0
    s_cbranch_scc1 L_end_101
    s_waitcnt vmcnt(0)
    v_cmp_eq_u32 vcc, 0, v0
    s_nop 4
    s_cbranch_vccnz L_fsp_113
    s_add_u32 m0, s46, 16384
    s_nop 0
    global_load_lds_dwordx4 v1, s[30:31] offset:0 sc1
    global_load_lds_dwordx4 v1, s[30:31] offset:1024 sc1
    global_load_lds_dwordx4 v1, s[30:31] offset:2048 sc1
    global_load_lds_dwordx4 v1, s[30:31] offset:3072 sc1
    s_add_u32 s30, s30, 524288
    s_addc_u32 s31, s31, 0
    s_add_u32 s34, s34, 128
    s_addc_u32 s35, s35, 0
    s_mov_b32 s8, 0
    global_load_dwordx4 v[20:23], v12, s[22:23] offset:0 sc1
    global_load_dwordx4 v[24:27], v12, s[22:23] offset:1024 sc1
    ds_read_b128 v[28:31], v6 offset:0
    ds_read_b128 v[32:35], v6 offset:1024
    ds_read_b128 v[36:39], v6 offset:2048
    ds_read_b128 v[40:43], v6 offset:3072
    ds_read_b128 v[44:47], v6 offset:4096
    ds_read_b128 v[48:51], v6 offset:5120
    ds_read_b128 v[92:95], v6 offset:6144
    ds_read_b128 v[96:99], v6 offset:7168
    ds_read_b128 v[100:103], v6 offset:8192
    ds_read_b128 v[104:107], v6 offset:9216
    v_mov_b64 v[52:53], 0
    v_mov_b64 v[54:55], 0
    v_mov_b64 v[56:57], 0
    v_mov_b64 v[58:59], 0
    v_mov_b64 v[60:61], 0
    v_mov_b64 v[62:63], 0
    v_mov_b64 v[64:65], 0
    v_mov_b64 v[66:67], 0
    v_mov_b64 v[68:69], 0
    v_mov_b64 v[70:71], 0
    v_mov_b64 v[72:73], 0
    v_mov_b64 v[74:75], 0
    v_mov_b32 v108, v18
    v_mov_b32 v109, v18
    v_mov_b32 v110, v18
    v_mov_b32 v111, v18
    ds_read_b128 v[76:79], v6 offset:10240
    ds_read_b128 v[80:83], v6 offset:11264
    ds_read_b128 v[84:87], v6 offset:12288
    ds_read_b128 v[88:91], v6 offset:13312
L_rstep_115:
    s_mov_b32 s41, 2097152
L_pa_116:
    s_waitcnt vmcnt(0) lgkmcnt(0)
    v_max3_u32 v0, v20, v21, v22
    v_max3_u32 v0, v0, v23, v24
    v_max3_u32 v0, v0, v25, v26
    v_max_u32 v0, v0, v27
    v_cmp_eq_u32 vcc, -1, v0
    s_nop 4
    s_cbranch_vccz L_pg_117
    s_mov_b64 exec, vcc
    global_load_dwordx4 v[20:23], v12, s[22:23] offset:0 sc1
    global_load_dwordx4 v[24:27], v12, s[22:23] offset:1024 sc1
    s_mov_b64 exec, -1
    s_sub_u32 s41, s41, 1
    s_cmp_eq_u32 s41, 0
    s_cbranch_scc1 L_end_101
    s_branch L_pa_116
L_pg_117:
    ds_write_b128 v12, v[20:23] offset:0
    ds_write_b128 v12, v[24:27] offset:1024
    global_load_dword v19, v16, s[34:35] sc1
    v_smfmac_f32_16x16x64_bf16 v[52:55], v[20:23], v[28:35], v2
    v_smfmac_f32_16x16x64_bf16 v[56:59], v[20:23], v[36:43], v2
    v_smfmac_f32_16x16x64_bf16 v[60:63], v[20:23], v[44:51], v2
    v_smfmac_f32_16x16x64_bf16 v[64:67], v[20:23], v[92:99], v2
    s_waitcnt lgkmcnt(0)
    s_barrier
    ds_read_b128 v[28:31], v13 offset:0
    ds_read_b128 v[32:35], v13 offset:1024
    ds_read_b128 v[36:39], v14 offset:0
    ds_read_b128 v[40:43], v14 offset:1024
    ds_read_b128 v[44:47], v15 offset:0
    ds_read_b128 v[48:51], v15 offset:1024
    v_smfmac_f32_16x16x64_bf16 v[52:55], v[24:27], v[100:107], v2
    v_smfmac_f32_16x16x64_bf16 v[64:67], v[24:27], a[0:7], v2
    v_smfmac_f32_16x16x64_bf16 v[56:59], v[24:27], v[76:83], v2
    s_add_u32 m0, s46, 32768
    v_smfmac_f32_16x16x64_bf16 v[60:63], v[24:27], v[84:91], v2
    v_smfmac_f32_16x16x64_bf16 v[68:71], v[20:23], a[56:63], v2
    ds_read_b128 v[92:95], v1 offset:20480
    ds_read_b128 v[96:99], v1 offset:21504
    v_smfmac_f32_16x16x64_bf16 v[72:75], v[20:23], a[120:127], v2
    ds_read_b128 v[100:103], v1 offset:22528
    ds_read_b128 v[104:107], v1 offset:23552
    v_smfmac_f32_16x16x64_bf16 v[68:71], v[24:27], a[64:71], v2
    ds_read_b128 v[76:79], v1 offset:16384
    ds_read_b128 v[80:83], v1 offset:17408
    v_smfmac_f32_16x16x64_bf16 v[72:75], v[24:27], a[128:135], v2
    ds_read_b128 v[84:87], v1 offset:18432
    ds_read_b128 v[88:91], v1 offset:19456
    s_waitcnt lgkmcnt(13)
    v_smfmac_f32_16x16x64_bf16 v[52:55], v[28:31], v[112:119], v2
    v_smfmac_f32_16x16x64_bf16 v[56:59], v[28:31], v[160:167], v2
    v_smfmac_f32_16x16x64_bf16 v[60:63], v[28:31], v[208:215], v2
    v_smfmac_f32_16x16x64_bf16 v[64:67], v[28:31], a[8:15], v2
    s_waitcnt lgkmcnt(12)
    v_smfmac_f32_16x16x64_bf16 v[52:55], v[32:35], v[120:127], v2
    v_smfmac_f32_16x16x64_bf16 v[56:59], v[32:35], v[168:175], v2
    v_smfmac_f32_16x16x64_bf16 v[60:63], v[32:35], v[216:223], v2
    v_smfmac_f32_16x16x64_bf16 v[64:67], v[32:35], a[16:23], v2
    s_waitcnt lgkmcnt(11)
    v_smfmac_f32_16x16x64_bf16 v[52:55], v[36:39], v[128:135], v2
    v_smfmac_f32_16x16x64_bf16 v[56:59], v[36:39], v[176:183], v2
    v_smfmac_f32_16x16x64_bf16 v[60:63], v[36:39], v[224:231], v2
    v_smfmac_f32_16x16x64_bf16 v[64:67], v[36:39], a[24:31], v2
    s_waitcnt lgkmcnt(10)
    v_smfmac_f32_16x16x64_bf16 v[52:55], v[40:43], v[136:143], v2
    v_smfmac_f32_16x16x64_bf16 v[56:59], v[40:43], v[184:191], v2
    v_smfmac_f32_16x16x64_bf16 v[60:63], v[40:43], v[232:239], v2
    v_smfmac_f32_16x16x64_bf16 v[64:67], v[40:43], a[32:39], v2
    s_waitcnt lgkmcnt(9)
    v_smfmac_f32_16x16x64_bf16 v[52:55], v[44:47], v[144:151], v2
    v_smfmac_f32_16x16x64_bf16 v[56:59], v[44:47], v[192:199], v2
    v_smfmac_f32_16x16x64_bf16 v[60:63], v[44:47], v[240:247], v2
    v_smfmac_f32_16x16x64_bf16 v[64:67], v[44:47], a[40:47], v2
    s_waitcnt lgkmcnt(8)
    v_smfmac_f32_16x16x64_bf16 v[52:55], v[48:51], v[152:159], v2
    v_smfmac_f32_16x16x64_bf16 v[56:59], v[48:51], v[200:207], v2
    v_smfmac_f32_16x16x64_bf16 v[60:63], v[48:51], v[248:255], v2
    v_smfmac_f32_16x16x64_bf16 v[64:67], v[48:51], a[48:55], v2
    v_smfmac_f32_16x16x64_bf16 v[68:71], v[28:31], a[72:79], v2
    v_smfmac_f32_16x16x64_bf16 v[72:75], v[28:31], a[136:143], v2
    s_nop 3
    v_permlane32_swap_b32 v52, v56
    v_permlane32_swap_b32 v53, v57
    v_permlane32_swap_b32 v54, v58
    v_permlane32_swap_b32 v55, v59
    v_smfmac_f32_16x16x64_bf16 v[68:71], v[32:35], a[80:87], v2
    v_permlane32_swap_b32 v60, v64
    v_permlane32_swap_b32 v61, v65
    v_permlane32_swap_b32 v62, v66
    v_permlane32_swap_b32 v63, v67
    v_smfmac_f32_16x16x64_bf16 v[72:75], v[32:35], a[144:151], v2
    v_add_f32 v52, v52, v56
    v_add_f32 v53, v53, v57
    v_add_f32 v54, v54, v58
    v_add_f32 v55, v55, v59
    v_cvt_pk_bf16_f32 v56, v52, v53
    v_cvt_pk_bf16_f32 v57, v54, v55
    ds_write_b64 v3, v[56:57] offset:0
    v_smfmac_f32_16x16x64_bf16 v[68:71], v[36:39], a[88:95], v2
    v_add_f32 v60, v60, v64
    v_add_f32 v61, v61, v65
    v_add_f32 v62, v62, v66
    v_add_f32 v63, v63, v67
    v_cvt_pk_bf16_f32 v64, v60, v61
    v_cvt_pk_bf16_f32 v65, v62, v63
    ds_write_b64 v3, v[64:65] offset:2048
    v_smfmac_f32_16x16x64_bf16 v[72:75], v[36:39], a[152:159], v2
    s_waitcnt lgkmcnt(0)
    s_barrier
    ds_read_b64_tr_b16 v[20:21], v4 offset:0
    ds_read_b64_tr_b16 v[22:23], v4 offset:256
    ds_read_b64_tr_b16 v[52:53], v4 offset:2048
    ds_read_b64_tr_b16 v[54:55], v4 offset:2304
    v_smfmac_f32_16x16x64_bf16 v[68:71], v[40:43], a[96:103], v2
    ds_read_b64_tr_b16 v[24:25], v4 offset:512
    ds_read_b64_tr_b16 v[26:27], v4 offset:768
    ds_read_b64_tr_b16 v[56:57], v4 offset:2560
    ds_read_b64_tr_b16 v[58:59], v4 offset:2816
    s_waitcnt vmcnt(0)
    v_cmp_ne_u32 s[100:101], 0, v19
    v_smfmac_f32_16x16x64_bf16 v[72:75], v[40:43], a[160:167], v2
    ds_read_b64_tr_b16 v[28:29], v4 offset:1024
    ds_read_b64_tr_b16 v[30:31], v4 offset:1280
    ds_read_b64_tr_b16 v[36:37], v4 offset:3072
    ds_read_b64_tr_b16 v[38:39], v4 offset:3328
    v_smfmac_f32_16x16x64_bf16 v[68:71], v[44:47], a[104:111], v2
    ds_read_b64_tr_b16 v[32:33], v4 offset:1536
    ds_read_b64_tr_b16 v[34:35], v4 offset:1792
    ds_read_b64_tr_b16 v[40:41], v4 offset:3584
    v_smfmac_f32_16x16x64_bf16 v[72:75], v[44:47], a[168:175], v2
    s_mov_b64 exec, s[100:101]
    global_load_lds_dwordx4 v1, s[30:31] offset:0 sc1
    s_mov_b64 exec, -1
    s_mov_b64 exec, s[100:101]
    global_load_lds_dwordx4 v1, s[30:31] offset:1024 sc1
    s_mov_b64 exec, -1
    v_smfmac_f32_16x16x64_bf16 v[68:71], v[48:51], a[112:119], v2
    s_mov_b64 exec, s[100:101]
    global_load_lds_dwordx4 v1, s[30:31] offset:2048 sc1
    s_mov_b64 exec, -1
    s_mov_b64 exec, s[100:101]
    global_load_lds_dwordx4 v1, s[30:31] offset:3072 sc1
    s_mov_b64 exec, -1
    v_smfmac_f32_16x16x64_bf16 v[72:75], v[48:51], a[176:183], v2
    s_waitcnt lgkmcnt(11)
    ds_read_b64_tr_b16 v[42:43], v4 offset:3840
    v_mfma_f32_16x16x32_bf16 v[60:63], v[76:79], v[20:23], 0
    v_mfma_f32_16x16x32_bf16 v[64:67], v[92:95], v[20:23], 0
    v_mfma_f32_16x16x32_bf16 v[108:111], v[52:55], v[20:23], v[108:111]
    s_nop 2
    v_permlane32_swap_b32 v68, v72
    v_permlane32_swap_b32 v69, v73
    s_waitcnt lgkmcnt(8)
    v_mfma_f32_16x16x32_bf16 v[60:63], v[80:83], v[24:27], v[60:63]
    v_permlane32_swap_b32 v70, v74
    v_permlane32_swap_b32 v71, v75
    v_mfma_f32_16x16x32_bf16 v[64:67], v[96:99], v[24:27], v[64:67]
    v_add_f32 v68, v68, v72
    v_add_f32 v69, v69, v73
    v_mfma_f32_16x16x32_bf16 v[108:111], v[56:59], v[24:27], v[108:111]
    v_add_f32 v70, v70, v74
    v_add_f32 v71, v71, v75
    s_waitcnt lgkmcnt(4)
    v_mfma_f32_16x16x32_bf16 v[60:63], v[84:87], v[28:31], v[60:63]
    v_cvt_pk_bf16_f32 v72, v68, v69
    v_cvt_pk_bf16_f32 v73, v70, v71
    v_mfma_f32_16x16x32_bf16 v[64:67], v[100:103], v[28:31], v[64:67]
    v_min_u32 v72, -2, v72
    v_min_u32 v73, -2, v73
    v_mfma_f32_16x16x32_bf16 v[108:111], v[36:39], v[28:31], v[108:111]
    v_mov_b64 v[74:75], v[72:73]
    global_store_dwordx2 v9, v[72:73], s[32:33] sc1
    s_waitcnt lgkmcnt(0)
    v_mfma_f32_16x16x32_bf16 v[60:63], v[88:91], v[32:35], v[60:63]
    v_permlane32_swap_b32 v72, v74
    v_permlane32_swap_b32 v73, v75
    v_mfma_f32_16x16x32_bf16 v[64:67], v[104:107], v[32:35], v[64:67]
    v_mov_b32 v68, 0x3f803f80
    v_mov_b32 v69, 0x3f803f80
    v_mfma_f32_16x16x32_bf16 v[108:111], v[40:43], v[32:35], v[108:111]
    v_mov_b32 v70, 0x3f803f80
    v_mov_b32 v71, 0x3f803f80
    ds_read_b128 v[20:23], v12 offset:24576
    ds_read_b128 v[24:27], v12 offset:25600
    ds_read_b64_tr_b16 v[28:29], v17 offset:2048
    ds_read_b64_tr_b16 v[30:31], v17 offset:2304
    ds_read_b128 v[76:79], v6 offset:14336
    ds_read_b128 v[80:83], v6 offset:15360
    ds_read_b128 v[84:87], v6 offset:16384
    ds_read_b128 v[88:91], v6 offset:17408
    ds_read_b128 v[92:95], v6 offset:18432
    ds_read_b128 v[96:99], v6 offset:19456
    ds_read_b128 v[100:103], v6 offset:20480
    ds_read_b128 v[104:107], v6 offset:21504
    ds_read_b128 v[36:39], v6 offset:22528
    ds_read_b128 v[40:43], v6 offset:23552
    v_max3_f32 v32, v60, v61, v62
    v_max3_f32 v33, v63, v64, v65
    v_max3_f32 v32, v32, v66, v67
    v_max3_f32 v33, v33, v108, v109
    v_max3_f32 v32, v32, v110, v111
    v_max_f32 v32, v32, v33
    v_mov_b32 v33, v32
    s_nop 1
    v_permlane16_swap_b32 v33, v32
    v_max_f32 v32, v32, v33
    v_mov_b32 v33, v32
    s_nop 1
    v_permlane32_swap_b32 v33, v32
    v_max_f32 v32, v32, v33
    v_mul_f32 v32, s44, v32
    s_waitcnt lgkmcnt(10)
    v_min_u32 v28, -2, v28
    v_min_u32 v29, -2, v29
    v_min_u32 v30, -2, v30
    v_min_u32 v31, -2, v31
    global_store_dwordx4 v8, v[28:31], s[32:33] sc1
    v_pk_fma_f32 v[108:109], v[108:109], s[44:45], v[32:33] op_sel_hi:[1,1,0] neg_lo:[0,0,1] neg_hi:[0,0,1]
    v_pk_fma_f32 v[110:111], v[110:111], s[44:45], v[32:33] op_sel_hi:[1,1,0] neg_lo:[0,0,1] neg_hi:[0,0,1]
    v_pk_fma_f32 v[60:61], v[60:61], s[44:45], v[32:33] op_sel_hi:[1,1,0] neg_lo:[0,0,1] neg_hi:[0,0,1]
    v_pk_fma_f32 v[62:63], v[62:63], s[44:45], v[32:33] op_sel_hi:[1,1,0] neg_lo:[0,0,1] neg_hi:[0,0,1]
    v_pk_fma_f32 v[64:65], v[64:65], s[44:45], v[32:33] op_sel_hi:[1,1,0] neg_lo:[0,0,1] neg_hi:[0,0,1]
    v_pk_fma_f32 v[66:67], v[66:67], s[44:45], v[32:33] op_sel_hi:[1,1,0] neg_lo:[0,0,1] neg_hi:[0,0,1]
    v_exp_f32 v108, v108
    v_exp_f32 v109, v109
    v_exp_f32 v110, v110
    v_exp_f32 v111, v111
    v_exp_f32 v60, v60
    v_cvt_pk_bf16_f32 v44, v108, v109
    v_cvt_pk_bf16_f32 v45, v110, v111
    v_exp_f32 v61, v61
    v_exp_f32 v62, v62
    v_mfma_f32_16x16x16_bf16 v[32:35], v[68:69], v[44:45], 0
    v_mfma_f32_16x16x16_bf16 v[52:55], v[72:73], v[44:45], 0
    v_mfma_f32_16x16x16_bf16 v[56:59], v[74:75], v[44:45], 0
    v_exp_f32 v63, v63
    v_exp_f32 v64, v64
    v_exp_f32 v65, v65
    v_exp_f32 v66, v66
    v_exp_f32 v67, v67
    v_cvt_pk_bf16_f32 v48, v60, v61
    v_cvt_pk_bf16_f32 v49, v62, v63
    v_cvt_pk_bf16_f32 v50, v64, v65
    v_cvt_pk_bf16_f32 v51, v66, v67
    s_nop 1
    v_mfma_f32_16x16x32_bf16 v[32:35], v[68:71], v[48:51], v[32:35]
    v_mfma_f32_16x16x32_bf16 v[52:55], v[20:23], v[48:51], v[52:55]
    v_mfma_f32_16x16x32_bf16 v[56:59], v[24:27], v[48:51], v[56:59]
    s_nop 5
    v_rcp_f32 v32, v32
    v_mov_b64 v[60:61], 0
    v_mov_b64 v[62:63], 0
    v_pk_mul_f32 v[52:53], v[52:53], v[32:33] op_sel_hi:[1,0]
    v_pk_mul_f32 v[54:55], v[54:55], v[32:33] op_sel_hi:[1,0]
    v_cvt_pk_bf16_f32 v52, v52, v53
    v_cvt_pk_bf16_f32 v53, v54, v55
    ds_write2_b32 v5, v52, v53 offset0:0 offset1:32
    v_pk_mul_f32 v[56:57], v[56:57], v[32:33] op_sel_hi:[1,0]
    v_pk_mul_f32 v[58:59], v[58:59], v[32:33] op_sel_hi:[1,0]
    v_cvt_pk_bf16_f32 v56, v56, v57
    v_cvt_pk_bf16_f32 v57, v58, v59
    ds_write2_b32 v5, v56, v57 offset0:64 offset1:96
    v_mov_b64 v[64:65], 0
    v_mov_b64 v[66:67], 0
    v_mov_b64 v[44:45], 0
    v_mov_b64 v[46:47], 0
    v_mov_b64 v[48:49], 0
    v_mov_b64 v[50:51], 0
    s_waitcnt lgkmcnt(0)
    s_barrier
    ds_read_b128 v[20:23], v1 offset:12288
    ds_read_b128 v[24:27], v1 offset:13312
    ds_read_b128 v[52:55], v6 offset:24576
    ds_read_b128 v[56:59], v6 offset:25600
    s_add_u32 s32, s32, 131072
    s_addc_u32 s33, s33, 0
    v_mov_b64 v[68:69], 0
    v_mov_b64 v[70:71], 0
    v_mov_b64 v[72:73], 0
    v_mov_b64 v[74:75], 0
    v_mov_b64 v[32:33], 0
    v_mov_b64 v[34:35], 0
    v_mov_b64 v[28:29], 0
    v_mov_b64 v[30:31], 0
    s_waitcnt lgkmcnt(3)
    s_nop 0
    v_smfmac_f32_16x16x64_bf16 v[28:31], v[20:23], a[184:191], v2
    v_smfmac_f32_16x16x64_bf16 v[32:35], v[20:23], a[192:199], v2
    v_smfmac_f32_16x16x64_bf16 v[44:47], v[20:23], a[200:207], v2
    v_smfmac_f32_16x16x64_bf16 v[48:51], v[20:23], a[208:215], v2
    s_waitcnt lgkmcnt(2)
    v_smfmac_f32_16x16x64_bf16 v[28:31], v[24:27], v[76:83], v2
    v_smfmac_f32_16x16x64_bf16 v[32:35], v[24:27], v[84:91], v2
    ds_read_b128 v[76:79], v6 offset:26624
    ds_read_b128 v[80:83], v6 offset:27648
    v_smfmac_f32_16x16x64_bf16 v[44:47], v[24:27], v[92:99], v2
    v_smfmac_f32_16x16x64_bf16 v[48:51], v[24:27], v[100:107], v2
    v_smfmac_f32_16x16x64_bf16 v[60:63], v[20:23], a[216:223], v2
    v_smfmac_f32_16x16x64_bf16 v[64:67], v[20:23], a[224:231], v2
    s_nop 1
    v_permlane32_swap_b32 v28, v32
    v_permlane32_swap_b32 v29, v33
    v_permlane32_swap_b32 v30, v34
    v_smfmac_f32_16x16x64_bf16 v[68:71], v[20:23], a[232:239], v2
    v_permlane32_swap_b32 v31, v35
    v_add_f32 v28, v28, v32
    v_add_f32 v29, v29, v33
    v_smfmac_f32_16x16x64_bf16 v[72:75], v[20:23], a[240:247], v2
    v_add_f32 v30, v30, v34
    v_add_f32 v31, v31, v35
    v_cvt_pk_bf16_f32 v28, v28, v29
    v_smfmac_f32_16x16x64_bf16 v[60:63], v[24:27], v[36:43], v2
    v_cvt_pk_bf16_f32 v29, v30, v31
    v_or_b32 v28, 1, v28
    global_store_dwordx2 v7, v[28:29], s[28:29] sc1
    s_waitcnt lgkmcnt(2)
    v_smfmac_f32_16x16x64_bf16 v[64:67], v[24:27], v[52:59], v2
    v_permlane32_swap_b32 v44, v48
    v_permlane32_swap_b32 v45, v49
    v_permlane32_swap_b32 v46, v50
    v_permlane32_swap_b32 v47, v51
    v_smfmac_f32_16x16x64_bf16 v[72:75], v[24:27], a[248:255], v2
    v_add_f32 v44, v44, v48
    v_add_f32 v45, v45, v49
    v_add_f32 v46, v46, v50
    v_add_f32 v47, v47, v51
    s_waitcnt lgkmcnt(0)
    v_smfmac_f32_16x16x64_bf16 v[68:71], v[24:27], v[76:83], v2
    v_cvt_pk_bf16_f32 v44, v44, v45
    v_cvt_pk_bf16_f32 v45, v46, v47
    v_or_b32 v44, 1, v44
    global_store_dwordx2 v7, v[44:45], s[50:51] sc1
    v_permlane32_swap_b32 v60, v64
    v_permlane32_swap_b32 v61, v65
    v_permlane32_swap_b32 v62, v66
    v_permlane32_swap_b32 v63, v67
    v_add_f32 v60, v60, v64
    v_add_f32 v61, v61, v65
    v_add_f32 v62, v62, v66
    v_add_f32 v63, v63, v67
    v_cvt_pk_bf16_f32 v60, v60, v61
    v_cvt_pk_bf16_f32 v61, v62, v63
    v_or_b32 v60, 1, v60
    global_store_dwordx2 v7, v[60:61], s[52:53] sc1
    v_permlane32_swap_b32 v68, v72
    v_permlane32_swap_b32 v69, v73
    v_permlane32_swap_b32 v70, v74
    v_permlane32_swap_b32 v71, v75
    v_add_f32 v68, v68, v72
    v_add_f32 v69, v69, v73
    v_add_f32 v70, v70, v74
    v_add_f32 v71, v71, v75
    v_cvt_pk_bf16_f32 v68, v68, v69
    v_cvt_pk_bf16_f32 v69, v70, v71
    v_or_b32 v68, 1, v68
    global_store_dwordx2 v7, v[68:69], s[54:55] sc1
    v_lshrrev_b32 v83, 1, v1
    ds_read_b128 v[28:31], v6 offset:0
    ds_read_b128 v[32:35], v6 offset:1024
    ds_read_b128 v[36:39], v6 offset:2048
    ds_read_b128 v[40:43], v6 offset:3072
    ds_read_b128 v[44:47], v6 offset:4096
    ds_read_b128 v[48:51], v6 offset:5120
    ds_read_b128 v[92:95], v6 offset:6144
    ds_read_b128 v[96:99], v6 offset:7168
    ds_read_b128 v[100:103], v6 offset:8192
    ds_read_b128 v[104:107], v6 offset:9216
    v_mov_b64 v[52:53], 0
    v_mov_b64 v[54:55], 0
    v_mov_b64 v[56:57], 0
    v_mov_b64 v[58:59], 0
    v_mov_b64 v[60:61], 0
    v_mov_b64 v[62:63], 0
    v_mov_b64 v[64:65], 0
    v_mov_b64 v[66:67], 0
    v_mov_b64 v[68:69], 0
    v_mov_b64 v[70:71], 0
    v_mov_b64 v[72:73], 0
    v_mov_b64 v[74:75], 0
    v_mov_b32 v108, v18
    v_mov_b32 v109, v18
    v_mov_b32 v110, v18
    v_mov_b32 v111, v18
    s_sleep 1
    global_load_dwordx2 v[84:85], v83, s[26:27] offset:0 sc1
    global_load_dwordx2 v[86:87], v83, s[26:27] offset:512 sc1
    global_load_dwordx2 v[88:89], v83, s[26:27] offset:1024 sc1
    global_load_dwordx2 v[90:91], v83, s[26:27] offset:1536 sc1
    s_mov_b32 s41, 2097152
L_pk_118:
    s_waitcnt vmcnt(0)
    v_bitop3_b32 v0, v84, v86, v88 bitop3:0x80
    v_bitop3_b32 v0, v0, v90, 1 bitop3:0x80
    v_cmp_eq_u32 vcc, 0, v0
    s_nop 4
    s_cbranch_vccz L_kg_119
    s_mov_b64 exec, vcc
    global_load_dwordx2 v[84:85], v83, s[26:27] offset:0 sc1
    global_load_dwordx2 v[86:87], v83, s[26:27] offset:512 sc1
    global_load_dwordx2 v[88:89], v83, s[26:27] offset:1024 sc1
    global_load_dwordx2 v[90:91], v83, s[26:27] offset:1536 sc1
    s_mov_b64 exec, -1
    s_sub_u32 s41, s41, 1
    s_cmp_eq_u32 s41, 0
    s_cbranch_scc1 L_end_101
    s_branch L_pk_118
L_kg_119:
    v_lshlrev_b32 v76, 16, v84
    v_and_b32 v77, 0xffff0000, v84
    v_lshlrev_b32 v78, 16, v85
    v_and_b32 v79, 0xffff0000, v85
    v_lshlrev_b32 v80, 16, v86
    v_and_b32 v81, 0xffff0000, v86
    v_lshlrev_b32 v82, 16, v87
    v_and_b32 v83, 0xffff0000, v87
    v_lshlrev_b32 v84, 16, v88
    v_and_b32 v85, 0xffff0000, v88
    v_lshlrev_b32 v86, 16, v89
    v_and_b32 v87, 0xffff0000, v89
    v_lshlrev_b32 v88, 16, v90
    v_and_b32 v89, 0xffff0000, v90
    v_lshlrev_b32 v90, 16, v91
    v_and_b32 v91, 0xffff0000, v91
    v_pk_add_f32 v[76:77], v[76:77], v[80:81]
    v_pk_add_f32 v[84:85], v[84:85], v[88:89]
    v_pk_add_f32 v[78:79], v[78:79], v[82:83]
    v_pk_add_f32 v[86:87], v[86:87], v[90:91]
    v_pk_add_f32 v[76:77], v[76:77], v[84:85]
    v_pk_add_f32 v[78:79], v[78:79], v[86:87]
    s_nop 1
    v_permlane32_swap_b32 v76, v78
    v_permlane32_swap_b32 v77, v79
    v_pk_add_f32 v[76:77], v[76:77], v[78:79]
    s_nop 1
    v_permlane16_swap_b32 v76, v77
    v_add_f32 v76, v76, v77
    s_nop 1
    v_add_f32_dpp v77, v76, v76 row_ror:8 row_mask:0xf bank_mask:0xf
    s_nop 1
    v_mov_b32_dpp v78, v77 quad_perm:[1,0,3,2] row_mask:0xf bank_mask:0xf
    v_cvt_pk_bf16_f32 v77, v77, v78
    v_min_u32 v77, -2, v77
    s_mov_b64 exec, s[42:43]
    global_store_dword v10, v77, s[24:25] sc1
    global_store_dword v10, v11, s[22:23] sc1
    s_mov_b64 exec, -1
    s_cmp_lg_u64 s[100:101], 0
    s_cbranch_scc1 L_p2_120
    s_mov_b32 s41, 2097152
L_fsp_121:
    global_load_dword v0, v16, s[34:35] sc1
    s_sub_u32 s41, s41, 1
    s_cmp_eq_u32 s41, 0
    s_cbranch_scc1 L_end_101
    s_waitcnt vmcnt(0)
    v_cmp_eq_u32 vcc, 0, v0
    s_nop 4
    s_cbranch_vccnz L_fsp_121
    s_add_u32 m0, s46, 32768
    s_nop 0
    global_load_lds_dwordx4 v1, s[30:31] offset:0 sc1
    global_load_lds_dwordx4 v1, s[30:31] offset:1024 sc1
    global_load_lds_dwordx4 v1, s[30:31] offset:2048 sc1
    global_load_lds_dwordx4 v1, s[30:31] offset:3072 sc1
L_p2_120:
    s_add_u32 s30, s30, 524288
    s_addc_u32 s31, s31, 0
    s_add_u32 s34, s34, 128
    s_addc_u32 s35, s35, 0
    ds_read_b128 v[76:79], v6 offset:10240
    ds_read_b128 v[80:83], v6 offset:11264
    ds_read_b128 v[84:87], v6 offset:12288
    ds_read_b128 v[88:91], v6 offset:13312
    s_sleep 2
    global_load_dwordx4 v[20:23], v12, s[24:25] offset:0 sc1
    global_load_dwordx4 v[24:27], v12, s[24:25] offset:1024 sc1
    s_mov_b32 s41, 2097152
L_pa_122:
    s_waitcnt vmcnt(0) lgkmcnt(0)
    v_max3_u32 v0, v20, v21, v22
    v_max3_u32 v0, v0, v23, v24
    v_max3_u32 v0, v0, v25, v26
    v_max_u32 v0, v0, v27
    v_cmp_eq_u32 vcc, -1, v0
    s_nop 4
    s_cbranch_vccz L_pg_123
    s_mov_b64 exec, vcc
    global_load_dwordx4 v[20:23], v12, s[24:25] offset:0 sc1
    global_load_dwordx4 v[24:27], v12, s[24:25] offset:1024 sc1
    s_mov_b64 exec, -1
    s_sub_u32 s41, s41, 1
    s_cmp_eq_u32 s41, 0
    s_cbranch_scc1 L_end_101
    s_branch L_pa_122
L_pg_123:
    ds_write_b128 v12, v[20:23] offset:0
    ds_write_b128 v12, v[24:27] offset:1024
    global_load_dword v19, v16, s[34:35] sc1
    v_smfmac_f32_16x16x64_bf16 v[52:55], v[20:23], v[28:35], v2
    v_smfmac_f32_16x16x64_bf16 v[56:59], v[20:23], v[36:43], v2
    v_smfmac_f32_16x16x64_bf16 v[60:63], v[20:23], v[44:51], v2
    v_smfmac_f32_16x16x64_bf16 v[64:67], v[20:23], v[92:99], v2
    s_waitcnt lgkmcnt(0)
    s_barrier
    ds_read_b128 v[28:31], v13 offset:0
    ds_read_b128 v[32:35], v13 offset:1024
    ds_read_b128 v[36:39], v14 offset:0
    ds_read_b128 v[40:43], v14 offset:1024
    ds_read_b128 v[44:47], v15 offset:0
    ds_read_b128 v[48:51], v15 offset:1024
    v_smfmac_f32_16x16x64_bf16 v[52:55], v[24:27], v[100:107], v2
    v_smfmac_f32_16x16x64_bf16 v[64:67], v[24:27], a[0:7], v2
    v_smfmac_f32_16x16x64_bf16 v[56:59], v[24:27], v[76:83], v2
    s_add_u32 m0, s46, 16384
    v_smfmac_f32_16x16x64_bf16 v[60:63], v[24:27], v[84:91], v2
    v_smfmac_f32_16x16x64_bf16 v[68:71], v[20:23], a[56:63], v2
    ds_read_b128 v[92:95], v1 offset:36864
    ds_read_b128 v[96:99], v1 offset:37888
    v_smfmac_f32_16x16x64_bf16 v[72:75], v[20:23], a[120:127], v2
    ds_read_b128 v[100:103], v1 offset:38912
    ds_read_b128 v[104:107], v1 offset:39936
    v_smfmac_f32_16x16x64_bf16 v[68:71], v[24:27], a[64:71], v2
    ds_read_b128 v[76:79], v1 offset:32768
    ds_read_b128 v[80:83], v1 offset:33792
    v_smfmac_f32_16x16x64_bf16 v[72:75], v[24:27], a[128:135], v2
    ds_read_b128 v[84:87], v1 offset:34816
    ds_read_b128 v[88:91], v1 offset:35840
    s_waitcnt lgkmcnt(13)
    v_smfmac_f32_16x16x64_bf16 v[52:55], v[28:31], v[112:119], v2
    v_smfmac_f32_16x16x64_bf16 v[56:59], v[28:31], v[160:167], v2
    v_smfmac_f32_16x16x64_bf16 v[60:63], v[28:31], v[208:215], v2
    v_smfmac_f32_16x16x64_bf16 v[64:67], v[28:31], a[8:15], v2
    s_waitcnt lgkmcnt(12)
    v_smfmac_f32_16x16x64_bf16 v[52:55], v[32:35], v[120:127], v2
    v_smfmac_f32_16x16x64_bf16 v[56:59], v[32:35], v[168:175], v2
    v_smfmac_f32_16x16x64_bf16 v[60:63], v[32:35], v[216:223], v2
    v_smfmac_f32_16x16x64_bf16 v[64:67], v[32:35], a[16:23], v2
    s_waitcnt lgkmcnt(11)
    v_smfmac_f32_16x16x64_bf16 v[52:55], v[36:39], v[128:135], v2
    v_smfmac_f32_16x16x64_bf16 v[56:59], v[36:39], v[176:183], v2
    v_smfmac_f32_16x16x64_bf16 v[60:63], v[36:39], v[224:231], v2
    v_smfmac_f32_16x16x64_bf16 v[64:67], v[36:39], a[24:31], v2
    s_waitcnt lgkmcnt(10)
    v_smfmac_f32_16x16x64_bf16 v[52:55], v[40:43], v[136:143], v2
    v_smfmac_f32_16x16x64_bf16 v[56:59], v[40:43], v[184:191], v2
    v_smfmac_f32_16x16x64_bf16 v[60:63], v[40:43], v[232:239], v2
    v_smfmac_f32_16x16x64_bf16 v[64:67], v[40:43], a[32:39], v2
    s_waitcnt lgkmcnt(9)
    v_smfmac_f32_16x16x64_bf16 v[52:55], v[44:47], v[144:151], v2
    v_smfmac_f32_16x16x64_bf16 v[56:59], v[44:47], v[192:199], v2
    v_smfmac_f32_16x16x64_bf16 v[60:63], v[44:47], v[240:247], v2
    v_smfmac_f32_16x16x64_bf16 v[64:67], v[44:47], a[40:47], v2
    s_waitcnt lgkmcnt(8)
    v_smfmac_f32_16x16x64_bf16 v[52:55], v[48:51], v[152:159], v2
    v_smfmac_f32_16x16x64_bf16 v[56:59], v[48:51], v[200:207], v2
    v_smfmac_f32_16x16x64_bf16 v[60:63], v[48:51], v[248:255], v2
    v_smfmac_f32_16x16x64_bf16 v[64:67], v[48:51], a[48:55], v2
    v_smfmac_f32_16x16x64_bf16 v[68:71], v[28:31], a[72:79], v2
    v_smfmac_f32_16x16x64_bf16 v[72:75], v[28:31], a[136:143], v2
    s_nop 3
    v_permlane32_swap_b32 v52, v56
    v_permlane32_swap_b32 v53, v57
    v_permlane32_swap_b32 v54, v58
    v_permlane32_swap_b32 v55, v59
    v_smfmac_f32_16x16x64_bf16 v[68:71], v[32:35], a[80:87], v2
    v_permlane32_swap_b32 v60, v64
    v_permlane32_swap_b32 v61, v65
    v_permlane32_swap_b32 v62, v66
    v_permlane32_swap_b32 v63, v67
    v_smfmac_f32_16x16x64_bf16 v[72:75], v[32:35], a[144:151], v2
    v_add_f32 v52, v52, v56
    v_add_f32 v53, v53, v57
    v_add_f32 v54, v54, v58
    v_add_f32 v55, v55, v59
    v_cvt_pk_bf16_f32 v56, v52, v53
    v_cvt_pk_bf16_f32 v57, v54, v55
    ds_write_b64 v3, v[56:57] offset:0
    v_smfmac_f32_16x16x64_bf16 v[68:71], v[36:39], a[88:95], v2
    v_add_f32 v60, v60, v64
    v_add_f32 v61, v61, v65
    v_add_f32 v62, v62, v66
    v_add_f32 v63, v63, v67
    v_cvt_pk_bf16_f32 v64, v60, v61
    v_cvt_pk_bf16_f32 v65, v62, v63
    ds_write_b64 v3, v[64:65] offset:2048
    v_smfmac_f32_16x16x64_bf16 v[72:75], v[36:39], a[152:159], v2
    s_waitcnt lgkmcnt(0)
    s_barrier
    ds_read_b64_tr_b16 v[20:21], v4 offset:0
    ds_read_b64_tr_b16 v[22:23], v4 offset:256
    ds_read_b64_tr_b16 v[52:53], v4 offset:2048
    ds_read_b64_tr_b16 v[54:55], v4 offset:2304
    v_smfmac_f32_16x16x64_bf16 v[68:71], v[40:43], a[96:103], v2
    ds_read_b64_tr_b16 v[24:25], v4 offset:512
    ds_read_b64_tr_b16 v[26:27], v4 offset:768
    ds_read_b64_tr_b16 v[56:57], v4 offset:2560
    ds_read_b64_tr_b16 v[58:59], v4 offset:2816
    s_waitcnt vmcnt(0)
    v_cmp_ne_u32 s[100:101], 0, v19
    v_smfmac_f32_16x16x64_bf16 v[72:75], v[40:43], a[160:167], v2
    ds_read_b64_tr_b16 v[28:29], v4 offset:1024
    ds_read_b64_tr_b16 v[30:31], v4 offset:1280
    ds_read_b64_tr_b16 v[36:37], v4 offset:3072
    ds_read_b64_tr_b16 v[38:39], v4 offset:3328
    v_smfmac_f32_16x16x64_bf16 v[68:71], v[44:47], a[104:111], v2
    ds_read_b64_tr_b16 v[32:33], v4 offset:1536
    ds_read_b64_tr_b16 v[34:35], v4 offset:1792
    ds_read_b64_tr_b16 v[40:41], v4 offset:3584
    v_smfmac_f32_16x16x64_bf16 v[72:75], v[44:47], a[168:175], v2
    s_mov_b64 exec, s[100:101]
    global_load_lds_dwordx4 v1, s[30:31] offset:0 sc1
    s_mov_b64 exec, -1
    s_mov_b64 exec, s[100:101]
    global_load_lds_dwordx4 v1, s[30:31] offset:1024 sc1
    s_mov_b64 exec, -1
    v_smfmac_f32_16x16x64_bf16 v[68:71], v[48:51], a[112:119], v2
    s_mov_b64 exec, s[100:101]
    global_load_lds_dwordx4 v1, s[30:31] offset:2048 sc1
    s_mov_b64 exec, -1
    s_mov_b64 exec, s[100:101]
    global_load_lds_dwordx4 v1, s[30:31] offset:3072 sc1
    s_mov_b64 exec, -1
    v_smfmac_f32_16x16x64_bf16 v[72:75], v[48:51], a[176:183], v2
    s_waitcnt lgkmcnt(11)
    ds_read_b64_tr_b16 v[42:43], v4 offset:3840
    v_mfma_f32_16x16x32_bf16 v[60:63], v[76:79], v[20:23], 0
    v_mfma_f32_16x16x32_bf16 v[64:67], v[92:95], v[20:23], 0
    v_mfma_f32_16x16x32_bf16 v[108:111], v[52:55], v[20:23], v[108:111]
    s_nop 2
    v_permlane32_swap_b32 v68, v72
    v_permlane32_swap_b32 v69, v73
    s_waitcnt lgkmcnt(8)
    v_mfma_f32_16x16x32_bf16 v[60:63], v[80:83], v[24:27], v[60:63]
    v_permlane32_swap_b32 v70, v74
    v_permlane32_swap_b32 v71, v75
    v_mfma_f32_16x16x32_bf16 v[64:67], v[96:99], v[24:27], v[64:67]
    v_add_f32 v68, v68, v72
    v_add_f32 v69, v69, v73
    v_mfma_f32_16x16x32_bf16 v[108:111], v[56:59], v[24:27], v[108:111]
    v_add_f32 v70, v70, v74
    v_add_f32 v71, v71, v75
    s_waitcnt lgkmcnt(4)
    v_mfma_f32_16x16x32_bf16 v[60:63], v[84:87], v[28:31], v[60:63]
    v_cvt_pk_bf16_f32 v72, v68, v69
    v_cvt_pk_bf16_f32 v73, v70, v71
    v_mfma_f32_16x16x32_bf16 v[64:67], v[100:103], v[28:31], v[64:67]
    v_min_u32 v72, -2, v72
    v_min_u32 v73, -2, v73
    v_mfma_f32_16x16x32_bf16 v[108:111], v[36:39], v[28:31], v[108:111]
    v_mov_b64 v[74:75], v[72:73]
    global_store_dwordx2 v9, v[72:73], s[32:33] sc1
    s_waitcnt lgkmcnt(0)
    v_mfma_f32_16x16x32_bf16 v[60:63], v[88:91], v[32:35], v[60:63]
    v_permlane32_swap_b32 v72, v74
    v_permlane32_swap_b32 v73, v75
    v_mfma_f32_16x16x32_bf16 v[64:67], v[104:107], v[32:35], v[64:67]
    v_mov_b32 v68, 0x3f803f80
    v_mov_b32 v69, 0x3f803f80
    v_mfma_f32_16x16x32_bf16 v[108:111], v[40:43], v[32:35], v[108:111]
    v_mov_b32 v70, 0x3f803f80
    v_mov_b32 v71, 0x3f803f80
    ds_read_b128 v[20:23], v12 offset:40960
    ds_read_b128 v[24:27], v12 offset:41984
    ds_read_b64_tr_b16 v[28:29], v17 offset:2048
    ds_read_b64_tr_b16 v[30:31], v17 offset:2304
    ds_read_b128 v[76:79], v6 offset:14336
    ds_read_b128 v[80:83], v6 offset:15360
    ds_read_b128 v[84:87], v6 offset:16384
    ds_read_b128 v[88:91], v6 offset:17408
    ds_read_b128 v[92:95], v6 offset:18432
    ds_read_b128 v[96:99], v6 offset:19456
    ds_read_b128 v[100:103], v6 offset:20480
    ds_read_b128 v[104:107], v6 offset:21504
    ds_read_b128 v[36:39], v6 offset:22528
    ds_read_b128 v[40:43], v6 offset:23552
    v_max3_f32 v32, v60, v61, v62
    v_max3_f32 v33, v63, v64, v65
    v_max3_f32 v32, v32, v66, v67
    v_max3_f32 v33, v33, v108, v109
    v_max3_f32 v32, v32, v110, v111
    v_max_f32 v32, v32, v33
    v_mov_b32 v33, v32
    s_nop 1
    v_permlane16_swap_b32 v33, v32
    v_max_f32 v32, v32, v33
    v_mov_b32 v33, v32
    s_nop 1
    v_permlane32_swap_b32 v33, v32
    v_max_f32 v32, v32, v33
    v_mul_f32 v32, s44, v32
    s_waitcnt lgkmcnt(10)
    v_min_u32 v28, -2, v28
    v_min_u32 v29, -2, v29
    v_min_u32 v30, -2, v30
    v_min_u32 v31, -2, v31
    global_store_dwordx4 v8, v[28:31], s[32:33] sc1
    v_pk_fma_f32 v[108:109], v[108:109], s[44:45], v[32:33] op_sel_hi:[1,1,0] neg_lo:[0,0,1] neg_hi:[0,0,1]
    v_pk_fma_f32 v[110:111], v[110:111], s[44:45], v[32:33] op_sel_hi:[1,1,0] neg_lo:[0,0,1] neg_hi:[0,0,1]
    v_pk_fma_f32 v[60:61], v[60:61], s[44:45], v[32:33] op_sel_hi:[1,1,0] neg_lo:[0,0,1] neg_hi:[0,0,1]
    v_pk_fma_f32 v[62:63], v[62:63], s[44:45], v[32:33] op_sel_hi:[1,1,0] neg_lo:[0,0,1] neg_hi:[0,0,1]
    v_pk_fma_f32 v[64:65], v[64:65], s[44:45], v[32:33] op_sel_hi:[1,1,0] neg_lo:[0,0,1] neg_hi:[0,0,1]
    v_pk_fma_f32 v[66:67], v[66:67], s[44:45], v[32:33] op_sel_hi:[1,1,0] neg_lo:[0,0,1] neg_hi:[0,0,1]
    v_exp_f32 v108, v108
    v_exp_f32 v109, v109
    v_exp_f32 v110, v110
    v_exp_f32 v111, v111
    v_exp_f32 v60, v60
    v_cvt_pk_bf16_f32 v44, v108, v109
    v_cvt_pk_bf16_f32 v45, v110, v111
    v_exp_f32 v61, v61
    v_exp_f32 v62, v62
    v_mfma_f32_16x16x16_bf16 v[32:35], v[68:69], v[44:45], 0
    v_mfma_f32_16x16x16_bf16 v[52:55], v[72:73], v[44:45], 0
    v_mfma_f32_16x16x16_bf16 v[56:59], v[74:75], v[44:45], 0
    v_exp_f32 v63, v63
    v_exp_f32 v64, v64
    v_exp_f32 v65, v65
    v_exp_f32 v66, v66
    v_exp_f32 v67, v67
    v_cvt_pk_bf16_f32 v48, v60, v61
    v_cvt_pk_bf16_f32 v49, v62, v63
    v_cvt_pk_bf16_f32 v50, v64, v65
    v_cvt_pk_bf16_f32 v51, v66, v67
    s_nop 1
    v_mfma_f32_16x16x32_bf16 v[32:35], v[68:71], v[48:51], v[32:35]
    v_mfma_f32_16x16x32_bf16 v[52:55], v[20:23], v[48:51], v[52:55]
    v_mfma_f32_16x16x32_bf16 v[56:59], v[24:27], v[48:51], v[56:59]
    s_nop 5
    v_rcp_f32 v32, v32
    v_mov_b64 v[60:61], 0
    v_mov_b64 v[62:63], 0
    v_pk_mul_f32 v[52:53], v[52:53], v[32:33] op_sel_hi:[1,0]
    v_pk_mul_f32 v[54:55], v[54:55], v[32:33] op_sel_hi:[1,0]
    v_cvt_pk_bf16_f32 v52, v52, v53
    v_cvt_pk_bf16_f32 v53, v54, v55
    ds_write2_b32 v5, v52, v53 offset0:0 offset1:32
    v_pk_mul_f32 v[56:57], v[56:57], v[32:33] op_sel_hi:[1,0]
    v_pk_mul_f32 v[58:59], v[58:59], v[32:33] op_sel_hi:[1,0]
    v_cvt_pk_bf16_f32 v56, v56, v57
    v_cvt_pk_bf16_f32 v57, v58, v59
    ds_write2_b32 v5, v56, v57 offset0:64 offset1:96
    v_mov_b64 v[64:65], 0
    v_mov_b64 v[66:67], 0
    v_mov_b64 v[44:45], 0
    v_mov_b64 v[46:47], 0
    v_mov_b64 v[48:49], 0
    v_mov_b64 v[50:51], 0
    s_waitcnt lgkmcnt(0)
    s_barrier
    ds_read_b128 v[20:23], v1 offset:12288
    ds_read_b128 v[24:27], v1 offset:13312
    ds_read_b128 v[52:55], v6 offset:24576
    ds_read_b128 v[56:59], v6 offset:25600
    s_add_u32 s32, s32, 131072
    s_addc_u32 s33, s33, 0
    v_mov_b64 v[68:69], 0
    v_mov_b64 v[70:71], 0
    v_mov_b64 v[72:73], 0
    v_mov_b64 v[74:75], 0
    v_mov_b64 v[32:33], 0
    v_mov_b64 v[34:35], 0
    v_mov_b64 v[28:29], 0
    v_mov_b64 v[30:31], 0
    s_cmp_ge_u32 s8, 62
    s_nop 0
    s_cbranch_scc1 L_rexit_114
    s_waitcnt lgkmcnt(3)
    v_smfmac_f32_16x16x64_bf16 v[28:31], v[20:23], a[184:191], v2
    v_smfmac_f32_16x16x64_bf16 v[32:35], v[20:23], a[192:199], v2
    v_smfmac_f32_16x16x64_bf16 v[44:47], v[20:23], a[200:207], v2
    v_smfmac_f32_16x16x64_bf16 v[48:51], v[20:23], a[208:215], v2
    s_waitcnt lgkmcnt(2)
    v_smfmac_f32_16x16x64_bf16 v[28:31], v[24:27], v[76:83], v2
    v_smfmac_f32_16x16x64_bf16 v[32:35], v[24:27], v[84:91], v2
    ds_read_b128 v[76:79], v6 offset:26624
    ds_read_b128 v[80:83], v6 offset:27648
    v_smfmac_f32_16x16x64_bf16 v[44:47], v[24:27], v[92:99], v2
    v_smfmac_f32_16x16x64_bf16 v[48:51], v[24:27], v[100:107], v2
    v_smfmac_f32_16x16x64_bf16 v[60:63], v[20:23], a[216:223], v2
    v_smfmac_f32_16x16x64_bf16 v[64:67], v[20:23], a[224:231], v2
    s_nop 1
    v_permlane32_swap_b32 v28, v32
    v_permlane32_swap_b32 v29, v33
    v_permlane32_swap_b32 v30, v34
    v_smfmac_f32_16x16x64_bf16 v[68:71], v[20:23], a[232:239], v2
    v_permlane32_swap_b32 v31, v35
    v_add_f32 v28, v28, v32
    v_add_f32 v29, v29, v33
    v_smfmac_f32_16x16x64_bf16 v[72:75], v[20:23], a[240:247], v2
    v_add_f32 v30, v30, v34
    v_add_f32 v31, v31, v35
    v_cvt_pk_bf16_f32 v28, v28, v29
    v_smfmac_f32_16x16x64_bf16 v[60:63], v[24:27], v[36:43], v2
    v_cvt_pk_bf16_f32 v29, v30, v31
    v_and_b32 v28, -2, v28
    global_store_dwordx2 v7, v[28:29], s[28:29] sc1
    s_waitcnt lgkmcnt(2)
    v_smfmac_f32_16x16x64_bf16 v[64:67], v[24:27], v[52:59], v2
    v_permlane32_swap_b32 v44, v48
    v_permlane32_swap_b32 v45, v49
    v_permlane32_swap_b32 v46, v50
    v_permlane32_swap_b32 v47, v51
    v_smfmac_f32_16x16x64_bf16 v[72:75], v[24:27], a[248:255], v2
    v_add_f32 v44, v44, v48
    v_add_f32 v45, v45, v49
    v_add_f32 v46, v46, v50
    v_add_f32 v47, v47, v51
    s_waitcnt lgkmcnt(0)
    v_smfmac_f32_16x16x64_bf16 v[68:71], v[24:27], v[76:83], v2
    v_cvt_pk_bf16_f32 v44, v44, v45
    v_cvt_pk_bf16_f32 v45, v46, v47
    v_and_b32 v44, -2, v44
    global_store_dwordx2 v7, v[44:45], s[50:51] sc1
    v_permlane32_swap_b32 v60, v64
    v_permlane32_swap_b32 v61, v65
    v_permlane32_swap_b32 v62, v66
    v_permlane32_swap_b32 v63, v67
    v_add_f32 v60, v60, v64
    v_add_f32 v61, v61, v65
    v_add_f32 v62, v62, v66
    v_add_f32 v63, v63, v67
    v_cvt_pk_bf16_f32 v60, v60, v61
    v_cvt_pk_bf16_f32 v61, v62, v63
    v_and_b32 v60, -2, v60
    global_store_dwordx2 v7, v[60:61], s[52:53] sc1
    v_permlane32_swap_b32 v68, v72
    v_permlane32_swap_b32 v69, v73
    v_permlane32_swap_b32 v70, v74
    v_permlane32_swap_b32 v71, v75
    v_add_f32 v68, v68, v72
    v_add_f32 v69, v69, v73
    v_add_f32 v70, v70, v74
    v_add_f32 v71, v71, v75
    v_cvt_pk_bf16_f32 v68, v68, v69
    v_cvt_pk_bf16_f32 v69, v70, v71
    v_and_b32 v68, -2, v68
    global_store_dwordx2 v7, v[68:69], s[54:55] sc1
    v_lshrrev_b32 v83, 1, v1
    ds_read_b128 v[28:31], v6 offset:0
    ds_read_b128 v[32:35], v6 offset:1024
    ds_read_b128 v[36:39], v6 offset:2048
    ds_read_b128 v[40:43], v6 offset:3072
    ds_read_b128 v[44:47], v6 offset:4096
    ds_read_b128 v[48:51], v6 offset:5120
    ds_read_b128 v[92:95], v6 offset:6144
    ds_read_b128 v[96:99], v6 offset:7168
    ds_read_b128 v[100:103], v6 offset:8192
    ds_read_b128 v[104:107], v6 offset:9216
    v_mov_b64 v[52:53], 0
    v_mov_b64 v[54:55], 0
    v_mov_b64 v[56:57], 0
    v_mov_b64 v[58:59], 0
    v_mov_b64 v[60:61], 0
    v_mov_b64 v[62:63], 0
    v_mov_b64 v[64:65], 0
    v_mov_b64 v[66:67], 0
    v_mov_b64 v[68:69], 0
    v_mov_b64 v[70:71], 0
    v_mov_b64 v[72:73], 0
    v_mov_b64 v[74:75], 0
    v_mov_b32 v108, v18
    v_mov_b32 v109, v18
    v_mov_b32 v110, v18
    v_mov_b32 v111, v18
    s_sleep 1
    global_load_dwordx2 v[84:85], v83, s[26:27] offset:0 sc1
    global_load_dwordx2 v[86:87], v83, s[26:27] offset:512 sc1
    global_load_dwordx2 v[88:89], v83, s[26:27] offset:1024 sc1
    global_load_dwordx2 v[90:91], v83, s[26:27] offset:1536 sc1
    s_mov_b32 s41, 2097152
L_pk_124:
    s_waitcnt vmcnt(0)
    v_or3_b32 v0, v84, v86, v88
    v_bitop3_b32 v0, v0, v90, 1 bitop3:0xa8
    v_cmp_ne_u32 vcc, 0, v0
    s_nop 4
    s_cbranch_vccz L_kg_125
    s_mov_b64 exec, vcc
    global_load_dwordx2 v[84:85], v83, s[26:27] offset:0 sc1
    global_load_dwordx2 v[86:87], v83, s[26:27] offset:512 sc1
    global_load_dwordx2 v[88:89], v83, s[26:27] offset:1024 sc1
    global_load_dwordx2 v[90:91], v83, s[26:27] offset:1536 sc1
    s_mov_b64 exec, -1
    s_sub_u32 s41, s41, 1
    s_cmp_eq_u32 s41, 0
    s_cbranch_scc1 L_end_101
    s_branch L_pk_124
L_kg_125:
    v_lshlrev_b32 v76, 16, v84
    v_and_b32 v77, 0xffff0000, v84
    v_lshlrev_b32 v78, 16, v85
    v_and_b32 v79, 0xffff0000, v85
    v_lshlrev_b32 v80, 16, v86
    v_and_b32 v81, 0xffff0000, v86
    v_lshlrev_b32 v82, 16, v87
    v_and_b32 v83, 0xffff0000, v87
    v_lshlrev_b32 v84, 16, v88
    v_and_b32 v85, 0xffff0000, v88
    v_lshlrev_b32 v86, 16, v89
    v_and_b32 v87, 0xffff0000, v89
    v_lshlrev_b32 v88, 16, v90
    v_and_b32 v89, 0xffff0000, v90
    v_lshlrev_b32 v90, 16, v91
    v_and_b32 v91, 0xffff0000, v91
    v_pk_add_f32 v[76:77], v[76:77], v[80:81]
    v_pk_add_f32 v[84:85], v[84:85], v[88:89]
    v_pk_add_f32 v[78:79], v[78:79], v[82:83]
    v_pk_add_f32 v[86:87], v[86:87], v[90:91]
    v_pk_add_f32 v[76:77], v[76:77], v[84:85]
    v_pk_add_f32 v[78:79], v[78:79], v[86:87]
    s_nop 1
    v_permlane32_swap_b32 v76, v78
    v_permlane32_swap_b32 v77, v79
    v_pk_add_f32 v[76:77], v[76:77], v[78:79]
    s_nop 1
    v_permlane16_swap_b32 v76, v77
    v_add_f32 v76, v76, v77
    s_nop 1
    v_add_f32_dpp v77, v76, v76 row_ror:8 row_mask:0xf bank_mask:0xf
    s_nop 1
    v_mov_b32_dpp v78, v77 quad_perm:[1,0,3,2] row_mask:0xf bank_mask:0xf
    v_cvt_pk_bf16_f32 v77, v77, v78
    v_min_u32 v77, -2, v77
    s_mov_b64 exec, s[42:43]
    global_store_dword v10, v77, s[22:23] sc1
    global_store_dword v10, v11, s[24:25] sc1
    s_mov_b64 exec, -1
    s_cmp_lg_u64 s[100:101], 0
    s_cbranch_scc1 L_p2_126
    s_mov_b32 s41, 2097152
L_fsp_127:
    global_load_dword v0, v16, s[34:35] sc1
    s_sub_u32 s41, s41, 1
    s_cmp_eq_u32 s41, 0
    s_cbranch_scc1 L_end_101
    s_waitcnt vmcnt(0)
    v_cmp_eq_u32 vcc, 0, v0
    s_nop 4
    s_cbranch_vccnz L_fsp_127
    s_add_u32 m0, s46, 16384
    s_nop 0
    global_load_lds_dwordx4 v1, s[30:31] offset:0 sc1
    global_load_lds_dwordx4 v1, s[30:31] offset:1024 sc1
    global_load_lds_dwordx4 v1, s[30:31] offset:2048 sc1
    global_load_lds_dwordx4 v1, s[30:31] offset:3072 sc1
L_p2_126:
    s_add_u32 s30, s30, 524288
    s_addc_u32 s31, s31, 0
    s_add_u32 s34, s34, 128
    s_addc_u32 s35, s35, 0
    ds_read_b128 v[76:79], v6 offset:10240
    ds_read_b128 v[80:83], v6 offset:11264
    ds_read_b128 v[84:87], v6 offset:12288
    ds_read_b128 v[88:91], v6 offset:13312
    s_sleep 2
    global_load_dwordx4 v[20:23], v12, s[22:23] offset:0 sc1
    global_load_dwordx4 v[24:27], v12, s[22:23] offset:1024 sc1
    s_add_u32 s8, s8, 2
    s_branch L_rstep_115
L_rexit_114:
    s_waitcnt vmcnt(0)
L_end_101:
    s_waitcnt vmcnt(0) lgkmcnt(0)
    s_endpgm
L_safe_x:
    s_sub_u32 s22, s6, 2
    s_lshr_b32 s26, s7, 2
    s_and_b32 s27, s7, 3
    s_mul_i32 s58, s26, 8320
    s_lshl_b32 s38, s27, 11
    s_add_u32 s58, s58, s38
    s_lshl_b32 s38, s9, 9
    s_add_u32 s58, s58, s38
    s_mov_b32 s44, 0x3e0293ee
    s_mov_b32 s45, 0x3e0293ee
    s_load_dwordx2 s[50:51], s[0:1], 0
    s_waitcnt lgkmcnt(0)
    s_load_dwordx2 s[12:13], s[0:1], 16
    s_load_dwordx2 s[14:15], s[0:1], 24
    s_load_dwordx2 s[16:17], s[0:1], 32
    s_load_dwordx2 s[18:19], s[0:1], 40
    v_lshrrev_b32 v1, 4, v0
    v_and_b32 v2, 15, v0
    v_lshlrev_b32 v3, 13, v1
    v_lshl_add_u32 v3, v2, 4, v3
    s_lshl_b32 s38, s7, 8
    v_add_u32 v3, s38, v3
    v_lshlrev_b32 v4, 10, v1
    v_lshl_add_u32 v4, v2, 4, v4
    s_lshr_b32 s38, s7, 2
    s_lshl_b32 s38, s38, 19
    s_and_b32 s39, s7, 3
    s_lshl_b32 s39, s39, 8
    s_add_u32 s38, s38, s39
    v_add_u32 v4, s38, v4
    v_and_b32 v5, 3, v1
    v_lshlrev_b32 v5, 5, v5
    v_bfe_u32 v6, v1, 3, 1
    v_lshlrev_b32 v6, 7, v6
    v_xor_b32 v5, v5, v6
    v_lshlrev_b32 v6, 4, v2
    v_xor_b32 v5, v5, v6
    v_lshl_add_u32 v5, v1, 8, v5
    v_add_u32 v5, 114688, v5
    v_and_b32 v6, 63, v0
    v_lshrrev_b32 v7, 4, v6
    v_bfe_u32 v8, v6, 2, 2
    v_and_b32 v9, 3, v6
    v_lshl_add_u32 v10, v7, 3, v8
    v_lshlrev_b32 v10, 8, v10
    v_add_u32 v10, 114688, v10
    v_lshlrev_b32 v8, 5, v8
    v_and_b32 v7, 1, v7
    v_lshlrev_b32 v7, 7, v7
    v_xor_b32 v8, v8, v7
    s_lshl_b32 s38, s9, 6
    v_lshlrev_b32 v12, 3, v9
    v_add_u32 v12, s38, v12
    v_xor_b32 v12, v12, v8
    v_add_u32 v6, v10, v12
    v_xor_b32 v12, 32, v12
    v_add_u32 v7, v10, v12
    v_lshlrev_b32 v12, 4, v9
    v_add_u32 v12, s38, v12
    v_xor_b32 v12, v12, v8
    v_add_u32 v13, v10, v12
    v_add_u32 v14, 8, v13
    v_and_b32 v8, 63, v0
    v_lshlrev_b32 v8, 4, v8
    s_mul_i32 s38, s9, 28672
    v_add_u32 v8, s38, v8
    s_waitcnt lgkmcnt(0)
    v_mov_b32 v11, v3
    global_load_dwordx4 v[16:19], v11, s[14:15]
    v_add_u32 v11, 131072, v3
    global_load_dwordx4 v[20:23], v11, s[14:15]
    v_add_u32 v11, 262144, v3
    global_load_dwordx4 v[24:27], v11, s[14:15]
    v_add_u32 v11, 393216, v3
    global_load_dwordx4 v[28:31], v11, s[14:15]
    v_add_u32 v11, 524288, v3
    global_load_dwordx4 v[32:35], v11, s[14:15]
    v_add_u32 v11, 655360, v3
    global_load_dwordx4 v[36:39], v11, s[14:15]
    v_add_u32 v11, 786432, v3
    global_load_dwordx4 v[40:43], v11, s[14:15]
    v_add_u32 v11, 917504, v3
    global_load_dwordx4 v[44:47], v11, s[14:15]
    v_add_u32 v11, 1048576, v3
    global_load_dwordx4 v[48:51], v11, s[14:15]
    v_add_u32 v11, 1179648, v3
    global_load_dwordx4 v[52:55], v11, s[14:15]
    v_add_u32 v11, 1310720, v3
    global_load_dwordx4 v[56:59], v11, s[14:15]
    v_add_u32 v11, 1441792, v3
    global_load_dwordx4 v[60:63], v11, s[14:15]
    v_add_u32 v11, 1572864, v3
    global_load_dwordx4 v[64:67], v11, s[14:15]
    v_add_u32 v11, 1703936, v3
    global_load_dwordx4 v[68:71], v11, s[14:15]
    v_add_u32 v11, 1835008, v3
    global_load_dwordx4 v[72:75], v11, s[14:15]
    v_add_u32 v11, 1966080, v3
    global_load_dwordx4 v[76:79], v11, s[14:15]
    v_add_u32 v11, 2097152, v3
    global_load_dwordx4 v[80:83], v11, s[14:15]
    v_add_u32 v11, 2228224, v3
    global_load_dwordx4 v[84:87], v11, s[14:15]
    v_add_u32 v11, 2359296, v3
    global_load_dwordx4 v[88:91], v11, s[14:15]
    v_add_u32 v11, 2490368, v3
    global_load_dwordx4 v[92:95], v11, s[14:15]
    v_mov_b32 v96, 0
    v_mov_b32 v97, 0
    v_mov_b32 v98, 0
    v_mov_b32 v99, 0
    s_mul_i32 s38, s7, 36864
    s_add_u32 s38, s38, 2097152
    v_lshlrev_b32 v100, 4, v0
    v_add_u32 v100, s38, v100
    global_store_dwordx4 v100, v[96:99], s[20:21] sc1
    v_add_u32 v100, 4096, v100
    global_store_dwordx4 v100, v[96:99], s[20:21] sc1
    v_add_u32 v100, 4096, v100
    global_store_dwordx4 v100, v[96:99], s[20:21] sc1
    v_add_u32 v100, 4096, v100
    global_store_dwordx4 v100, v[96:99], s[20:21] sc1
    v_add_u32 v100, 4096, v100
    global_store_dwordx4 v100, v[96:99], s[20:21] sc1
    v_add_u32 v100, 4096, v100
    global_store_dwordx4 v100, v[96:99], s[20:21] sc1
    v_add_u32 v100, 4096, v100
    global_store_dwordx4 v100, v[96:99], s[20:21] sc1
    v_add_u32 v100, 4096, v100
    global_store_dwordx4 v100, v[96:99], s[20:21] sc1
    v_add_u32 v100, 4096, v100
    global_store_dwordx4 v100, v[96:99], s[20:21] sc1
    v_add_u32 v100, 4096, v100
    s_lshl_b32 s38, s7, 4
    s_add_u32 s38, s38, 983040
    v_mov_b32 v101, s38
    global_store_dwordx4 v101, v[96:99], s[20:21] sc1
    s_waitcnt vmcnt(16)
    ds_write_b128 v5, v[16:19] offset:0
    ds_write_b128 v5, v[20:23] offset:4096
    ds_write_b128 v5, v[24:27] offset:8192
    ds_write_b128 v5, v[28:31] offset:12288
    s_waitcnt lgkmcnt(0)
    v_add_u32 v11, 2621440, v3
    global_load_dwordx4 v[16:19], v11, s[14:15]
    v_add_u32 v11, 2752512, v3
    global_load_dwordx4 v[20:23], v11, s[14:15]
    v_add_u32 v11, 2883584, v3
    global_load_dwordx4 v[24:27], v11, s[14:15]
    v_add_u32 v11, 3014656, v3
    global_load_dwordx4 v[28:31], v11, s[14:15]
    s_barrier
    ds_read_b64_tr_b16 v[240:241], v6 offset:0
    ds_read_b64_tr_b16 v[242:243], v6 offset:1024
    ds_read_b64_tr_b16 v[244:245], v6 offset:8192
    ds_read_b64_tr_b16 v[246:247], v6 offset:9216
    ds_read_b64_tr_b16 a[48:49], v7 offset:0
    ds_read_b64_tr_b16 a[50:51], v7 offset:1024
    ds_read_b64_tr_b16 a[52:53], v7 offset:8192
    ds_read_b64_tr_b16 a[54:55], v7 offset:9216
    s_waitcnt lgkmcnt(0)
    s_waitcnt vmcnt(16)
    ds_write_b128 v5, v[32:35] offset:16384
    ds_write_b128 v5, v[36:39] offset:20480
    ds_write_b128 v5, v[40:43] offset:24576
    ds_write_b128 v5, v[44:47] offset:28672
    s_waitcnt lgkmcnt(0)
    v_add_u32 v11, 3145728, v3
    global_load_dwordx4 v[32:35], v11, s[14:15]
    v_add_u32 v11, 3276800, v3
    global_load_dwordx4 v[36:39], v11, s[14:15]
    v_add_u32 v11, 3407872, v3
    global_load_dwordx4 v[40:43], v11, s[14:15]
    v_add_u32 v11, 3538944, v3
    global_load_dwordx4 v[44:47], v11, s[14:15]
    s_barrier
    ds_read_b64_tr_b16 v[248:249], v6 offset:16384
    ds_read_b64_tr_b16 v[250:251], v6 offset:17408
    ds_read_b64_tr_b16 v[252:253], v6 offset:24576
    ds_read_b64_tr_b16 v[254:255], v6 offset:25600
    ds_read_b64_tr_b16 a[56:57], v7 offset:16384
    ds_read_b64_tr_b16 a[58:59], v7 offset:17408
    ds_read_b64_tr_b16 a[60:61], v7 offset:24576
    ds_read_b64_tr_b16 a[62:63], v7 offset:25600
    s_waitcnt lgkmcnt(0)
    s_waitcnt vmcnt(16)
    ds_write_b128 v5, v[48:51] offset:0
    ds_write_b128 v5, v[52:55] offset:4096
    ds_write_b128 v5, v[56:59] offset:8192
    ds_write_b128 v5, v[60:63] offset:12288
    s_waitcnt lgkmcnt(0)
    v_add_u32 v11, 3670016, v3
    global_load_dwordx4 v[48:51], v11, s[14:15]
    v_add_u32 v11, 3801088, v3
    global_load_dwordx4 v[52:55], v11, s[14:15]
    v_add_u32 v11, 3932160, v3
    global_load_dwordx4 v[56:59], v11, s[14:15]
    v_add_u32 v11, 4063232, v3
    global_load_dwordx4 v[60:63], v11, s[14:15]
    s_barrier
    ds_read_b64_tr_b16 a[0:1], v6 offset:0
    ds_read_b64_tr_b16 a[2:3], v6 offset:1024
    ds_read_b64_tr_b16 a[4:5], v6 offset:8192
    ds_read_b64_tr_b16 a[6:7], v6 offset:9216
    ds_read_b64_tr_b16 a[64:65], v7 offset:0
    ds_read_b64_tr_b16 a[66:67], v7 offset:1024
    ds_read_b64_tr_b16 a[68:69], v7 offset:8192
    ds_read_b64_tr_b16 a[70:71], v7 offset:9216
    s_waitcnt lgkmcnt(0)
    s_waitcnt vmcnt(16)
    ds_write_b128 v5, v[64:67] offset:16384
    ds_write_b128 v5, v[68:71] offset:20480
    ds_write_b128 v5, v[72:75] offset:24576
    ds_write_b128 v5, v[76:79] offset:28672
    s_waitcnt lgkmcnt(0)
    v_mov_b32 v11, v3
    global_load_dwordx4 v[64:67], v11, s[16:17]
    v_add_u32 v11, 131072, v3
    global_load_dwordx4 v[68:71], v11, s[16:17]
    v_add_u32 v11, 262144, v3
    global_load_dwordx4 v[72:75], v11, s[16:17]
    v_add_u32 v11, 393216, v3
    global_load_dwordx4 v[76:79], v11, s[16:17]
    s_barrier
    ds_read_b64_tr_b16 a[8:9], v6 offset:16384
    ds_read_b64_tr_b16 a[10:11], v6 offset:17408
    ds_read_b64_tr_b16 a[12:13], v6 offset:24576
    ds_read_b64_tr_b16 a[14:15], v6 offset:25600
    ds_read_b64_tr_b16 a[72:73], v7 offset:16384
    ds_read_b64_tr_b16 a[74:75], v7 offset:17408
    ds_read_b64_tr_b16 a[76:77], v7 offset:24576
    ds_read_b64_tr_b16 a[78:79], v7 offset:25600
    s_waitcnt lgkmcnt(0)
    s_waitcnt vmcnt(16)
    ds_write_b128 v5, v[80:83] offset:0
    ds_write_b128 v5, v[84:87] offset:4096
    ds_write_b128 v5, v[88:91] offset:8192
    ds_write_b128 v5, v[92:95] offset:12288
    s_waitcnt lgkmcnt(0)
    v_add_u32 v11, 524288, v3
    global_load_dwordx4 v[80:83], v11, s[16:17]
    v_add_u32 v11, 655360, v3
    global_load_dwordx4 v[84:87], v11, s[16:17]
    v_add_u32 v11, 786432, v3
    global_load_dwordx4 v[88:91], v11, s[16:17]
    v_add_u32 v11, 917504, v3
    global_load_dwordx4 v[92:95], v11, s[16:17]
    s_barrier
    ds_read_b64_tr_b16 a[16:17], v6 offset:0
    ds_read_b64_tr_b16 a[18:19], v6 offset:1024
    ds_read_b64_tr_b16 a[20:21], v6 offset:8192
    ds_read_b64_tr_b16 a[22:23], v6 offset:9216
    ds_read_b64_tr_b16 a[80:81], v7 offset:0
    ds_read_b64_tr_b16 a[82:83], v7 offset:1024
    ds_read_b64_tr_b16 a[84:85], v7 offset:8192
    ds_read_b64_tr_b16 a[86:87], v7 offset:9216
    s_waitcnt lgkmcnt(0)
    s_waitcnt vmcnt(16)
    ds_write_b128 v5, v[16:19] offset:16384
    ds_write_b128 v5, v[20:23] offset:20480
    ds_write_b128 v5, v[24:27] offset:24576
    ds_write_b128 v5, v[28:31] offset:28672
    s_waitcnt lgkmcnt(0)
    v_add_u32 v11, 1048576, v3
    global_load_dwordx4 v[16:19], v11, s[16:17]
    v_add_u32 v11, 1179648, v3
    global_load_dwordx4 v[20:23], v11, s[16:17]
    v_add_u32 v11, 1310720, v3
    global_load_dwordx4 v[24:27], v11, s[16:17]
    v_add_u32 v11, 1441792, v3
    global_load_dwordx4 v[28:31], v11, s[16:17]
    s_barrier
    ds_read_b64_tr_b16 a[24:25], v6 offset:16384
    ds_read_b64_tr_b16 a[26:27], v6 offset:17408
    ds_read_b64_tr_b16 a[28:29], v6 offset:24576
    ds_read_b64_tr_b16 a[30:31], v6 offset:25600
    ds_read_b64_tr_b16 a[88:89], v7 offset:16384
    ds_read_b64_tr_b16 a[90:91], v7 offset:17408
    ds_read_b64_tr_b16 a[92:93], v7 offset:24576
    ds_read_b64_tr_b16 a[94:95], v7 offset:25600
    s_waitcnt lgkmcnt(0)
    s_lshl_b32 s38, s6, 2
    s_add_u32 s38, s38, 96
    s_cmp_lg_u32 s9, 0
    s_cbranch_scc1 L_arr_129
    v_mov_b32 v1, s38
    v_mov_b32 v2, 1
    s_mov_b64 exec, 1
    global_atomic_add v1, v2, s[10:11] sc1
    s_mov_b64 exec, -1
L_arr_129:
    s_waitcnt vmcnt(16)
    ds_write_b128 v5, v[32:35] offset:0
    ds_write_b128 v5, v[36:39] offset:4096
    ds_write_b128 v5, v[40:43] offset:8192
    ds_write_b128 v5, v[44:47] offset:12288
    s_waitcnt lgkmcnt(0)
    v_add_u32 v11, 1572864, v3
    global_load_dwordx4 v[32:35], v11, s[16:17]
    v_add_u32 v11, 1703936, v3
    global_load_dwordx4 v[36:39], v11, s[16:17]
    v_add_u32 v11, 1835008, v3
    global_load_dwordx4 v[40:43], v11, s[16:17]
    v_add_u32 v11, 1966080, v3
    global_load_dwordx4 v[44:47], v11, s[16:17]
    s_barrier
    ds_read_b64_tr_b16 a[32:33], v6 offset:0
    ds_read_b64_tr_b16 a[34:35], v6 offset:1024
    ds_read_b64_tr_b16 a[36:37], v6 offset:8192
    ds_read_b64_tr_b16 a[38:39], v6 offset:9216
    ds_read_b64_tr_b16 a[96:97], v7 offset:0
    ds_read_b64_tr_b16 a[98:99], v7 offset:1024
    ds_read_b64_tr_b16 a[100:101], v7 offset:8192
    ds_read_b64_tr_b16 a[102:103], v7 offset:9216
    s_waitcnt lgkmcnt(0)
    s_waitcnt vmcnt(16)
    ds_write_b128 v5, v[48:51] offset:16384
    ds_write_b128 v5, v[52:55] offset:20480
    ds_write_b128 v5, v[56:59] offset:24576
    ds_write_b128 v5, v[60:63] offset:28672
    s_waitcnt lgkmcnt(0)
    v_add_u32 v11, 2097152, v3
    global_load_dwordx4 v[48:51], v11, s[16:17]
    v_add_u32 v11, 2228224, v3
    global_load_dwordx4 v[52:55], v11, s[16:17]
    v_add_u32 v11, 2359296, v3
    global_load_dwordx4 v[56:59], v11, s[16:17]
    v_add_u32 v11, 2490368, v3
    global_load_dwordx4 v[60:63], v11, s[16:17]
    s_barrier
    ds_read_b64_tr_b16 a[40:41], v6 offset:16384
    ds_read_b64_tr_b16 a[42:43], v6 offset:17408
    ds_read_b64_tr_b16 a[44:45], v6 offset:24576
    ds_read_b64_tr_b16 a[46:47], v6 offset:25600
    ds_read_b64_tr_b16 a[104:105], v7 offset:16384
    ds_read_b64_tr_b16 a[106:107], v7 offset:17408
    ds_read_b64_tr_b16 a[108:109], v7 offset:24576
    ds_read_b64_tr_b16 a[110:111], v7 offset:25600
    s_waitcnt lgkmcnt(0)
    s_waitcnt vmcnt(16)
    ds_write_b128 v5, v[64:67] offset:0
    ds_write_b128 v5, v[68:71] offset:4096
    ds_write_b128 v5, v[72:75] offset:8192
    ds_write_b128 v5, v[76:79] offset:12288
    s_waitcnt lgkmcnt(0)
    v_add_u32 v11, 2621440, v3
    global_load_dwordx4 v[64:67], v11, s[16:17]
    v_add_u32 v11, 2752512, v3
    global_load_dwordx4 v[68:71], v11, s[16:17]
    v_add_u32 v11, 2883584, v3
    global_load_dwordx4 v[72:75], v11, s[16:17]
    v_add_u32 v11, 3014656, v3
    global_load_dwordx4 v[76:79], v11, s[16:17]
    s_barrier
    ds_read_b64_tr_b16 a[112:113], v6 offset:0
    ds_read_b64_tr_b16 a[114:115], v6 offset:1024
    ds_read_b64_tr_b16 a[116:117], v6 offset:8192
    ds_read_b64_tr_b16 a[118:119], v6 offset:9216
    ds_read_b64_tr_b16 a[176:177], v7 offset:0
    ds_read_b64_tr_b16 a[178:179], v7 offset:1024
    ds_read_b64_tr_b16 a[180:181], v7 offset:8192
    ds_read_b64_tr_b16 a[182:183], v7 offset:9216
    s_waitcnt lgkmcnt(0)
    s_waitcnt vmcnt(16)
    ds_write_b128 v5, v[80:83] offset:16384
    ds_write_b128 v5, v[84:87] offset:20480
    ds_write_b128 v5, v[88:91] offset:24576
    ds_write_b128 v5, v[92:95] offset:28672
    s_waitcnt lgkmcnt(0)
    v_add_u32 v11, 3145728, v3
    global_load_dwordx4 v[80:83], v11, s[16:17]
    v_add_u32 v11, 3276800, v3
    global_load_dwordx4 v[84:87], v11, s[16:17]
    v_add_u32 v11, 3407872, v3
    global_load_dwordx4 v[88:91], v11, s[16:17]
    v_add_u32 v11, 3538944, v3
    global_load_dwordx4 v[92:95], v11, s[16:17]
    s_barrier
    ds_read_b64_tr_b16 a[120:121], v6 offset:16384
    ds_read_b64_tr_b16 a[122:123], v6 offset:17408
    ds_read_b64_tr_b16 a[124:125], v6 offset:24576
    ds_read_b64_tr_b16 a[126:127], v6 offset:25600
    ds_read_b64_tr_b16 v[96:97], v7 offset:16384
    ds_read_b64_tr_b16 v[98:99], v7 offset:17408
    ds_read_b64_tr_b16 v[100:101], v7 offset:24576
    ds_read_b64_tr_b16 v[102:103], v7 offset:25600
    s_waitcnt lgkmcnt(0)
    ds_write_b128 v8, v[96:99] offset:0
    ds_write_b128 v8, v[100:103] offset:1024
    s_waitcnt lgkmcnt(0)
    s_waitcnt vmcnt(16)
    ds_write_b128 v5, v[16:19] offset:0
    ds_write_b128 v5, v[20:23] offset:4096
    ds_write_b128 v5, v[24:27] offset:8192
    ds_write_b128 v5, v[28:31] offset:12288
    s_waitcnt lgkmcnt(0)
    v_add_u32 v11, 3670016, v3
    global_load_dwordx4 v[16:19], v11, s[16:17]
    v_add_u32 v11, 3801088, v3
    global_load_dwordx4 v[20:23], v11, s[16:17]
    v_add_u32 v11, 3932160, v3
    global_load_dwordx4 v[24:27], v11, s[16:17]
    v_add_u32 v11, 4063232, v3
    global_load_dwordx4 v[28:31], v11, s[16:17]
    s_barrier
    ds_read_b64_tr_b16 a[128:129], v6 offset:0
    ds_read_b64_tr_b16 a[130:131], v6 offset:1024
    ds_read_b64_tr_b16 a[132:133], v6 offset:8192
    ds_read_b64_tr_b16 a[134:135], v6 offset:9216
    ds_read_b64_tr_b16 v[96:97], v7 offset:0
    ds_read_b64_tr_b16 v[98:99], v7 offset:1024
    ds_read_b64_tr_b16 v[100:101], v7 offset:8192
    ds_read_b64_tr_b16 v[102:103], v7 offset:9216
    s_waitcnt lgkmcnt(0)
    ds_write_b128 v8, v[96:99] offset:2048
    ds_write_b128 v8, v[100:103] offset:3072
    s_waitcnt lgkmcnt(0)
    s_waitcnt vmcnt(16)
    ds_write_b128 v5, v[32:35] offset:16384
    ds_write_b128 v5, v[36:39] offset:20480
    ds_write_b128 v5, v[40:43] offset:24576
    ds_write_b128 v5, v[44:47] offset:28672
    s_waitcnt lgkmcnt(0)
    v_mov_b32 v11, v3
    global_load_dwordx4 v[32:35], v11, s[12:13]
    v_add_u32 v11, 131072, v3
    global_load_dwordx4 v[36:39], v11, s[12:13]
    v_add_u32 v11, 262144, v3
    global_load_dwordx4 v[40:43], v11, s[12:13]
    v_add_u32 v11, 393216, v3
    global_load_dwordx4 v[44:47], v11, s[12:13]
    s_barrier
    ds_read_b64_tr_b16 a[136:137], v6 offset:16384
    ds_read_b64_tr_b16 a[138:139], v6 offset:17408
    ds_read_b64_tr_b16 a[140:141], v6 offset:24576
    ds_read_b64_tr_b16 a[142:143], v6 offset:25600
    ds_read_b64_tr_b16 v[96:97], v7 offset:16384
    ds_read_b64_tr_b16 v[98:99], v7 offset:17408
    ds_read_b64_tr_b16 v[100:101], v7 offset:24576
    ds_read_b64_tr_b16 v[102:103], v7 offset:25600
    s_waitcnt lgkmcnt(0)
    ds_write_b128 v8, v[96:99] offset:4096
    ds_write_b128 v8, v[100:103] offset:5120
    s_waitcnt lgkmcnt(0)
    s_waitcnt vmcnt(16)
    ds_write_b128 v5, v[48:51] offset:0
    ds_write_b128 v5, v[52:55] offset:4096
    ds_write_b128 v5, v[56:59] offset:8192
    ds_write_b128 v5, v[60:63] offset:12288
    s_waitcnt lgkmcnt(0)
    v_add_u32 v11, 524288, v3
    global_load_dwordx4 v[48:51], v11, s[12:13]
    v_add_u32 v11, 655360, v3
    global_load_dwordx4 v[52:55], v11, s[12:13]
    v_add_u32 v11, 786432, v3
    global_load_dwordx4 v[56:59], v11, s[12:13]
    v_add_u32 v11, 917504, v3
    global_load_dwordx4 v[60:63], v11, s[12:13]
    s_barrier
    ds_read_b64_tr_b16 a[144:145], v6 offset:0
    ds_read_b64_tr_b16 a[146:147], v6 offset:1024
    ds_read_b64_tr_b16 a[148:149], v6 offset:8192
    ds_read_b64_tr_b16 a[150:151], v6 offset:9216
    ds_read_b64_tr_b16 v[96:97], v7 offset:0
    ds_read_b64_tr_b16 v[98:99], v7 offset:1024
    ds_read_b64_tr_b16 v[100:101], v7 offset:8192
    ds_read_b64_tr_b16 v[102:103], v7 offset:9216
    s_waitcnt lgkmcnt(0)
    ds_write_b128 v8, v[96:99] offset:6144
    ds_write_b128 v8, v[100:103] offset:7168
    s_waitcnt lgkmcnt(0)
    s_cmp_lg_u32 s9, 0
    s_cbranch_scc1 L_rd_130
    v_lshlrev_b32 v1, 2, v0
    v_mov_b32 v2, 0
    global_atomic_add v104, v1, v2, s[10:11] sc0 sc1
    s_nop 0
L_rd_130:
    s_waitcnt vmcnt(16)
    ds_write_b128 v5, v[64:67] offset:16384
    ds_write_b128 v5, v[68:71] offset:20480
    ds_write_b128 v5, v[72:75] offset:24576
    ds_write_b128 v5, v[76:79] offset:28672
    s_waitcnt lgkmcnt(0)
    v_add_u32 v11, 1048576, v3
    global_load_dwordx4 v[64:67], v11, s[12:13]
    v_add_u32 v11, 1179648, v3
    global_load_dwordx4 v[68:71], v11, s[12:13]
    v_add_u32 v11, 1310720, v3
    global_load_dwordx4 v[72:75], v11, s[12:13]
    v_add_u32 v11, 1441792, v3
    global_load_dwordx4 v[76:79], v11, s[12:13]
    s_barrier
    ds_read_b64_tr_b16 a[152:153], v6 offset:16384
    ds_read_b64_tr_b16 a[154:155], v6 offset:17408
    ds_read_b64_tr_b16 a[156:157], v6 offset:24576
    ds_read_b64_tr_b16 a[158:159], v6 offset:25600
    ds_read_b64_tr_b16 v[96:97], v7 offset:16384
    ds_read_b64_tr_b16 v[98:99], v7 offset:17408
    ds_read_b64_tr_b16 v[100:101], v7 offset:24576
    ds_read_b64_tr_b16 v[102:103], v7 offset:25600
    s_waitcnt lgkmcnt(0)
    ds_write_b128 v8, v[96:99] offset:8192
    ds_write_b128 v8, v[100:103] offset:9216
    s_waitcnt lgkmcnt(0)
    s_waitcnt vmcnt(16)
    ds_write_b128 v5, v[80:83] offset:0
    ds_write_b128 v5, v[84:87] offset:4096
    ds_write_b128 v5, v[88:91] offset:8192
    ds_write_b128 v5, v[92:95] offset:12288
    s_waitcnt lgkmcnt(0)
    v_add_u32 v11, 1572864, v3
    global_load_dwordx4 v[80:83], v11, s[12:13]
    v_add_u32 v11, 1703936, v3
    global_load_dwordx4 v[84:87], v11, s[12:13]
    v_add_u32 v11, 1835008, v3
    global_load_dwordx4 v[88:91], v11, s[12:13]
    v_add_u32 v11, 1966080, v3
    global_load_dwordx4 v[92:95], v11, s[12:13]
    s_barrier
    ds_read_b64_tr_b16 a[160:161], v6 offset:0
    ds_read_b64_tr_b16 a[162:163], v6 offset:1024
    ds_read_b64_tr_b16 a[164:165], v6 offset:8192
    ds_read_b64_tr_b16 a[166:167], v6 offset:9216
    ds_read_b64_tr_b16 v[96:97], v7 offset:0
    ds_read_b64_tr_b16 v[98:99], v7 offset:1024
    ds_read_b64_tr_b16 v[100:101], v7 offset:8192
    ds_read_b64_tr_b16 v[102:103], v7 offset:9216
    s_waitcnt lgkmcnt(0)
    ds_write_b128 v8, v[96:99] offset:10240
    ds_write_b128 v8, v[100:103] offset:11264
    s_waitcnt lgkmcnt(0)
    s_waitcnt vmcnt(16)
    ds_write_b128 v5, v[16:19] offset:16384
    ds_write_b128 v5, v[20:23] offset:20480
    ds_write_b128 v5, v[24:27] offset:24576
    ds_write_b128 v5, v[28:31] offset:28672
    s_waitcnt lgkmcnt(0)
    v_add_u32 v11, 2097152, v3
    global_load_dwordx4 v[16:19], v11, s[12:13]
    v_add_u32 v11, 2228224, v3
    global_load_dwordx4 v[20:23], v11, s[12:13]
    v_add_u32 v11, 2359296, v3
    global_load_dwordx4 v[24:27], v11, s[12:13]
    v_add_u32 v11, 2490368, v3
    global_load_dwordx4 v[28:31], v11, s[12:13]
    s_barrier
    ds_read_b64_tr_b16 a[168:169], v6 offset:16384
    ds_read_b64_tr_b16 a[170:171], v6 offset:17408
    ds_read_b64_tr_b16 a[172:173], v6 offset:24576
    ds_read_b64_tr_b16 a[174:175], v6 offset:25600
    ds_read_b64_tr_b16 v[96:97], v7 offset:16384
    ds_read_b64_tr_b16 v[98:99], v7 offset:17408
    ds_read_b64_tr_b16 v[100:101], v7 offset:24576
    ds_read_b64_tr_b16 v[102:103], v7 offset:25600
    s_waitcnt lgkmcnt(0)
    ds_write_b128 v8, v[96:99] offset:12288
    ds_write_b128 v8, v[100:103] offset:13312
    s_waitcnt lgkmcnt(0)
    s_waitcnt vmcnt(16)
    ds_write_b128 v5, v[32:35] offset:0
    ds_write_b128 v5, v[36:39] offset:4096
    ds_write_b128 v5, v[40:43] offset:8192
    ds_write_b128 v5, v[44:47] offset:12288
    s_waitcnt lgkmcnt(0)
    v_add_u32 v11, 2621440, v3
    global_load_dwordx4 v[32:35], v11, s[12:13]
    v_add_u32 v11, 2752512, v3
    global_load_dwordx4 v[36:39], v11, s[12:13]
    v_add_u32 v11, 2883584, v3
    global_load_dwordx4 v[40:43], v11, s[12:13]
    v_add_u32 v11, 3014656, v3
    global_load_dwordx4 v[44:47], v11, s[12:13]
    s_barrier
    ds_read_b64_tr_b16 v[112:113], v6 offset:0
    ds_read_b64_tr_b16 v[114:115], v6 offset:1024
    ds_read_b64_tr_b16 v[116:117], v6 offset:8192
    ds_read_b64_tr_b16 v[118:119], v6 offset:9216
    ds_read_b64_tr_b16 v[176:177], v7 offset:0
    ds_read_b64_tr_b16 v[178:179], v7 offset:1024
    ds_read_b64_tr_b16 v[180:181], v7 offset:8192
    ds_read_b64_tr_b16 v[182:183], v7 offset:9216
    s_waitcnt lgkmcnt(0)
    s_waitcnt vmcnt(16)
    ds_write_b128 v5, v[48:51] offset:16384
    ds_write_b128 v5, v[52:55] offset:20480
    ds_write_b128 v5, v[56:59] offset:24576
    ds_write_b128 v5, v[60:63] offset:28672
    s_waitcnt lgkmcnt(0)
    v_add_u32 v11, 3145728, v3
    global_load_dwordx4 v[48:51], v11, s[12:13]
    v_add_u32 v11, 3276800, v3
    global_load_dwordx4 v[52:55], v11, s[12:13]
    v_add_u32 v11, 3407872, v3
    global_load_dwordx4 v[56:59], v11, s[12:13]
    v_add_u32 v11, 3538944, v3
    global_load_dwordx4 v[60:63], v11, s[12:13]
    s_barrier
    ds_read_b64_tr_b16 v[120:121], v6 offset:16384
    ds_read_b64_tr_b16 v[122:123], v6 offset:17408
    ds_read_b64_tr_b16 v[124:125], v6 offset:24576
    ds_read_b64_tr_b16 v[126:127], v6 offset:25600
    ds_read_b64_tr_b16 v[184:185], v7 offset:16384
    ds_read_b64_tr_b16 v[186:187], v7 offset:17408
    ds_read_b64_tr_b16 v[188:189], v7 offset:24576
    ds_read_b64_tr_b16 v[190:191], v7 offset:25600
    s_waitcnt lgkmcnt(0)
    s_waitcnt vmcnt(16)
    ds_write_b128 v5, v[64:67] offset:0
    ds_write_b128 v5, v[68:71] offset:4096
    ds_write_b128 v5, v[72:75] offset:8192
    ds_write_b128 v5, v[76:79] offset:12288
    s_waitcnt lgkmcnt(0)
    v_add_u32 v11, 3670016, v3
    global_load_dwordx4 v[64:67], v11, s[12:13]
    v_add_u32 v11, 3801088, v3
    global_load_dwordx4 v[68:71], v11, s[12:13]
    v_add_u32 v11, 3932160, v3
    global_load_dwordx4 v[72:75], v11, s[12:13]
    v_add_u32 v11, 4063232, v3
    global_load_dwordx4 v[76:79], v11, s[12:13]
    s_barrier
    ds_read_b64_tr_b16 v[128:129], v6 offset:0
    ds_read_b64_tr_b16 v[130:131], v6 offset:1024
    ds_read_b64_tr_b16 v[132:133], v6 offset:8192
    ds_read_b64_tr_b16 v[134:135], v6 offset:9216
    ds_read_b64_tr_b16 v[192:193], v7 offset:0
    ds_read_b64_tr_b16 v[194:195], v7 offset:1024
    ds_read_b64_tr_b16 v[196:197], v7 offset:8192
    ds_read_b64_tr_b16 v[198:199], v7 offset:9216
    s_waitcnt lgkmcnt(0)
    s_waitcnt vmcnt(16)
    ds_write_b128 v5, v[80:83] offset:16384
    ds_write_b128 v5, v[84:87] offset:20480
    ds_write_b128 v5, v[88:91] offset:24576
    ds_write_b128 v5, v[92:95] offset:28672
    s_waitcnt lgkmcnt(0)
    v_mov_b32 v11, v4
    global_load_dwordx4 v[80:83], v11, s[18:19]
    v_add_u32 v11, 16384, v4
    global_load_dwordx4 v[84:87], v11, s[18:19]
    v_add_u32 v11, 32768, v4
    global_load_dwordx4 v[88:91], v11, s[18:19]
    v_add_u32 v11, 49152, v4
    global_load_dwordx4 v[92:95], v11, s[18:19]
    s_barrier
    ds_read_b64_tr_b16 v[136:137], v6 offset:16384
    ds_read_b64_tr_b16 v[138:139], v6 offset:17408
    ds_read_b64_tr_b16 v[140:141], v6 offset:24576
    ds_read_b64_tr_b16 v[142:143], v6 offset:25600
    ds_read_b64_tr_b16 v[200:201], v7 offset:16384
    ds_read_b64_tr_b16 v[202:203], v7 offset:17408
    ds_read_b64_tr_b16 v[204:205], v7 offset:24576
    ds_read_b64_tr_b16 v[206:207], v7 offset:25600
    s_waitcnt lgkmcnt(0)
    s_waitcnt vmcnt(16)
    ds_write_b128 v5, v[16:19] offset:0
    ds_write_b128 v5, v[20:23] offset:4096
    ds_write_b128 v5, v[24:27] offset:8192
    ds_write_b128 v5, v[28:31] offset:12288
    s_waitcnt lgkmcnt(0)
    v_add_u32 v11, 65536, v4
    global_load_dwordx4 v[16:19], v11, s[18:19]
    v_add_u32 v11, 81920, v4
    global_load_dwordx4 v[20:23], v11, s[18:19]
    v_add_u32 v11, 98304, v4
    global_load_dwordx4 v[24:27], v11, s[18:19]
    v_add_u32 v11, 114688, v4
    global_load_dwordx4 v[28:31], v11, s[18:19]
    s_barrier
    ds_read_b64_tr_b16 v[144:145], v6 offset:0
    ds_read_b64_tr_b16 v[146:147], v6 offset:1024
    ds_read_b64_tr_b16 v[148:149], v6 offset:8192
    ds_read_b64_tr_b16 v[150:151], v6 offset:9216
    ds_read_b64_tr_b16 v[208:209], v7 offset:0
    ds_read_b64_tr_b16 v[210:211], v7 offset:1024
    ds_read_b64_tr_b16 v[212:213], v7 offset:8192
    ds_read_b64_tr_b16 v[214:215], v7 offset:9216
    s_waitcnt lgkmcnt(0)
    s_waitcnt vmcnt(16)
    ds_write_b128 v5, v[32:35] offset:16384
    ds_write_b128 v5, v[36:39] offset:20480
    ds_write_b128 v5, v[40:43] offset:24576
    ds_write_b128 v5, v[44:47] offset:28672
    s_waitcnt lgkmcnt(0)
    v_add_u32 v11, 131072, v4
    global_load_dwordx4 v[32:35], v11, s[18:19]
    v_add_u32 v11, 147456, v4
    global_load_dwordx4 v[36:39], v11, s[18:19]
    v_add_u32 v11, 163840, v4
    global_load_dwordx4 v[40:43], v11, s[18:19]
    v_add_u32 v11, 180224, v4
    global_load_dwordx4 v[44:47], v11, s[18:19]
    s_barrier
    ds_read_b64_tr_b16 v[152:153], v6 offset:16384
    ds_read_b64_tr_b16 v[154:155], v6 offset:17408
    ds_read_b64_tr_b16 v[156:157], v6 offset:24576
    ds_read_b64_tr_b16 v[158:159], v6 offset:25600
    ds_read_b64_tr_b16 v[216:217], v7 offset:16384
    ds_read_b64_tr_b16 v[218:219], v7 offset:17408
    ds_read_b64_tr_b16 v[220:221], v7 offset:24576
    ds_read_b64_tr_b16 v[222:223], v7 offset:25600
    s_waitcnt lgkmcnt(0)
    s_waitcnt vmcnt(16)
    ds_write_b128 v5, v[48:51] offset:0
    ds_write_b128 v5, v[52:55] offset:4096
    ds_write_b128 v5, v[56:59] offset:8192
    ds_write_b128 v5, v[60:63] offset:12288
    s_waitcnt lgkmcnt(0)
    v_add_u32 v11, 196608, v4
    global_load_dwordx4 v[48:51], v11, s[18:19]
    v_add_u32 v11, 212992, v4
    global_load_dwordx4 v[52:55], v11, s[18:19]
    v_add_u32 v11, 229376, v4
    global_load_dwordx4 v[56:59], v11, s[18:19]
    v_add_u32 v11, 245760, v4
    global_load_dwordx4 v[60:63], v11, s[18:19]
    s_barrier
    ds_read_b64_tr_b16 v[160:161], v6 offset:0
    ds_read_b64_tr_b16 v[162:163], v6 offset:1024
    ds_read_b64_tr_b16 v[164:165], v6 offset:8192
    ds_read_b64_tr_b16 v[166:167], v6 offset:9216
    ds_read_b64_tr_b16 v[224:225], v7 offset:0
    ds_read_b64_tr_b16 v[226:227], v7 offset:1024
    ds_read_b64_tr_b16 v[228:229], v7 offset:8192
    ds_read_b64_tr_b16 v[230:231], v7 offset:9216
    s_waitcnt lgkmcnt(0)
    s_waitcnt vmcnt(16)
    ds_write_b128 v5, v[64:67] offset:16384
    ds_write_b128 v5, v[68:71] offset:20480
    ds_write_b128 v5, v[72:75] offset:24576
    ds_write_b128 v5, v[76:79] offset:28672
    s_waitcnt lgkmcnt(0)
    v_add_u32 v11, 262144, v4
    global_load_dwordx4 v[64:67], v11, s[18:19]
    v_add_u32 v11, 278528, v4
    global_load_dwordx4 v[68:71], v11, s[18:19]
    v_add_u32 v11, 294912, v4
    global_load_dwordx4 v[72:75], v11, s[18:19]
    v_add_u32 v11, 311296, v4
    global_load_dwordx4 v[76:79], v11, s[18:19]
    s_barrier
    ds_read_b64_tr_b16 v[168:169], v6 offset:16384
    ds_read_b64_tr_b16 v[170:171], v6 offset:17408
    ds_read_b64_tr_b16 v[172:173], v6 offset:24576
    ds_read_b64_tr_b16 v[174:175], v6 offset:25600
    ds_read_b64_tr_b16 v[232:233], v7 offset:16384
    ds_read_b64_tr_b16 v[234:235], v7 offset:17408
    ds_read_b64_tr_b16 v[236:237], v7 offset:24576
    ds_read_b64_tr_b16 v[238:239], v7 offset:25600
    s_waitcnt lgkmcnt(0)
    s_waitcnt vmcnt(16)
    ds_write_b128 v5, v[80:83] offset:0
    ds_write_b128 v5, v[84:87] offset:4096
    ds_write_b128 v5, v[88:91] offset:8192
    ds_write_b128 v5, v[92:95] offset:12288
    s_waitcnt lgkmcnt(0)
    v_add_u32 v11, 327680, v4
    global_load_dwordx4 v[80:83], v11, s[18:19]
    v_add_u32 v11, 344064, v4
    global_load_dwordx4 v[84:87], v11, s[18:19]
    v_add_u32 v11, 360448, v4
    global_load_dwordx4 v[88:91], v11, s[18:19]
    v_add_u32 v11, 376832, v4
    global_load_dwordx4 v[92:95], v11, s[18:19]
    s_barrier
    ds_read_b64_tr_b16 a[184:185], v13 offset:0
    ds_read_b64_tr_b16 a[186:187], v13 offset:1024
    ds_read_b64_tr_b16 a[188:189], v13 offset:8192
    ds_read_b64_tr_b16 a[190:191], v13 offset:9216
    ds_read_b64_tr_b16 a[248:249], v14 offset:0
    ds_read_b64_tr_b16 a[250:251], v14 offset:1024
    ds_read_b64_tr_b16 a[252:253], v14 offset:8192
    ds_read_b64_tr_b16 a[254:255], v14 offset:9216
    s_waitcnt lgkmcnt(0)
    s_cmp_lg_u32 s9, 0
    s_cbranch_scc1 L_rd_131
    v_lshlrev_b32 v1, 2, v0
    v_mov_b32 v2, 0
    global_atomic_add v105, v1, v2, s[10:11] sc0 sc1
    s_nop 0
L_rd_131:
    s_waitcnt vmcnt(16)
    ds_write_b128 v5, v[16:19] offset:16384
    ds_write_b128 v5, v[20:23] offset:20480
    ds_write_b128 v5, v[24:27] offset:24576
    ds_write_b128 v5, v[28:31] offset:28672
    s_waitcnt lgkmcnt(0)
    v_add_u32 v11, 393216, v4
    global_load_dwordx4 v[16:19], v11, s[18:19]
    v_add_u32 v11, 409600, v4
    global_load_dwordx4 v[20:23], v11, s[18:19]
    v_add_u32 v11, 425984, v4
    global_load_dwordx4 v[24:27], v11, s[18:19]
    v_add_u32 v11, 442368, v4
    global_load_dwordx4 v[28:31], v11, s[18:19]
    s_barrier
    ds_read_b64_tr_b16 a[192:193], v13 offset:16384
    ds_read_b64_tr_b16 a[194:195], v13 offset:17408
    ds_read_b64_tr_b16 a[196:197], v13 offset:24576
    ds_read_b64_tr_b16 a[198:199], v13 offset:25600
    ds_read_b64_tr_b16 v[96:97], v14 offset:16384
    ds_read_b64_tr_b16 v[98:99], v14 offset:17408
    ds_read_b64_tr_b16 v[100:101], v14 offset:24576
    ds_read_b64_tr_b16 v[102:103], v14 offset:25600
    s_waitcnt lgkmcnt(0)
    ds_write_b128 v8, v[96:99] offset:14336
    ds_write_b128 v8, v[100:103] offset:15360
    s_waitcnt lgkmcnt(0)
    s_waitcnt vmcnt(16)
    ds_write_b128 v5, v[32:35] offset:0
    ds_write_b128 v5, v[36:39] offset:4096
    ds_write_b128 v5, v[40:43] offset:8192
    ds_write_b128 v5, v[44:47] offset:12288
    s_waitcnt lgkmcnt(0)
    v_add_u32 v11, 458752, v4
    global_load_dwordx4 v[32:35], v11, s[18:19]
    v_add_u32 v11, 475136, v4
    global_load_dwordx4 v[36:39], v11, s[18:19]
    v_add_u32 v11, 491520, v4
    global_load_dwordx4 v[40:43], v11, s[18:19]
    v_add_u32 v11, 507904, v4
    global_load_dwordx4 v[44:47], v11, s[18:19]
    s_barrier
    ds_read_b64_tr_b16 a[200:201], v13 offset:0
    ds_read_b64_tr_b16 a[202:203], v13 offset:1024
    ds_read_b64_tr_b16 a[204:205], v13 offset:8192
    ds_read_b64_tr_b16 a[206:207], v13 offset:9216
    ds_read_b64_tr_b16 v[96:97], v14 offset:0
    ds_read_b64_tr_b16 v[98:99], v14 offset:1024
    ds_read_b64_tr_b16 v[100:101], v14 offset:8192
    ds_read_b64_tr_b16 v[102:103], v14 offset:9216
    s_waitcnt lgkmcnt(0)
    ds_write_b128 v8, v[96:99] offset:16384
    ds_write_b128 v8, v[100:103] offset:17408
    s_waitcnt lgkmcnt(0)
    s_waitcnt vmcnt(16)
    ds_write_b128 v5, v[48:51] offset:16384
    ds_write_b128 v5, v[52:55] offset:20480
    ds_write_b128 v5, v[56:59] offset:24576
    ds_write_b128 v5, v[60:63] offset:28672
    s_waitcnt lgkmcnt(0)
    s_barrier
    ds_read_b64_tr_b16 a[208:209], v13 offset:16384
    ds_read_b64_tr_b16 a[210:211], v13 offset:17408
    ds_read_b64_tr_b16 a[212:213], v13 offset:24576
    ds_read_b64_tr_b16 a[214:215], v13 offset:25600
    ds_read_b64_tr_b16 v[96:97], v14 offset:16384
    ds_read_b64_tr_b16 v[98:99], v14 offset:17408
    ds_read_b64_tr_b16 v[100:101], v14 offset:24576
    ds_read_b64_tr_b16 v[102:103], v14 offset:25600
    s_waitcnt lgkmcnt(0)
    ds_write_b128 v8, v[96:99] offset:18432
    ds_write_b128 v8, v[100:103] offset:19456
    s_waitcnt lgkmcnt(0)
    s_waitcnt vmcnt(12)
    ds_write_b128 v5, v[64:67] offset:0
    ds_write_b128 v5, v[68:71] offset:4096
    ds_write_b128 v5, v[72:75] offset:8192
    ds_write_b128 v5, v[76:79] offset:12288
    s_waitcnt lgkmcnt(0)
    s_barrier
    ds_read_b64_tr_b16 a[216:217], v13 offset:0
    ds_read_b64_tr_b16 a[218:219], v13 offset:1024
    ds_read_b64_tr_b16 a[220:221], v13 offset:8192
    ds_read_b64_tr_b16 a[222:223], v13 offset:9216
    ds_read_b64_tr_b16 v[96:97], v14 offset:0
    ds_read_b64_tr_b16 v[98:99], v14 offset:1024
    ds_read_b64_tr_b16 v[100:101], v14 offset:8192
    ds_read_b64_tr_b16 v[102:103], v14 offset:9216
    s_waitcnt lgkmcnt(0)
    ds_write_b128 v8, v[96:99] offset:20480
    ds_write_b128 v8, v[100:103] offset:21504
    s_waitcnt lgkmcnt(0)
    s_waitcnt vmcnt(8)
    ds_write_b128 v5, v[80:83] offset:16384
    ds_write_b128 v5, v[84:87] offset:20480
    ds_write_b128 v5, v[88:91] offset:24576
    ds_write_b128 v5, v[92:95] offset:28672
    s_waitcnt lgkmcnt(0)
    s_barrier
    ds_read_b64_tr_b16 a[224:225], v13 offset:16384
    ds_read_b64_tr_b16 a[226:227], v13 offset:17408
    ds_read_b64_tr_b16 a[228:229], v13 offset:24576
    ds_read_b64_tr_b16 a[230:231], v13 offset:25600
    ds_read_b64_tr_b16 v[96:97], v14 offset:16384
    ds_read_b64_tr_b16 v[98:99], v14 offset:17408
    ds_read_b64_tr_b16 v[100:101], v14 offset:24576
    ds_read_b64_tr_b16 v[102:103], v14 offset:25600
    s_waitcnt lgkmcnt(0)
    ds_write_b128 v8, v[96:99] offset:22528
    ds_write_b128 v8, v[100:103] offset:23552
    s_waitcnt lgkmcnt(0)
    s_waitcnt vmcnt(4)
    ds_write_b128 v5, v[16:19] offset:0
    ds_write_b128 v5, v[20:23] offset:4096
    ds_write_b128 v5, v[24:27] offset:8192
    ds_write_b128 v5, v[28:31] offset:12288
    s_waitcnt lgkmcnt(0)
    s_barrier
    ds_read_b64_tr_b16 a[232:233], v13 offset:0
    ds_read_b64_tr_b16 a[234:235], v13 offset:1024
    ds_read_b64_tr_b16 a[236:237], v13 offset:8192
    ds_read_b64_tr_b16 a[238:239], v13 offset:9216
    ds_read_b64_tr_b16 v[96:97], v14 offset:0
    ds_read_b64_tr_b16 v[98:99], v14 offset:1024
    ds_read_b64_tr_b16 v[100:101], v14 offset:8192
    ds_read_b64_tr_b16 v[102:103], v14 offset:9216
    s_waitcnt lgkmcnt(0)
    ds_write_b128 v8, v[96:99] offset:24576
    ds_write_b128 v8, v[100:103] offset:25600
    s_waitcnt lgkmcnt(0)
    s_waitcnt vmcnt(0)
    ds_write_b128 v5, v[32:35] offset:16384
    ds_write_b128 v5, v[36:39] offset:20480
    ds_write_b128 v5, v[40:43] offset:24576
    ds_write_b128 v5, v[44:47] offset:28672
    s_waitcnt lgkmcnt(0)
    s_barrier
    ds_read_b64_tr_b16 a[240:241], v13 offset:16384
    ds_read_b64_tr_b16 a[242:243], v13 offset:17408
    ds_read_b64_tr_b16 a[244:245], v13 offset:24576
    ds_read_b64_tr_b16 a[246:247], v13 offset:25600
    ds_read_b64_tr_b16 v[96:97], v14 offset:16384
    ds_read_b64_tr_b16 v[98:99], v14 offset:17408
    ds_read_b64_tr_b16 v[100:101], v14 offset:24576
    ds_read_b64_tr_b16 v[102:103], v14 offset:25600
    s_waitcnt lgkmcnt(0)
    ds_write_b128 v8, v[96:99] offset:26624
    ds_write_b128 v8, v[100:103] offset:27648
    s_waitcnt lgkmcnt(0)
    s_cmp_lg_u32 s9, 0
    s_cbranch_scc1 L_ev_132
    s_waitcnt vmcnt(0)
    v_readlane_b32 s38, v104, 8
    v_cmp_eq_u32 vcc, 32, v105
    s_add_u32 s39, s6, 24
    s_lshl_b64 s[12:13], 1, s39
    s_or_b32 s12, s12, 0
    s_or_b32 s13, s13, 2
    v_mov_b32 v1, 161792
    s_nop 1
    s_andn2_b64 s[12:13], s[12:13], vcc
    s_cselect_b32 s39, 1, 0
    v_mov_b32 v2, s39
    ds_write_b32 v1, v2
    s_waitcnt lgkmcnt(0)
L_ev_132:
    s_barrier
    v_mov_b32 v16, 161792
    ds_read_b32 v17, v16
    s_waitcnt lgkmcnt(0)
    v_readfirstlane_b32 s38, v17
    s_barrier
    s_cmp_eq_u32 s38, 0
    s_nop 2
    s_cbranch_scc1 L_go_133
    s_lshl_b32 s39, s6, 2
    s_add_u32 s39, s39, 96
    v_mov_b32 v17, s39
    s_mov_b32 s41, 2097152
    s_nop 0
L_dw_134:
    global_load_dword v18, v17, s[10:11] sc1
    s_waitcnt vmcnt(0)
    v_readfirstlane_b32 s38, v18
    s_sub_u32 s41, s41, 1
    s_cmp_eq_u32 s41, 0
    s_nop 2
    s_cbranch_scc1 L_end_128
    s_cmp_lt_u32 s38, 32
    s_cbranch_scc1 L_dw_134
    v_mov_b32 v17, 132
    s_mov_b32 s41, 2097152
    s_nop 0
L_dw_135:
    global_load_dword v18, v17, s[10:11] sc1
    s_waitcnt vmcnt(0)
    v_readfirstlane_b32 s38, v18
    s_sub_u32 s41, s41, 1
    s_cmp_eq_u32 s41, 0
    s_nop 2
    s_cbranch_scc1 L_end_128
    s_cmp_lt_u32 s38, 32
    s_cbranch_scc1 L_dw_135
L_go_133:
    v_and_b32 v16, 63, v0
    v_lshlrev_b32 v1, 4, v16
    v_and_b32 v17, 15, v16
    v_lshrrev_b32 v18, 4, v16
    v_lshrrev_b32 v19, 5, v16
    v_and_b32 v20, 31, v16
    v_xor_b32 v20, v20, v19
    s_and_b32 s38, s9, 1
    s_lshl_b32 s38, s38, 3
    v_xor_b32 v20, s38, v20
    v_lshlrev_b32 v20, 4, v20
    v_lshl_add_u32 v20, v19, 10, v20
    s_lshl_b32 s38, s9, 13
    v_add_u32 v2, s38, v20
    v_xor_b32 v19, v17, v18
    v_lshlrev_b32 v19, 4, v19
    v_lshl_add_u32 v19, v17, 9, v19
    v_add_u32 v3, 114688, v19
    v_xor_b32 v4, 64, v3
    v_xor_b32 v5, 128, v3
    v_xor_b32 v6, 192, v3
    v_add_u32 v7, 114688, v1
    s_mul_i32 s38, s9, 28672
    v_add_u32 v8, s38, v1
    s_lshl_b32 s38, s9, 12
    v_add_u32 v9, s38, v1
    s_add_u32 s46, s38, 114688
    v_mul_u32_u24 v11, 35072, v18
    v_lshl_add_u32 v11, v17, 3, v11
    s_mul_i32 s38, s26, 2176
    s_lshl_b32 s39, s27, 9
    s_add_u32 s38, s38, s39
    s_lshl_b32 s39, s9, 7
    s_add_u32 s38, s38, s39
    v_add_u32 v11, s38, v11
    v_add_u32 v12, 17536, v11
    v_mov_b32 v13, -1
    v_mov_b32 v14, 0
    s_mov_b32 s23, -2
    s_mov_b32 s25, 0
    s_mov_b32 s59, 0
    s_add_u32 s56, s20, 984064
    s_addc_u32 s57, s21, 0
    s_add_u32 s100, s20, 984064
    s_addc_u32 s101, s21, 0
L_xw_136:
    s_mul_i32 s62, s23, 5
    s_add_u32 s62, s62, s22
    s_sub_u32 s63, s62, 15
    s_sub_u32 s12, s62, 5
    s_add_u32 s13, s62, 10
    s_add_u32 s14, s62, 5
    s_add_u32 s15, s63, 5
    s_bfe_u32 s36, s23, 0x10001
    s_xor_b32 s36, s36, 1
    s_and_b32 s38, s23, 1
    s_lshl_b32 s61, s38, 19
    s_add_u32 s61, s61, 1048576
    s_mul_i32 s37, s38, 589824
    s_add_u32 s37, s37, 2097152
    s_min_u32 s38, s62, s63
    s_cmp_ge_u32 s38, 64
    s_cbranch_scc1 L_g_137
    s_bitcmp1_b32 s25, 2
    s_cbranch_scc1 L_ka_138
    s_cmp_ge_u32 s62, 64
    s_cbranch_scc1 L_ka_138
    s_waitcnt vmcnt(0)
    s_barrier
    s_min_u32 s38, s62, 127
    s_lshl_b32 s38, s38, 19
    s_lshl_b32 s39, s7, 14
    s_add_u32 s38, s38, s39
    s_add_u32 s54, s4, s38
    s_addc_u32 s55, s5, 0
    s_add_u32 m0, s46, 0
    s_nop 0
    global_load_lds_dwordx4 v9, s[54:55] offset:0 sc1
    global_load_lds_dwordx4 v9, s[54:55] offset:1024 sc1
    global_load_lds_dwordx4 v9, s[54:55] offset:2048 sc1
    global_load_lds_dwordx4 v9, s[54:55] offset:3072 sc1
L_ka_138:
    s_bitcmp1_b32 s25, 3
    s_cbranch_scc1 L_ka_139
    s_cmp_ge_u32 s63, 64
    s_cbranch_scc1 L_ka_139
    s_waitcnt vmcnt(0)
    s_barrier
    s_min_u32 s38, s63, 127
    s_lshl_b32 s38, s38, 19
    s_lshl_b32 s39, s7, 14
    s_add_u32 s38, s38, s39
    s_add_u32 s38, s38, 33554432
    s_add_u32 s54, s4, s38
    s_addc_u32 s55, s5, 0
    s_add_u32 m0, s46, 32768
    s_nop 0
    global_load_lds_dwordx4 v9, s[54:55] offset:0 sc1
    global_load_lds_dwordx4 v9, s[54:55] offset:1024 sc1
    global_load_lds_dwordx4 v9, s[54:55] offset:2048 sc1
    global_load_lds_dwordx4 v9, s[54:55] offset:3072 sc1
L_ka_139:
    s_lshr_b32 s40, s9, 1
    s_cmp_eq_u32 s40, 0
    s_cselect_b32 s24, s62, s63
    s_cmp_ge_u32 s24, 64
    s_cbranch_scc1 L_as_140
    s_lshl_b32 s60, s40, 6
    s_add_u32 s60, s60, s24
    s_min_u32 s38, s60, 127
    s_lshl_b32 s38, s38, 18
    s_lshl_b32 s39, s7, 13
    s_add_u32 s38, s38, s39
    s_add_u32 s38, s38, 67108864
    s_add_u32 s30, s4, s38
    s_addc_u32 s31, s5, 0
    s_min_u32 s38, s60, 127
    s_lshl_b32 s38, s38, 17
    s_lshl_b32 s39, s7, 12
    s_add_u32 s38, s38, s39
    s_add_u32 s38, s38, 100663296
    s_add_u32 s34, s4, s38
    s_addc_u32 s35, s5, 0
    v_lshrrev_b32 v16, 4, v1
    v_lshrrev_b32 v18, 4, v16
    v_and_b32 v19, 7, v16
    v_lshlrev_b32 v19, 4, v19
    v_lshl_add_u32 v19, v18, 7, v19
    global_load_dwordx4 v[80:83], v19, s[34:35] offset:0 sc1
    global_load_dwordx4 v[84:87], v19, s[34:35] offset:512 sc1
    global_load_dwordx4 v[88:91], v19, s[34:35] offset:1024 sc1
    global_load_dwordx4 v[92:95], v19, s[34:35] offset:1536 sc1
    s_and_b32 s38, s9, 1
    s_lshl_b32 s39, s38, 12
    v_add_u32 v23, s39, v1
    global_load_dwordx4 v[64:67], v23, s[30:31] offset:0 sc1
    global_load_dwordx4 v[68:71], v23, s[30:31] offset:1024 sc1
    global_load_dwordx4 v[72:75], v23, s[30:31] offset:2048 sc1
    global_load_dwordx4 v[76:79], v23, s[30:31] offset:3072 sc1
    v_and_b32 v17, 15, v16
    s_lshl_b32 s39, s38, 4
    v_add_u32 v21, s39, v17
    v_lshlrev_b32 v24, 2, v18
    v_sub_u32 v21, v21, v24
    s_lshl_b32 s40, s40, 15
    v_add_u32 v61, s40, v7
    v_lshrrev_b32 v60, 3, v17
    v_lshlrev_b32 v60, 10, v60
    v_lshl_add_u32 v60, v18, 8, v60
    v_bfe_u32 v24, v17, 2, 1
    v_lshl_add_u32 v60, v24, 7, v60
    v_and_b32 v24, 3, v17
    v_lshl_add_u32 v60, v24, 4, v60
    s_add_u32 s40, s40, 122880
    v_add_u32 v60, s40, v60
    v_lshrrev_b32 v20, 2, v17
    v_lshlrev_b32 v20, 7, v20
    v_lshl_add_u32 v20, v24, 4, v20
    v_and_b32 v24, 1, v18
    v_lshl_add_u32 v20, v24, 3, v20
    v_add_u32 v62, 2048, v20
    v_mov_b32 v22, 0xff800000
    v_cmp_gt_u32 vcc, 2, v18
    s_nop 1
    v_cndmask_b32 v48, v22, v14, vcc
    v_cndmask_b32 v49, v22, v14, vcc
    v_cndmask_b32 v50, v22, v14, vcc
    v_cndmask_b32 v51, v22, v14, vcc
    v_cmp_le_i32 vcc, 0, v21
    s_nop 1
    v_cndmask_b32 v52, v22, v14, vcc
    v_cmp_le_i32 vcc, 1, v21
    s_nop 1
    v_cndmask_b32 v53, v22, v14, vcc
    v_cmp_le_i32 vcc, 2, v21
    s_nop 1
    v_cndmask_b32 v54, v22, v14, vcc
    v_cmp_le_i32 vcc, 3, v21
    s_nop 1
    v_cndmask_b32 v55, v22, v14, vcc
    v_cmp_le_i32 vcc, 16, v21
    s_nop 1
    v_cndmask_b32 v56, v22, v14, vcc
    v_cmp_le_i32 vcc, 17, v21
    s_nop 1
    v_cndmask_b32 v57, v22, v14, vcc
    v_cmp_le_i32 vcc, 18, v21
    s_nop 1
    v_cndmask_b32 v58, v22, v14, vcc
    v_cmp_le_i32 vcc, 19, v21
    s_nop 1
    v_cndmask_b32 v59, v22, v14, vcc
    v_mov_b32 v63, v19
    s_waitcnt vmcnt(0)
    s_barrier
    s_bitcmp1_b32 s59, 0
    s_cselect_b64 exec, 1, 0
    global_store_dword v14, v13, s[56:57] sc1
    s_mov_b64 exec, -1
    s_bitset0_b32 s59, 0
    ds_read_b128 v[16:19], v61 offset:0
    ds_read_b128 v[32:35], v61 offset:4096
    ds_read_b128 v[20:23], v61 offset:1024
    ds_read_b128 v[36:39], v61 offset:5120
    ds_read_b128 v[24:27], v61 offset:2048
    ds_read_b128 v[40:43], v61 offset:6144
    ds_read_b128 v[28:31], v61 offset:3072
    ds_read_b128 v[44:47], v61 offset:7168
    s_waitcnt lgkmcnt(6)
    v_mfma_f32_16x16x32_bf16 v[52:55], v[16:19], v[64:67], v[52:55]
    v_mfma_f32_16x16x32_bf16 v[56:59], v[32:35], v[64:67], v[56:59]
    s_waitcnt lgkmcnt(4)
    v_mfma_f32_16x16x32_bf16 v[52:55], v[20:23], v[68:71], v[52:55]
    v_mfma_f32_16x16x32_bf16 v[56:59], v[36:39], v[68:71], v[56:59]
    s_waitcnt lgkmcnt(2)
    v_mfma_f32_16x16x32_bf16 v[52:55], v[24:27], v[72:75], v[52:55]
    v_mfma_f32_16x16x32_bf16 v[56:59], v[40:43], v[72:75], v[56:59]
    s_waitcnt lgkmcnt(0)
    v_mfma_f32_16x16x32_bf16 v[52:55], v[28:31], v[76:79], v[52:55]
    v_mfma_f32_16x16x32_bf16 v[56:59], v[44:47], v[76:79], v[56:59]
    ds_read_b128 v[16:19], v60 offset:0
    ds_read_b128 v[20:23], v60 offset:64
    ds_read_b128 v[24:27], v60 offset:2048
    ds_read_b128 v[28:31], v60 offset:2112
    ds_read_b128 v[32:35], v60 offset:4096
    ds_read_b128 v[36:39], v60 offset:4160
    ds_read_b128 v[40:43], v60 offset:6144
    ds_read_b128 v[44:47], v60 offset:6208
    s_mov_b32 s41, 2097152
L_fw_142:
    v_max3_u32 v60, v80, v81, v82
    v_max3_u32 v61, v83, v84, v85
    v_max3_u32 v60, v60, v86, v87
    v_max3_u32 v61, v61, v88, v89
    v_max3_u32 v60, v60, v90, v91
    v_max3_u32 v61, v61, v92, v93
    v_max3_u32 v60, v60, v94, v95
    v_max_u32 v60, v60, v61
    v_cmp_eq_u32 vcc, -1, v60
    s_nop 4
    s_cbranch_vccz L_fg_143
    s_mov_b64 exec, vcc
    global_load_dwordx4 v[80:83], v63, s[34:35] offset:0 sc1
    global_load_dwordx4 v[84:87], v63, s[34:35] offset:512 sc1
    global_load_dwordx4 v[88:91], v63, s[34:35] offset:1024 sc1
    global_load_dwordx4 v[92:95], v63, s[34:35] offset:1536 sc1
    s_mov_b64 exec, -1
    s_sub_u32 s41, s41, 1
    s_cmp_eq_u32 s41, 0
    s_cbranch_scc1 L_end_128
    s_waitcnt vmcnt(0)
    s_branch L_fw_142
L_fg_143:
    global_load_dwordx2 v[96:97], v62, s[34:35] offset:0 sc1
    global_load_dwordx2 v[98:99], v62, s[34:35] offset:64 sc1
    global_load_dwordx2 v[100:101], v62, s[34:35] offset:512 sc1
    global_load_dwordx2 v[102:103], v62, s[34:35] offset:576 sc1
    global_load_dwordx2 v[104:105], v62, s[34:35] offset:1024 sc1
    global_load_dwordx2 v[106:107], v62, s[34:35] offset:1088 sc1
    global_load_dwordx2 v[108:109], v62, s[34:35] offset:1536 sc1
    global_load_dwordx2 v[110:111], v62, s[34:35] offset:1600 sc1
    v_mfma_f32_16x16x32_bf16 v[48:51], v[80:83], v[64:67], v[48:51]
    v_mfma_f32_16x16x32_bf16 v[48:51], v[84:87], v[68:71], v[48:51]
    v_mfma_f32_16x16x32_bf16 v[48:51], v[88:91], v[72:75], v[48:51]
    v_mfma_f32_16x16x32_bf16 v[48:51], v[92:95], v[76:79], v[48:51]
    v_max3_f32 v60, v52, v53, v54
    v_max3_f32 v61, v55, v56, v57
    v_max3_f32 v60, v60, v58, v59
    v_max_f32 v60, v60, v61
    s_nop 3
    v_max3_f32 v80, v60, v48, v49
    v_max3_f32 v80, v80, v50, v51
    v_mov_b32 v81, v80
    s_nop 1
    v_permlane16_swap_b32 v81, v80
    v_max_f32 v80, v80, v81
    v_mov_b32 v81, v80
    s_nop 1
    v_permlane32_swap_b32 v81, v80
    v_max_f32 v80, v80, v81
    v_mul_f32 v80, s44, v80
    v_pk_fma_f32 v[48:49], v[48:49], s[44:45], v[80:81] op_sel_hi:[1,1,0] neg_lo:[0,0,1] neg_hi:[0,0,1]
    v_pk_fma_f32 v[50:51], v[50:51], s[44:45], v[80:81] op_sel_hi:[1,1,0] neg_lo:[0,0,1] neg_hi:[0,0,1]
    v_pk_fma_f32 v[52:53], v[52:53], s[44:45], v[80:81] op_sel_hi:[1,1,0] neg_lo:[0,0,1] neg_hi:[0,0,1]
    v_pk_fma_f32 v[54:55], v[54:55], s[44:45], v[80:81] op_sel_hi:[1,1,0] neg_lo:[0,0,1] neg_hi:[0,0,1]
    v_pk_fma_f32 v[56:57], v[56:57], s[44:45], v[80:81] op_sel_hi:[1,1,0] neg_lo:[0,0,1] neg_hi:[0,0,1]
    v_pk_fma_f32 v[58:59], v[58:59], s[44:45], v[80:81] op_sel_hi:[1,1,0] neg_lo:[0,0,1] neg_hi:[0,0,1]
    v_exp_f32 v48, v48
    v_exp_f32 v49, v49
    v_exp_f32 v50, v50
    v_exp_f32 v51, v51
    v_exp_f32 v52, v52
    v_exp_f32 v53, v53
    v_exp_f32 v54, v54
    v_exp_f32 v55, v55
    v_exp_f32 v56, v56
    v_exp_f32 v57, v57
    v_exp_f32 v58, v58
    v_exp_f32 v59, v59
    v_pk_add_f32 v[80:81], v[48:49], v[50:51]
    v_pk_add_f32 v[82:83], v[52:53], v[54:55]
    v_pk_add_f32 v[84:85], v[56:57], v[58:59]
    v_pk_add_f32 v[80:81], v[80:81], v[82:83]
    v_pk_add_f32 v[80:81], v[80:81], v[84:85]
    v_add_f32 v80, v80, v81
    v_mov_b32 v81, v80
    s_nop 1
    v_permlane16_swap_b32 v81, v80
    v_add_f32 v80, v80, v81
    v_mov_b32 v81, v80
    s_nop 1
    v_permlane32_swap_b32 v81, v80
    v_add_f32 v80, v80, v81
    v_rcp_f32 v80, v80
    s_nop 0
    v_pk_mul_f32 v[48:49], v[48:49], v[80:81] op_sel_hi:[1,0]
    v_pk_mul_f32 v[50:51], v[50:51], v[80:81] op_sel_hi:[1,0]
    v_pk_mul_f32 v[52:53], v[52:53], v[80:81] op_sel_hi:[1,0]
    v_pk_mul_f32 v[54:55], v[54:55], v[80:81] op_sel_hi:[1,0]
    v_pk_mul_f32 v[56:57], v[56:57], v[80:81] op_sel_hi:[1,0]
    v_pk_mul_f32 v[58:59], v[58:59], v[80:81] op_sel_hi:[1,0]
    v_cvt_pk_bf16_f32 v48, v48, v49
    v_cvt_pk_bf16_f32 v49, v50, v51
    v_cvt_pk_bf16_f32 v52, v52, v53
    v_cvt_pk_bf16_f32 v53, v54, v55
    v_cvt_pk_bf16_f32 v54, v56, v57
    v_cvt_pk_bf16_f32 v55, v58, v59
    s_waitcnt lgkmcnt(0)
    s_nop 0
    v_mfma_f32_16x16x32_bf16 v[64:67], v[16:19], v[52:55], 0
    v_mfma_f32_16x16x32_bf16 v[68:71], v[20:23], v[52:55], 0
    v_mfma_f32_16x16x32_bf16 v[72:75], v[24:27], v[52:55], 0
    v_mfma_f32_16x16x32_bf16 v[76:79], v[28:31], v[52:55], 0
    v_mfma_f32_16x16x32_bf16 v[80:83], v[32:35], v[52:55], 0
    v_mfma_f32_16x16x32_bf16 v[84:87], v[36:39], v[52:55], 0
    v_mfma_f32_16x16x32_bf16 v[88:91], v[40:43], v[52:55], 0
    v_mfma_f32_16x16x32_bf16 v[92:95], v[44:47], v[52:55], 0
    s_mov_b32 s41, 2097152
    s_nop 6
L_vw_144:
    s_waitcnt vmcnt(0)
    v_max3_u32 v60, v96, v97, v98
    v_max3_u32 v61, v99, v100, v101
    v_max3_u32 v60, v60, v102, v103
    v_max3_u32 v61, v61, v104, v105
    v_max3_u32 v60, v60, v106, v107
    v_max3_u32 v61, v61, v108, v109
    v_max3_u32 v60, v60, v110, v111
    v_max_u32 v60, v60, v61
    v_cmp_eq_u32 vcc, -1, v60
    s_nop 4
    s_cbranch_vccz L_vg_145
    s_mov_b64 exec, vcc
    global_load_dwordx2 v[96:97], v62, s[34:35] offset:0 sc1
    global_load_dwordx2 v[98:99], v62, s[34:35] offset:64 sc1
    global_load_dwordx2 v[100:101], v62, s[34:35] offset:512 sc1
    global_load_dwordx2 v[102:103], v62, s[34:35] offset:576 sc1
    global_load_dwordx2 v[104:105], v62, s[34:35] offset:1024 sc1
    global_load_dwordx2 v[106:107], v62, s[34:35] offset:1088 sc1
    global_load_dwordx2 v[108:109], v62, s[34:35] offset:1536 sc1
    global_load_dwordx2 v[110:111], v62, s[34:35] offset:1600 sc1
    s_mov_b64 exec, -1
    s_sub_u32 s41, s41, 1
    s_cmp_eq_u32 s41, 0
    s_cbranch_scc1 L_end_128
    s_branch L_vw_144
L_vg_145:
    s_lshl_b32 s38, s7, 13
    s_and_b32 s39, s9, 1
    s_lshl_b32 s39, s39, 12
    s_add_u32 s38, s38, s39
    s_lshr_b32 s39, s9, 1
    s_lshl_b32 s39, s39, 18
    s_add_u32 s38, s38, s39
    s_add_u32 s38, s38, s61
    s_add_u32 s28, s20, s38
    s_addc_u32 s29, s21, 0
    v_mfma_f32_16x16x16_bf16 v[64:67], v[96:97], v[48:49], v[64:67]
    v_mfma_f32_16x16x16_bf16 v[68:71], v[98:99], v[48:49], v[68:71]
    v_mfma_f32_16x16x16_bf16 v[72:75], v[100:101], v[48:49], v[72:75]
    v_mfma_f32_16x16x16_bf16 v[76:79], v[102:103], v[48:49], v[76:79]
    v_mfma_f32_16x16x16_bf16 v[80:83], v[104:105], v[48:49], v[80:83]
    s_nop 3
    v_cvt_pk_bf16_f32 v64, v64, v65
    v_cvt_pk_bf16_f32 v65, v66, v67
    v_cvt_pk_bf16_f32 v66, v68, v69
    v_cvt_pk_bf16_f32 v67, v70, v71
    global_store_dwordx4 v1, v[64:67], s[28:29] offset:0 sc1
    v_mfma_f32_16x16x16_bf16 v[84:87], v[106:107], v[48:49], v[84:87]
    v_mfma_f32_16x16x16_bf16 v[88:91], v[108:109], v[48:49], v[88:91]
    v_cvt_pk_bf16_f32 v72, v72, v73
    v_cvt_pk_bf16_f32 v73, v74, v75
    v_cvt_pk_bf16_f32 v74, v76, v77
    v_cvt_pk_bf16_f32 v75, v78, v79
    global_store_dwordx4 v1, v[72:75], s[28:29] offset:1024 sc1
    v_mfma_f32_16x16x16_bf16 v[92:95], v[110:111], v[48:49], v[92:95]
    v_cvt_pk_bf16_f32 v80, v80, v81
    v_cvt_pk_bf16_f32 v81, v82, v83
    v_cvt_pk_bf16_f32 v82, v84, v85
    v_cvt_pk_bf16_f32 v83, v86, v87
    global_store_dwordx4 v1, v[80:83], s[28:29] offset:2048 sc1
    v_cvt_pk_bf16_f32 v88, v88, v89
    v_cvt_pk_bf16_f32 v89, v90, v91
    s_nop 0
    v_cvt_pk_bf16_f32 v90, v92, v93
    v_cvt_pk_bf16_f32 v91, v94, v95
    global_store_dwordx4 v1, v[88:91], s[28:29] offset:3072 sc1
    s_nop 1
    s_branch L_ad_141
L_as_140:
    s_waitcnt vmcnt(0)
    s_barrier
    s_bitcmp1_b32 s59, 0
    s_cselect_b64 exec, 1, 0
    global_store_dword v14, v13, s[56:57] sc1
    s_mov_b64 exec, -1
    s_bitset0_b32 s59, 0
L_ad_141:
    s_lshl_b32 s38, s7, 4
    s_lshl_b32 s39, s9, 2
    s_add_u32 s38, s38, s39
    s_add_u32 s38, s38, 983040
    v_mov_b32 v60, s38
    s_add_u32 s40, s23, 1
    v_mov_b32 v61, s40
    s_lshl_b32 s38, s26, 6
    s_add_u32 s38, s38, 983040
    v_bfe_u32 v62, v1, 4, 4
    v_lshlrev_b32 v62, 2, v62
    v_add_u32 v62, s38, v62
    s_waitcnt vmcnt(0)
    s_mov_b64 exec, 1
    global_store_dword v60, v61, s[20:21] sc1
    s_mov_b64 exec, -1
    s_mov_b32 s41, 2097152
L_of_146:
    global_load_dword v63, v62, s[20:21] sc1
    s_sub_u32 s41, s41, 1
    s_cmp_eq_u32 s41, 0
    s_cbranch_scc1 L_end_128
    s_waitcnt vmcnt(0)
    v_cmp_gt_u32 vcc, s40, v63
    s_nop 4
    s_cbranch_vccnz L_of_146
    s_mov_b32 s25, 0
    s_cmp_lt_u32 s62, 64
    s_cbranch_scc1 L_tg_147
    s_sub_u32 s60, s63, 10
    s_lshl_b32 s38, s60, 7
    s_add_u32 s38, s38, 117465088
    v_bfe_u32 v16, v1, 4, 5
    v_lshlrev_b32 v16, 2, v16
    v_add_u32 v16, s38, v16
    s_mov_b32 s41, 2097152
    s_nop 0
L_pf_148:
    global_load_dword v17, v16, s[4:5] sc1
    s_sub_u32 s41, s41, 1
    s_cmp_eq_u32 s41, 0
    s_cbranch_scc1 L_end_128
    s_waitcnt vmcnt(0)
    v_cmp_eq_u32 vcc, 0, v17
    s_nop 4
    s_cbranch_vccnz L_pf_148
    s_lshl_b32 s38, s26, 15
    s_add_u32 s38, s38, s61
    s_add_u32 s38, s38, 278528
    s_add_u32 s54, s20, s38
    s_addc_u32 s55, s21, 0
    s_add_u32 m0, s46, 0
    s_nop 0
    global_load_lds_dwordx4 v9, s[54:55] offset:0 sc1
    global_load_lds_dwordx4 v9, s[54:55] offset:1024 sc1
    global_load_lds_dwordx4 v9, s[54:55] offset:2048 sc1
    global_load_lds_dwordx4 v9, s[54:55] offset:3072 sc1
L_tg_147:
    s_cmp_ge_u32 s62, 64
    s_cbranch_scc1 L_g_149
    s_lshl_b32 s38, s26, 15
    s_add_u32 s38, s38, s61
    s_add_u32 s38, s38, 0
    s_add_u32 s54, s20, s38
    s_addc_u32 s55, s21, 0
    s_add_u32 m0, s46, 0
    s_nop 0
    global_load_lds_dwordx4 v9, s[54:55] offset:0 sc1
    global_load_lds_dwordx4 v9, s[54:55] offset:1024 sc1
    global_load_lds_dwordx4 v9, s[54:55] offset:2048 sc1
    global_load_lds_dwordx4 v9, s[54:55] offset:3072 sc1
    s_lshl_b32 s38, s26, 15
    s_add_u32 s38, s38, s61
    s_add_u32 s38, s38, 16384
    s_add_u32 s54, s20, s38
    s_addc_u32 s55, s21, 0
    s_add_u32 m0, s46, 16384
    s_nop 0
    global_load_lds_dwordx4 v9, s[54:55] offset:0 sc1
    global_load_lds_dwordx4 v9, s[54:55] offset:1024 sc1
    global_load_lds_dwordx4 v9, s[54:55] offset:2048 sc1
    global_load_lds_dwordx4 v9, s[54:55] offset:3072 sc1
L_g_149:
    s_lshl_b32 s38, s26, 15
    s_add_u32 s38, s38, s61
    s_add_u32 s38, s38, 262144
    s_add_u32 s54, s20, s38
    s_addc_u32 s55, s21, 0
    s_add_u32 m0, s46, 32768
    s_nop 0
    global_load_lds_dwordx4 v9, s[54:55] offset:0 sc1
    global_load_lds_dwordx4 v9, s[54:55] offset:1024 sc1
    global_load_lds_dwordx4 v9, s[54:55] offset:2048 sc1
    global_load_lds_dwordx4 v9, s[54:55] offset:3072 sc1
    s_cmp_ge_u32 s62, 64
    s_cbranch_scc1 L_g_150
    s_waitcnt vmcnt(8)
    s_barrier
    ds_read_b128 v[64:67], v7 offset:0
    ds_read_b128 v[68:71], v7 offset:4096
    ds_read_b128 v[72:75], v7 offset:1024
    ds_read_b128 v[76:79], v7 offset:5120
    ds_read_b128 v[80:83], v7 offset:2048
    ds_read_b128 v[84:87], v7 offset:6144
    ds_read_b128 v[96:99], v8 offset:14336
    ds_read_b128 v[100:103], v8 offset:15360
    s_waitcnt lgkmcnt(6)
    v_mfma_f32_16x16x32_bf16 v[16:19], v[64:67], a[184:187], 0
    v_mfma_f32_16x16x32_bf16 v[20:23], v[68:71], a[184:187], 0
    v_mfma_f32_16x16x32_bf16 v[24:27], v[64:67], a[248:251], 0
    v_mfma_f32_16x16x32_bf16 v[28:31], v[68:71], a[248:251], 0
    ds_read_b128 v[64:67], v7 offset:3072
    ds_read_b128 v[68:71], v7 offset:7168
    s_waitcnt lgkmcnt(6)
    v_mfma_f32_16x16x32_bf16 v[16:19], v[72:75], a[188:191], v[16:19]
    v_mfma_f32_16x16x32_bf16 v[20:23], v[76:79], a[188:191], v[20:23]
    v_mfma_f32_16x16x32_bf16 v[24:27], v[72:75], a[252:255], v[24:27]
    v_mfma_f32_16x16x32_bf16 v[28:31], v[76:79], a[252:255], v[28:31]
    ds_read_b128 v[72:75], v7 offset:8192
    ds_read_b128 v[76:79], v7 offset:12288
    ds_read_b128 v[88:91], v8 offset:16384
    ds_read_b128 v[92:95], v8 offset:17408
    s_waitcnt lgkmcnt(8)
    s_waitcnt lgkmcnt(6)
    v_mfma_f32_16x16x32_bf16 v[16:19], v[80:83], a[192:195], v[16:19]
    v_mfma_f32_16x16x32_bf16 v[20:23], v[84:87], a[192:195], v[20:23]
    v_mfma_f32_16x16x32_bf16 v[24:27], v[80:83], v[96:99], v[24:27]
    v_mfma_f32_16x16x32_bf16 v[28:31], v[84:87], v[96:99], v[28:31]
    ds_read_b128 v[80:83], v7 offset:9216
    ds_read_b128 v[84:87], v7 offset:13312
    s_waitcnt lgkmcnt(6)
    v_mfma_f32_16x16x32_bf16 v[16:19], v[64:67], a[196:199], v[16:19]
    v_mfma_f32_16x16x32_bf16 v[20:23], v[68:71], a[196:199], v[20:23]
    v_mfma_f32_16x16x32_bf16 v[24:27], v[64:67], v[100:103], v[24:27]
    v_mfma_f32_16x16x32_bf16 v[28:31], v[68:71], v[100:103], v[28:31]
    ds_read_b128 v[64:67], v7 offset:10240
    ds_read_b128 v[68:71], v7 offset:14336
    ds_read_b128 v[96:99], v8 offset:18432
    ds_read_b128 v[100:103], v8 offset:19456
    s_waitcnt lgkmcnt(8)
    s_waitcnt lgkmcnt(6)
    v_mfma_f32_16x16x32_bf16 v[16:19], v[72:75], a[200:203], v[16:19]
    v_mfma_f32_16x16x32_bf16 v[20:23], v[76:79], a[200:203], v[20:23]
    v_mfma_f32_16x16x32_bf16 v[24:27], v[72:75], v[88:91], v[24:27]
    v_mfma_f32_16x16x32_bf16 v[28:31], v[76:79], v[88:91], v[28:31]
    ds_read_b128 v[72:75], v7 offset:11264
    ds_read_b128 v[76:79], v7 offset:15360
    s_waitcnt lgkmcnt(6)
    v_mfma_f32_16x16x32_bf16 v[16:19], v[80:83], a[204:207], v[16:19]
    v_mfma_f32_16x16x32_bf16 v[20:23], v[84:87], a[204:207], v[20:23]
    v_mfma_f32_16x16x32_bf16 v[24:27], v[80:83], v[92:95], v[24:27]
    v_mfma_f32_16x16x32_bf16 v[28:31], v[84:87], v[92:95], v[28:31]
    ds_read_b128 v[88:91], v8 offset:20480
    ds_read_b128 v[92:95], v8 offset:21504
    s_waitcnt lgkmcnt(6)
    s_waitcnt lgkmcnt(4)
    v_mfma_f32_16x16x32_bf16 v[16:19], v[64:67], a[208:211], v[16:19]
    v_mfma_f32_16x16x32_bf16 v[20:23], v[68:71], a[208:211], v[20:23]
    v_mfma_f32_16x16x32_bf16 v[24:27], v[64:67], v[96:99], v[24:27]
    v_mfma_f32_16x16x32_bf16 v[28:31], v[68:71], v[96:99], v[28:31]
    s_waitcnt lgkmcnt(2)
    s_waitcnt vmcnt(0)
    s_barrier
    ds_read_b128 v[80:83], v7 offset:16384
    ds_read_b128 v[84:87], v7 offset:20480
    ds_read_b128 v[64:67], v7 offset:17408
    ds_read_b128 v[68:71], v7 offset:21504
    v_mfma_f32_16x16x32_bf16 v[16:19], v[72:75], a[212:215], v[16:19]
    s_lshl_b32 s38, s26, 15
    s_add_u32 s38, s38, s61
    s_add_u32 s38, s38, 278528
    s_add_u32 s54, s20, s38
    s_addc_u32 s55, s21, 0
    v_mfma_f32_16x16x32_bf16 v[20:23], v[76:79], a[212:215], v[20:23]
    s_cmp_lt_u32 s63, 64
    s_cselect_b64 s[52:53], -1, 0
    v_mfma_f32_16x16x32_bf16 v[24:27], v[72:75], v[100:103], v[24:27]
    s_add_u32 m0, s46, 0
    v_mfma_f32_16x16x32_bf16 v[28:31], v[76:79], v[100:103], v[28:31]
    s_mov_b64 exec, s[52:53]
    global_load_lds_dwordx4 v9, s[54:55] offset:0 sc1
    s_mov_b64 exec, -1
    ds_read_b128 v[72:75], v7 offset:18432
    ds_read_b128 v[76:79], v7 offset:22528
    ds_read_b128 v[96:99], v8 offset:22528
    ds_read_b128 v[100:103], v8 offset:23552
    s_waitcnt lgkmcnt(6)
    v_mfma_f32_16x16x32_bf16 v[16:19], v[80:83], a[216:219], v[16:19]
    s_mov_b64 exec, s[52:53]
    global_load_lds_dwordx4 v9, s[54:55] offset:1024 sc1
    s_mov_b64 exec, -1
    v_mfma_f32_16x16x32_bf16 v[20:23], v[84:87], a[216:219], v[20:23]
    s_mov_b64 exec, s[52:53]
    global_load_lds_dwordx4 v9, s[54:55] offset:2048 sc1
    s_mov_b64 exec, -1
    v_mfma_f32_16x16x32_bf16 v[24:27], v[80:83], v[88:91], v[24:27]
    s_mov_b64 exec, s[52:53]
    global_load_lds_dwordx4 v9, s[54:55] offset:3072 sc1
    s_mov_b64 exec, -1
    v_mfma_f32_16x16x32_bf16 v[28:31], v[84:87], v[88:91], v[28:31]
    ds_read_b128 v[80:83], v7 offset:19456
    ds_read_b128 v[84:87], v7 offset:23552
    s_waitcnt lgkmcnt(6)
    v_mfma_f32_16x16x32_bf16 v[16:19], v[64:67], a[220:223], v[16:19]
    v_mfma_f32_16x16x32_bf16 v[20:23], v[68:71], a[220:223], v[20:23]
    v_mfma_f32_16x16x32_bf16 v[24:27], v[64:67], v[92:95], v[24:27]
    v_mfma_f32_16x16x32_bf16 v[28:31], v[68:71], v[92:95], v[28:31]
    ds_read_b128 v[64:67], v7 offset:24576
    ds_read_b128 v[68:71], v7 offset:28672
    ds_read_b128 v[88:91], v8 offset:24576
    ds_read_b128 v[92:95], v8 offset:25600
    s_waitcnt lgkmcnt(8)
    s_waitcnt lgkmcnt(6)
    v_mfma_f32_16x16x32_bf16 v[16:19], v[72:75], a[224:227], v[16:19]
    v_mfma_f32_16x16x32_bf16 v[20:23], v[76:79], a[224:227], v[20:23]
    v_mfma_f32_16x16x32_bf16 v[24:27], v[72:75], v[96:99], v[24:27]
    v_mfma_f32_16x16x32_bf16 v[28:31], v[76:79], v[96:99], v[28:31]
    ds_read_b128 v[72:75], v7 offset:25600
    ds_read_b128 v[76:79], v7 offset:29696
    s_waitcnt lgkmcnt(6)
    v_mfma_f32_16x16x32_bf16 v[16:19], v[80:83], a[228:231], v[16:19]
    v_mfma_f32_16x16x32_bf16 v[20:23], v[84:87], a[228:231], v[20:23]
    v_mfma_f32_16x16x32_bf16 v[24:27], v[80:83], v[100:103], v[24:27]
    v_mfma_f32_16x16x32_bf16 v[28:31], v[84:87], v[100:103], v[28:31]
    ds_read_b128 v[80:83], v7 offset:26624
    ds_read_b128 v[84:87], v7 offset:30720
    ds_read_b128 v[96:99], v8 offset:26624
    ds_read_b128 v[100:103], v8 offset:27648
    s_waitcnt lgkmcnt(8)
    s_waitcnt lgkmcnt(6)
    v_mfma_f32_16x16x32_bf16 v[16:19], v[64:67], a[232:235], v[16:19]
    v_mfma_f32_16x16x32_bf16 v[20:23], v[68:71], a[232:235], v[20:23]
    v_mfma_f32_16x16x32_bf16 v[24:27], v[64:67], v[88:91], v[24:27]
    v_mfma_f32_16x16x32_bf16 v[28:31], v[68:71], v[88:91], v[28:31]
    ds_read_b128 v[64:67], v7 offset:27648
    ds_read_b128 v[68:71], v7 offset:31744
    s_waitcnt lgkmcnt(6)
    v_mfma_f32_16x16x32_bf16 v[16:19], v[72:75], a[236:239], v[16:19]
    v_mfma_f32_16x16x32_bf16 v[20:23], v[76:79], a[236:239], v[20:23]
    v_mfma_f32_16x16x32_bf16 v[24:27], v[72:75], v[92:95], v[24:27]
    v_mfma_f32_16x16x32_bf16 v[28:31], v[76:79], v[92:95], v[28:31]
    s_waitcnt lgkmcnt(4)
    s_waitcnt lgkmcnt(2)
    v_mfma_f32_16x16x32_bf16 v[16:19], v[80:83], a[240:243], v[16:19]
    v_mfma_f32_16x16x32_bf16 v[20:23], v[84:87], a[240:243], v[20:23]
    v_mfma_f32_16x16x32_bf16 v[24:27], v[80:83], v[96:99], v[24:27]
    v_mfma_f32_16x16x32_bf16 v[28:31], v[84:87], v[96:99], v[28:31]
    s_waitcnt lgkmcnt(0)
    s_barrier
    v_mfma_f32_16x16x32_bf16 v[16:19], v[64:67], a[244:247], v[16:19]
    v_mfma_f32_16x16x32_bf16 v[20:23], v[68:71], a[244:247], v[20:23]
    v_mfma_f32_16x16x32_bf16 v[24:27], v[64:67], v[100:103], v[24:27]
    v_mfma_f32_16x16x32_bf16 v[28:31], v[68:71], v[100:103], v[28:31]
    s_add_u32 s38, s37, 0
    s_add_u32 s34, s20, s38
    s_addc_u32 s35, s21, 0
    s_add_u32 s32, s34, 140288
    s_addc_u32 s33, s35, 0
    s_sub_u32 s39, s23, 0
    s_bfe_u32 s39, s39, 0x10001
    s_xor_b32 s39, s39, 1
    v_cvt_pk_bf16_f32 v16, v16, v17
    v_cvt_pk_bf16_f32 v17, v24, v25
    v_cvt_pk_bf16_f32 v18, v18, v19
    v_cvt_pk_bf16_f32 v19, v26, v27
    v_and_or_b32 v16, v16, -2, s39
    global_store_dwordx2 v11, v[16:17], s[34:35] sc1
    v_and_or_b32 v18, v18, -2, s39
    global_store_dwordx2 v12, v[18:19], s[34:35] sc1
    v_cvt_pk_bf16_f32 v20, v20, v21
    v_cvt_pk_bf16_f32 v21, v28, v29
    v_cvt_pk_bf16_f32 v22, v22, v23
    v_cvt_pk_bf16_f32 v23, v30, v31
    v_and_or_b32 v20, v20, -2, s39
    global_store_dwordx2 v11, v[20:21], s[32:33] sc1
    v_and_or_b32 v22, v22, -2, s39
    global_store_dwordx2 v12, v[22:23], s[32:33] sc1
    s_nop 0
L_g_150:
    s_cmp_ge_u32 s63, 64
    s_cbranch_scc1 L_g_151
    s_cmp_lt_u32 s62, 64
    s_cbranch_scc1 L_wb_152
    s_waitcnt vmcnt(0)
    s_barrier
L_wb_152:
    v_mov_b32 v10, 0
    s_cmp_ge_u32 s12, 64
    s_nop 0
    s_cbranch_scc1 L_g_153
    s_lshl_b32 s38, s12, 7
    s_lshl_b32 s39, s9, 5
    s_add_u32 s38, s38, s39
    s_add_u32 s38, s38, 117473280
    v_bfe_u32 v15, v1, 4, 3
    v_lshlrev_b32 v15, 2, v15
    v_add_u32 v15, s38, v15
    global_load_dword v10, v15, s[4:5] sc1
    s_nop 0
L_g_153:
    ds_read_b128 v[64:67], v7 offset:32768
    ds_read_b128 v[68:71], v7 offset:36864
    ds_read_b128 v[72:75], v7 offset:33792
    ds_read_b128 v[76:79], v7 offset:37888
    ds_read_b128 v[80:83], v7 offset:34816
    ds_read_b128 v[84:87], v7 offset:38912
    ds_read_b128 v[96:99], v8 offset:14336
    ds_read_b128 v[100:103], v8 offset:15360
    s_waitcnt lgkmcnt(6)
    v_mfma_f32_16x16x32_bf16 v[16:19], v[64:67], a[184:187], 0
    v_mfma_f32_16x16x32_bf16 v[20:23], v[68:71], a[184:187], 0
    v_mfma_f32_16x16x32_bf16 v[24:27], v[64:67], a[248:251], 0
    v_mfma_f32_16x16x32_bf16 v[28:31], v[68:71], a[248:251], 0
    ds_read_b128 v[64:67], v7 offset:35840
    ds_read_b128 v[68:71], v7 offset:39936
    s_waitcnt lgkmcnt(6)
    v_mfma_f32_16x16x32_bf16 v[16:19], v[72:75], a[188:191], v[16:19]
    v_mfma_f32_16x16x32_bf16 v[20:23], v[76:79], a[188:191], v[20:23]
    v_mfma_f32_16x16x32_bf16 v[24:27], v[72:75], a[252:255], v[24:27]
    v_mfma_f32_16x16x32_bf16 v[28:31], v[76:79], a[252:255], v[28:31]
    ds_read_b128 v[72:75], v7 offset:40960
    ds_read_b128 v[76:79], v7 offset:45056
    ds_read_b128 v[88:91], v8 offset:16384
    ds_read_b128 v[92:95], v8 offset:17408
    s_waitcnt lgkmcnt(8)
    s_waitcnt lgkmcnt(6)
    v_mfma_f32_16x16x32_bf16 v[16:19], v[80:83], a[192:195], v[16:19]
    v_mfma_f32_16x16x32_bf16 v[20:23], v[84:87], a[192:195], v[20:23]
    v_mfma_f32_16x16x32_bf16 v[24:27], v[80:83], v[96:99], v[24:27]
    v_mfma_f32_16x16x32_bf16 v[28:31], v[84:87], v[96:99], v[28:31]
    ds_read_b128 v[80:83], v7 offset:41984
    ds_read_b128 v[84:87], v7 offset:46080
    s_waitcnt lgkmcnt(6)
    v_mfma_f32_16x16x32_bf16 v[16:19], v[64:67], a[196:199], v[16:19]
    v_mfma_f32_16x16x32_bf16 v[20:23], v[68:71], a[196:199], v[20:23]
    v_mfma_f32_16x16x32_bf16 v[24:27], v[64:67], v[100:103], v[24:27]
    v_mfma_f32_16x16x32_bf16 v[28:31], v[68:71], v[100:103], v[28:31]
    ds_read_b128 v[64:67], v7 offset:43008
    ds_read_b128 v[68:71], v7 offset:47104
    ds_read_b128 v[96:99], v8 offset:18432
    ds_read_b128 v[100:103], v8 offset:19456
    s_waitcnt lgkmcnt(8)
    s_waitcnt lgkmcnt(6)
    v_mfma_f32_16x16x32_bf16 v[16:19], v[72:75], a[200:203], v[16:19]
    v_mfma_f32_16x16x32_bf16 v[20:23], v[76:79], a[200:203], v[20:23]
    v_mfma_f32_16x16x32_bf16 v[24:27], v[72:75], v[88:91], v[24:27]
    v_mfma_f32_16x16x32_bf16 v[28:31], v[76:79], v[88:91], v[28:31]
    ds_read_b128 v[72:75], v7 offset:44032
    ds_read_b128 v[76:79], v7 offset:48128
    s_waitcnt lgkmcnt(6)
    v_mfma_f32_16x16x32_bf16 v[16:19], v[80:83], a[204:207], v[16:19]
    v_mfma_f32_16x16x32_bf16 v[20:23], v[84:87], a[204:207], v[20:23]
    v_mfma_f32_16x16x32_bf16 v[24:27], v[80:83], v[92:95], v[24:27]
    v_mfma_f32_16x16x32_bf16 v[28:31], v[84:87], v[92:95], v[28:31]
    ds_read_b128 v[88:91], v8 offset:20480
    ds_read_b128 v[92:95], v8 offset:21504
    s_waitcnt lgkmcnt(6)
    s_waitcnt lgkmcnt(4)
    v_mfma_f32_16x16x32_bf16 v[16:19], v[64:67], a[208:211], v[16:19]
    v_mfma_f32_16x16x32_bf16 v[20:23], v[68:71], a[208:211], v[20:23]
    v_mfma_f32_16x16x32_bf16 v[24:27], v[64:67], v[96:99], v[24:27]
    v_mfma_f32_16x16x32_bf16 v[28:31], v[68:71], v[96:99], v[28:31]
    s_waitcnt lgkmcnt(2)
    s_waitcnt vmcnt(0)
    s_barrier
    ds_read_b128 v[80:83], v7 offset:0
    ds_read_b128 v[84:87], v7 offset:4096
    ds_read_b128 v[64:67], v7 offset:1024
    ds_read_b128 v[68:71], v7 offset:5120
    v_mfma_f32_16x16x32_bf16 v[16:19], v[72:75], a[212:215], v[16:19]
    v_cmp_eq_u32 vcc, 0, v10
    v_mfma_f32_16x16x32_bf16 v[20:23], v[76:79], a[212:215], v[20:23]
    s_min_u32 s38, s12, 127
    s_lshl_b32 s38, s38, 15
    s_add_u32 s38, s38, 127926272
    s_add_u32 s16, s4, s38
    s_addc_u32 s17, s5, 0
    v_mfma_f32_16x16x32_bf16 v[24:27], v[72:75], v[100:103], v[24:27]
    s_cmp_eq_u64 vcc, 0
    s_cselect_b32 s38, 1, 0
    s_or_b32 s25, s25, s38
    v_mfma_f32_16x16x32_bf16 v[28:31], v[76:79], v[100:103], v[28:31]
    s_bitcmp1_b32 s25, 0
    s_cselect_b64 s[52:53], -1, 0
    ds_read_b128 v[72:75], v7 offset:2048
    ds_read_b128 v[76:79], v7 offset:6144
    ds_read_b128 v[96:99], v8 offset:22528
    ds_read_b128 v[100:103], v8 offset:23552
    s_waitcnt lgkmcnt(6)
    v_mfma_f32_16x16x32_bf16 v[16:19], v[80:83], a[216:219], v[16:19]
    s_add_u32 m0, s46, 16384
    v_mfma_f32_16x16x32_bf16 v[20:23], v[84:87], a[216:219], v[20:23]
    s_mov_b64 exec, s[52:53]
    global_load_lds_dwordx4 v2, s[16:17] offset:0 sc1
    s_mov_b64 exec, -1
    v_mfma_f32_16x16x32_bf16 v[24:27], v[80:83], v[88:91], v[24:27]
    s_add_u32 m0, s46, 17408
    v_xor_b32 v105, 2080, v2
    v_mfma_f32_16x16x32_bf16 v[28:31], v[84:87], v[88:91], v[28:31]
    s_mov_b64 exec, s[52:53]
    global_load_lds_dwordx4 v105, s[16:17] offset:0 sc1
    s_mov_b64 exec, -1
    ds_read_b128 v[80:83], v7 offset:3072
    ds_read_b128 v[84:87], v7 offset:7168
    s_waitcnt lgkmcnt(6)
    v_mfma_f32_16x16x32_bf16 v[16:19], v[64:67], a[220:223], v[16:19]
    s_add_u32 m0, s46, 18432
    v_xor_b32 v106, 4160, v2
    v_mfma_f32_16x16x32_bf16 v[20:23], v[68:71], a[220:223], v[20:23]
    s_mov_b64 exec, s[52:53]
    global_load_lds_dwordx4 v106, s[16:17] offset:0 sc1
    s_mov_b64 exec, -1
    v_mfma_f32_16x16x32_bf16 v[24:27], v[64:67], v[92:95], v[24:27]
    s_add_u32 m0, s46, 19456
    v_xor_b32 v107, 6240, v2
    v_mfma_f32_16x16x32_bf16 v[28:31], v[68:71], v[92:95], v[28:31]
    s_mov_b64 exec, s[52:53]
    global_load_lds_dwordx4 v107, s[16:17] offset:0 sc1
    s_mov_b64 exec, -1
    ds_read_b128 v[64:67], v7 offset:8192
    ds_read_b128 v[68:71], v7 offset:12288
    ds_read_b128 v[88:91], v8 offset:24576
    ds_read_b128 v[92:95], v8 offset:25600
    s_waitcnt lgkmcnt(8)
    s_waitcnt lgkmcnt(6)
    v_mfma_f32_16x16x32_bf16 v[16:19], v[72:75], a[224:227], v[16:19]
    s_add_u32 m0, s46, 32256
    v_mfma_f32_16x16x32_bf16 v[20:23], v[76:79], a[224:227], v[20:23]
    s_mov_b64 exec, s[52:53]
    global_load_lds_dwordx4 v2, s[16:17] offset:512 sc1
    s_mov_b64 exec, -1
    v_mfma_f32_16x16x32_bf16 v[24:27], v[72:75], v[96:99], v[24:27]
    s_add_u32 m0, s46, 33280
    v_xor_b32 v105, 2080, v2
    v_mfma_f32_16x16x32_bf16 v[28:31], v[76:79], v[96:99], v[28:31]
    s_mov_b64 exec, s[52:53]
    global_load_lds_dwordx4 v105, s[16:17] offset:512 sc1
    s_mov_b64 exec, -1
    ds_read_b128 v[72:75], v7 offset:9216
    ds_read_b128 v[76:79], v7 offset:13312
    s_waitcnt lgkmcnt(6)
    v_mfma_f32_16x16x32_bf16 v[16:19], v[80:83], a[228:231], v[16:19]
    s_add_u32 m0, s46, 34304
    v_xor_b32 v106, 4160, v2
    v_mfma_f32_16x16x32_bf16 v[20:23], v[84:87], a[228:231], v[20:23]
    s_mov_b64 exec, s[52:53]
    global_load_lds_dwordx4 v106, s[16:17] offset:512 sc1
    s_mov_b64 exec, -1
    v_mfma_f32_16x16x32_bf16 v[24:27], v[80:83], v[100:103], v[24:27]
    s_add_u32 m0, s46, 35328
    v_xor_b32 v107, 6240, v2
    v_mfma_f32_16x16x32_bf16 v[28:31], v[84:87], v[100:103], v[28:31]
    s_mov_b64 exec, s[52:53]
    global_load_lds_dwordx4 v107, s[16:17] offset:512 sc1
    s_mov_b64 exec, -1
    ds_read_b128 v[80:83], v7 offset:10240
    ds_read_b128 v[84:87], v7 offset:14336
    ds_read_b128 v[96:99], v8 offset:26624
    ds_read_b128 v[100:103], v8 offset:27648
    s_waitcnt lgkmcnt(8)
    s_waitcnt lgkmcnt(6)
    v_mfma_f32_16x16x32_bf16 v[16:19], v[64:67], a[232:235], v[16:19]
    v_mfma_f32_16x16x32_bf16 v[20:23], v[68:71], a[232:235], v[20:23]
    v_mfma_f32_16x16x32_bf16 v[24:27], v[64:67], v[88:91], v[24:27]
    v_mfma_f32_16x16x32_bf16 v[28:31], v[68:71], v[88:91], v[28:31]
    ds_read_b128 v[64:67], v7 offset:11264
    ds_read_b128 v[68:71], v7 offset:15360
    s_waitcnt lgkmcnt(6)
    v_mfma_f32_16x16x32_bf16 v[16:19], v[72:75], a[236:239], v[16:19]
    v_mfma_f32_16x16x32_bf16 v[20:23], v[76:79], a[236:239], v[20:23]
    v_mfma_f32_16x16x32_bf16 v[24:27], v[72:75], v[92:95], v[24:27]
    v_mfma_f32_16x16x32_bf16 v[28:31], v[76:79], v[92:95], v[28:31]
    s_waitcnt lgkmcnt(4)
    s_waitcnt lgkmcnt(2)
    v_mfma_f32_16x16x32_bf16 v[16:19], v[80:83], a[240:243], v[16:19]
    v_mfma_f32_16x16x32_bf16 v[20:23], v[84:87], a[240:243], v[20:23]
    v_mfma_f32_16x16x32_bf16 v[24:27], v[80:83], v[96:99], v[24:27]
    v_mfma_f32_16x16x32_bf16 v[28:31], v[84:87], v[96:99], v[28:31]
    s_waitcnt lgkmcnt(0)
    s_barrier
    v_mfma_f32_16x16x32_bf16 v[16:19], v[64:67], a[244:247], v[16:19]
    v_mfma_f32_16x16x32_bf16 v[20:23], v[68:71], a[244:247], v[20:23]
    v_mfma_f32_16x16x32_bf16 v[24:27], v[64:67], v[100:103], v[24:27]
    v_mfma_f32_16x16x32_bf16 v[28:31], v[68:71], v[100:103], v[28:31]
    s_add_u32 s38, s37, 294912
    s_add_u32 s34, s20, s38
    s_addc_u32 s35, s21, 0
    s_add_u32 s32, s34, 140288
    s_addc_u32 s33, s35, 0
    s_sub_u32 s39, s23, 3
    s_bfe_u32 s39, s39, 0x10001
    s_xor_b32 s39, s39, 1
    v_cvt_pk_bf16_f32 v16, v16, v17
    v_cvt_pk_bf16_f32 v17, v24, v25
    v_cvt_pk_bf16_f32 v18, v18, v19
    v_cvt_pk_bf16_f32 v19, v26, v27
    v_and_or_b32 v16, v16, -2, s39
    global_store_dwordx2 v11, v[16:17], s[34:35] sc1
    v_and_or_b32 v18, v18, -2, s39
    global_store_dwordx2 v12, v[18:19], s[34:35] sc1
    v_cvt_pk_bf16_f32 v20, v20, v21
    v_cvt_pk_bf16_f32 v21, v28, v29
    v_cvt_pk_bf16_f32 v22, v22, v23
    v_cvt_pk_bf16_f32 v23, v30, v31
    v_and_or_b32 v20, v20, -2, s39
    global_store_dwordx2 v11, v[20:21], s[32:33] sc1
    v_and_or_b32 v22, v22, -2, s39
    global_store_dwordx2 v12, v[22:23], s[32:33] sc1
    s_nop 0
L_g_151:
    s_lshr_b32 s40, s7, 4
    s_cmp_eq_u32 s40, 0
    s_cselect_b32 s24, s62, s63
    s_cmp_ge_u32 s24, 64
    s_cbranch_scc1 L_rd_154
    s_and_b32 s60, s7, 15
    s_mul_i32 s38, s60, 17536
    s_mul_i32 s39, s40, 294912
    s_add_u32 s38, s38, s39
    s_lshl_b32 s39, s9, 9
    s_add_u32 s38, s38, s39
    s_add_u32 s38, s38, s37
    s_add_u32 s28, s20, s38
    s_addc_u32 s29, s21, 0
    v_lshrrev_b32 v49, 1, v1
    v_add_u32 v50, 4352, v49
    v_add_u32 v51, 8704, v49
    v_add_u32 v52, 13056, v49
    global_load_dwordx2 v[32:33], v49, s[28:29] offset:0 sc1
    global_load_dwordx2 v[34:35], v49, s[28:29] offset:2176 sc1
    global_load_dwordx2 v[36:37], v50, s[28:29] offset:0 sc1
    global_load_dwordx2 v[38:39], v50, s[28:29] offset:2176 sc1
    global_load_dwordx2 v[40:41], v51, s[28:29] offset:0 sc1
    global_load_dwordx2 v[42:43], v51, s[28:29] offset:2176 sc1
    global_load_dwordx2 v[44:45], v52, s[28:29] offset:0 sc1
    global_load_dwordx2 v[46:47], v52, s[28:29] offset:2176 sc1
    s_lshl_b32 s60, s60, 1
    s_and_b32 s38, s9, 1
    s_add_u32 s60, s60, s38
    s_lshl_b32 s38, s24, 5
    s_add_u32 s60, s60, s38
    s_lshl_b32 s38, s60, 10
    s_add_u32 s30, s4, s38
    s_addc_u32 s31, s5, 0
    s_add_u32 s32, s50, s38
    s_addc_u32 s33, s51, 0
    s_add_u32 s34, s30, 130023424
    s_addc_u32 s35, s31, 0
    s_cmp_eq_u32 s40, 0
    s_cselect_b64 s[32:33], s[32:33], s[34:35]
    global_load_dwordx4 v[60:63], v1, s[32:33] sc1
    s_lshl_b32 s38, s40, 21
    s_add_u32 s30, s30, s38
    s_addc_u32 s31, s31, 0
    s_lshl_b32 s38, s40, 13
    s_lshl_b32 s39, s60, 2
    s_add_u32 s38, s38, s39
    s_add_u32 s38, s38, 117456896
    s_add_u32 s100, s4, s38
    s_addc_u32 s101, s5, 0
    v_lshrrev_b32 v48, 6, v1
    v_lshlrev_b32 v48, 5, v48
    v_bfe_u32 v64, v1, 4, 2
    v_lshl_add_u32 v48, v64, 2, v48
    s_lshl_b32 s38, s9, 9
    s_add_u32 s38, s38, 114688
    v_add_u32 v48, s38, v48
    s_lshl_b32 s38, s9, 11
    s_add_u32 s38, s38, 114688
    v_lshl_add_u32 v56, v1, 1, s38
    s_mul_i32 s40, s40, 3
    s_sub_u32 s40, s23, s40
    s_bfe_u32 s40, s40, 0x10001
    s_xor_b32 s40, s40, 1
    s_sub_u32 s40, 0, s40
    s_mov_b32 s41, 2097152
L_rp_156:
    s_waitcnt vmcnt(0)
    v_bitop3_b32 v64, v32, v34, s40 bitop3:0x7e
    v_bitop3_b32 v65, v36, v38, s40 bitop3:0x7e
    v_bitop3_b32 v66, v40, v42, s40 bitop3:0x7e
    v_bitop3_b32 v67, v44, v46, s40 bitop3:0x7e
    v_or3_b32 v64, v64, v65, v66
    v_bitop3_b32 v64, v64, v67, 1 bitop3:0xa8
    v_cmp_ne_u32 vcc, 0, v64
    s_nop 4
    s_cbranch_vccz L_rg_157
    s_mov_b64 exec, vcc
    global_load_dwordx2 v[32:33], v49, s[28:29] offset:0 sc1
    global_load_dwordx2 v[34:35], v49, s[28:29] offset:2176 sc1
    global_load_dwordx2 v[36:37], v50, s[28:29] offset:0 sc1
    global_load_dwordx2 v[38:39], v50, s[28:29] offset:2176 sc1
    global_load_dwordx2 v[40:41], v51, s[28:29] offset:0 sc1
    global_load_dwordx2 v[42:43], v51, s[28:29] offset:2176 sc1
    global_load_dwordx2 v[44:45], v52, s[28:29] offset:0 sc1
    global_load_dwordx2 v[46:47], v52, s[28:29] offset:2176 sc1
    s_mov_b64 exec, -1
    s_sub_u32 s41, s41, 1
    s_cmp_eq_u32 s41, 0
    s_cbranch_scc1 L_end_128
    s_branch L_rp_156
L_rg_157:
    v_lshlrev_b32 v16, 16, v32
    v_and_b32 v17, 0xffff0000, v32
    v_lshlrev_b32 v18, 16, v33
    v_and_b32 v19, 0xffff0000, v33
    v_lshlrev_b32 v20, 16, v34
    v_and_b32 v21, 0xffff0000, v34
    v_lshlrev_b32 v22, 16, v35
    v_and_b32 v23, 0xffff0000, v35
    v_lshlrev_b32 v24, 16, v36
    v_and_b32 v25, 0xffff0000, v36
    v_lshlrev_b32 v26, 16, v37
    v_and_b32 v27, 0xffff0000, v37
    v_lshlrev_b32 v28, 16, v38
    v_and_b32 v29, 0xffff0000, v38
    v_lshlrev_b32 v30, 16, v39
    v_and_b32 v31, 0xffff0000, v39
    v_lshlrev_b32 v32, 16, v40
    v_and_b32 v33, 0xffff0000, v40
    v_lshlrev_b32 v34, 16, v41
    v_and_b32 v35, 0xffff0000, v41
    v_lshlrev_b32 v36, 16, v42
    v_and_b32 v37, 0xffff0000, v42
    v_lshlrev_b32 v38, 16, v43
    v_and_b32 v39, 0xffff0000, v43
    v_pk_add_f32 v[16:17], v[16:17], v[32:33]
    v_pk_add_f32 v[18:19], v[18:19], v[34:35]
    v_pk_add_f32 v[20:21], v[20:21], v[36:37]
    v_pk_add_f32 v[22:23], v[22:23], v[38:39]
    v_lshlrev_b32 v32, 16, v44
    v_and_b32 v33, 0xffff0000, v44
    v_lshlrev_b32 v34, 16, v45
    v_and_b32 v35, 0xffff0000, v45
    v_lshlrev_b32 v36, 16, v46
    v_and_b32 v37, 0xffff0000, v46
    v_lshlrev_b32 v38, 16, v47
    v_and_b32 v39, 0xffff0000, v47
    v_pk_add_f32 v[24:25], v[24:25], v[32:33]
    v_pk_add_f32 v[26:27], v[26:27], v[34:35]
    v_pk_add_f32 v[28:29], v[28:29], v[36:37]
    v_pk_add_f32 v[30:31], v[30:31], v[38:39]
    v_pk_add_f32 v[16:17], v[16:17], v[24:25]
    v_pk_add_f32 v[18:19], v[18:19], v[26:27]
    v_pk_add_f32 v[20:21], v[20:21], v[28:29]
    v_pk_add_f32 v[22:23], v[22:23], v[30:31]
    v_pk_add_f32 v[16:17], v[16:17], v[20:21]
    v_pk_add_f32 v[18:19], v[18:19], v[22:23]
    ds_write2_b32 v48, v16, v18 offset0:0 offset1:4
    v_add_u32 v49, 2048, v48
    ds_write2_b32 v49, v17, v19 offset0:0 offset1:4
    s_waitcnt lgkmcnt(0)
    s_barrier
    s_cmp_ge_u32 s9, 2
    s_cbranch_scc1 L_re_155
    ds_read_b128 v[16:19], v56
    ds_read_b128 v[20:23], v56 offset:16
    s_waitcnt lgkmcnt(0)
    v_cvt_pk_bf16_f32 v40, v16, v17
    v_cvt_pk_bf16_f32 v41, v18, v19
    v_cvt_pk_bf16_f32 v42, v20, v21
    v_cvt_pk_bf16_f32 v43, v22, v23
    v_lshlrev_b32 v16, 16, v40
    v_and_b32 v17, 0xffff0000, v40
    v_lshlrev_b32 v18, 16, v41
    v_and_b32 v19, 0xffff0000, v41
    v_lshlrev_b32 v20, 16, v42
    v_and_b32 v21, 0xffff0000, v42
    v_lshlrev_b32 v22, 16, v43
    v_and_b32 v23, 0xffff0000, v43
    v_lshlrev_b32 v24, 16, v60
    v_and_b32 v25, 0xffff0000, v60
    v_lshlrev_b32 v26, 16, v61
    v_and_b32 v27, 0xffff0000, v61
    v_lshlrev_b32 v28, 16, v62
    v_and_b32 v29, 0xffff0000, v62
    v_lshlrev_b32 v30, 16, v63
    v_and_b32 v31, 0xffff0000, v63
    v_pk_add_f32 v[24:25], v[24:25], v[16:17]
    v_pk_add_f32 v[26:27], v[26:27], v[18:19]
    v_pk_add_f32 v[28:29], v[28:29], v[20:21]
    v_pk_add_f32 v[30:31], v[30:31], v[22:23]
    v_cvt_pk_bf16_f32 v64, v24, v25
    v_cvt_pk_bf16_f32 v65, v26, v27
    v_cvt_pk_bf16_f32 v66, v28, v29
    v_cvt_pk_bf16_f32 v67, v30, v31
    v_add_u32 v48, 123731968, v1
    global_store_dwordx4 v48, v[64:67], s[30:31] sc1
    v_lshlrev_b32 v24, 16, v64
    v_and_b32 v25, 0xffff0000, v64
    v_lshlrev_b32 v26, 16, v65
    v_and_b32 v27, 0xffff0000, v65
    v_lshlrev_b32 v28, 16, v66
    v_and_b32 v29, 0xffff0000, v66
    v_lshlrev_b32 v30, 16, v67
    v_and_b32 v31, 0xffff0000, v67
    v_pk_add_f32 v[32:33], v[24:25], v[26:27]
    v_pk_add_f32 v[34:35], v[28:29], v[30:31]
    v_pk_add_f32 v[32:33], v[32:33], v[34:35]
    v_add_f32 v44, v32, v33
    s_nop 1
    v_add_f32_dpp v45, v44, v44 quad_perm:[1,0,3,2] row_mask:0xf bank_mask:0xf
    s_nop 1
    v_add_f32_dpp v44, v45, v45 quad_perm:[2,3,0,1] row_mask:0xf bank_mask:0xf
    s_nop 1
    v_add_f32_dpp v45, v44, v44 row_half_mirror row_mask:0xf bank_mask:0xf
    s_nop 1
    v_add_f32_dpp v44, v45, v45 row_mirror row_mask:0xf bank_mask:0xf
    v_mov_b32 v45, v44
    s_nop 1
    v_permlane16_swap_b32 v45, v44
    v_add_f32 v44, v44, v45
    v_mov_b32 v45, v44
    s_nop 1
    v_permlane32_swap_b32 v45, v44
    v_add_f32 v44, v44, v45
    v_mul_f32 v44, 0x3b000000, v44
    v_pk_add_f32 v[32:33], v[24:25], v[44:45] op_sel_hi:[1,0] neg_lo:[0,1] neg_hi:[0,1]
    v_pk_add_f32 v[34:35], v[26:27], v[44:45] op_sel_hi:[1,0] neg_lo:[0,1] neg_hi:[0,1]
    v_pk_add_f32 v[36:37], v[28:29], v[44:45] op_sel_hi:[1,0] neg_lo:[0,1] neg_hi:[0,1]
    v_pk_add_f32 v[38:39], v[30:31], v[44:45] op_sel_hi:[1,0] neg_lo:[0,1] neg_hi:[0,1]
    v_pk_mul_f32 v[46:47], v[32:33], v[32:33]
    v_pk_fma_f32 v[46:47], v[34:35], v[34:35], v[46:47]
    v_pk_fma_f32 v[46:47], v[36:37], v[36:37], v[46:47]
    v_pk_fma_f32 v[46:47], v[38:39], v[38:39], v[46:47]
    v_add_f32 v46, v46, v47
    s_nop 1
    v_add_f32_dpp v47, v46, v46 quad_perm:[1,0,3,2] row_mask:0xf bank_mask:0xf
    s_nop 1
    v_add_f32_dpp v46, v47, v47 quad_perm:[2,3,0,1] row_mask:0xf bank_mask:0xf
    s_nop 1
    v_add_f32_dpp v47, v46, v46 row_half_mirror row_mask:0xf bank_mask:0xf
    s_nop 1
    v_add_f32_dpp v46, v47, v47 row_mirror row_mask:0xf bank_mask:0xf
    v_mov_b32 v47, v46
    s_nop 1
    v_permlane16_swap_b32 v47, v46
    v_add_f32 v46, v46, v47
    v_mov_b32 v47, v46
    s_nop 1
    v_permlane32_swap_b32 v47, v46
    v_add_f32 v46, v46, v47
    v_mul_f32 v46, 0x3b000000, v46
    v_cvt_pk_bf16_f32 v44, v44, v44
    v_and_b32 v44, 0xffff0000, v44
    v_cvt_pk_bf16_f32 v46, v46, v46
    v_and_b32 v46, 0xffff0000, v46
    v_add_f32 v46, 0x3727c5ac, v46
    v_cvt_pk_bf16_f32 v46, v46, v46
    v_and_b32 v46, 0xffff0000, v46
    v_sqrt_f32 v46, v46
    s_nop 0
    v_cvt_pk_bf16_f32 v46, v46, v46
    v_and_b32 v46, 0xffff0000, v46
    v_rcp_f32 v46, v46
    v_pk_add_f32 v[32:33], v[24:25], v[44:45] op_sel_hi:[1,0] neg_lo:[0,1] neg_hi:[0,1]
    v_pk_add_f32 v[34:35], v[26:27], v[44:45] op_sel_hi:[1,0] neg_lo:[0,1] neg_hi:[0,1]
    v_pk_add_f32 v[36:37], v[28:29], v[44:45] op_sel_hi:[1,0] neg_lo:[0,1] neg_hi:[0,1]
    v_pk_add_f32 v[38:39], v[30:31], v[44:45] op_sel_hi:[1,0] neg_lo:[0,1] neg_hi:[0,1]
    v_cvt_pk_bf16_f32 v40, v32, v33
    v_cvt_pk_bf16_f32 v41, v34, v35
    v_cvt_pk_bf16_f32 v42, v36, v37
    v_cvt_pk_bf16_f32 v43, v38, v39
    v_lshlrev_b32 v32, 16, v40
    v_and_b32 v33, 0xffff0000, v40
    v_lshlrev_b32 v34, 16, v41
    v_and_b32 v35, 0xffff0000, v41
    v_lshlrev_b32 v36, 16, v42
    v_and_b32 v37, 0xffff0000, v42
    v_lshlrev_b32 v38, 16, v43
    v_and_b32 v39, 0xffff0000, v43
    v_pk_mul_f32 v[32:33], v[32:33], v[46:47] op_sel_hi:[1,0]
    v_pk_mul_f32 v[34:35], v[34:35], v[46:47] op_sel_hi:[1,0]
    v_pk_mul_f32 v[36:37], v[36:37], v[46:47] op_sel_hi:[1,0]
    v_pk_mul_f32 v[38:39], v[38:39], v[46:47] op_sel_hi:[1,0]
    v_cvt_pk_bf16_f32 v40, v32, v33
    v_cvt_pk_bf16_f32 v41, v34, v35
    v_cvt_pk_bf16_f32 v42, v36, v37
    v_cvt_pk_bf16_f32 v43, v38, v39
    v_min_u32 v40, -2, v40
    v_add_u32 v50, 119537664, v1
    global_store_dwordx4 v50, v[40:43], s[30:31] sc1
    s_bitset1_b32 s59, 1
    s_nop 0
    s_branch L_re_155
L_rd_154:
    s_waitcnt vmcnt(0)
L_re_155:
L_g_137:
    s_cmp_ge_u32 s12, 64
    s_cbranch_scc1 L_g_158
    s_bitcmp1_b32 s25, 0
    s_cbranch_scc1 L_q1p_159
    s_lshl_b32 s38, s12, 7
    s_lshl_b32 s39, s9, 5
    s_add_u32 s38, s38, s39
    s_add_u32 s38, s38, 117473280
    v_bfe_u32 v15, v1, 4, 3
    v_lshlrev_b32 v15, 2, v15
    v_add_u32 v15, s38, v15
    s_waitcnt vmcnt(0)
    s_bitcmp1_b32 s59, 1
    s_cselect_b64 exec, 1, 0
    global_store_dword v14, v13, s[100:101] sc1
    s_mov_b64 exec, -1
    s_bitset0_b32 s59, 1
    s_mov_b32 s41, 2097152
L_pf_160:
    global_load_dword v10, v15, s[4:5] sc1
    s_sub_u32 s41, s41, 1
    s_cmp_eq_u32 s41, 0
    s_cbranch_scc1 L_end_128
    s_waitcnt vmcnt(0)
    v_cmp_eq_u32 vcc, 0, v10
    s_nop 4
    s_cbranch_vccnz L_pf_160
    s_min_u32 s38, s12, 127
    s_lshl_b32 s38, s38, 15
    s_add_u32 s38, s38, 127926272
    s_add_u32 s16, s4, s38
    s_addc_u32 s17, s5, 0
    s_add_u32 m0, s46, 16384
    s_nop 0
    global_load_lds_dwordx4 v2, s[16:17] offset:0 sc1
    s_add_u32 m0, s46, 17408
    v_xor_b32 v105, 2080, v2
    global_load_lds_dwordx4 v105, s[16:17] offset:0 sc1
    s_add_u32 m0, s46, 18432
    v_xor_b32 v106, 4160, v2
    global_load_lds_dwordx4 v106, s[16:17] offset:0 sc1
    s_add_u32 m0, s46, 19456
    v_xor_b32 v107, 6240, v2
    global_load_lds_dwordx4 v107, s[16:17] offset:0 sc1
    s_add_u32 m0, s46, 32256
    s_nop 0
    global_load_lds_dwordx4 v2, s[16:17] offset:512 sc1
    s_add_u32 m0, s46, 33280
    v_xor_b32 v105, 2080, v2
    global_load_lds_dwordx4 v105, s[16:17] offset:512 sc1
    s_add_u32 m0, s46, 34304
    v_xor_b32 v106, 4160, v2
    global_load_lds_dwordx4 v106, s[16:17] offset:512 sc1
    s_add_u32 m0, s46, 35328
    v_xor_b32 v107, 6240, v2
    global_load_lds_dwordx4 v107, s[16:17] offset:512 sc1
    s_waitcnt vmcnt(4)
L_q1p_159:
    s_barrier
    s_mov_b32 s24, s12
    ds_read_b128 v[64:67], v3 offset:16384
    ds_read_b128 v[68:71], v3 offset:24576
    ds_read_b128 v[72:75], v4 offset:16384
    ds_read_b128 v[76:79], v4 offset:24576
    ds_read_b128 v[80:83], v5 offset:16384
    ds_read_b128 v[84:87], v5 offset:24576
    ds_read_b128 v[96:99], v8 offset:0
    ds_read_b128 v[100:103], v8 offset:1024
    s_waitcnt lgkmcnt(6)
    v_mfma_f32_16x16x32_bf16 v[16:19], v[112:115], v[64:67], 0
    v_mfma_f32_16x16x32_bf16 v[20:23], v[112:115], v[68:71], 0
    v_mfma_f32_16x16x32_bf16 v[24:27], v[176:179], v[64:67], 0
    v_mfma_f32_16x16x32_bf16 v[28:31], v[176:179], v[68:71], 0
    v_mfma_f32_16x16x32_bf16 v[32:35], v[240:243], v[64:67], 0
    v_mfma_f32_16x16x32_bf16 v[36:39], v[240:243], v[68:71], 0
    v_mfma_f32_16x16x32_bf16 v[40:43], a[48:51], v[64:67], 0
    v_mfma_f32_16x16x32_bf16 v[44:47], a[48:51], v[68:71], 0
    v_mfma_f32_16x16x32_bf16 v[48:51], v[64:67], a[112:115], 0
    v_mfma_f32_16x16x32_bf16 v[52:55], v[68:71], a[112:115], 0
    v_mfma_f32_16x16x32_bf16 v[56:59], v[64:67], a[176:179], 0
    v_mfma_f32_16x16x32_bf16 v[60:63], v[68:71], a[176:179], 0
    ds_read_b128 v[64:67], v6 offset:16384
    ds_read_b128 v[68:71], v6 offset:24576
    s_waitcnt lgkmcnt(6)
    v_mfma_f32_16x16x32_bf16 v[16:19], v[116:119], v[72:75], v[16:19]
    v_mfma_f32_16x16x32_bf16 v[20:23], v[116:119], v[76:79], v[20:23]
    v_mfma_f32_16x16x32_bf16 v[24:27], v[180:183], v[72:75], v[24:27]
    v_mfma_f32_16x16x32_bf16 v[28:31], v[180:183], v[76:79], v[28:31]
    v_mfma_f32_16x16x32_bf16 v[32:35], v[244:247], v[72:75], v[32:35]
    v_mfma_f32_16x16x32_bf16 v[36:39], v[244:247], v[76:79], v[36:39]
    v_mfma_f32_16x16x32_bf16 v[40:43], a[52:55], v[72:75], v[40:43]
    v_mfma_f32_16x16x32_bf16 v[44:47], a[52:55], v[76:79], v[44:47]
    v_mfma_f32_16x16x32_bf16 v[48:51], v[72:75], a[116:119], v[48:51]
    v_mfma_f32_16x16x32_bf16 v[52:55], v[76:79], a[116:119], v[52:55]
    v_mfma_f32_16x16x32_bf16 v[56:59], v[72:75], a[180:183], v[56:59]
    v_mfma_f32_16x16x32_bf16 v[60:63], v[76:79], a[180:183], v[60:63]
    ds_read_b128 v[72:75], v3 offset:16640
    ds_read_b128 v[76:79], v3 offset:24832
    ds_read_b128 v[88:91], v8 offset:2048
    ds_read_b128 v[92:95], v8 offset:3072
    s_waitcnt lgkmcnt(8)
    s_waitcnt lgkmcnt(6)
    v_mfma_f32_16x16x32_bf16 v[16:19], v[120:123], v[80:83], v[16:19]
    v_mfma_f32_16x16x32_bf16 v[20:23], v[120:123], v[84:87], v[20:23]
    v_mfma_f32_16x16x32_bf16 v[24:27], v[184:187], v[80:83], v[24:27]
    v_mfma_f32_16x16x32_bf16 v[28:31], v[184:187], v[84:87], v[28:31]
    v_mfma_f32_16x16x32_bf16 v[32:35], v[248:251], v[80:83], v[32:35]
    v_mfma_f32_16x16x32_bf16 v[36:39], v[248:251], v[84:87], v[36:39]
    v_mfma_f32_16x16x32_bf16 v[40:43], a[56:59], v[80:83], v[40:43]
    v_mfma_f32_16x16x32_bf16 v[44:47], a[56:59], v[84:87], v[44:47]
    v_mfma_f32_16x16x32_bf16 v[48:51], v[80:83], a[120:123], v[48:51]
    v_mfma_f32_16x16x32_bf16 v[52:55], v[84:87], a[120:123], v[52:55]
    v_mfma_f32_16x16x32_bf16 v[56:59], v[80:83], v[96:99], v[56:59]
    v_mfma_f32_16x16x32_bf16 v[60:63], v[84:87], v[96:99], v[60:63]
    ds_read_b128 v[80:83], v4 offset:16640
    ds_read_b128 v[84:87], v4 offset:24832
    s_waitcnt lgkmcnt(6)
    v_mfma_f32_16x16x32_bf16 v[16:19], v[124:127], v[64:67], v[16:19]
    s_waitcnt vmcnt(0)
    v_mfma_f32_16x16x32_bf16 v[20:23], v[124:127], v[68:71], v[20:23]
    s_bitcmp1_b32 s59, 1
    s_cselect_b64 exec, 1, 0
    global_store_dword v14, v13, s[100:101] sc1
    s_mov_b64 exec, -1
    s_bitset0_b32 s59, 1
    v_mfma_f32_16x16x32_bf16 v[24:27], v[188:191], v[64:67], v[24:27]
    s_min_u32 s38, s13, 127
    s_lshl_b32 s38, s38, 15
    s_add_u32 s38, s38, 146800640
    s_add_u32 s16, s4, s38
    s_addc_u32 s17, s5, 0
    v_mfma_f32_16x16x32_bf16 v[28:31], v[188:191], v[68:71], v[28:31]
    s_cmp_lt_u32 s13, 64
    s_cselect_b32 s38, 2, 0
    s_or_b32 s25, s25, s38
    v_mfma_f32_16x16x32_bf16 v[32:35], v[252:255], v[64:67], v[32:35]
    s_bitcmp1_b32 s25, 1
    s_cselect_b64 s[52:53], -1, 0
    v_mfma_f32_16x16x32_bf16 v[36:39], v[252:255], v[68:71], v[36:39]
    s_add_u32 m0, s46, 0
    v_mfma_f32_16x16x32_bf16 v[40:43], a[60:63], v[64:67], v[40:43]
    s_mov_b64 exec, s[52:53]
    global_load_lds_dwordx4 v2, s[16:17] offset:0 sc1
    s_mov_b64 exec, -1
    v_mfma_f32_16x16x32_bf16 v[44:47], a[60:63], v[68:71], v[44:47]
    s_add_u32 m0, s46, 1024
    v_xor_b32 v105, 2080, v2
    v_mfma_f32_16x16x32_bf16 v[48:51], v[64:67], a[124:127], v[48:51]
    s_mov_b64 exec, s[52:53]
    global_load_lds_dwordx4 v105, s[16:17] offset:0 sc1
    s_mov_b64 exec, -1
    v_mfma_f32_16x16x32_bf16 v[52:55], v[68:71], a[124:127], v[52:55]
    s_add_u32 m0, s46, 2048
    v_xor_b32 v106, 4160, v2
    v_mfma_f32_16x16x32_bf16 v[56:59], v[64:67], v[100:103], v[56:59]
    s_mov_b64 exec, s[52:53]
    global_load_lds_dwordx4 v106, s[16:17] offset:0 sc1
    s_mov_b64 exec, -1
    v_mfma_f32_16x16x32_bf16 v[60:63], v[68:71], v[100:103], v[60:63]
    s_add_u32 m0, s46, 3072
    v_xor_b32 v107, 6240, v2
    ds_read_b128 v[64:67], v5 offset:16640
    ds_read_b128 v[68:71], v5 offset:24832
    ds_read_b128 v[96:99], v8 offset:4096
    ds_read_b128 v[100:103], v8 offset:5120
    s_waitcnt lgkmcnt(8)
    s_waitcnt lgkmcnt(6)
    v_mfma_f32_16x16x32_bf16 v[16:19], v[128:131], v[72:75], v[16:19]
    s_mov_b64 exec, s[52:53]
    global_load_lds_dwordx4 v107, s[16:17] offset:0 sc1
    s_mov_b64 exec, -1
    v_mfma_f32_16x16x32_bf16 v[20:23], v[128:131], v[76:79], v[20:23]
    v_mfma_f32_16x16x32_bf16 v[24:27], v[192:195], v[72:75], v[24:27]
    v_mfma_f32_16x16x32_bf16 v[28:31], v[192:195], v[76:79], v[28:31]
    v_mfma_f32_16x16x32_bf16 v[32:35], a[0:3], v[72:75], v[32:35]
    v_mfma_f32_16x16x32_bf16 v[36:39], a[0:3], v[76:79], v[36:39]
    v_mfma_f32_16x16x32_bf16 v[40:43], a[64:67], v[72:75], v[40:43]
    v_mfma_f32_16x16x32_bf16 v[44:47], a[64:67], v[76:79], v[44:47]
    v_mfma_f32_16x16x32_bf16 v[48:51], v[72:75], a[128:131], v[48:51]
    v_mfma_f32_16x16x32_bf16 v[52:55], v[76:79], a[128:131], v[52:55]
    v_mfma_f32_16x16x32_bf16 v[56:59], v[72:75], v[88:91], v[56:59]
    v_mfma_f32_16x16x32_bf16 v[60:63], v[76:79], v[88:91], v[60:63]
    ds_read_b128 v[72:75], v6 offset:16640
    ds_read_b128 v[76:79], v6 offset:24832
    s_waitcnt lgkmcnt(6)
    v_mfma_f32_16x16x32_bf16 v[16:19], v[132:135], v[80:83], v[16:19]
    v_mfma_f32_16x16x32_bf16 v[20:23], v[132:135], v[84:87], v[20:23]
    v_mfma_f32_16x16x32_bf16 v[24:27], v[196:199], v[80:83], v[24:27]
    v_mfma_f32_16x16x32_bf16 v[28:31], v[196:199], v[84:87], v[28:31]
    v_mfma_f32_16x16x32_bf16 v[32:35], a[4:7], v[80:83], v[32:35]
    v_mfma_f32_16x16x32_bf16 v[36:39], a[4:7], v[84:87], v[36:39]
    v_mfma_f32_16x16x32_bf16 v[40:43], a[68:71], v[80:83], v[40:43]
    v_mfma_f32_16x16x32_bf16 v[44:47], a[68:71], v[84:87], v[44:47]
    v_mfma_f32_16x16x32_bf16 v[48:51], v[80:83], a[132:135], v[48:51]
    v_mfma_f32_16x16x32_bf16 v[52:55], v[84:87], a[132:135], v[52:55]
    v_mfma_f32_16x16x32_bf16 v[56:59], v[80:83], v[92:95], v[56:59]
    v_mfma_f32_16x16x32_bf16 v[60:63], v[84:87], v[92:95], v[60:63]
    ds_read_b128 v[88:91], v8 offset:6144
    ds_read_b128 v[92:95], v8 offset:7168
    s_waitcnt lgkmcnt(6)
    s_waitcnt lgkmcnt(4)
    v_mfma_f32_16x16x32_bf16 v[16:19], v[136:139], v[64:67], v[16:19]
    v_mfma_f32_16x16x32_bf16 v[20:23], v[136:139], v[68:71], v[20:23]
    v_mfma_f32_16x16x32_bf16 v[24:27], v[200:203], v[64:67], v[24:27]
    v_mfma_f32_16x16x32_bf16 v[28:31], v[200:203], v[68:71], v[28:31]
    v_mfma_f32_16x16x32_bf16 v[32:35], a[8:11], v[64:67], v[32:35]
    v_mfma_f32_16x16x32_bf16 v[36:39], a[8:11], v[68:71], v[36:39]
    v_mfma_f32_16x16x32_bf16 v[40:43], a[72:75], v[64:67], v[40:43]
    v_mfma_f32_16x16x32_bf16 v[44:47], a[72:75], v[68:71], v[44:47]
    v_mfma_f32_16x16x32_bf16 v[48:51], v[64:67], a[136:139], v[48:51]
    v_mfma_f32_16x16x32_bf16 v[52:55], v[68:71], a[136:139], v[52:55]
    v_mfma_f32_16x16x32_bf16 v[56:59], v[64:67], v[96:99], v[56:59]
    v_mfma_f32_16x16x32_bf16 v[60:63], v[68:71], v[96:99], v[60:63]
    s_waitcnt lgkmcnt(2)
    s_waitcnt vmcnt(0)
    s_barrier
    ds_read_b128 v[80:83], v3 offset:32768
    ds_read_b128 v[84:87], v3 offset:40960
    ds_read_b128 v[64:67], v4 offset:32768
    ds_read_b128 v[68:71], v4 offset:40960
    v_mfma_f32_16x16x32_bf16 v[16:19], v[140:143], v[72:75], v[16:19]
    s_add_u32 m0, s46, 15872
    v_mfma_f32_16x16x32_bf16 v[20:23], v[140:143], v[76:79], v[20:23]
    s_mov_b64 exec, s[52:53]
    global_load_lds_dwordx4 v2, s[16:17] offset:512 sc1
    s_mov_b64 exec, -1
    v_mfma_f32_16x16x32_bf16 v[24:27], v[204:207], v[72:75], v[24:27]
    s_add_u32 m0, s46, 16896
    v_xor_b32 v105, 2080, v2
    v_mfma_f32_16x16x32_bf16 v[28:31], v[204:207], v[76:79], v[28:31]
    s_mov_b64 exec, s[52:53]
    global_load_lds_dwordx4 v105, s[16:17] offset:512 sc1
    s_mov_b64 exec, -1
    v_mfma_f32_16x16x32_bf16 v[32:35], a[12:15], v[72:75], v[32:35]
    s_add_u32 m0, s46, 17920
    v_xor_b32 v106, 4160, v2
    v_mfma_f32_16x16x32_bf16 v[36:39], a[12:15], v[76:79], v[36:39]
    s_mov_b64 exec, s[52:53]
    global_load_lds_dwordx4 v106, s[16:17] offset:512 sc1
    s_mov_b64 exec, -1
    v_mfma_f32_16x16x32_bf16 v[40:43], a[76:79], v[72:75], v[40:43]
    s_add_u32 m0, s46, 18944
    v_xor_b32 v107, 6240, v2
    v_mfma_f32_16x16x32_bf16 v[44:47], a[76:79], v[76:79], v[44:47]
    s_mov_b64 exec, s[52:53]
    global_load_lds_dwordx4 v107, s[16:17] offset:512 sc1
    s_mov_b64 exec, -1
    v_mfma_f32_16x16x32_bf16 v[48:51], v[72:75], a[140:143], v[48:51]
    v_mfma_f32_16x16x32_bf16 v[52:55], v[76:79], a[140:143], v[52:55]
    v_mfma_f32_16x16x32_bf16 v[56:59], v[72:75], v[100:103], v[56:59]
    v_mfma_f32_16x16x32_bf16 v[60:63], v[76:79], v[100:103], v[60:63]
    ds_read_b128 v[72:75], v5 offset:32768
    ds_read_b128 v[76:79], v5 offset:40960
    ds_read_b128 v[96:99], v8 offset:8192
    ds_read_b128 v[100:103], v8 offset:9216
    s_waitcnt lgkmcnt(6)
    v_mfma_f32_16x16x32_bf16 v[16:19], v[144:147], v[80:83], v[16:19]
    v_mfma_f32_16x16x32_bf16 v[20:23], v[144:147], v[84:87], v[20:23]
    v_mfma_f32_16x16x32_bf16 v[24:27], v[208:211], v[80:83], v[24:27]
    v_mfma_f32_16x16x32_bf16 v[28:31], v[208:211], v[84:87], v[28:31]
    v_mfma_f32_16x16x32_bf16 v[32:35], a[16:19], v[80:83], v[32:35]
    v_mfma_f32_16x16x32_bf16 v[36:39], a[16:19], v[84:87], v[36:39]
    v_mfma_f32_16x16x32_bf16 v[40:43], a[80:83], v[80:83], v[40:43]
    v_mfma_f32_16x16x32_bf16 v[44:47], a[80:83], v[84:87], v[44:47]
    v_mfma_f32_16x16x32_bf16 v[48:51], v[80:83], a[144:147], v[48:51]
    v_mfma_f32_16x16x32_bf16 v[52:55], v[84:87], a[144:147], v[52:55]
    v_mfma_f32_16x16x32_bf16 v[56:59], v[80:83], v[88:91], v[56:59]
    v_mfma_f32_16x16x32_bf16 v[60:63], v[84:87], v[88:91], v[60:63]
    ds_read_b128 v[80:83], v6 offset:32768
    ds_read_b128 v[84:87], v6 offset:40960
    s_waitcnt lgkmcnt(6)
    v_mfma_f32_16x16x32_bf16 v[16:19], v[148:151], v[64:67], v[16:19]
    v_mfma_f32_16x16x32_bf16 v[20:23], v[148:151], v[68:71], v[20:23]
    v_mfma_f32_16x16x32_bf16 v[24:27], v[212:215], v[64:67], v[24:27]
    v_mfma_f32_16x16x32_bf16 v[28:31], v[212:215], v[68:71], v[28:31]
    v_mfma_f32_16x16x32_bf16 v[32:35], a[20:23], v[64:67], v[32:35]
    v_mfma_f32_16x16x32_bf16 v[36:39], a[20:23], v[68:71], v[36:39]
    v_mfma_f32_16x16x32_bf16 v[40:43], a[84:87], v[64:67], v[40:43]
    v_mfma_f32_16x16x32_bf16 v[44:47], a[84:87], v[68:71], v[44:47]
    v_mfma_f32_16x16x32_bf16 v[48:51], v[64:67], a[148:151], v[48:51]
    v_mfma_f32_16x16x32_bf16 v[52:55], v[68:71], a[148:151], v[52:55]
    v_mfma_f32_16x16x32_bf16 v[56:59], v[64:67], v[92:95], v[56:59]
    v_mfma_f32_16x16x32_bf16 v[60:63], v[68:71], v[92:95], v[60:63]
    ds_read_b128 v[64:67], v3 offset:33024
    ds_read_b128 v[68:71], v3 offset:41216
    ds_read_b128 v[88:91], v8 offset:10240
    ds_read_b128 v[92:95], v8 offset:11264
    s_waitcnt lgkmcnt(8)
    s_waitcnt lgkmcnt(6)
    v_mfma_f32_16x16x32_bf16 v[16:19], v[152:155], v[72:75], v[16:19]
    v_mfma_f32_16x16x32_bf16 v[20:23], v[152:155], v[76:79], v[20:23]
    v_mfma_f32_16x16x32_bf16 v[24:27], v[216:219], v[72:75], v[24:27]
    v_mfma_f32_16x16x32_bf16 v[28:31], v[216:219], v[76:79], v[28:31]
    v_mfma_f32_16x16x32_bf16 v[32:35], a[24:27], v[72:75], v[32:35]
    v_mfma_f32_16x16x32_bf16 v[36:39], a[24:27], v[76:79], v[36:39]
    v_mfma_f32_16x16x32_bf16 v[40:43], a[88:91], v[72:75], v[40:43]
    v_mfma_f32_16x16x32_bf16 v[44:47], a[88:91], v[76:79], v[44:47]
    v_mfma_f32_16x16x32_bf16 v[48:51], v[72:75], a[152:155], v[48:51]
    v_mfma_f32_16x16x32_bf16 v[52:55], v[76:79], a[152:155], v[52:55]
    v_mfma_f32_16x16x32_bf16 v[56:59], v[72:75], v[96:99], v[56:59]
    v_mfma_f32_16x16x32_bf16 v[60:63], v[76:79], v[96:99], v[60:63]
    ds_read_b128 v[72:75], v4 offset:33024
    ds_read_b128 v[76:79], v4 offset:41216
    s_waitcnt lgkmcnt(6)
    v_mfma_f32_16x16x32_bf16 v[16:19], v[156:159], v[80:83], v[16:19]
    v_mfma_f32_16x16x32_bf16 v[20:23], v[156:159], v[84:87], v[20:23]
    v_mfma_f32_16x16x32_bf16 v[24:27], v[220:223], v[80:83], v[24:27]
    v_mfma_f32_16x16x32_bf16 v[28:31], v[220:223], v[84:87], v[28:31]
    v_mfma_f32_16x16x32_bf16 v[32:35], a[28:31], v[80:83], v[32:35]
    v_mfma_f32_16x16x32_bf16 v[36:39], a[28:31], v[84:87], v[36:39]
    v_mfma_f32_16x16x32_bf16 v[40:43], a[92:95], v[80:83], v[40:43]
    v_mfma_f32_16x16x32_bf16 v[44:47], a[92:95], v[84:87], v[44:47]
    v_mfma_f32_16x16x32_bf16 v[48:51], v[80:83], a[156:159], v[48:51]
    v_mfma_f32_16x16x32_bf16 v[52:55], v[84:87], a[156:159], v[52:55]
    v_mfma_f32_16x16x32_bf16 v[56:59], v[80:83], v[100:103], v[56:59]
    v_mfma_f32_16x16x32_bf16 v[60:63], v[84:87], v[100:103], v[60:63]
    ds_read_b128 v[80:83], v5 offset:33024
    ds_read_b128 v[84:87], v5 offset:41216
    ds_read_b128 v[96:99], v8 offset:12288
    ds_read_b128 v[100:103], v8 offset:13312
    s_waitcnt lgkmcnt(8)
    s_waitcnt lgkmcnt(6)
    v_mfma_f32_16x16x32_bf16 v[16:19], v[160:163], v[64:67], v[16:19]
    v_mfma_f32_16x16x32_bf16 v[20:23], v[160:163], v[68:71], v[20:23]
    v_mfma_f32_16x16x32_bf16 v[24:27], v[224:227], v[64:67], v[24:27]
    v_mfma_f32_16x16x32_bf16 v[28:31], v[224:227], v[68:71], v[28:31]
    v_mfma_f32_16x16x32_bf16 v[32:35], a[32:35], v[64:67], v[32:35]
    v_mfma_f32_16x16x32_bf16 v[36:39], a[32:35], v[68:71], v[36:39]
    v_mfma_f32_16x16x32_bf16 v[40:43], a[96:99], v[64:67], v[40:43]
    v_mfma_f32_16x16x32_bf16 v[44:47], a[96:99], v[68:71], v[44:47]
    v_mfma_f32_16x16x32_bf16 v[48:51], v[64:67], a[160:163], v[48:51]
    v_mfma_f32_16x16x32_bf16 v[52:55], v[68:71], a[160:163], v[52:55]
    v_mfma_f32_16x16x32_bf16 v[56:59], v[64:67], v[88:91], v[56:59]
    v_mfma_f32_16x16x32_bf16 v[60:63], v[68:71], v[88:91], v[60:63]
    ds_read_b128 v[64:67], v6 offset:33024
    ds_read_b128 v[68:71], v6 offset:41216
    s_waitcnt lgkmcnt(6)
    v_mfma_f32_16x16x32_bf16 v[16:19], v[164:167], v[72:75], v[16:19]
    v_mfma_f32_16x16x32_bf16 v[20:23], v[164:167], v[76:79], v[20:23]
    v_mfma_f32_16x16x32_bf16 v[24:27], v[228:231], v[72:75], v[24:27]
    v_mfma_f32_16x16x32_bf16 v[28:31], v[228:231], v[76:79], v[28:31]
    v_mfma_f32_16x16x32_bf16 v[32:35], a[36:39], v[72:75], v[32:35]
    v_mfma_f32_16x16x32_bf16 v[36:39], a[36:39], v[76:79], v[36:39]
    v_mfma_f32_16x16x32_bf16 v[40:43], a[100:103], v[72:75], v[40:43]
    v_mfma_f32_16x16x32_bf16 v[44:47], a[100:103], v[76:79], v[44:47]
    v_mfma_f32_16x16x32_bf16 v[48:51], v[72:75], a[164:167], v[48:51]
    v_mfma_f32_16x16x32_bf16 v[52:55], v[76:79], a[164:167], v[52:55]
    v_mfma_f32_16x16x32_bf16 v[56:59], v[72:75], v[92:95], v[56:59]
    v_mfma_f32_16x16x32_bf16 v[60:63], v[76:79], v[92:95], v[60:63]
    s_waitcnt lgkmcnt(4)
    s_waitcnt lgkmcnt(2)
    v_mfma_f32_16x16x32_bf16 v[16:19], v[168:171], v[80:83], v[16:19]
    v_mfma_f32_16x16x32_bf16 v[20:23], v[168:171], v[84:87], v[20:23]
    v_mfma_f32_16x16x32_bf16 v[24:27], v[232:235], v[80:83], v[24:27]
    v_mfma_f32_16x16x32_bf16 v[28:31], v[232:235], v[84:87], v[28:31]
    v_mfma_f32_16x16x32_bf16 v[32:35], a[40:43], v[80:83], v[32:35]
    v_mfma_f32_16x16x32_bf16 v[36:39], a[40:43], v[84:87], v[36:39]
    v_mfma_f32_16x16x32_bf16 v[40:43], a[104:107], v[80:83], v[40:43]
    v_mfma_f32_16x16x32_bf16 v[44:47], a[104:107], v[84:87], v[44:47]
    v_mfma_f32_16x16x32_bf16 v[48:51], v[80:83], a[168:171], v[48:51]
    v_mfma_f32_16x16x32_bf16 v[52:55], v[84:87], a[168:171], v[52:55]
    v_mfma_f32_16x16x32_bf16 v[56:59], v[80:83], v[96:99], v[56:59]
    v_mfma_f32_16x16x32_bf16 v[60:63], v[84:87], v[96:99], v[60:63]
    s_waitcnt lgkmcnt(0)
    s_barrier
    v_mfma_f32_16x16x32_bf16 v[16:19], v[172:175], v[64:67], v[16:19]
    v_mfma_f32_16x16x32_bf16 v[20:23], v[172:175], v[68:71], v[20:23]
    v_mfma_f32_16x16x32_bf16 v[24:27], v[236:239], v[64:67], v[24:27]
    v_mfma_f32_16x16x32_bf16 v[28:31], v[236:239], v[68:71], v[28:31]
    v_mfma_f32_16x16x32_bf16 v[32:35], a[44:47], v[64:67], v[32:35]
    v_mfma_f32_16x16x32_bf16 v[36:39], a[44:47], v[68:71], v[36:39]
    v_mfma_f32_16x16x32_bf16 v[40:43], a[108:111], v[64:67], v[40:43]
    v_mfma_f32_16x16x32_bf16 v[44:47], a[108:111], v[68:71], v[44:47]
    v_mfma_f32_16x16x32_bf16 v[48:51], v[64:67], a[172:175], v[48:51]
    v_mfma_f32_16x16x32_bf16 v[52:55], v[68:71], a[172:175], v[52:55]
    v_mfma_f32_16x16x32_bf16 v[56:59], v[64:67], v[100:103], v[56:59]
    v_mfma_f32_16x16x32_bf16 v[60:63], v[68:71], v[100:103], v[60:63]
    s_min_u32 s38, s24, 127
    s_lshl_b32 s38, s38, 19
    s_lshl_b32 s39, s7, 14
    s_add_u32 s38, s38, s39
    s_add_u32 s38, s38, 33554432
    s_add_u32 s28, s4, s38
    s_addc_u32 s29, s5, 0
    s_min_u32 s38, s24, 127
    s_lshl_b32 s38, s38, 18
    s_lshl_b32 s39, s7, 13
    s_add_u32 s38, s38, s39
    s_add_u32 s38, s38, 83886080
    s_add_u32 s30, s4, s38
    s_addc_u32 s31, s5, 0
    s_min_u32 s38, s24, 127
    s_lshl_b32 s38, s38, 7
    s_lshl_b32 s39, s7, 2
    s_add_u32 s38, s38, s39
    s_add_u32 s38, s38, 117448704
    s_add_u32 s56, s4, s38
    s_addc_u32 s57, s5, 0
    s_min_u32 s38, s24, 127
    s_lshl_b32 s38, s38, 17
    s_lshl_b32 s39, s7, 12
    s_add_u32 s38, s38, s39
    s_add_u32 s38, s38, 109051904
    s_add_u32 s32, s4, s38
    s_addc_u32 s33, s5, 0
    v_mov_b32 v92, -1
    v_mov_b32 v93, -1
    v_mov_b32 v94, -1
    v_mov_b32 v95, -1
    s_lshl_b32 s38, s9, 10
    v_add_u32 v88, s38, v1
    v_add_u32 v89, 4096, v88
    s_lshl_b32 s38, s9, 11
    s_add_u32 s38, s38, 8192
    v_add_u32 v90, s38, v1
    s_waitcnt vmcnt(0)
    global_store_dwordx4 v88, v[92:95], s[32:33] sc1
    v_cvt_pk_bf16_f32 v64, v32, v33
    v_cvt_pk_bf16_f32 v65, v34, v35
    v_cvt_pk_bf16_f32 v66, v40, v41
    v_cvt_pk_bf16_f32 v67, v42, v43
    global_store_dwordx4 v88, v[64:67], s[28:29] sc1
    v_cvt_pk_bf16_f32 v68, v36, v37
    v_cvt_pk_bf16_f32 v69, v38, v39
    v_cvt_pk_bf16_f32 v70, v44, v45
    v_cvt_pk_bf16_f32 v71, v46, v47
    global_store_dwordx4 v89, v[68:71], s[28:29] sc1
    v_cvt_pk_bf16_f32 v72, v48, v49
    v_cvt_pk_bf16_f32 v73, v50, v51
    v_cvt_pk_bf16_f32 v74, v52, v53
    v_cvt_pk_bf16_f32 v75, v54, v55
    global_store_dwordx4 v90, v[72:75], s[28:29] offset:0 sc1
    v_cvt_pk_bf16_f32 v76, v56, v57
    v_cvt_pk_bf16_f32 v77, v58, v59
    v_cvt_pk_bf16_f32 v78, v60, v61
    v_cvt_pk_bf16_f32 v79, v62, v63
    global_store_dwordx4 v90, v[76:79], s[28:29] offset:1024 sc1
    v_cvt_pk_bf16_f32 v80, v16, v17
    v_cvt_pk_bf16_f32 v81, v18, v19
    v_cvt_pk_bf16_f32 v82, v24, v25
    v_cvt_pk_bf16_f32 v83, v26, v27
    global_store_dwordx4 v88, v[80:83], s[30:31]
    v_cvt_pk_bf16_f32 v84, v20, v21
    v_cvt_pk_bf16_f32 v85, v22, v23
    v_cvt_pk_bf16_f32 v86, v28, v29
    v_cvt_pk_bf16_f32 v87, v30, v31
    global_store_dwordx4 v89, v[84:87], s[30:31]
    s_cmp_eq_u32 s9, 0
    s_cselect_b32 s38, 1, 0
    s_or_b32 s59, s59, s38
L_g_158:
    s_cmp_ge_u32 s13, 64
    s_cbranch_scc1 L_g_161
    s_bitcmp1_b32 s25, 1
    s_cbranch_scc1 L_cp_162
    s_barrier
    s_min_u32 s38, s13, 127
    s_lshl_b32 s38, s38, 15
    s_add_u32 s38, s38, 146800640
    s_add_u32 s16, s4, s38
    s_addc_u32 s17, s5, 0
    s_add_u32 m0, s46, 0
    s_nop 0
    global_load_lds_dwordx4 v2, s[16:17] offset:0 sc1
    s_add_u32 m0, s46, 1024
    v_xor_b32 v105, 2080, v2
    global_load_lds_dwordx4 v105, s[16:17] offset:0 sc1
    s_add_u32 m0, s46, 2048
    v_xor_b32 v106, 4160, v2
    global_load_lds_dwordx4 v106, s[16:17] offset:0 sc1
    s_add_u32 m0, s46, 3072
    v_xor_b32 v107, 6240, v2
    global_load_lds_dwordx4 v107, s[16:17] offset:0 sc1
    s_add_u32 m0, s46, 15872
    s_nop 0
    global_load_lds_dwordx4 v2, s[16:17] offset:512 sc1
    s_add_u32 m0, s46, 16896
    v_xor_b32 v105, 2080, v2
    global_load_lds_dwordx4 v105, s[16:17] offset:512 sc1
    s_add_u32 m0, s46, 17920
    v_xor_b32 v106, 4160, v2
    global_load_lds_dwordx4 v106, s[16:17] offset:512 sc1
    s_add_u32 m0, s46, 18944
    v_xor_b32 v107, 6240, v2
    global_load_lds_dwordx4 v107, s[16:17] offset:512 sc1
    s_waitcnt vmcnt(4)
L_cp_162:
    s_barrier
    s_mov_b32 s24, s13
    ds_read_b128 v[64:67], v3 offset:0
    ds_read_b128 v[68:71], v3 offset:8192
    ds_read_b128 v[72:75], v4 offset:0
    ds_read_b128 v[76:79], v4 offset:8192
    ds_read_b128 v[80:83], v5 offset:0
    ds_read_b128 v[84:87], v5 offset:8192
    ds_read_b128 v[96:99], v8 offset:0
    ds_read_b128 v[100:103], v8 offset:1024
    s_waitcnt lgkmcnt(6)
    v_mfma_f32_16x16x32_bf16 v[16:19], v[112:115], v[64:67], 0
    v_mfma_f32_16x16x32_bf16 v[20:23], v[112:115], v[68:71], 0
    v_mfma_f32_16x16x32_bf16 v[24:27], v[176:179], v[64:67], 0
    v_mfma_f32_16x16x32_bf16 v[28:31], v[176:179], v[68:71], 0
    v_mfma_f32_16x16x32_bf16 v[32:35], v[240:243], v[64:67], 0
    v_mfma_f32_16x16x32_bf16 v[36:39], v[240:243], v[68:71], 0
    v_mfma_f32_16x16x32_bf16 v[40:43], a[48:51], v[64:67], 0
    v_mfma_f32_16x16x32_bf16 v[44:47], a[48:51], v[68:71], 0
    v_mfma_f32_16x16x32_bf16 v[48:51], v[64:67], a[112:115], 0
    v_mfma_f32_16x16x32_bf16 v[52:55], v[68:71], a[112:115], 0
    v_mfma_f32_16x16x32_bf16 v[56:59], v[64:67], a[176:179], 0
    v_mfma_f32_16x16x32_bf16 v[60:63], v[68:71], a[176:179], 0
    ds_read_b128 v[64:67], v6 offset:0
    ds_read_b128 v[68:71], v6 offset:8192
    s_waitcnt lgkmcnt(6)
    v_mfma_f32_16x16x32_bf16 v[16:19], v[116:119], v[72:75], v[16:19]
    v_mfma_f32_16x16x32_bf16 v[20:23], v[116:119], v[76:79], v[20:23]
    v_mfma_f32_16x16x32_bf16 v[24:27], v[180:183], v[72:75], v[24:27]
    v_mfma_f32_16x16x32_bf16 v[28:31], v[180:183], v[76:79], v[28:31]
    v_mfma_f32_16x16x32_bf16 v[32:35], v[244:247], v[72:75], v[32:35]
    v_mfma_f32_16x16x32_bf16 v[36:39], v[244:247], v[76:79], v[36:39]
    v_mfma_f32_16x16x32_bf16 v[40:43], a[52:55], v[72:75], v[40:43]
    v_mfma_f32_16x16x32_bf16 v[44:47], a[52:55], v[76:79], v[44:47]
    v_mfma_f32_16x16x32_bf16 v[48:51], v[72:75], a[116:119], v[48:51]
    v_mfma_f32_16x16x32_bf16 v[52:55], v[76:79], a[116:119], v[52:55]
    v_mfma_f32_16x16x32_bf16 v[56:59], v[72:75], a[180:183], v[56:59]
    v_mfma_f32_16x16x32_bf16 v[60:63], v[76:79], a[180:183], v[60:63]
    ds_read_b128 v[72:75], v3 offset:256
    ds_read_b128 v[76:79], v3 offset:8448
    ds_read_b128 v[88:91], v8 offset:2048
    ds_read_b128 v[92:95], v8 offset:3072
    s_waitcnt lgkmcnt(8)
    s_waitcnt lgkmcnt(6)
    v_mfma_f32_16x16x32_bf16 v[16:19], v[120:123], v[80:83], v[16:19]
    v_mfma_f32_16x16x32_bf16 v[20:23], v[120:123], v[84:87], v[20:23]
    v_mfma_f32_16x16x32_bf16 v[24:27], v[184:187], v[80:83], v[24:27]
    v_mfma_f32_16x16x32_bf16 v[28:31], v[184:187], v[84:87], v[28:31]
    v_mfma_f32_16x16x32_bf16 v[32:35], v[248:251], v[80:83], v[32:35]
    v_mfma_f32_16x16x32_bf16 v[36:39], v[248:251], v[84:87], v[36:39]
    v_mfma_f32_16x16x32_bf16 v[40:43], a[56:59], v[80:83], v[40:43]
    v_mfma_f32_16x16x32_bf16 v[44:47], a[56:59], v[84:87], v[44:47]
    v_mfma_f32_16x16x32_bf16 v[48:51], v[80:83], a[120:123], v[48:51]
    v_mfma_f32_16x16x32_bf16 v[52:55], v[84:87], a[120:123], v[52:55]
    v_mfma_f32_16x16x32_bf16 v[56:59], v[80:83], v[96:99], v[56:59]
    v_mfma_f32_16x16x32_bf16 v[60:63], v[84:87], v[96:99], v[60:63]
    ds_read_b128 v[80:83], v4 offset:256
    ds_read_b128 v[84:87], v4 offset:8448
    s_waitcnt lgkmcnt(6)
    v_mfma_f32_16x16x32_bf16 v[16:19], v[124:127], v[64:67], v[16:19]
    v_mfma_f32_16x16x32_bf16 v[20:23], v[124:127], v[68:71], v[20:23]
    v_mfma_f32_16x16x32_bf16 v[24:27], v[188:191], v[64:67], v[24:27]
    v_mfma_f32_16x16x32_bf16 v[28:31], v[188:191], v[68:71], v[28:31]
    v_mfma_f32_16x16x32_bf16 v[32:35], v[252:255], v[64:67], v[32:35]
    v_mfma_f32_16x16x32_bf16 v[36:39], v[252:255], v[68:71], v[36:39]
    v_mfma_f32_16x16x32_bf16 v[40:43], a[60:63], v[64:67], v[40:43]
    v_mfma_f32_16x16x32_bf16 v[44:47], a[60:63], v[68:71], v[44:47]
    v_mfma_f32_16x16x32_bf16 v[48:51], v[64:67], a[124:127], v[48:51]
    v_mfma_f32_16x16x32_bf16 v[52:55], v[68:71], a[124:127], v[52:55]
    v_mfma_f32_16x16x32_bf16 v[56:59], v[64:67], v[100:103], v[56:59]
    v_mfma_f32_16x16x32_bf16 v[60:63], v[68:71], v[100:103], v[60:63]
    ds_read_b128 v[64:67], v5 offset:256
    ds_read_b128 v[68:71], v5 offset:8448
    ds_read_b128 v[96:99], v8 offset:4096
    ds_read_b128 v[100:103], v8 offset:5120
    s_waitcnt lgkmcnt(8)
    s_waitcnt lgkmcnt(6)
    v_mfma_f32_16x16x32_bf16 v[16:19], v[128:131], v[72:75], v[16:19]
    v_mfma_f32_16x16x32_bf16 v[20:23], v[128:131], v[76:79], v[20:23]
    v_mfma_f32_16x16x32_bf16 v[24:27], v[192:195], v[72:75], v[24:27]
    v_mfma_f32_16x16x32_bf16 v[28:31], v[192:195], v[76:79], v[28:31]
    v_mfma_f32_16x16x32_bf16 v[32:35], a[0:3], v[72:75], v[32:35]
    v_mfma_f32_16x16x32_bf16 v[36:39], a[0:3], v[76:79], v[36:39]
    v_mfma_f32_16x16x32_bf16 v[40:43], a[64:67], v[72:75], v[40:43]
    v_mfma_f32_16x16x32_bf16 v[44:47], a[64:67], v[76:79], v[44:47]
    v_mfma_f32_16x16x32_bf16 v[48:51], v[72:75], a[128:131], v[48:51]
    v_mfma_f32_16x16x32_bf16 v[52:55], v[76:79], a[128:131], v[52:55]
    v_mfma_f32_16x16x32_bf16 v[56:59], v[72:75], v[88:91], v[56:59]
    v_mfma_f32_16x16x32_bf16 v[60:63], v[76:79], v[88:91], v[60:63]
    ds_read_b128 v[72:75], v6 offset:256
    ds_read_b128 v[76:79], v6 offset:8448
    s_waitcnt lgkmcnt(6)
    v_mfma_f32_16x16x32_bf16 v[16:19], v[132:135], v[80:83], v[16:19]
    v_mfma_f32_16x16x32_bf16 v[20:23], v[132:135], v[84:87], v[20:23]
    v_mfma_f32_16x16x32_bf16 v[24:27], v[196:199], v[80:83], v[24:27]
    v_mfma_f32_16x16x32_bf16 v[28:31], v[196:199], v[84:87], v[28:31]
    v_mfma_f32_16x16x32_bf16 v[32:35], a[4:7], v[80:83], v[32:35]
    v_mfma_f32_16x16x32_bf16 v[36:39], a[4:7], v[84:87], v[36:39]
    v_mfma_f32_16x16x32_bf16 v[40:43], a[68:71], v[80:83], v[40:43]
    v_mfma_f32_16x16x32_bf16 v[44:47], a[68:71], v[84:87], v[44:47]
    v_mfma_f32_16x16x32_bf16 v[48:51], v[80:83], a[132:135], v[48:51]
    v_mfma_f32_16x16x32_bf16 v[52:55], v[84:87], a[132:135], v[52:55]
    v_mfma_f32_16x16x32_bf16 v[56:59], v[80:83], v[92:95], v[56:59]
    v_mfma_f32_16x16x32_bf16 v[60:63], v[84:87], v[92:95], v[60:63]
    ds_read_b128 v[88:91], v8 offset:6144
    ds_read_b128 v[92:95], v8 offset:7168
    s_waitcnt lgkmcnt(6)
    s_waitcnt lgkmcnt(4)
    v_mfma_f32_16x16x32_bf16 v[16:19], v[136:139], v[64:67], v[16:19]
    v_mfma_f32_16x16x32_bf16 v[20:23], v[136:139], v[68:71], v[20:23]
    v_mfma_f32_16x16x32_bf16 v[24:27], v[200:203], v[64:67], v[24:27]
    v_mfma_f32_16x16x32_bf16 v[28:31], v[200:203], v[68:71], v[28:31]
    v_mfma_f32_16x16x32_bf16 v[32:35], a[8:11], v[64:67], v[32:35]
    v_mfma_f32_16x16x32_bf16 v[36:39], a[8:11], v[68:71], v[36:39]
    v_mfma_f32_16x16x32_bf16 v[40:43], a[72:75], v[64:67], v[40:43]
    v_mfma_f32_16x16x32_bf16 v[44:47], a[72:75], v[68:71], v[44:47]
    v_mfma_f32_16x16x32_bf16 v[48:51], v[64:67], a[136:139], v[48:51]
    v_mfma_f32_16x16x32_bf16 v[52:55], v[68:71], a[136:139], v[52:55]
    v_mfma_f32_16x16x32_bf16 v[56:59], v[64:67], v[96:99], v[56:59]
    v_mfma_f32_16x16x32_bf16 v[60:63], v[68:71], v[96:99], v[60:63]
    s_waitcnt lgkmcnt(2)
    s_waitcnt vmcnt(0)
    s_barrier
    ds_read_b128 v[80:83], v3 offset:16384
    ds_read_b128 v[84:87], v3 offset:24576
    ds_read_b128 v[64:67], v4 offset:16384
    ds_read_b128 v[68:71], v4 offset:24576
    v_mfma_f32_16x16x32_bf16 v[16:19], v[140:143], v[72:75], v[16:19]
    s_bitcmp1_b32 s59, 0
    s_cselect_b64 exec, 1, 0
    global_store_dword v14, v13, s[56:57] sc1
    s_mov_b64 exec, -1
    s_bitset0_b32 s59, 0
    v_mfma_f32_16x16x32_bf16 v[20:23], v[140:143], v[76:79], v[20:23]
    s_bitcmp1_b32 s59, 1
    s_cselect_b64 exec, 1, 0
    global_store_dword v14, v13, s[100:101] sc1
    s_mov_b64 exec, -1
    s_bitset0_b32 s59, 1
    v_mfma_f32_16x16x32_bf16 v[24:27], v[204:207], v[72:75], v[24:27]
    s_cmp_lt_u32 s15, 64
    s_cselect_b32 s38, 8, 0
    s_or_b32 s25, s25, s38
    v_mfma_f32_16x16x32_bf16 v[28:31], v[204:207], v[76:79], v[28:31]
    s_bitcmp1_b32 s25, 3
    s_cselect_b64 s[52:53], -1, 0
    v_mfma_f32_16x16x32_bf16 v[32:35], a[12:15], v[72:75], v[32:35]
    s_min_u32 s38, s15, 127
    s_lshl_b32 s38, s38, 19
    s_lshl_b32 s39, s7, 14
    s_add_u32 s38, s38, s39
    s_add_u32 s38, s38, 33554432
    s_add_u32 s54, s4, s38
    s_addc_u32 s55, s5, 0
    v_mfma_f32_16x16x32_bf16 v[36:39], a[12:15], v[76:79], v[36:39]
    s_add_u32 m0, s46, 32768
    v_mfma_f32_16x16x32_bf16 v[40:43], a[76:79], v[72:75], v[40:43]
    s_mov_b64 exec, s[52:53]
    global_load_lds_dwordx4 v9, s[54:55] offset:0 sc1
    s_mov_b64 exec, -1
    v_mfma_f32_16x16x32_bf16 v[44:47], a[76:79], v[76:79], v[44:47]
    s_mov_b64 exec, s[52:53]
    global_load_lds_dwordx4 v9, s[54:55] offset:1024 sc1
    s_mov_b64 exec, -1
    v_mfma_f32_16x16x32_bf16 v[48:51], v[72:75], a[140:143], v[48:51]
    s_mov_b64 exec, s[52:53]
    global_load_lds_dwordx4 v9, s[54:55] offset:2048 sc1
    s_mov_b64 exec, -1
    v_mfma_f32_16x16x32_bf16 v[52:55], v[76:79], a[140:143], v[52:55]
    s_mov_b64 exec, s[52:53]
    global_load_lds_dwordx4 v9, s[54:55] offset:3072 sc1
    s_mov_b64 exec, -1
    v_mfma_f32_16x16x32_bf16 v[56:59], v[72:75], v[100:103], v[56:59]
    s_cmp_lt_u32 s14, 64
    s_cselect_b32 s38, 4, 0
    s_or_b32 s25, s25, s38
    v_mfma_f32_16x16x32_bf16 v[60:63], v[76:79], v[100:103], v[60:63]
    s_bitcmp1_b32 s25, 2
    s_cselect_b64 s[52:53], -1, 0
    ds_read_b128 v[72:75], v5 offset:16384
    ds_read_b128 v[76:79], v5 offset:24576
    ds_read_b128 v[96:99], v8 offset:8192
    ds_read_b128 v[100:103], v8 offset:9216
    s_waitcnt lgkmcnt(6)
    v_mfma_f32_16x16x32_bf16 v[16:19], v[144:147], v[80:83], v[16:19]
    s_min_u32 s38, s14, 127
    s_lshl_b32 s38, s38, 19
    s_lshl_b32 s39, s7, 14
    s_add_u32 s38, s38, s39
    s_add_u32 s54, s4, s38
    s_addc_u32 s55, s5, 0
    v_mfma_f32_16x16x32_bf16 v[20:23], v[144:147], v[84:87], v[20:23]
    s_add_u32 m0, s46, 0
    v_mfma_f32_16x16x32_bf16 v[24:27], v[208:211], v[80:83], v[24:27]
    s_mov_b64 exec, s[52:53]
    global_load_lds_dwordx4 v9, s[54:55] offset:0 sc1
    s_mov_b64 exec, -1
    v_mfma_f32_16x16x32_bf16 v[28:31], v[208:211], v[84:87], v[28:31]
    s_mov_b64 exec, s[52:53]
    global_load_lds_dwordx4 v9, s[54:55] offset:1024 sc1
    s_mov_b64 exec, -1
    v_mfma_f32_16x16x32_bf16 v[32:35], a[16:19], v[80:83], v[32:35]
    s_mov_b64 exec, s[52:53]
    global_load_lds_dwordx4 v9, s[54:55] offset:2048 sc1
    s_mov_b64 exec, -1
    v_mfma_f32_16x16x32_bf16 v[36:39], a[16:19], v[84:87], v[36:39]
    s_mov_b64 exec, s[52:53]
    global_load_lds_dwordx4 v9, s[54:55] offset:3072 sc1
    s_mov_b64 exec, -1
    v_mfma_f32_16x16x32_bf16 v[40:43], a[80:83], v[80:83], v[40:43]
    v_mfma_f32_16x16x32_bf16 v[44:47], a[80:83], v[84:87], v[44:47]
    v_mfma_f32_16x16x32_bf16 v[48:51], v[80:83], a[144:147], v[48:51]
    v_mfma_f32_16x16x32_bf16 v[52:55], v[84:87], a[144:147], v[52:55]
    v_mfma_f32_16x16x32_bf16 v[56:59], v[80:83], v[88:91], v[56:59]
    v_mfma_f32_16x16x32_bf16 v[60:63], v[84:87], v[88:91], v[60:63]
    ds_read_b128 v[80:83], v6 offset:16384
    ds_read_b128 v[84:87], v6 offset:24576
    s_waitcnt lgkmcnt(6)
    v_mfma_f32_16x16x32_bf16 v[16:19], v[148:151], v[64:67], v[16:19]
    v_mfma_f32_16x16x32_bf16 v[20:23], v[148:151], v[68:71], v[20:23]
    v_mfma_f32_16x16x32_bf16 v[24:27], v[212:215], v[64:67], v[24:27]
    v_mfma_f32_16x16x32_bf16 v[28:31], v[212:215], v[68:71], v[28:31]
    v_mfma_f32_16x16x32_bf16 v[32:35], a[20:23], v[64:67], v[32:35]
    v_mfma_f32_16x16x32_bf16 v[36:39], a[20:23], v[68:71], v[36:39]
    v_mfma_f32_16x16x32_bf16 v[40:43], a[84:87], v[64:67], v[40:43]
    v_mfma_f32_16x16x32_bf16 v[44:47], a[84:87], v[68:71], v[44:47]
    v_mfma_f32_16x16x32_bf16 v[48:51], v[64:67], a[148:151], v[48:51]
    v_mfma_f32_16x16x32_bf16 v[52:55], v[68:71], a[148:151], v[52:55]
    v_mfma_f32_16x16x32_bf16 v[56:59], v[64:67], v[92:95], v[56:59]
    v_mfma_f32_16x16x32_bf16 v[60:63], v[68:71], v[92:95], v[60:63]
    ds_read_b128 v[64:67], v3 offset:16640
    ds_read_b128 v[68:71], v3 offset:24832
    ds_read_b128 v[88:91], v8 offset:10240
    ds_read_b128 v[92:95], v8 offset:11264
    s_waitcnt lgkmcnt(8)
    s_waitcnt lgkmcnt(6)
    v_mfma_f32_16x16x32_bf16 v[16:19], v[152:155], v[72:75], v[16:19]
    v_mfma_f32_16x16x32_bf16 v[20:23], v[152:155], v[76:79], v[20:23]
    v_mfma_f32_16x16x32_bf16 v[24:27], v[216:219], v[72:75], v[24:27]
    v_mfma_f32_16x16x32_bf16 v[28:31], v[216:219], v[76:79], v[28:31]
    v_mfma_f32_16x16x32_bf16 v[32:35], a[24:27], v[72:75], v[32:35]
    v_mfma_f32_16x16x32_bf16 v[36:39], a[24:27], v[76:79], v[36:39]
    v_mfma_f32_16x16x32_bf16 v[40:43], a[88:91], v[72:75], v[40:43]
    v_mfma_f32_16x16x32_bf16 v[44:47], a[88:91], v[76:79], v[44:47]
    v_mfma_f32_16x16x32_bf16 v[48:51], v[72:75], a[152:155], v[48:51]
    v_mfma_f32_16x16x32_bf16 v[52:55], v[76:79], a[152:155], v[52:55]
    v_mfma_f32_16x16x32_bf16 v[56:59], v[72:75], v[96:99], v[56:59]
    v_mfma_f32_16x16x32_bf16 v[60:63], v[76:79], v[96:99], v[60:63]
    ds_read_b128 v[72:75], v4 offset:16640
    ds_read_b128 v[76:79], v4 offset:24832
    s_waitcnt lgkmcnt(6)
    v_mfma_f32_16x16x32_bf16 v[16:19], v[156:159], v[80:83], v[16:19]
    v_mfma_f32_16x16x32_bf16 v[20:23], v[156:159], v[84:87], v[20:23]
    v_mfma_f32_16x16x32_bf16 v[24:27], v[220:223], v[80:83], v[24:27]
    v_mfma_f32_16x16x32_bf16 v[28:31], v[220:223], v[84:87], v[28:31]
    v_mfma_f32_16x16x32_bf16 v[32:35], a[28:31], v[80:83], v[32:35]
    v_mfma_f32_16x16x32_bf16 v[36:39], a[28:31], v[84:87], v[36:39]
    v_mfma_f32_16x16x32_bf16 v[40:43], a[92:95], v[80:83], v[40:43]
    v_mfma_f32_16x16x32_bf16 v[44:47], a[92:95], v[84:87], v[44:47]
    v_mfma_f32_16x16x32_bf16 v[48:51], v[80:83], a[156:159], v[48:51]
    v_mfma_f32_16x16x32_bf16 v[52:55], v[84:87], a[156:159], v[52:55]
    v_mfma_f32_16x16x32_bf16 v[56:59], v[80:83], v[100:103], v[56:59]
    v_mfma_f32_16x16x32_bf16 v[60:63], v[84:87], v[100:103], v[60:63]
    ds_read_b128 v[80:83], v5 offset:16640
    ds_read_b128 v[84:87], v5 offset:24832
    ds_read_b128 v[96:99], v8 offset:12288
    ds_read_b128 v[100:103], v8 offset:13312
    s_waitcnt lgkmcnt(8)
    s_waitcnt lgkmcnt(6)
    v_mfma_f32_16x16x32_bf16 v[16:19], v[160:163], v[64:67], v[16:19]
    v_mfma_f32_16x16x32_bf16 v[20:23], v[160:163], v[68:71], v[20:23]
    v_mfma_f32_16x16x32_bf16 v[24:27], v[224:227], v[64:67], v[24:27]
    v_mfma_f32_16x16x32_bf16 v[28:31], v[224:227], v[68:71], v[28:31]
    v_mfma_f32_16x16x32_bf16 v[32:35], a[32:35], v[64:67], v[32:35]
    v_mfma_f32_16x16x32_bf16 v[36:39], a[32:35], v[68:71], v[36:39]
    v_mfma_f32_16x16x32_bf16 v[40:43], a[96:99], v[64:67], v[40:43]
    v_mfma_f32_16x16x32_bf16 v[44:47], a[96:99], v[68:71], v[44:47]
    v_mfma_f32_16x16x32_bf16 v[48:51], v[64:67], a[160:163], v[48:51]
    v_mfma_f32_16x16x32_bf16 v[52:55], v[68:71], a[160:163], v[52:55]
    v_mfma_f32_16x16x32_bf16 v[56:59], v[64:67], v[88:91], v[56:59]
    v_mfma_f32_16x16x32_bf16 v[60:63], v[68:71], v[88:91], v[60:63]
    ds_read_b128 v[64:67], v6 offset:16640
    ds_read_b128 v[68:71], v6 offset:24832
    s_waitcnt lgkmcnt(6)
    v_mfma_f32_16x16x32_bf16 v[16:19], v[164:167], v[72:75], v[16:19]
    v_mfma_f32_16x16x32_bf16 v[20:23], v[164:167], v[76:79], v[20:23]
    v_mfma_f32_16x16x32_bf16 v[24:27], v[228:231], v[72:75], v[24:27]
    v_mfma_f32_16x16x32_bf16 v[28:31], v[228:231], v[76:79], v[28:31]
    v_mfma_f32_16x16x32_bf16 v[32:35], a[36:39], v[72:75], v[32:35]
    v_mfma_f32_16x16x32_bf16 v[36:39], a[36:39], v[76:79], v[36:39]
    v_mfma_f32_16x16x32_bf16 v[40:43], a[100:103], v[72:75], v[40:43]
    v_mfma_f32_16x16x32_bf16 v[44:47], a[100:103], v[76:79], v[44:47]
    v_mfma_f32_16x16x32_bf16 v[48:51], v[72:75], a[164:167], v[48:51]
    v_mfma_f32_16x16x32_bf16 v[52:55], v[76:79], a[164:167], v[52:55]
    v_mfma_f32_16x16x32_bf16 v[56:59], v[72:75], v[92:95], v[56:59]
    v_mfma_f32_16x16x32_bf16 v[60:63], v[76:79], v[92:95], v[60:63]
    s_waitcnt lgkmcnt(4)
    s_waitcnt lgkmcnt(2)
    v_mfma_f32_16x16x32_bf16 v[16:19], v[168:171], v[80:83], v[16:19]
    v_mfma_f32_16x16x32_bf16 v[20:23], v[168:171], v[84:87], v[20:23]
    v_mfma_f32_16x16x32_bf16 v[24:27], v[232:235], v[80:83], v[24:27]
    v_mfma_f32_16x16x32_bf16 v[28:31], v[232:235], v[84:87], v[28:31]
    v_mfma_f32_16x16x32_bf16 v[32:35], a[40:43], v[80:83], v[32:35]
    v_mfma_f32_16x16x32_bf16 v[36:39], a[40:43], v[84:87], v[36:39]
    v_mfma_f32_16x16x32_bf16 v[40:43], a[104:107], v[80:83], v[40:43]
    v_mfma_f32_16x16x32_bf16 v[44:47], a[104:107], v[84:87], v[44:47]
    v_mfma_f32_16x16x32_bf16 v[48:51], v[80:83], a[168:171], v[48:51]
    v_mfma_f32_16x16x32_bf16 v[52:55], v[84:87], a[168:171], v[52:55]
    v_mfma_f32_16x16x32_bf16 v[56:59], v[80:83], v[96:99], v[56:59]
    v_mfma_f32_16x16x32_bf16 v[60:63], v[84:87], v[96:99], v[60:63]
    s_waitcnt lgkmcnt(0)
    s_barrier
    v_mfma_f32_16x16x32_bf16 v[16:19], v[172:175], v[64:67], v[16:19]
    v_mfma_f32_16x16x32_bf16 v[20:23], v[172:175], v[68:71], v[20:23]
    v_mfma_f32_16x16x32_bf16 v[24:27], v[236:239], v[64:67], v[24:27]
    v_mfma_f32_16x16x32_bf16 v[28:31], v[236:239], v[68:71], v[28:31]
    v_mfma_f32_16x16x32_bf16 v[32:35], a[44:47], v[64:67], v[32:35]
    v_mfma_f32_16x16x32_bf16 v[36:39], a[44:47], v[68:71], v[36:39]
    v_mfma_f32_16x16x32_bf16 v[40:43], a[108:111], v[64:67], v[40:43]
    v_mfma_f32_16x16x32_bf16 v[44:47], a[108:111], v[68:71], v[44:47]
    v_mfma_f32_16x16x32_bf16 v[48:51], v[64:67], a[172:175], v[48:51]
    v_mfma_f32_16x16x32_bf16 v[52:55], v[68:71], a[172:175], v[52:55]
    v_mfma_f32_16x16x32_bf16 v[56:59], v[64:67], v[100:103], v[56:59]
    v_mfma_f32_16x16x32_bf16 v[60:63], v[68:71], v[100:103], v[60:63]
    s_min_u32 s38, s24, 127
    s_lshl_b32 s38, s38, 19
    s_lshl_b32 s39, s7, 14
    s_add_u32 s38, s38, s39
    s_add_u32 s28, s4, s38
    s_addc_u32 s29, s5, 0
    s_min_u32 s38, s24, 127
    s_lshl_b32 s38, s38, 18
    s_lshl_b32 s39, s7, 13
    s_add_u32 s38, s38, s39
    s_add_u32 s38, s38, 67108864
    s_add_u32 s30, s4, s38
    s_addc_u32 s31, s5, 0
    s_min_u32 s38, s24, 127
    s_lshl_b32 s38, s38, 7
    s_lshl_b32 s39, s7, 2
    s_add_u32 s38, s38, s39
    s_add_u32 s38, s38, 117440512
    s_add_u32 s56, s4, s38
    s_addc_u32 s57, s5, 0
    s_min_u32 s38, s24, 127
    s_lshl_b32 s38, s38, 17
    s_lshl_b32 s39, s7, 12
    s_add_u32 s38, s38, s39
    s_add_u32 s38, s38, 100663296
    s_add_u32 s32, s4, s38
    s_addc_u32 s33, s5, 0
    v_mov_b32 v92, -1
    v_mov_b32 v93, -1
    v_mov_b32 v94, -1
    v_mov_b32 v95, -1
    s_lshl_b32 s38, s9, 10
    v_add_u32 v88, s38, v1
    v_add_u32 v89, 4096, v88
    s_lshl_b32 s38, s9, 11
    s_add_u32 s38, s38, 8192
    v_add_u32 v90, s38, v1
    s_waitcnt vmcnt(0)
    global_store_dwordx4 v88, v[92:95], s[32:33] sc1
    v_cvt_pk_bf16_f32 v64, v32, v33
    v_cvt_pk_bf16_f32 v65, v34, v35
    v_cvt_pk_bf16_f32 v66, v40, v41
    v_cvt_pk_bf16_f32 v67, v42, v43
    global_store_dwordx4 v88, v[64:67], s[28:29] sc1
    v_cvt_pk_bf16_f32 v68, v36, v37
    v_cvt_pk_bf16_f32 v69, v38, v39
    v_cvt_pk_bf16_f32 v70, v44, v45
    v_cvt_pk_bf16_f32 v71, v46, v47
    global_store_dwordx4 v89, v[68:71], s[28:29] sc1
    v_cvt_pk_bf16_f32 v72, v48, v49
    v_cvt_pk_bf16_f32 v73, v50, v51
    v_cvt_pk_bf16_f32 v74, v52, v53
    v_cvt_pk_bf16_f32 v75, v54, v55
    global_store_dwordx4 v90, v[72:75], s[28:29] offset:0 sc1
    v_cvt_pk_bf16_f32 v76, v56, v57
    v_cvt_pk_bf16_f32 v77, v58, v59
    v_cvt_pk_bf16_f32 v78, v60, v61
    v_cvt_pk_bf16_f32 v79, v62, v63
    global_store_dwordx4 v90, v[76:79], s[28:29] offset:1024 sc1
    v_cvt_pk_bf16_f32 v80, v16, v17
    v_cvt_pk_bf16_f32 v81, v18, v19
    v_cvt_pk_bf16_f32 v82, v24, v25
    v_cvt_pk_bf16_f32 v83, v26, v27
    global_store_dwordx4 v88, v[80:83], s[30:31]
    v_cvt_pk_bf16_f32 v84, v20, v21
    v_cvt_pk_bf16_f32 v85, v22, v23
    v_cvt_pk_bf16_f32 v86, v28, v29
    v_cvt_pk_bf16_f32 v87, v30, v31
    global_store_dwordx4 v89, v[84:87], s[30:31]
    s_cmp_eq_u32 s9, 0
    s_cselect_b32 s38, 1, 0
    s_or_b32 s59, s59, s38
    s_cmp_ge_i32 s23, -1
    s_cbranch_scc1 L_ce_163
    s_waitcnt vmcnt(0)
    s_barrier
    s_bitcmp1_b32 s59, 0
    s_cselect_b64 exec, 1, 0
    global_store_dword v14, v13, s[56:57] sc1
    s_mov_b64 exec, -1
    s_bitset0_b32 s59, 0
    s_branch L_ce_163
L_g_161:
    s_waitcnt vmcnt(0)
    s_bitcmp1_b32 s59, 1
    s_cselect_b64 exec, 1, 0
    global_store_dword v14, v13, s[100:101] sc1
    s_mov_b64 exec, -1
    s_bitset0_b32 s59, 1
    s_barrier
    s_bitcmp1_b32 s59, 0
    s_cselect_b64 exec, 1, 0
    global_store_dword v14, v13, s[56:57] sc1
    s_mov_b64 exec, -1
    s_bitset0_b32 s59, 0
L_ce_163:
    s_add_u32 s23, s23, 1
    s_cmp_lt_i32 s23, 16
    s_cbranch_scc0 L_xe_164
    s_branch L_xw_136
L_xe_164:
L_end_128:
    s_waitcnt vmcnt(0) lgkmcnt(0)
    s_endpgm
L_safe_f:
    s_lshr_b32 s22, s7, 3
    s_and_b32 s26, s7, 7
    s_and_b32 s27, s22, 1
    s_mul_i32 s58, s26, 8320
    s_lshl_b32 s38, s9, 9
    s_add_u32 s58, s58, s38
    s_mul_i32 s60, s22, 1179648
    s_cmp_eq_u32 s27, 0
    s_lshl_b32 s38, s27, 21
    s_add_u32 s61, s38, 119537664
    s_add_u32 s62, s38, 123731968
    s_lshl_b32 s38, s27, 13
    s_add_u32 s63, s38, 117456896
    s_load_dwordx2 s[52:53], s[0:1], 96
    s_load_dwordx2 s[54:55], s[0:1], 72
    s_load_dwordx2 s[56:57], s[0:1], 88
    s_waitcnt lgkmcnt(0)
    v_lshlrev_b32 v2, 4, v0
    v_mov_b32 v8, 0
    v_mov_b32 v9, 0
    v_mov_b32 v10, 0
    v_mov_b32 v11, 0
    s_mul_i32 s38, s26, 73728
    s_add_u32 s38, s38, s60
    v_add_u32 v3, s38, v2
    v_add_u32 v12, 0, v3
    global_store_dwordx4 v12, v[8:11], s[20:21] sc1
    v_add_u32 v12, 4096, v3
    global_store_dwordx4 v12, v[8:11], s[20:21] sc1
    v_add_u32 v12, 8192, v3
    global_store_dwordx4 v12, v[8:11], s[20:21] sc1
    v_add_u32 v12, 12288, v3
    global_store_dwordx4 v12, v[8:11], s[20:21] sc1
    v_add_u32 v12, 16384, v3
    global_store_dwordx4 v12, v[8:11], s[20:21] sc1
    v_add_u32 v12, 20480, v3
    global_store_dwordx4 v12, v[8:11], s[20:21] sc1
    v_add_u32 v12, 24576, v3
    global_store_dwordx4 v12, v[8:11], s[20:21] sc1
    v_add_u32 v12, 28672, v3
    global_store_dwordx4 v12, v[8:11], s[20:21] sc1
    v_add_u32 v12, 32768, v3
    global_store_dwordx4 v12, v[8:11], s[20:21] sc1
    v_add_u32 v12, 36864, v3
    global_store_dwordx4 v12, v[8:11], s[20:21] sc1
    v_add_u32 v12, 40960, v3
    global_store_dwordx4 v12, v[8:11], s[20:21] sc1
    v_add_u32 v12, 45056, v3
    global_store_dwordx4 v12, v[8:11], s[20:21] sc1
    v_add_u32 v12, 49152, v3
    global_store_dwordx4 v12, v[8:11], s[20:21] sc1
    v_add_u32 v12, 53248, v3
    global_store_dwordx4 v12, v[8:11], s[20:21] sc1
    v_add_u32 v12, 57344, v3
    global_store_dwordx4 v12, v[8:11], s[20:21] sc1
    v_add_u32 v12, 61440, v3
    global_store_dwordx4 v12, v[8:11], s[20:21] sc1
    v_add_u32 v12, 65536, v3
    global_store_dwordx4 v12, v[8:11], s[20:21] sc1
    v_add_u32 v12, 69632, v3
    global_store_dwordx4 v12, v[8:11], s[20:21] sc1
    v_add_u32 v12, 589824, v3
    global_store_dwordx4 v12, v[8:11], s[20:21] sc1
    v_add_u32 v12, 593920, v3
    global_store_dwordx4 v12, v[8:11], s[20:21] sc1
    v_add_u32 v12, 598016, v3
    global_store_dwordx4 v12, v[8:11], s[20:21] sc1
    v_add_u32 v12, 602112, v3
    global_store_dwordx4 v12, v[8:11], s[20:21] sc1
    v_add_u32 v12, 606208, v3
    global_store_dwordx4 v12, v[8:11], s[20:21] sc1
    v_add_u32 v12, 610304, v3
    global_store_dwordx4 v12, v[8:11], s[20:21] sc1
    v_add_u32 v12, 614400, v3
    global_store_dwordx4 v12, v[8:11], s[20:21] sc1
    v_add_u32 v12, 618496, v3
    global_store_dwordx4 v12, v[8:11], s[20:21] sc1
    v_add_u32 v12, 622592, v3
    global_store_dwordx4 v12, v[8:11], s[20:21] sc1
    v_add_u32 v12, 626688, v3
    global_store_dwordx4 v12, v[8:11], s[20:21] sc1
    v_add_u32 v12, 630784, v3
    global_store_dwordx4 v12, v[8:11], s[20:21] sc1
    v_add_u32 v12, 634880, v3
    global_store_dwordx4 v12, v[8:11], s[20:21] sc1
    v_add_u32 v12, 638976, v3
    global_store_dwordx4 v12, v[8:11], s[20:21] sc1
    v_add_u32 v12, 643072, v3
    global_store_dwordx4 v12, v[8:11], s[20:21] sc1
    v_add_u32 v12, 647168, v3
    global_store_dwordx4 v12, v[8:11], s[20:21] sc1
    v_add_u32 v12, 651264, v3
    global_store_dwordx4 v12, v[8:11], s[20:21] sc1
    v_add_u32 v12, 655360, v3
    global_store_dwordx4 v12, v[8:11], s[20:21] sc1
    v_add_u32 v12, 659456, v3
    global_store_dwordx4 v12, v[8:11], s[20:21] sc1
    s_waitcnt vmcnt(0)
    s_barrier
    s_lshl_b32 s38, s6, 2
    s_add_u32 s38, s38, 96
    s_cmp_lg_u32 s9, 0
    s_cbranch_scc1 L_arr_166
    v_mov_b32 v1, s38
    v_mov_b32 v2, 1
    s_mov_b64 exec, 1
    global_atomic_add v1, v2, s[10:11] sc1
    s_mov_b64 exec, -1
L_arr_166:
    s_sleep 127
    s_sleep 127
    v_and_b32 v16, 63, v0
    v_lshlrev_b32 v1, 4, v16
    v_and_b32 v17, 15, v16
    v_lshrrev_b32 v18, 4, v16
    s_and_b32 s38, s9, 1
    s_lshl_b32 s38, s38, 3
    v_xor_b32 v19, s38, v17
    v_lshlrev_b32 v19, 4, v19
    v_lshl_add_u32 v19, v16, 8, v19
    s_lshr_b32 s38, s9, 1
    s_lshl_b32 s38, s38, 14
    s_add_u32 s38, s38, 114688
    v_add_u32 v2, s38, v19
    v_xor_b32 v19, v17, v18
    v_lshlrev_b32 v19, 4, v19
    v_lshl_add_u32 v19, v18, 8, v19
    v_add_u32 v3, 114688, v19
    v_xor_b32 v4, 64, v3
    v_xor_b32 v5, 128, v3
    v_xor_b32 v6, 192, v3
    v_add_u32 v7, 114688, v1
    s_mul_i32 s38, s9, 28672
    v_add_u32 v8, s38, v1
    s_lshl_b32 s38, s9, 13
    v_add_u32 v9, s38, v1
    v_add_u32 v10, 4096, v9
    v_mul_u32_u24 v11, 66688, v18
    v_lshl_add_u32 v11, v17, 4, v11
    v_add_u32 v11, s58, v11
    v_add_u32 v12, 266752, v11
    v_mov_b32 v13, -1
    v_mov_b32 v14, 0
    s_load_dwordx2 s[28:29], s[0:1], 64
    s_load_dwordx2 s[30:31], s[0:1], 80
    s_mul_i32 s40, s9, 16384
    s_add_u32 s40, s40, 16384
    v_add_u32 v109, s40, v1
    v_lshrrev_b32 v110, 8, v1
    v_lshlrev_b32 v110, 8, v110
    v_bfe_u32 v108, v1, 6, 2
    v_lshl_add_u32 v110, v108, 5, v110
    v_bfe_u32 v108, v1, 4, 2
    v_lshl_add_u32 v110, v108, 3, v110
    v_add_u32 v110, s40, v110
    s_waitcnt lgkmcnt(0)
    v_mov_b32 v128, 0
    v_mov_b32 v129, 0
    v_mov_b32 v130, 0
    v_mov_b32 v131, 0
    s_add_u32 s39, s9, 0
    s_cmp_ge_u32 s39, 11
    s_cbranch_scc1 L_f1z_167
    s_mul_i32 s38, s26, 11
    s_add_u32 s38, s38, s39
    s_cmp_ge_u32 s38, 86
    s_cbranch_scc1 L_f1z_167
    s_lshl_b32 s38, s38, 5
    v_lshrrev_b32 v111, 8, v1
    v_lshlrev_b32 v111, 3, v111
    v_add_u32 v111, s38, v111
    global_load_dwordx2 v[80:81], v111, s[54:55]
    v_lshrrev_b32 v108, 5, v1
    v_mul_u32_u24 v108, 2752, v108
    v_and_b32 v111, 16, v1
    v_add_u32 v108, v108, v111
    v_add_u32 v108, s38, v108
    global_load_dwordx4 v[16:19], v108, s[28:29]
    v_add_u32 v108, 88064, v108
    global_load_dwordx4 v[20:23], v108, s[28:29]
    v_add_u32 v108, 88064, v108
    global_load_dwordx4 v[24:27], v108, s[28:29]
    v_add_u32 v108, 88064, v108
    global_load_dwordx4 v[28:31], v108, s[28:29]
    v_add_u32 v108, 88064, v108
    global_load_dwordx4 v[32:35], v108, s[28:29]
    v_add_u32 v108, 88064, v108
    global_load_dwordx4 v[36:39], v108, s[28:29]
    v_add_u32 v108, 88064, v108
    global_load_dwordx4 v[40:43], v108, s[28:29]
    v_add_u32 v108, 88064, v108
    global_load_dwordx4 v[44:47], v108, s[28:29]
    v_add_u32 v108, 88064, v108
    global_load_dwordx4 v[48:51], v108, s[28:29]
    v_add_u32 v108, 88064, v108
    global_load_dwordx4 v[52:55], v108, s[28:29]
    v_add_u32 v108, 88064, v108
    global_load_dwordx4 v[56:59], v108, s[28:29]
    v_add_u32 v108, 88064, v108
    global_load_dwordx4 v[60:63], v108, s[28:29]
    v_add_u32 v108, 88064, v108
    global_load_dwordx4 v[64:67], v108, s[28:29]
    v_add_u32 v108, 88064, v108
    global_load_dwordx4 v[68:71], v108, s[28:29]
    v_add_u32 v108, 88064, v108
    global_load_dwordx4 v[72:75], v108, s[28:29]
    v_add_u32 v108, 88064, v108
    global_load_dwordx4 v[76:79], v108, s[28:29]
    s_waitcnt vmcnt(0)
    ds_write_b128 v109, v[16:19] offset:0
    ds_write_b128 v109, v[20:23] offset:1024
    ds_write_b128 v109, v[24:27] offset:2048
    ds_write_b128 v109, v[28:31] offset:3072
    ds_write_b128 v109, v[32:35] offset:4096
    ds_write_b128 v109, v[36:39] offset:5120
    ds_write_b128 v109, v[40:43] offset:6144
    ds_write_b128 v109, v[44:47] offset:7168
    ds_write_b128 v109, v[48:51] offset:8192
    ds_write_b128 v109, v[52:55] offset:9216
    ds_write_b128 v109, v[56:59] offset:10240
    ds_write_b128 v109, v[60:63] offset:11264
    ds_write_b128 v109, v[64:67] offset:12288
    ds_write_b128 v109, v[68:71] offset:13312
    ds_write_b128 v109, v[72:75] offset:14336
    ds_write_b128 v109, v[76:79] offset:15360
    v_lshlrev_b32 v128, 16, v80
    v_and_b32 v129, 0xffff0000, v80
    v_lshlrev_b32 v130, 16, v81
    v_and_b32 v131, 0xffff0000, v81
    s_waitcnt lgkmcnt(0)
    ds_read_b64_tr_b16 a[0:1], v110 offset:0
    ds_read_b64_tr_b16 a[2:3], v110 offset:128
    ds_read_b64_tr_b16 a[4:5], v110 offset:1024
    ds_read_b64_tr_b16 a[6:7], v110 offset:1152
    ds_read_b64_tr_b16 a[8:9], v110 offset:2048
    ds_read_b64_tr_b16 a[10:11], v110 offset:2176
    ds_read_b64_tr_b16 a[12:13], v110 offset:3072
    ds_read_b64_tr_b16 a[14:15], v110 offset:3200
    ds_read_b64_tr_b16 a[16:17], v110 offset:4096
    ds_read_b64_tr_b16 a[18:19], v110 offset:4224
    ds_read_b64_tr_b16 a[20:21], v110 offset:5120
    ds_read_b64_tr_b16 a[22:23], v110 offset:5248
    ds_read_b64_tr_b16 a[24:25], v110 offset:6144
    ds_read_b64_tr_b16 a[26:27], v110 offset:6272
    ds_read_b64_tr_b16 a[28:29], v110 offset:7168
    ds_read_b64_tr_b16 a[30:31], v110 offset:7296
    ds_read_b64_tr_b16 a[32:33], v110 offset:8192
    ds_read_b64_tr_b16 a[34:35], v110 offset:8320
    ds_read_b64_tr_b16 a[36:37], v110 offset:9216
    ds_read_b64_tr_b16 a[38:39], v110 offset:9344
    ds_read_b64_tr_b16 a[40:41], v110 offset:10240
    ds_read_b64_tr_b16 a[42:43], v110 offset:10368
    ds_read_b64_tr_b16 a[44:45], v110 offset:11264
    ds_read_b64_tr_b16 a[46:47], v110 offset:11392
    ds_read_b64_tr_b16 a[48:49], v110 offset:12288
    ds_read_b64_tr_b16 a[50:51], v110 offset:12416
    ds_read_b64_tr_b16 a[52:53], v110 offset:13312
    ds_read_b64_tr_b16 a[54:55], v110 offset:13440
    ds_read_b64_tr_b16 a[56:57], v110 offset:14336
    ds_read_b64_tr_b16 a[58:59], v110 offset:14464
    ds_read_b64_tr_b16 a[60:61], v110 offset:15360
    ds_read_b64_tr_b16 a[62:63], v110 offset:15488
    s_waitcnt lgkmcnt(0)
    s_branch L_f1d_168
L_f1z_167:
    v_accvgpr_write_b32 a0, 0
    v_accvgpr_write_b32 a1, 0
    v_accvgpr_write_b32 a2, 0
    v_accvgpr_write_b32 a3, 0
    v_accvgpr_write_b32 a4, 0
    v_accvgpr_write_b32 a5, 0
    v_accvgpr_write_b32 a6, 0
    v_accvgpr_write_b32 a7, 0
    v_accvgpr_write_b32 a8, 0
    v_accvgpr_write_b32 a9, 0
    v_accvgpr_write_b32 a10, 0
    v_accvgpr_write_b32 a11, 0
    v_accvgpr_write_b32 a12, 0
    v_accvgpr_write_b32 a13, 0
    v_accvgpr_write_b32 a14, 0
    v_accvgpr_write_b32 a15, 0
    v_accvgpr_write_b32 a16, 0
    v_accvgpr_write_b32 a17, 0
    v_accvgpr_write_b32 a18, 0
    v_accvgpr_write_b32 a19, 0
    v_accvgpr_write_b32 a20, 0
    v_accvgpr_write_b32 a21, 0
    v_accvgpr_write_b32 a22, 0
    v_accvgpr_write_b32 a23, 0
    v_accvgpr_write_b32 a24, 0
    v_accvgpr_write_b32 a25, 0
    v_accvgpr_write_b32 a26, 0
    v_accvgpr_write_b32 a27, 0
    v_accvgpr_write_b32 a28, 0
    v_accvgpr_write_b32 a29, 0
    v_accvgpr_write_b32 a30, 0
    v_accvgpr_write_b32 a31, 0
    v_accvgpr_write_b32 a32, 0
    v_accvgpr_write_b32 a33, 0
    v_accvgpr_write_b32 a34, 0
    v_accvgpr_write_b32 a35, 0
    v_accvgpr_write_b32 a36, 0
    v_accvgpr_write_b32 a37, 0
    v_accvgpr_write_b32 a38, 0
    v_accvgpr_write_b32 a39, 0
    v_accvgpr_write_b32 a40, 0
    v_accvgpr_write_b32 a41, 0
    v_accvgpr_write_b32 a42, 0
    v_accvgpr_write_b32 a43, 0
    v_accvgpr_write_b32 a44, 0
    v_accvgpr_write_b32 a45, 0
    v_accvgpr_write_b32 a46, 0
    v_accvgpr_write_b32 a47, 0
    v_accvgpr_write_b32 a48, 0
    v_accvgpr_write_b32 a49, 0
    v_accvgpr_write_b32 a50, 0
    v_accvgpr_write_b32 a51, 0
    v_accvgpr_write_b32 a52, 0
    v_accvgpr_write_b32 a53, 0
    v_accvgpr_write_b32 a54, 0
    v_accvgpr_write_b32 a55, 0
    v_accvgpr_write_b32 a56, 0
    v_accvgpr_write_b32 a57, 0
    v_accvgpr_write_b32 a58, 0
    v_accvgpr_write_b32 a59, 0
    v_accvgpr_write_b32 a60, 0
    v_accvgpr_write_b32 a61, 0
    v_accvgpr_write_b32 a62, 0
    v_accvgpr_write_b32 a63, 0
    s_nop 1
L_f1d_168:
    v_mov_b32 v132, 0
    v_mov_b32 v133, 0
    v_mov_b32 v134, 0
    v_mov_b32 v135, 0
    s_add_u32 s39, s9, 4
    s_cmp_ge_u32 s39, 11
    s_cbranch_scc1 L_f1z_169
    s_mul_i32 s38, s26, 11
    s_add_u32 s38, s38, s39
    s_cmp_ge_u32 s38, 86
    s_cbranch_scc1 L_f1z_169
    s_lshl_b32 s38, s38, 5
    v_lshrrev_b32 v111, 8, v1
    v_lshlrev_b32 v111, 3, v111
    v_add_u32 v111, s38, v111
    global_load_dwordx2 v[80:81], v111, s[54:55]
    v_lshrrev_b32 v108, 5, v1
    v_mul_u32_u24 v108, 2752, v108
    v_and_b32 v111, 16, v1
    v_add_u32 v108, v108, v111
    v_add_u32 v108, s38, v108
    global_load_dwordx4 v[16:19], v108, s[28:29]
    v_add_u32 v108, 88064, v108
    global_load_dwordx4 v[20:23], v108, s[28:29]
    v_add_u32 v108, 88064, v108
    global_load_dwordx4 v[24:27], v108, s[28:29]
    v_add_u32 v108, 88064, v108
    global_load_dwordx4 v[28:31], v108, s[28:29]
    v_add_u32 v108, 88064, v108
    global_load_dwordx4 v[32:35], v108, s[28:29]
    v_add_u32 v108, 88064, v108
    global_load_dwordx4 v[36:39], v108, s[28:29]
    v_add_u32 v108, 88064, v108
    global_load_dwordx4 v[40:43], v108, s[28:29]
    v_add_u32 v108, 88064, v108
    global_load_dwordx4 v[44:47], v108, s[28:29]
    v_add_u32 v108, 88064, v108
    global_load_dwordx4 v[48:51], v108, s[28:29]
    v_add_u32 v108, 88064, v108
    global_load_dwordx4 v[52:55], v108, s[28:29]
    v_add_u32 v108, 88064, v108
    global_load_dwordx4 v[56:59], v108, s[28:29]
    v_add_u32 v108, 88064, v108
    global_load_dwordx4 v[60:63], v108, s[28:29]
    v_add_u32 v108, 88064, v108
    global_load_dwordx4 v[64:67], v108, s[28:29]
    v_add_u32 v108, 88064, v108
    global_load_dwordx4 v[68:71], v108, s[28:29]
    v_add_u32 v108, 88064, v108
    global_load_dwordx4 v[72:75], v108, s[28:29]
    v_add_u32 v108, 88064, v108
    global_load_dwordx4 v[76:79], v108, s[28:29]
    s_waitcnt vmcnt(0)
    ds_write_b128 v109, v[16:19] offset:0
    ds_write_b128 v109, v[20:23] offset:1024
    ds_write_b128 v109, v[24:27] offset:2048
    ds_write_b128 v109, v[28:31] offset:3072
    ds_write_b128 v109, v[32:35] offset:4096
    ds_write_b128 v109, v[36:39] offset:5120
    ds_write_b128 v109, v[40:43] offset:6144
    ds_write_b128 v109, v[44:47] offset:7168
    ds_write_b128 v109, v[48:51] offset:8192
    ds_write_b128 v109, v[52:55] offset:9216
    ds_write_b128 v109, v[56:59] offset:10240
    ds_write_b128 v109, v[60:63] offset:11264
    ds_write_b128 v109, v[64:67] offset:12288
    ds_write_b128 v109, v[68:71] offset:13312
    ds_write_b128 v109, v[72:75] offset:14336
    ds_write_b128 v109, v[76:79] offset:15360
    v_lshlrev_b32 v132, 16, v80
    v_and_b32 v133, 0xffff0000, v80
    v_lshlrev_b32 v134, 16, v81
    v_and_b32 v135, 0xffff0000, v81
    s_waitcnt lgkmcnt(0)
    ds_read_b64_tr_b16 a[64:65], v110 offset:0
    ds_read_b64_tr_b16 a[66:67], v110 offset:128
    ds_read_b64_tr_b16 a[68:69], v110 offset:1024
    ds_read_b64_tr_b16 a[70:71], v110 offset:1152
    ds_read_b64_tr_b16 a[72:73], v110 offset:2048
    ds_read_b64_tr_b16 a[74:75], v110 offset:2176
    ds_read_b64_tr_b16 a[76:77], v110 offset:3072
    ds_read_b64_tr_b16 a[78:79], v110 offset:3200
    ds_read_b64_tr_b16 a[80:81], v110 offset:4096
    ds_read_b64_tr_b16 a[82:83], v110 offset:4224
    ds_read_b64_tr_b16 a[84:85], v110 offset:5120
    ds_read_b64_tr_b16 a[86:87], v110 offset:5248
    ds_read_b64_tr_b16 a[88:89], v110 offset:6144
    ds_read_b64_tr_b16 a[90:91], v110 offset:6272
    ds_read_b64_tr_b16 a[92:93], v110 offset:7168
    ds_read_b64_tr_b16 a[94:95], v110 offset:7296
    ds_read_b64_tr_b16 a[96:97], v110 offset:8192
    ds_read_b64_tr_b16 a[98:99], v110 offset:8320
    ds_read_b64_tr_b16 a[100:101], v110 offset:9216
    ds_read_b64_tr_b16 a[102:103], v110 offset:9344
    ds_read_b64_tr_b16 a[104:105], v110 offset:10240
    ds_read_b64_tr_b16 a[106:107], v110 offset:10368
    ds_read_b64_tr_b16 a[108:109], v110 offset:11264
    ds_read_b64_tr_b16 a[110:111], v110 offset:11392
    ds_read_b64_tr_b16 a[112:113], v110 offset:12288
    ds_read_b64_tr_b16 a[114:115], v110 offset:12416
    ds_read_b64_tr_b16 a[116:117], v110 offset:13312
    ds_read_b64_tr_b16 a[118:119], v110 offset:13440
    ds_read_b64_tr_b16 a[120:121], v110 offset:14336
    ds_read_b64_tr_b16 a[122:123], v110 offset:14464
    ds_read_b64_tr_b16 a[124:125], v110 offset:15360
    ds_read_b64_tr_b16 a[126:127], v110 offset:15488
    s_waitcnt lgkmcnt(0)
    s_branch L_f1d_170
L_f1z_169:
    v_accvgpr_write_b32 a64, 0
    v_accvgpr_write_b32 a65, 0
    v_accvgpr_write_b32 a66, 0
    v_accvgpr_write_b32 a67, 0
    v_accvgpr_write_b32 a68, 0
    v_accvgpr_write_b32 a69, 0
    v_accvgpr_write_b32 a70, 0
    v_accvgpr_write_b32 a71, 0
    v_accvgpr_write_b32 a72, 0
    v_accvgpr_write_b32 a73, 0
    v_accvgpr_write_b32 a74, 0
    v_accvgpr_write_b32 a75, 0
    v_accvgpr_write_b32 a76, 0
    v_accvgpr_write_b32 a77, 0
    v_accvgpr_write_b32 a78, 0
    v_accvgpr_write_b32 a79, 0
    v_accvgpr_write_b32 a80, 0
    v_accvgpr_write_b32 a81, 0
    v_accvgpr_write_b32 a82, 0
    v_accvgpr_write_b32 a83, 0
    v_accvgpr_write_b32 a84, 0
    v_accvgpr_write_b32 a85, 0
    v_accvgpr_write_b32 a86, 0
    v_accvgpr_write_b32 a87, 0
    v_accvgpr_write_b32 a88, 0
    v_accvgpr_write_b32 a89, 0
    v_accvgpr_write_b32 a90, 0
    v_accvgpr_write_b32 a91, 0
    v_accvgpr_write_b32 a92, 0
    v_accvgpr_write_b32 a93, 0
    v_accvgpr_write_b32 a94, 0
    v_accvgpr_write_b32 a95, 0
    v_accvgpr_write_b32 a96, 0
    v_accvgpr_write_b32 a97, 0
    v_accvgpr_write_b32 a98, 0
    v_accvgpr_write_b32 a99, 0
    v_accvgpr_write_b32 a100, 0
    v_accvgpr_write_b32 a101, 0
    v_accvgpr_write_b32 a102, 0
    v_accvgpr_write_b32 a103, 0
    v_accvgpr_write_b32 a104, 0
    v_accvgpr_write_b32 a105, 0
    v_accvgpr_write_b32 a106, 0
    v_accvgpr_write_b32 a107, 0
    v_accvgpr_write_b32 a108, 0
    v_accvgpr_write_b32 a109, 0
    v_accvgpr_write_b32 a110, 0
    v_accvgpr_write_b32 a111, 0
    v_accvgpr_write_b32 a112, 0
    v_accvgpr_write_b32 a113, 0
    v_accvgpr_write_b32 a114, 0
    v_accvgpr_write_b32 a115, 0
    v_accvgpr_write_b32 a116, 0
    v_accvgpr_write_b32 a117, 0
    v_accvgpr_write_b32 a118, 0
    v_accvgpr_write_b32 a119, 0
    v_accvgpr_write_b32 a120, 0
    v_accvgpr_write_b32 a121, 0
    v_accvgpr_write_b32 a122, 0
    v_accvgpr_write_b32 a123, 0
    v_accvgpr_write_b32 a124, 0
    v_accvgpr_write_b32 a125, 0
    v_accvgpr_write_b32 a126, 0
    v_accvgpr_write_b32 a127, 0
    s_nop 1
L_f1d_170:
    v_mov_b32 v136, 0
    v_mov_b32 v137, 0
    v_mov_b32 v138, 0
    v_mov_b32 v139, 0
    s_add_u32 s39, s9, 8
    s_cmp_ge_u32 s39, 11
    s_cbranch_scc1 L_f1z_171
    s_mul_i32 s38, s26, 11
    s_add_u32 s38, s38, s39
    s_cmp_ge_u32 s38, 86
    s_cbranch_scc1 L_f1z_171
    s_lshl_b32 s38, s38, 5
    v_lshrrev_b32 v111, 8, v1
    v_lshlrev_b32 v111, 3, v111
    v_add_u32 v111, s38, v111
    global_load_dwordx2 v[80:81], v111, s[54:55]
    v_lshrrev_b32 v108, 5, v1
    v_mul_u32_u24 v108, 2752, v108
    v_and_b32 v111, 16, v1
    v_add_u32 v108, v108, v111
    v_add_u32 v108, s38, v108
    global_load_dwordx4 v[16:19], v108, s[28:29]
    v_add_u32 v108, 88064, v108
    global_load_dwordx4 v[20:23], v108, s[28:29]
    v_add_u32 v108, 88064, v108
    global_load_dwordx4 v[24:27], v108, s[28:29]
    v_add_u32 v108, 88064, v108
    global_load_dwordx4 v[28:31], v108, s[28:29]
    v_add_u32 v108, 88064, v108
    global_load_dwordx4 v[32:35], v108, s[28:29]
    v_add_u32 v108, 88064, v108
    global_load_dwordx4 v[36:39], v108, s[28:29]
    v_add_u32 v108, 88064, v108
    global_load_dwordx4 v[40:43], v108, s[28:29]
    v_add_u32 v108, 88064, v108
    global_load_dwordx4 v[44:47], v108, s[28:29]
    v_add_u32 v108, 88064, v108
    global_load_dwordx4 v[48:51], v108, s[28:29]
    v_add_u32 v108, 88064, v108
    global_load_dwordx4 v[52:55], v108, s[28:29]
    v_add_u32 v108, 88064, v108
    global_load_dwordx4 v[56:59], v108, s[28:29]
    v_add_u32 v108, 88064, v108
    global_load_dwordx4 v[60:63], v108, s[28:29]
    v_add_u32 v108, 88064, v108
    global_load_dwordx4 v[64:67], v108, s[28:29]
    v_add_u32 v108, 88064, v108
    global_load_dwordx4 v[68:71], v108, s[28:29]
    v_add_u32 v108, 88064, v108
    global_load_dwordx4 v[72:75], v108, s[28:29]
    v_add_u32 v108, 88064, v108
    global_load_dwordx4 v[76:79], v108, s[28:29]
    s_waitcnt vmcnt(0)
    ds_write_b128 v109, v[16:19] offset:0
    ds_write_b128 v109, v[20:23] offset:1024
    ds_write_b128 v109, v[24:27] offset:2048
    ds_write_b128 v109, v[28:31] offset:3072
    ds_write_b128 v109, v[32:35] offset:4096
    ds_write_b128 v109, v[36:39] offset:5120
    ds_write_b128 v109, v[40:43] offset:6144
    ds_write_b128 v109, v[44:47] offset:7168
    ds_write_b128 v109, v[48:51] offset:8192
    ds_write_b128 v109, v[52:55] offset:9216
    ds_write_b128 v109, v[56:59] offset:10240
    ds_write_b128 v109, v[60:63] offset:11264
    ds_write_b128 v109, v[64:67] offset:12288
    ds_write_b128 v109, v[68:71] offset:13312
    ds_write_b128 v109, v[72:75] offset:14336
    ds_write_b128 v109, v[76:79] offset:15360
    v_lshlrev_b32 v136, 16, v80
    v_and_b32 v137, 0xffff0000, v80
    v_lshlrev_b32 v138, 16, v81
    v_and_b32 v139, 0xffff0000, v81
    s_waitcnt lgkmcnt(0)
    ds_read_b64_tr_b16 a[128:129], v110 offset:0
    ds_read_b64_tr_b16 a[130:131], v110 offset:128
    ds_read_b64_tr_b16 a[132:133], v110 offset:1024
    ds_read_b64_tr_b16 a[134:135], v110 offset:1152
    ds_read_b64_tr_b16 a[136:137], v110 offset:2048
    ds_read_b64_tr_b16 a[138:139], v110 offset:2176
    ds_read_b64_tr_b16 a[140:141], v110 offset:3072
    ds_read_b64_tr_b16 a[142:143], v110 offset:3200
    ds_read_b64_tr_b16 a[144:145], v110 offset:4096
    ds_read_b64_tr_b16 a[146:147], v110 offset:4224
    ds_read_b64_tr_b16 a[148:149], v110 offset:5120
    ds_read_b64_tr_b16 a[150:151], v110 offset:5248
    ds_read_b64_tr_b16 a[152:153], v110 offset:6144
    ds_read_b64_tr_b16 a[154:155], v110 offset:6272
    ds_read_b64_tr_b16 a[156:157], v110 offset:7168
    ds_read_b64_tr_b16 a[158:159], v110 offset:7296
    ds_read_b64_tr_b16 a[160:161], v110 offset:8192
    ds_read_b64_tr_b16 a[162:163], v110 offset:8320
    ds_read_b64_tr_b16 a[164:165], v110 offset:9216
    ds_read_b64_tr_b16 a[166:167], v110 offset:9344
    ds_read_b64_tr_b16 a[168:169], v110 offset:10240
    ds_read_b64_tr_b16 a[170:171], v110 offset:10368
    ds_read_b64_tr_b16 a[172:173], v110 offset:11264
    ds_read_b64_tr_b16 a[174:175], v110 offset:11392
    ds_read_b64_tr_b16 a[176:177], v110 offset:12288
    ds_read_b64_tr_b16 a[178:179], v110 offset:12416
    ds_read_b64_tr_b16 a[180:181], v110 offset:13312
    ds_read_b64_tr_b16 a[182:183], v110 offset:13440
    ds_read_b64_tr_b16 a[184:185], v110 offset:14336
    ds_read_b64_tr_b16 a[186:187], v110 offset:14464
    ds_read_b64_tr_b16 a[188:189], v110 offset:15360
    ds_read_b64_tr_b16 a[190:191], v110 offset:15488
    s_waitcnt lgkmcnt(0)
    s_branch L_f1d_172
L_f1z_171:
    v_accvgpr_write_b32 a128, 0
    v_accvgpr_write_b32 a129, 0
    v_accvgpr_write_b32 a130, 0
    v_accvgpr_write_b32 a131, 0
    v_accvgpr_write_b32 a132, 0
    v_accvgpr_write_b32 a133, 0
    v_accvgpr_write_b32 a134, 0
    v_accvgpr_write_b32 a135, 0
    v_accvgpr_write_b32 a136, 0
    v_accvgpr_write_b32 a137, 0
    v_accvgpr_write_b32 a138, 0
    v_accvgpr_write_b32 a139, 0
    v_accvgpr_write_b32 a140, 0
    v_accvgpr_write_b32 a141, 0
    v_accvgpr_write_b32 a142, 0
    v_accvgpr_write_b32 a143, 0
    v_accvgpr_write_b32 a144, 0
    v_accvgpr_write_b32 a145, 0
    v_accvgpr_write_b32 a146, 0
    v_accvgpr_write_b32 a147, 0
    v_accvgpr_write_b32 a148, 0
    v_accvgpr_write_b32 a149, 0
    v_accvgpr_write_b32 a150, 0
    v_accvgpr_write_b32 a151, 0
    v_accvgpr_write_b32 a152, 0
    v_accvgpr_write_b32 a153, 0
    v_accvgpr_write_b32 a154, 0
    v_accvgpr_write_b32 a155, 0
    v_accvgpr_write_b32 a156, 0
    v_accvgpr_write_b32 a157, 0
    v_accvgpr_write_b32 a158, 0
    v_accvgpr_write_b32 a159, 0
    v_accvgpr_write_b32 a160, 0
    v_accvgpr_write_b32 a161, 0
    v_accvgpr_write_b32 a162, 0
    v_accvgpr_write_b32 a163, 0
    v_accvgpr_write_b32 a164, 0
    v_accvgpr_write_b32 a165, 0
    v_accvgpr_write_b32 a166, 0
    v_accvgpr_write_b32 a167, 0
    v_accvgpr_write_b32 a168, 0
    v_accvgpr_write_b32 a169, 0
    v_accvgpr_write_b32 a170, 0
    v_accvgpr_write_b32 a171, 0
    v_accvgpr_write_b32 a172, 0
    v_accvgpr_write_b32 a173, 0
    v_accvgpr_write_b32 a174, 0
    v_accvgpr_write_b32 a175, 0
    v_accvgpr_write_b32 a176, 0
    v_accvgpr_write_b32 a177, 0
    v_accvgpr_write_b32 a178, 0
    v_accvgpr_write_b32 a179, 0
    v_accvgpr_write_b32 a180, 0
    v_accvgpr_write_b32 a181, 0
    v_accvgpr_write_b32 a182, 0
    v_accvgpr_write_b32 a183, 0
    v_accvgpr_write_b32 a184, 0
    v_accvgpr_write_b32 a185, 0
    v_accvgpr_write_b32 a186, 0
    v_accvgpr_write_b32 a187, 0
    v_accvgpr_write_b32 a188, 0
    v_accvgpr_write_b32 a189, 0
    v_accvgpr_write_b32 a190, 0
    v_accvgpr_write_b32 a191, 0
    s_nop 1
L_f1d_172:
    v_lshrrev_b32 v110, 8, v1
    v_lshlrev_b32 v110, 8, v110
    v_bfe_u32 v108, v1, 6, 2
    v_lshl_add_u32 v110, v108, 6, v110
    v_bfe_u32 v108, v1, 4, 2
    v_lshl_add_u32 v110, v108, 4, v110
    v_add_u32 v110, s40, v110
    global_load_dwordx4 v[140:143], v1, s[56:57]
    v_lshrrev_b32 v108, 6, v1
    v_lshlrev_b32 v108, 10, v108
    v_and_b32 v111, 48, v1
    v_add_u32 v108, v108, v111
    s_mul_i32 s38, s26, 180224
    s_lshl_b32 s39, s9, 6
    s_add_u32 s38, s38, s39
    s_add_u32 s38, s38, 0
    v_add_u32 v108, s38, v108
    global_load_dwordx4 v[16:19], v108, s[30:31]
    v_add_u32 v108, 16384, v108
    global_load_dwordx4 v[20:23], v108, s[30:31]
    v_add_u32 v108, 16384, v108
    global_load_dwordx4 v[24:27], v108, s[30:31]
    v_add_u32 v108, 16384, v108
    global_load_dwordx4 v[28:31], v108, s[30:31]
    v_add_u32 v108, 16384, v108
    global_load_dwordx4 v[32:35], v108, s[30:31]
    v_add_u32 v108, 16384, v108
    global_load_dwordx4 v[36:39], v108, s[30:31]
    v_add_u32 v108, 16384, v108
    global_load_dwordx4 v[40:43], v108, s[30:31]
    v_add_u32 v108, 16384, v108
    global_load_dwordx4 v[44:47], v108, s[30:31]
    v_add_u32 v108, 16384, v108
    global_load_dwordx4 v[48:51], v108, s[30:31]
    v_add_u32 v108, 16384, v108
    v_mov_b32 v52, 0
    v_mov_b32 v53, 0
    v_mov_b32 v54, 0
    v_mov_b32 v55, 0
    v_mov_b32 v56, 0
    v_mov_b32 v57, 0
    v_mov_b32 v58, 0
    v_mov_b32 v59, 0
    s_cmp_eq_u32 s26, 7
    s_nop 0
    s_cbranch_scc1 L_f2z_173
    global_load_dwordx4 v[52:55], v108, s[30:31]
    v_add_u32 v108, 16384, v108
    global_load_dwordx4 v[56:59], v108, s[30:31]
    v_add_u32 v108, 16384, v108
    s_nop 1
L_f2z_173:
    s_waitcnt vmcnt(0)
    ds_write_b128 v109, v[16:19] offset:0
    ds_write_b128 v109, v[20:23] offset:1024
    ds_write_b128 v109, v[24:27] offset:2048
    ds_write_b128 v109, v[28:31] offset:3072
    ds_write_b128 v109, v[32:35] offset:4096
    ds_write_b128 v109, v[36:39] offset:5120
    ds_write_b128 v109, v[40:43] offset:6144
    ds_write_b128 v109, v[44:47] offset:7168
    ds_write_b128 v109, v[48:51] offset:8192
    ds_write_b128 v109, v[52:55] offset:9216
    ds_write_b128 v109, v[56:59] offset:10240
    s_waitcnt lgkmcnt(0)
    ds_read_b64_tr_b16 a[192:193], v110 offset:0
    ds_read_b64_tr_b16 a[194:195], v110 offset:1024
    ds_read_b64_tr_b16 a[196:197], v110 offset:8
    ds_read_b64_tr_b16 a[198:199], v110 offset:1032
    ds_read_b64_tr_b16 a[200:201], v110 offset:2048
    ds_read_b64_tr_b16 a[202:203], v110 offset:3072
    ds_read_b64_tr_b16 a[204:205], v110 offset:2056
    ds_read_b64_tr_b16 a[206:207], v110 offset:3080
    ds_read_b64_tr_b16 a[208:209], v110 offset:4096
    ds_read_b64_tr_b16 a[210:211], v110 offset:5120
    ds_read_b64_tr_b16 a[212:213], v110 offset:4104
    ds_read_b64_tr_b16 a[214:215], v110 offset:5128
    ds_read_b64_tr_b16 a[216:217], v110 offset:6144
    ds_read_b64_tr_b16 a[218:219], v110 offset:7168
    ds_read_b64_tr_b16 a[220:221], v110 offset:6152
    ds_read_b64_tr_b16 a[222:223], v110 offset:7176
    ds_read_b64_tr_b16 a[224:225], v110 offset:8192
    ds_read_b64_tr_b16 a[226:227], v110 offset:9216
    ds_read_b64_tr_b16 a[228:229], v110 offset:8200
    ds_read_b64_tr_b16 a[230:231], v110 offset:9224
    ds_read_b64_tr_b16 a[232:233], v110 offset:10240
    ds_read_b64_tr_b16 a[234:235], v110 offset:10248
    s_waitcnt lgkmcnt(0)
    v_lshrrev_b32 v108, 6, v1
    v_lshlrev_b32 v108, 10, v108
    v_and_b32 v111, 48, v1
    v_add_u32 v108, v108, v111
    s_mul_i32 s38, s26, 180224
    s_lshl_b32 s39, s9, 6
    s_add_u32 s38, s38, s39
    s_add_u32 s38, s38, 256
    v_add_u32 v108, s38, v108
    global_load_dwordx4 v[16:19], v108, s[30:31]
    v_add_u32 v108, 16384, v108
    global_load_dwordx4 v[20:23], v108, s[30:31]
    v_add_u32 v108, 16384, v108
    global_load_dwordx4 v[24:27], v108, s[30:31]
    v_add_u32 v108, 16384, v108
    global_load_dwordx4 v[28:31], v108, s[30:31]
    v_add_u32 v108, 16384, v108
    global_load_dwordx4 v[32:35], v108, s[30:31]
    v_add_u32 v108, 16384, v108
    global_load_dwordx4 v[36:39], v108, s[30:31]
    v_add_u32 v108, 16384, v108
    global_load_dwordx4 v[40:43], v108, s[30:31]
    v_add_u32 v108, 16384, v108
    global_load_dwordx4 v[44:47], v108, s[30:31]
    v_add_u32 v108, 16384, v108
    global_load_dwordx4 v[48:51], v108, s[30:31]
    v_add_u32 v108, 16384, v108
    v_mov_b32 v52, 0
    v_mov_b32 v53, 0
    v_mov_b32 v54, 0
    v_mov_b32 v55, 0
    v_mov_b32 v56, 0
    v_mov_b32 v57, 0
    v_mov_b32 v58, 0
    v_mov_b32 v59, 0
    s_cmp_eq_u32 s26, 7
    s_nop 0
    s_cbranch_scc1 L_f2z_174
    global_load_dwordx4 v[52:55], v108, s[30:31]
    v_add_u32 v108, 16384, v108
    global_load_dwordx4 v[56:59], v108, s[30:31]
    v_add_u32 v108, 16384, v108
    s_nop 1
L_f2z_174:
    s_waitcnt vmcnt(0)
    ds_write_b128 v109, v[16:19] offset:0
    ds_write_b128 v109, v[20:23] offset:1024
    ds_write_b128 v109, v[24:27] offset:2048
    ds_write_b128 v109, v[28:31] offset:3072
    ds_write_b128 v109, v[32:35] offset:4096
    ds_write_b128 v109, v[36:39] offset:5120
    ds_write_b128 v109, v[40:43] offset:6144
    ds_write_b128 v109, v[44:47] offset:7168
    ds_write_b128 v109, v[48:51] offset:8192
    ds_write_b128 v109, v[52:55] offset:9216
    ds_write_b128 v109, v[56:59] offset:10240
    s_waitcnt lgkmcnt(0)
    ds_read_b64_tr_b16 a[236:237], v110 offset:0
    ds_read_b64_tr_b16 a[238:239], v110 offset:1024
    ds_read_b64_tr_b16 a[240:241], v110 offset:8
    ds_read_b64_tr_b16 a[242:243], v110 offset:1032
    ds_read_b64_tr_b16 a[244:245], v110 offset:2048
    ds_read_b64_tr_b16 a[246:247], v110 offset:3072
    ds_read_b64_tr_b16 a[248:249], v110 offset:2056
    ds_read_b64_tr_b16 a[250:251], v110 offset:3080
    ds_read_b64_tr_b16 a[252:253], v110 offset:4096
    ds_read_b64_tr_b16 a[254:255], v110 offset:5120
    ds_read_b64_tr_b16 v[144:145], v110 offset:4104
    ds_read_b64_tr_b16 v[146:147], v110 offset:5128
    ds_read_b64_tr_b16 v[148:149], v110 offset:6144
    ds_read_b64_tr_b16 v[150:151], v110 offset:7168
    ds_read_b64_tr_b16 v[152:153], v110 offset:6152
    ds_read_b64_tr_b16 v[154:155], v110 offset:7176
    ds_read_b64_tr_b16 v[156:157], v110 offset:8192
    ds_read_b64_tr_b16 v[158:159], v110 offset:9216
    ds_read_b64_tr_b16 v[160:161], v110 offset:8200
    ds_read_b64_tr_b16 v[162:163], v110 offset:9224
    ds_read_b64_tr_b16 v[164:165], v110 offset:10240
    ds_read_b64_tr_b16 v[166:167], v110 offset:10248
    s_waitcnt lgkmcnt(0)
    v_lshrrev_b32 v108, 6, v1
    v_lshlrev_b32 v108, 10, v108
    v_and_b32 v111, 48, v1
    v_add_u32 v108, v108, v111
    s_mul_i32 s38, s26, 180224
    s_lshl_b32 s39, s9, 6
    s_add_u32 s38, s38, s39
    s_add_u32 s38, s38, 512
    v_add_u32 v108, s38, v108
    global_load_dwordx4 v[16:19], v108, s[30:31]
    v_add_u32 v108, 16384, v108
    global_load_dwordx4 v[20:23], v108, s[30:31]
    v_add_u32 v108, 16384, v108
    global_load_dwordx4 v[24:27], v108, s[30:31]
    v_add_u32 v108, 16384, v108
    global_load_dwordx4 v[28:31], v108, s[30:31]
    v_add_u32 v108, 16384, v108
    global_load_dwordx4 v[32:35], v108, s[30:31]
    v_add_u32 v108, 16384, v108
    global_load_dwordx4 v[36:39], v108, s[30:31]
    v_add_u32 v108, 16384, v108
    global_load_dwordx4 v[40:43], v108, s[30:31]
    v_add_u32 v108, 16384, v108
    global_load_dwordx4 v[44:47], v108, s[30:31]
    v_add_u32 v108, 16384, v108
    global_load_dwordx4 v[48:51], v108, s[30:31]
    v_add_u32 v108, 16384, v108
    v_mov_b32 v52, 0
    v_mov_b32 v53, 0
    v_mov_b32 v54, 0
    v_mov_b32 v55, 0
    v_mov_b32 v56, 0
    v_mov_b32 v57, 0
    v_mov_b32 v58, 0
    v_mov_b32 v59, 0
    s_cmp_eq_u32 s26, 7
    s_nop 0
    s_cbranch_scc1 L_f2z_175
    global_load_dwordx4 v[52:55], v108, s[30:31]
    v_add_u32 v108, 16384, v108
    global_load_dwordx4 v[56:59], v108, s[30:31]
    v_add_u32 v108, 16384, v108
    s_nop 1
L_f2z_175:
    s_waitcnt vmcnt(0)
    ds_write_b128 v109, v[16:19] offset:0
    ds_write_b128 v109, v[20:23] offset:1024
    ds_write_b128 v109, v[24:27] offset:2048
    ds_write_b128 v109, v[28:31] offset:3072
    ds_write_b128 v109, v[32:35] offset:4096
    ds_write_b128 v109, v[36:39] offset:5120
    ds_write_b128 v109, v[40:43] offset:6144
    ds_write_b128 v109, v[44:47] offset:7168
    ds_write_b128 v109, v[48:51] offset:8192
    ds_write_b128 v109, v[52:55] offset:9216
    ds_write_b128 v109, v[56:59] offset:10240
    s_waitcnt lgkmcnt(0)
    ds_read_b64_tr_b16 v[168:169], v110 offset:0
    ds_read_b64_tr_b16 v[170:171], v110 offset:1024
    ds_read_b64_tr_b16 v[172:173], v110 offset:8
    ds_read_b64_tr_b16 v[174:175], v110 offset:1032
    ds_read_b64_tr_b16 v[176:177], v110 offset:2048
    ds_read_b64_tr_b16 v[178:179], v110 offset:3072
    ds_read_b64_tr_b16 v[180:181], v110 offset:2056
    ds_read_b64_tr_b16 v[182:183], v110 offset:3080
    ds_read_b64_tr_b16 v[184:185], v110 offset:4096
    ds_read_b64_tr_b16 v[186:187], v110 offset:5120
    ds_read_b64_tr_b16 v[188:189], v110 offset:4104
    ds_read_b64_tr_b16 v[190:191], v110 offset:5128
    ds_read_b64_tr_b16 v[192:193], v110 offset:6144
    ds_read_b64_tr_b16 v[194:195], v110 offset:7168
    ds_read_b64_tr_b16 v[196:197], v110 offset:6152
    ds_read_b64_tr_b16 v[198:199], v110 offset:7176
    ds_read_b64_tr_b16 v[200:201], v110 offset:8192
    ds_read_b64_tr_b16 v[202:203], v110 offset:9216
    ds_read_b64_tr_b16 v[204:205], v110 offset:8200
    ds_read_b64_tr_b16 v[206:207], v110 offset:9224
    ds_read_b64_tr_b16 v[208:209], v110 offset:10240
    ds_read_b64_tr_b16 v[210:211], v110 offset:10248
    s_waitcnt lgkmcnt(0)
    v_lshrrev_b32 v108, 6, v1
    v_lshlrev_b32 v108, 10, v108
    v_and_b32 v111, 48, v1
    v_add_u32 v108, v108, v111
    s_mul_i32 s38, s26, 180224
    s_lshl_b32 s39, s9, 6
    s_add_u32 s38, s38, s39
    s_add_u32 s38, s38, 768
    v_add_u32 v108, s38, v108
    global_load_dwordx4 v[16:19], v108, s[30:31]
    v_add_u32 v108, 16384, v108
    global_load_dwordx4 v[20:23], v108, s[30:31]
    v_add_u32 v108, 16384, v108
    global_load_dwordx4 v[24:27], v108, s[30:31]
    v_add_u32 v108, 16384, v108
    global_load_dwordx4 v[28:31], v108, s[30:31]
    v_add_u32 v108, 16384, v108
    global_load_dwordx4 v[32:35], v108, s[30:31]
    v_add_u32 v108, 16384, v108
    global_load_dwordx4 v[36:39], v108, s[30:31]
    v_add_u32 v108, 16384, v108
    global_load_dwordx4 v[40:43], v108, s[30:31]
    v_add_u32 v108, 16384, v108
    global_load_dwordx4 v[44:47], v108, s[30:31]
    v_add_u32 v108, 16384, v108
    global_load_dwordx4 v[48:51], v108, s[30:31]
    v_add_u32 v108, 16384, v108
    v_mov_b32 v52, 0
    v_mov_b32 v53, 0
    v_mov_b32 v54, 0
    v_mov_b32 v55, 0
    v_mov_b32 v56, 0
    v_mov_b32 v57, 0
    v_mov_b32 v58, 0
    v_mov_b32 v59, 0
    s_cmp_eq_u32 s26, 7
    s_nop 0
    s_cbranch_scc1 L_f2z_176
    global_load_dwordx4 v[52:55], v108, s[30:31]
    v_add_u32 v108, 16384, v108
    global_load_dwordx4 v[56:59], v108, s[30:31]
    v_add_u32 v108, 16384, v108
    s_nop 1
L_f2z_176:
    s_waitcnt vmcnt(0)
    ds_write_b128 v109, v[16:19] offset:0
    ds_write_b128 v109, v[20:23] offset:1024
    ds_write_b128 v109, v[24:27] offset:2048
    ds_write_b128 v109, v[28:31] offset:3072
    ds_write_b128 v109, v[32:35] offset:4096
    ds_write_b128 v109, v[36:39] offset:5120
    ds_write_b128 v109, v[40:43] offset:6144
    ds_write_b128 v109, v[44:47] offset:7168
    ds_write_b128 v109, v[48:51] offset:8192
    ds_write_b128 v109, v[52:55] offset:9216
    ds_write_b128 v109, v[56:59] offset:10240
    s_waitcnt lgkmcnt(0)
    ds_read_b64_tr_b16 v[212:213], v110 offset:0
    ds_read_b64_tr_b16 v[214:215], v110 offset:1024
    ds_read_b64_tr_b16 v[216:217], v110 offset:8
    ds_read_b64_tr_b16 v[218:219], v110 offset:1032
    ds_read_b64_tr_b16 v[220:221], v110 offset:2048
    ds_read_b64_tr_b16 v[222:223], v110 offset:3072
    ds_read_b64_tr_b16 v[224:225], v110 offset:2056
    ds_read_b64_tr_b16 v[226:227], v110 offset:3080
    ds_read_b64_tr_b16 v[228:229], v110 offset:4096
    ds_read_b64_tr_b16 v[230:231], v110 offset:5120
    ds_read_b64_tr_b16 v[232:233], v110 offset:4104
    ds_read_b64_tr_b16 v[234:235], v110 offset:5128
    ds_read_b64_tr_b16 v[236:237], v110 offset:6144
    ds_read_b64_tr_b16 v[238:239], v110 offset:7168
    ds_read_b64_tr_b16 v[240:241], v110 offset:6152
    ds_read_b64_tr_b16 v[242:243], v110 offset:7176
    ds_read_b64_tr_b16 v[244:245], v110 offset:8192
    ds_read_b64_tr_b16 v[246:247], v110 offset:9216
    ds_read_b64_tr_b16 v[248:249], v110 offset:8200
    ds_read_b64_tr_b16 v[250:251], v110 offset:9224
    ds_read_b64_tr_b16 v[252:253], v110 offset:10240
    ds_read_b64_tr_b16 v[254:255], v110 offset:10248
    s_waitcnt lgkmcnt(0)
    s_barrier
    s_lshl_b32 s39, s6, 2
    s_add_u32 s39, s39, 96
    v_mov_b32 v17, s39
    s_mov_b32 s41, 2097152
    s_nop 0
L_dw_178:
    global_load_dword v18, v17, s[10:11] sc1
    s_waitcnt vmcnt(0)
    v_readfirstlane_b32 s38, v18
    s_sub_u32 s41, s41, 1
    s_cmp_eq_u32 s41, 0
    s_nop 2
    s_cbranch_scc1 L_end_165
    s_cmp_lt_u32 s38, 32
    s_cbranch_scc1 L_dw_178
L_go_177:
    v_mov_b32 v8, -1
    v_lshrrev_b32 v12, 8, v1
    v_mul_u32_u24 v11, 35072, v12
    v_and_b32 v12, 0xf0, v1
    v_add_u32 v11, v11, v12
    s_mul_i32 s38, s26, 2176
    s_lshl_b32 s39, s9, 8
    s_add_u32 s38, s38, s39
    v_add_u32 v11, s38, v11
    v_add_u32 v12, 17536, v11
    s_mov_b32 s18, 0
    v_bfe_u32 v16, v1, 4, 4
    v_lshrrev_b32 v17, 8, v1
    v_xor_b32 v17, v17, v16
    v_lshlrev_b32 v17, 4, v17
    v_lshl_add_u32 v17, v16, 10, v17
    v_add_u32 v3, 114688, v17
    v_xor_b32 v4, 64, v3
    v_xor_b32 v5, 128, v3
    v_xor_b32 v6, 192, v3
    s_and_b32 s38, s9, 1
    s_lshl_b32 s38, s38, 7
    v_xor_b32 v2, s38, v9
    s_mov_b32 s44, 0xbdd2d3e8
    s_mov_b32 s45, 0xbdd2d3e8
    s_lshl_b32 s46, s9, 13
    s_add_u32 s46, s46, 114688
    s_mov_b64 s[50:51], 0
    s_mov_b64 s[100:101], 0
    v_mov_b32 v15, 117481472
    s_mov_b32 s23, 0
    s_lshr_b32 s61, s22, 1
    s_lshl_b32 s38, s27, 6
    s_add_u32 s61, s61, s38
L_fj_179:
    s_and_b32 s24, s61, 63
    s_lshr_b32 s27, s61, 6
    s_lshl_b32 s38, s27, 21
    s_add_u32 s62, s38, 123731968
    s_cmp_ge_u32 s61, 116
    s_cselect_b32 s38, 4, 2
    s_add_u32 s63, s61, s38
    s_lshr_b32 s38, s61, 1
    s_cmp_eq_u32 s38, 31
    s_cselect_b32 s38, 54, 0
    s_add_u32 s63, s63, s38
    s_and_b32 s25, s23, 1
    s_mul_i32 s25, s25, 589824
    s_add_u32 s25, s25, s60
    s_bfe_u32 s36, s23, 0x10001
    s_xor_b32 s36, s36, 1
    s_cmp_lg_u64 s[50:51], 0
    s_cbranch_scc1 L_fpf_180
    s_waitcnt vmcnt(0)
    s_mov_b64 exec, s[100:101]
    global_store_dword v15, v8, s[4:5] sc1
    s_mov_b64 exec, -1
    s_mov_b64 s[100:101], 0
    s_lshl_b32 s38, s61, 7
    s_add_u32 s38, s38, 117456896
    s_lshl_b32 s39, s9, 5
    s_add_u32 s38, s38, s39
    v_bfe_u32 v79, v1, 4, 3
    v_lshlrev_b32 v79, 2, v79
    v_add_u32 v79, s38, v79
    s_mov_b32 s41, 2097152
    s_nop 0
L_pf_181:
    global_load_dword v76, v79, s[4:5] sc1
    s_sub_u32 s41, s41, 1
    s_cmp_eq_u32 s41, 0
    s_cbranch_scc1 L_end_165
    s_waitcnt vmcnt(0)
    v_cmp_eq_u32 vcc, 0, v76
    s_nop 4
    s_cbranch_vccnz L_pf_181
    s_lshl_b32 s38, s61, 15
    s_add_u32 s38, s38, 119537664
    s_add_u32 s28, s4, s38
    s_addc_u32 s29, s5, 0
    s_add_u32 m0, s46, 0
    s_nop 0
    global_load_lds_dwordx4 v2, s[28:29] offset:0 sc1
    v_xor_b32 v113, 16, v2
    global_load_lds_dwordx4 v113, s[28:29] offset:1024 sc1
    v_xor_b32 v114, 32, v2
    global_load_lds_dwordx4 v114, s[28:29] offset:2048 sc1
    v_xor_b32 v115, 48, v2
    global_load_lds_dwordx4 v115, s[28:29] offset:3072 sc1
    s_add_u32 m0, s46, 4096
    v_xor_b32 v116, 4160, v2
    global_load_lds_dwordx4 v116, s[28:29] offset:0 sc1
    v_xor_b32 v117, 4176, v2
    global_load_lds_dwordx4 v117, s[28:29] offset:1024 sc1
    v_xor_b32 v118, 4192, v2
    global_load_lds_dwordx4 v118, s[28:29] offset:2048 sc1
    v_xor_b32 v119, 4208, v2
    global_load_lds_dwordx4 v119, s[28:29] offset:3072 sc1
    s_waitcnt vmcnt(0)
L_fpf_180:
    s_cmp_eq_u32 s18, 0
    s_cbranch_scc1 L_f2c_182
    s_waitcnt vmcnt(1)
    s_mov_b32 s18, 0
L_f2c_182:
    s_barrier
    v_mov_b32 v74, 0xc0135761
    v_mov_b32 v77, 1.0
    v_lshrrev_b32 v78, 1, v1
    s_lshl_b32 s38, s9, 9
    v_add_u32 v75, s38, v78
    v_mov_b32 v76, 0
    ds_read_b128 v[28:31], v3 offset:0
    ds_read_b128 v[32:35], v4 offset:0
    ds_read_b128 v[36:39], v5 offset:0
    ds_read_b128 v[40:43], v6 offset:0
    s_waitcnt lgkmcnt(3)
    v_mfma_f32_16x16x32_bf16 v[16:19], a[0:3], v[28:31], 0
    v_mfma_f32_16x16x32_bf16 v[20:23], a[64:67], v[28:31], 0
    v_mfma_f32_16x16x32_bf16 v[24:27], a[128:131], v[28:31], 0
    ds_read_b128 v[28:31], v3 offset:256
    s_waitcnt lgkmcnt(3)
    v_mfma_f32_16x16x32_bf16 v[16:19], a[4:7], v[32:35], v[16:19]
    v_mfma_f32_16x16x32_bf16 v[20:23], a[68:71], v[32:35], v[20:23]
    v_mfma_f32_16x16x32_bf16 v[24:27], a[132:135], v[32:35], v[24:27]
    ds_read_b128 v[32:35], v4 offset:256
    s_waitcnt lgkmcnt(3)
    v_mfma_f32_16x16x32_bf16 v[16:19], a[8:11], v[36:39], v[16:19]
    v_mfma_f32_16x16x32_bf16 v[20:23], a[72:75], v[36:39], v[20:23]
    v_mfma_f32_16x16x32_bf16 v[24:27], a[136:139], v[36:39], v[24:27]
    ds_read_b128 v[36:39], v5 offset:256
    s_waitcnt lgkmcnt(3)
    v_mfma_f32_16x16x32_bf16 v[16:19], a[12:15], v[40:43], v[16:19]
    v_mfma_f32_16x16x32_bf16 v[20:23], a[76:79], v[40:43], v[20:23]
    v_mfma_f32_16x16x32_bf16 v[24:27], a[140:143], v[40:43], v[24:27]
    ds_read_b128 v[40:43], v6 offset:256
    s_waitcnt lgkmcnt(3)
    v_mfma_f32_16x16x32_bf16 v[16:19], a[16:19], v[28:31], v[16:19]
    v_mfma_f32_16x16x32_bf16 v[20:23], a[80:83], v[28:31], v[20:23]
    v_mfma_f32_16x16x32_bf16 v[24:27], a[144:147], v[28:31], v[24:27]
    ds_read_b128 v[28:31], v3 offset:512
    s_waitcnt lgkmcnt(3)
    v_mfma_f32_16x16x32_bf16 v[16:19], a[20:23], v[32:35], v[16:19]
    v_mfma_f32_16x16x32_bf16 v[20:23], a[84:87], v[32:35], v[20:23]
    v_mfma_f32_16x16x32_bf16 v[24:27], a[148:151], v[32:35], v[24:27]
    ds_read_b128 v[32:35], v4 offset:512
    s_waitcnt lgkmcnt(3)
    v_mfma_f32_16x16x32_bf16 v[16:19], a[24:27], v[36:39], v[16:19]
    v_mfma_f32_16x16x32_bf16 v[20:23], a[88:91], v[36:39], v[20:23]
    v_mfma_f32_16x16x32_bf16 v[24:27], a[152:155], v[36:39], v[24:27]
    ds_read_b128 v[36:39], v5 offset:512
    s_waitcnt lgkmcnt(3)
    v_mfma_f32_16x16x32_bf16 v[16:19], a[28:31], v[40:43], v[16:19]
    v_mfma_f32_16x16x32_bf16 v[20:23], a[92:95], v[40:43], v[20:23]
    v_mfma_f32_16x16x32_bf16 v[24:27], a[156:159], v[40:43], v[24:27]
    ds_read_b128 v[40:43], v6 offset:512
    s_waitcnt lgkmcnt(3)
    v_mfma_f32_16x16x32_bf16 v[16:19], a[32:35], v[28:31], v[16:19]
    v_mfma_f32_16x16x32_bf16 v[20:23], a[96:99], v[28:31], v[20:23]
    v_mfma_f32_16x16x32_bf16 v[24:27], a[160:163], v[28:31], v[24:27]
    ds_read_b128 v[28:31], v3 offset:768
    s_waitcnt lgkmcnt(3)
    v_mfma_f32_16x16x32_bf16 v[16:19], a[36:39], v[32:35], v[16:19]
    v_mfma_f32_16x16x32_bf16 v[20:23], a[100:103], v[32:35], v[20:23]
    v_mfma_f32_16x16x32_bf16 v[24:27], a[164:167], v[32:35], v[24:27]
    ds_read_b128 v[32:35], v4 offset:768
    s_waitcnt lgkmcnt(3)
    v_mfma_f32_16x16x32_bf16 v[16:19], a[40:43], v[36:39], v[16:19]
    v_mfma_f32_16x16x32_bf16 v[20:23], a[104:107], v[36:39], v[20:23]
    v_mfma_f32_16x16x32_bf16 v[24:27], a[168:171], v[36:39], v[24:27]
    s_waitcnt vmcnt(0)
    s_mov_b64 exec, s[100:101]
    global_store_dword v15, v8, s[4:5] sc1
    s_mov_b64 exec, -1
    s_mov_b64 s[100:101], 0
    s_lshl_b32 s39, s26, 1
    s_and_b32 s38, s9, 1
    s_add_u32 s39, s39, s38
    s_lshr_b32 s38, s9, 1
    s_lshl_b32 s38, s38, 4
    s_add_u32 s39, s39, s38
    s_lshl_b32 s38, s24, 5
    s_add_u32 s39, s39, s38
    s_lshl_b32 s38, s39, 10
    s_add_u32 s30, s4, s38
    s_addc_u32 s31, s5, 0
    s_add_u32 s32, s52, s38
    s_addc_u32 s33, s53, 0
    ds_read_b128 v[36:39], v5 offset:768
    s_waitcnt lgkmcnt(3)
    v_mfma_f32_16x16x32_bf16 v[16:19], a[44:47], v[40:43], v[16:19]
    v_mfma_f32_16x16x32_bf16 v[20:23], a[108:111], v[40:43], v[20:23]
    v_mfma_f32_16x16x32_bf16 v[24:27], a[172:175], v[40:43], v[24:27]
    v_add_u32 v112, s62, v1
    global_load_dwordx4 v[124:127], v112, s[30:31] sc1
    s_lshl_b32 s39, s39, 2
    v_mov_b32 v15, s39
    v_add_u32 v15, 117473280, v15
    ds_read_b128 v[40:43], v6 offset:768
    s_waitcnt lgkmcnt(3)
    v_mfma_f32_16x16x32_bf16 v[16:19], a[48:51], v[28:31], v[16:19]
    v_mfma_f32_16x16x32_bf16 v[20:23], a[112:115], v[28:31], v[20:23]
    v_mfma_f32_16x16x32_bf16 v[24:27], a[176:179], v[28:31], v[24:27]
    s_lshl_b32 s38, s63, 7
    s_add_u32 s38, s38, 117456896
    s_lshl_b32 s39, s9, 5
    s_add_u32 s38, s38, s39
    v_bfe_u32 v79, v1, 4, 3
    v_lshlrev_b32 v79, 2, v79
    v_add_u32 v79, s38, v79
    ds_read_b128 v[28:31], v3 offset:16384
    s_waitcnt lgkmcnt(3)
    v_mfma_f32_16x16x32_bf16 v[16:19], a[52:55], v[32:35], v[16:19]
    v_mfma_f32_16x16x32_bf16 v[20:23], a[116:119], v[32:35], v[20:23]
    v_mfma_f32_16x16x32_bf16 v[24:27], a[180:183], v[32:35], v[24:27]
    s_lshl_b32 s38, s63, 15
    s_add_u32 s38, s38, 119537664
    s_add_u32 s28, s4, s38
    s_addc_u32 s29, s5, 0
    s_add_u32 s34, s20, s25
    s_addc_u32 s35, s21, 0
    ds_read_b128 v[32:35], v4 offset:16384
    s_waitcnt lgkmcnt(3)
    v_mfma_f32_16x16x32_bf16 v[16:19], a[56:59], v[36:39], v[16:19]
    v_mfma_f32_16x16x32_bf16 v[20:23], a[120:123], v[36:39], v[20:23]
    v_mfma_f32_16x16x32_bf16 v[24:27], a[184:187], v[36:39], v[24:27]
    s_add_u32 s12, s34, 140288
    s_addc_u32 s13, s35, 0
    s_lshr_b32 s38, s9, 1
    s_lshl_b32 s38, s38, 3
    s_add_u32 s38, s38, s26
    s_mul_i32 s38, s38, 17536
    s_and_b32 s39, s9, 1
    s_lshl_b32 s39, s39, 10
    s_add_u32 s38, s38, s39
    s_add_u32 s14, s34, s38
    s_addc_u32 s15, s35, 0
    ds_read_b128 v[36:39], v5 offset:16384
    s_waitcnt lgkmcnt(3)
    v_mfma_f32_16x16x32_bf16 v[16:19], a[60:63], v[40:43], v[16:19]
    v_mfma_f32_16x16x32_bf16 v[20:23], a[124:127], v[40:43], v[20:23]
    v_mfma_f32_16x16x32_bf16 v[24:27], a[188:191], v[40:43], v[24:27]
    ds_read_b128 v[40:43], v6 offset:16384
    s_waitcnt lgkmcnt(3)
    v_mfma_f32_16x16x32_bf16 v[44:47], a[0:3], v[28:31], 0
    v_mfma_f32_16x16x32_bf16 v[48:51], a[64:67], v[28:31], 0
    v_mfma_f32_16x16x32_bf16 v[52:55], a[128:131], v[28:31], 0
    s_nop 0
    v_cvt_pk_bf16_f32 v68, v16, v17
    v_cvt_pk_bf16_f32 v69, v18, v19
    v_lshlrev_b32 v16, 16, v68
    ds_read_b128 v[28:31], v3 offset:16640
    s_waitcnt lgkmcnt(3)
    v_mfma_f32_16x16x32_bf16 v[44:47], a[4:7], v[32:35], v[44:47]
    v_and_b32 v17, 0xffff0000, v68
    v_lshlrev_b32 v18, 16, v69
    v_and_b32 v19, 0xffff0000, v69
    v_add_f32 v16, v16, v128
    v_mfma_f32_16x16x32_bf16 v[48:51], a[68:71], v[32:35], v[48:51]
    v_add_f32 v17, v17, v129
    v_add_f32 v18, v18, v130
    v_add_f32 v19, v19, v131
    v_mfma_f32_16x16x32_bf16 v[52:55], a[132:135], v[32:35], v[52:55]
    v_cvt_pk_bf16_f32 v68, v16, v17
    v_cvt_pk_bf16_f32 v69, v18, v19
    v_lshlrev_b32 v16, 16, v68
    v_and_b32 v17, 0xffff0000, v68
    ds_read_b128 v[32:35], v4 offset:16640
    s_waitcnt lgkmcnt(3)
    v_mfma_f32_16x16x32_bf16 v[44:47], a[8:11], v[36:39], v[44:47]
    v_lshlrev_b32 v18, 16, v69
    v_and_b32 v19, 0xffff0000, v69
    v_cvt_pk_bf16_f32 v70, v20, v21
    v_mfma_f32_16x16x32_bf16 v[48:51], a[72:75], v[36:39], v[48:51]
    v_cvt_pk_bf16_f32 v71, v22, v23
    v_lshlrev_b32 v20, 16, v70
    v_and_b32 v21, 0xffff0000, v70
    v_lshlrev_b32 v22, 16, v71
    v_mfma_f32_16x16x32_bf16 v[52:55], a[136:139], v[36:39], v[52:55]
    v_and_b32 v23, 0xffff0000, v71
    v_add_f32 v20, v20, v132
    v_add_f32 v21, v21, v133
    ds_read_b128 v[36:39], v5 offset:16640
    s_waitcnt lgkmcnt(3)
    v_mfma_f32_16x16x32_bf16 v[44:47], a[12:15], v[40:43], v[44:47]
    v_add_f32 v22, v22, v134
    v_add_f32 v23, v23, v135
    v_cvt_pk_bf16_f32 v70, v20, v21
    v_cvt_pk_bf16_f32 v71, v22, v23
    v_mfma_f32_16x16x32_bf16 v[48:51], a[76:79], v[40:43], v[48:51]
    v_lshlrev_b32 v20, 16, v70
    v_and_b32 v21, 0xffff0000, v70
    v_lshlrev_b32 v22, 16, v71
    v_mfma_f32_16x16x32_bf16 v[52:55], a[140:143], v[40:43], v[52:55]
    v_and_b32 v23, 0xffff0000, v71
    v_cvt_pk_bf16_f32 v72, v24, v25
    v_cvt_pk_bf16_f32 v73, v26, v27
    v_lshlrev_b32 v24, 16, v72
    ds_read_b128 v[40:43], v6 offset:16640
    s_waitcnt lgkmcnt(3)
    v_mfma_f32_16x16x32_bf16 v[44:47], a[16:19], v[28:31], v[44:47]
    v_and_b32 v25, 0xffff0000, v72
    v_lshlrev_b32 v26, 16, v73
    v_and_b32 v27, 0xffff0000, v73
    v_mfma_f32_16x16x32_bf16 v[48:51], a[80:83], v[28:31], v[48:51]
    v_add_f32 v24, v24, v136
    v_add_f32 v25, v25, v137
    v_add_f32 v26, v26, v138
    v_add_f32 v27, v27, v139
    v_mfma_f32_16x16x32_bf16 v[52:55], a[144:147], v[28:31], v[52:55]
    v_cvt_pk_bf16_f32 v72, v24, v25
    v_cvt_pk_bf16_f32 v73, v26, v27
    v_lshlrev_b32 v24, 16, v72
    ds_read_b128 v[28:31], v3 offset:16896
    s_waitcnt lgkmcnt(3)
    v_mfma_f32_16x16x32_bf16 v[44:47], a[20:23], v[32:35], v[44:47]
    v_and_b32 v25, 0xffff0000, v72
    v_lshlrev_b32 v26, 16, v73
    v_and_b32 v27, 0xffff0000, v73
    v_mul_f32 v56, v16, v16
    v_mfma_f32_16x16x32_bf16 v[48:51], a[84:87], v[32:35], v[48:51]
    v_mul_f32 v57, v17, v17
    v_mul_f32 v58, v18, v18
    v_mul_f32 v59, v19, v19
    v_mfma_f32_16x16x32_bf16 v[52:55], a[148:151], v[32:35], v[52:55]
    v_mul_f32 v60, v20, v20
    v_mul_f32 v61, v21, v21
    v_mul_f32 v62, v22, v22
    v_mul_f32 v63, v23, v23
    ds_read_b128 v[32:35], v4 offset:16896
    s_waitcnt lgkmcnt(3)
    v_mfma_f32_16x16x32_bf16 v[44:47], a[24:27], v[36:39], v[44:47]
    v_mul_f32 v64, v24, v24
    v_mul_f32 v65, v25, v25
    v_mul_f32 v66, v26, v26
    v_mfma_f32_16x16x32_bf16 v[48:51], a[88:91], v[36:39], v[48:51]
    v_mul_f32 v67, v27, v27
    v_fma_f32 v56, v56, s44, v74
    v_fma_f32 v57, v57, s44, v74
    v_fma_f32 v58, v58, s44, v74
    v_mfma_f32_16x16x32_bf16 v[52:55], a[152:155], v[36:39], v[52:55]
    v_fma_f32 v59, v59, s44, v74
    v_fma_f32 v60, v60, s44, v74
    v_fma_f32 v61, v61, s44, v74
    ds_read_b128 v[36:39], v5 offset:16896
    s_waitcnt lgkmcnt(3)
    v_mfma_f32_16x16x32_bf16 v[44:47], a[28:31], v[40:43], v[44:47]
    v_fma_f32 v62, v62, s44, v74
    v_fma_f32 v63, v63, s44, v74
    v_fma_f32 v64, v64, s44, v74
    v_fma_f32 v65, v65, s44, v74
    v_mfma_f32_16x16x32_bf16 v[48:51], a[92:95], v[40:43], v[48:51]
    v_fma_f32 v66, v66, s44, v74
    v_fma_f32 v67, v67, s44, v74
    v_mul_f32 v56, v56, v16
    v_mfma_f32_16x16x32_bf16 v[52:55], a[156:159], v[40:43], v[52:55]
    v_mul_f32 v57, v57, v17
    v_mul_f32 v58, v58, v18
    v_mul_f32 v59, v59, v19
    v_mul_f32 v60, v60, v20
    ds_read_b128 v[40:43], v6 offset:16896
    s_waitcnt lgkmcnt(3)
    v_mfma_f32_16x16x32_bf16 v[44:47], a[32:35], v[28:31], v[44:47]
    v_mul_f32 v61, v61, v21
    v_mul_f32 v62, v62, v22
    v_mul_f32 v63, v63, v23
    v_mfma_f32_16x16x32_bf16 v[48:51], a[96:99], v[28:31], v[48:51]
    v_mul_f32 v64, v64, v24
    v_mul_f32 v65, v65, v25
    v_mul_f32 v66, v66, v26
    v_mul_f32 v67, v67, v27
    v_mfma_f32_16x16x32_bf16 v[52:55], a[160:163], v[28:31], v[52:55]
    v_exp_f32 v56, v56
    ds_read_b128 v[28:31], v3 offset:17152
    s_waitcnt lgkmcnt(3)
    v_mfma_f32_16x16x32_bf16 v[44:47], a[36:39], v[32:35], v[44:47]
    v_exp_f32 v57, v57
    v_exp_f32 v58, v58
    v_mfma_f32_16x16x32_bf16 v[48:51], a[100:103], v[32:35], v[48:51]
    v_exp_f32 v59, v59
    v_exp_f32 v60, v60
    v_mfma_f32_16x16x32_bf16 v[52:55], a[164:167], v[32:35], v[52:55]
    v_exp_f32 v61, v61
    v_exp_f32 v62, v62
    ds_read_b128 v[32:35], v4 offset:17152
    s_waitcnt lgkmcnt(3)
    v_mfma_f32_16x16x32_bf16 v[44:47], a[40:43], v[36:39], v[44:47]
    v_exp_f32 v63, v63
    v_mfma_f32_16x16x32_bf16 v[48:51], a[104:107], v[36:39], v[48:51]
    v_exp_f32 v64, v64
    v_exp_f32 v65, v65
    v_mfma_f32_16x16x32_bf16 v[52:55], a[168:171], v[36:39], v[52:55]
    v_exp_f32 v66, v66
    v_exp_f32 v67, v67
    ds_read_b128 v[36:39], v5 offset:17152
    s_waitcnt lgkmcnt(3)
    v_mfma_f32_16x16x32_bf16 v[44:47], a[44:47], v[40:43], v[44:47]
    v_add_f32 v56, 1.0, v56
    v_add_f32 v57, 1.0, v57
    v_add_f32 v58, 1.0, v58
    v_add_f32 v59, 1.0, v59
    v_mfma_f32_16x16x32_bf16 v[48:51], a[108:111], v[40:43], v[48:51]
    v_add_f32 v60, 1.0, v60
    v_add_f32 v61, 1.0, v61
    v_add_f32 v62, 1.0, v62
    v_mfma_f32_16x16x32_bf16 v[52:55], a[172:175], v[40:43], v[52:55]
    v_add_f32 v63, 1.0, v63
    v_add_f32 v64, 1.0, v64
    v_add_f32 v65, 1.0, v65
    v_add_f32 v66, 1.0, v66
    ds_read_b128 v[40:43], v6 offset:17152
    s_waitcnt lgkmcnt(3)
    v_mfma_f32_16x16x32_bf16 v[44:47], a[48:51], v[28:31], v[44:47]
    v_add_f32 v67, 1.0, v67
    v_rcp_f32 v56, v56
    v_mfma_f32_16x16x32_bf16 v[48:51], a[112:115], v[28:31], v[48:51]
    v_rcp_f32 v57, v57
    v_rcp_f32 v58, v58
    v_mfma_f32_16x16x32_bf16 v[52:55], a[176:179], v[28:31], v[52:55]
    v_rcp_f32 v59, v59
    s_waitcnt lgkmcnt(2)
    v_mfma_f32_16x16x32_bf16 v[44:47], a[52:55], v[32:35], v[44:47]
    v_rcp_f32 v60, v60
    v_rcp_f32 v61, v61
    v_mfma_f32_16x16x32_bf16 v[48:51], a[116:119], v[32:35], v[48:51]
    v_rcp_f32 v62, v62
    v_rcp_f32 v63, v63
    v_mfma_f32_16x16x32_bf16 v[52:55], a[180:183], v[32:35], v[52:55]
    v_rcp_f32 v64, v64
    v_rcp_f32 v65, v65
    s_waitcnt lgkmcnt(1)
    v_mfma_f32_16x16x32_bf16 v[44:47], a[56:59], v[36:39], v[44:47]
    v_rcp_f32 v66, v66
    v_mfma_f32_16x16x32_bf16 v[48:51], a[120:123], v[36:39], v[48:51]
    v_rcp_f32 v67, v67
    v_mul_f32 v56, v56, v16
    v_mul_f32 v57, v57, v17
    v_mul_f32 v58, v58, v18
    v_mfma_f32_16x16x32_bf16 v[52:55], a[184:187], v[36:39], v[52:55]
    v_mul_f32 v59, v59, v19
    v_mul_f32 v60, v60, v20
    v_mul_f32 v61, v61, v21
    s_waitcnt lgkmcnt(0)
    v_mfma_f32_16x16x32_bf16 v[44:47], a[60:63], v[40:43], v[44:47]
    v_mul_f32 v62, v62, v22
    v_mul_f32 v63, v63, v23
    v_mul_f32 v64, v64, v24
    v_mul_f32 v65, v65, v25
    v_mfma_f32_16x16x32_bf16 v[48:51], a[124:127], v[40:43], v[48:51]
    v_mul_f32 v66, v66, v26
    v_mul_f32 v67, v67, v27
    v_cvt_pk_bf16_f32 v68, v56, v57
    v_mfma_f32_16x16x32_bf16 v[52:55], a[188:191], v[40:43], v[52:55]
    v_cvt_pk_bf16_f32 v69, v58, v59
    v_cvt_pk_bf16_f32 v70, v60, v61
    v_cvt_pk_bf16_f32 v71, v62, v63
    v_cvt_pk_bf16_f32 v72, v64, v65
    v_cvt_pk_bf16_f32 v73, v66, v67
    ds_write_b64 v75, v[68:69] offset:0
    ds_write_b64 v75, v[70:71] offset:2048
    ds_write_b64 v75, v[72:73] offset:4096
    s_waitcnt lgkmcnt(0)
    s_barrier
    ds_read2st64_b64 v[16:19], v78 offset0:0 offset1:1
    ds_read2st64_b64 v[20:23], v78 offset0:2 offset1:3
    ds_read2st64_b64 v[24:27], v78 offset0:4 offset1:5
    ds_read2st64_b64 v[28:31], v78 offset0:6 offset1:7
    ds_read2st64_b64 v[32:35], v78 offset0:8 offset1:9
    ds_read_b64 v[36:37], v78 offset:5120
    global_load_dword v76, v79, s[4:5] sc1
    v_cvt_pk_bf16_f32 v68, v44, v45
    v_cvt_pk_bf16_f32 v69, v46, v47
    v_lshlrev_b32 v44, 16, v68
    v_and_b32 v45, 0xffff0000, v68
    v_lshlrev_b32 v46, 16, v69
    v_and_b32 v47, 0xffff0000, v69
    v_add_f32 v44, v44, v128
    v_add_f32 v45, v45, v129
    v_add_f32 v46, v46, v130
    v_add_f32 v47, v47, v131
    v_cvt_pk_bf16_f32 v68, v44, v45
    v_cvt_pk_bf16_f32 v69, v46, v47
    v_lshlrev_b32 v44, 16, v68
    v_and_b32 v45, 0xffff0000, v68
    v_lshlrev_b32 v46, 16, v69
    v_and_b32 v47, 0xffff0000, v69
    v_cvt_pk_bf16_f32 v70, v48, v49
    v_cvt_pk_bf16_f32 v71, v50, v51
    v_lshlrev_b32 v48, 16, v70
    v_and_b32 v49, 0xffff0000, v70
    v_lshlrev_b32 v50, 16, v71
    v_and_b32 v51, 0xffff0000, v71
    v_add_f32 v48, v48, v132
    v_add_f32 v49, v49, v133
    s_waitcnt lgkmcnt(5)
    v_mfma_f32_16x16x32_bf16 v[80:83], v[16:19], a[192:195], 0
    v_add_f32 v50, v50, v134
    v_add_f32 v51, v51, v135
    v_cvt_pk_bf16_f32 v70, v48, v49
    v_mfma_f32_16x16x32_bf16 v[84:87], v[16:19], a[196:199], 0
    v_cvt_pk_bf16_f32 v71, v50, v51
    v_lshlrev_b32 v48, 16, v70
    v_and_b32 v49, 0xffff0000, v70
    v_mfma_f32_16x16x32_bf16 v[88:91], v[16:19], a[236:239], 0
    v_lshlrev_b32 v50, 16, v71
    v_and_b32 v51, 0xffff0000, v71
    v_cvt_pk_bf16_f32 v72, v52, v53
    v_mfma_f32_16x16x32_bf16 v[92:95], v[16:19], a[240:243], 0
    v_cvt_pk_bf16_f32 v73, v54, v55
    v_lshlrev_b32 v52, 16, v72
    v_and_b32 v53, 0xffff0000, v72
    s_waitcnt lgkmcnt(4)
    v_mfma_f32_16x16x32_bf16 v[80:83], v[20:23], a[200:203], v[80:83]
    v_lshlrev_b32 v54, 16, v73
    v_and_b32 v55, 0xffff0000, v73
    v_add_f32 v52, v52, v136
    v_mfma_f32_16x16x32_bf16 v[84:87], v[20:23], a[204:207], v[84:87]
    v_add_f32 v53, v53, v137
    v_add_f32 v54, v54, v138
    v_add_f32 v55, v55, v139
    v_mfma_f32_16x16x32_bf16 v[88:91], v[20:23], a[244:247], v[88:91]
    v_cvt_pk_bf16_f32 v72, v52, v53
    v_cvt_pk_bf16_f32 v73, v54, v55
    v_lshlrev_b32 v52, 16, v72
    v_mfma_f32_16x16x32_bf16 v[92:95], v[20:23], a[248:251], v[92:95]
    v_and_b32 v53, 0xffff0000, v72
    v_lshlrev_b32 v54, 16, v73
    v_and_b32 v55, 0xffff0000, v73
    s_waitcnt lgkmcnt(3)
    v_mfma_f32_16x16x32_bf16 v[80:83], v[24:27], a[208:211], v[80:83]
    v_mul_f32 v56, v44, v44
    v_mul_f32 v57, v45, v45
    v_mul_f32 v58, v46, v46
    v_mfma_f32_16x16x32_bf16 v[84:87], v[24:27], a[212:215], v[84:87]
    v_mul_f32 v59, v47, v47
    v_mul_f32 v60, v48, v48
    v_mul_f32 v61, v49, v49
    v_mfma_f32_16x16x32_bf16 v[88:91], v[24:27], a[252:255], v[88:91]
    v_mul_f32 v62, v50, v50
    v_mul_f32 v63, v51, v51
    v_mul_f32 v64, v52, v52
    v_mfma_f32_16x16x32_bf16 v[92:95], v[24:27], v[144:147], v[92:95]
    v_mul_f32 v65, v53, v53
    v_mul_f32 v66, v54, v54
    v_mul_f32 v67, v55, v55
    s_waitcnt lgkmcnt(2)
    v_mfma_f32_16x16x32_bf16 v[80:83], v[28:31], a[216:219], v[80:83]
    v_fma_f32 v56, v56, s44, v74
    v_fma_f32 v57, v57, s44, v74
    v_fma_f32 v58, v58, s44, v74
    v_mfma_f32_16x16x32_bf16 v[84:87], v[28:31], a[220:223], v[84:87]
    v_fma_f32 v59, v59, s44, v74
    v_fma_f32 v60, v60, s44, v74
    v_fma_f32 v61, v61, s44, v74
    v_mfma_f32_16x16x32_bf16 v[88:91], v[28:31], v[148:151], v[88:91]
    v_fma_f32 v62, v62, s44, v74
    v_fma_f32 v63, v63, s44, v74
    v_fma_f32 v64, v64, s44, v74
    v_mfma_f32_16x16x32_bf16 v[92:95], v[28:31], v[152:155], v[92:95]
    v_fma_f32 v65, v65, s44, v74
    v_fma_f32 v66, v66, s44, v74
    v_fma_f32 v67, v67, s44, v74
    s_waitcnt lgkmcnt(1)
    v_mfma_f32_16x16x32_bf16 v[80:83], v[32:35], a[224:227], v[80:83]
    v_mul_f32 v56, v56, v44
    v_mul_f32 v57, v57, v45
    v_mul_f32 v58, v58, v46
    v_mfma_f32_16x16x32_bf16 v[84:87], v[32:35], a[228:231], v[84:87]
    v_mul_f32 v59, v59, v47
    v_mul_f32 v60, v60, v48
    v_mul_f32 v61, v61, v49
    v_mfma_f32_16x16x32_bf16 v[88:91], v[32:35], v[156:159], v[88:91]
    v_mul_f32 v62, v62, v50
    v_mul_f32 v63, v63, v51
    v_mul_f32 v64, v64, v52
    v_mfma_f32_16x16x32_bf16 v[92:95], v[32:35], v[160:163], v[92:95]
    v_mul_f32 v65, v65, v53
    v_mul_f32 v66, v66, v54
    v_mul_f32 v67, v67, v55
    s_waitcnt lgkmcnt(0)
    v_mfma_f32_16x16x16_bf16 v[80:83], v[36:37], a[232:233], v[80:83]
    v_exp_f32 v56, v56
    v_mfma_f32_16x16x16_bf16 v[84:87], v[36:37], a[234:235], v[84:87]
    v_exp_f32 v57, v57
    v_exp_f32 v58, v58
    v_mfma_f32_16x16x16_bf16 v[88:91], v[36:37], v[164:165], v[88:91]
    v_exp_f32 v59, v59
    v_mfma_f32_16x16x16_bf16 v[92:95], v[36:37], v[166:167], v[92:95]
    v_exp_f32 v60, v60
    v_exp_f32 v61, v61
    v_mfma_f32_16x16x32_bf16 v[96:99], v[16:19], v[168:171], 0
    v_exp_f32 v62, v62
    v_mfma_f32_16x16x32_bf16 v[100:103], v[16:19], v[172:175], 0
    v_exp_f32 v63, v63
    v_exp_f32 v64, v64
    v_mfma_f32_16x16x32_bf16 v[104:107], v[16:19], v[212:215], 0
    v_exp_f32 v65, v65
    v_cvt_pk_bf16_f32 v80, v80, v81
    v_cvt_pk_bf16_f32 v81, v84, v85
    v_mfma_f32_16x16x32_bf16 v[108:111], v[16:19], v[216:219], 0
    v_exp_f32 v66, v66
    v_exp_f32 v67, v67
    v_mfma_f32_16x16x32_bf16 v[96:99], v[20:23], v[176:179], v[96:99]
    v_add_f32 v56, 1.0, v56
    v_add_f32 v57, 1.0, v57
    v_add_f32 v58, 1.0, v58
    v_mfma_f32_16x16x32_bf16 v[100:103], v[20:23], v[180:183], v[100:103]
    v_add_f32 v59, 1.0, v59
    v_add_f32 v60, 1.0, v60
    v_add_f32 v61, 1.0, v61
    v_mfma_f32_16x16x32_bf16 v[104:107], v[20:23], v[220:223], v[104:107]
    v_add_f32 v62, 1.0, v62
    v_add_f32 v63, 1.0, v63
    v_add_f32 v64, 1.0, v64
    v_cvt_pk_bf16_f32 v84, v82, v83
    v_cvt_pk_bf16_f32 v82, v88, v89
    v_mfma_f32_16x16x32_bf16 v[108:111], v[20:23], v[224:227], v[108:111]
    v_add_f32 v65, 1.0, v65
    v_add_f32 v66, 1.0, v66
    v_add_f32 v67, 1.0, v67
    v_mfma_f32_16x16x32_bf16 v[96:99], v[24:27], v[184:187], v[96:99]
    v_rcp_f32 v56, v56
    v_mfma_f32_16x16x32_bf16 v[100:103], v[24:27], v[188:191], v[100:103]
    v_rcp_f32 v57, v57
    v_rcp_f32 v58, v58
    v_mfma_f32_16x16x32_bf16 v[104:107], v[24:27], v[228:231], v[104:107]
    v_rcp_f32 v59, v59
    v_cvt_pk_bf16_f32 v83, v92, v93
    v_and_or_b32 v80, v80, -2, s36
    v_mfma_f32_16x16x32_bf16 v[108:111], v[24:27], v[232:235], v[108:111]
    v_rcp_f32 v60, v60
    v_rcp_f32 v61, v61
    v_mfma_f32_16x16x32_bf16 v[96:99], v[28:31], v[192:195], v[96:99]
    v_rcp_f32 v62, v62
    v_mfma_f32_16x16x32_bf16 v[100:103], v[28:31], v[196:199], v[100:103]
    v_rcp_f32 v63, v63
    v_rcp_f32 v64, v64
    v_mfma_f32_16x16x32_bf16 v[104:107], v[28:31], v[236:239], v[104:107]
    v_rcp_f32 v65, v65
    global_store_dwordx4 v11, v[80:83], s[34:35] offset:0 sc1
    v_cvt_pk_bf16_f32 v85, v86, v87
    v_mfma_f32_16x16x32_bf16 v[108:111], v[28:31], v[240:243], v[108:111]
    v_rcp_f32 v66, v66
    v_rcp_f32 v67, v67
    v_mfma_f32_16x16x32_bf16 v[96:99], v[32:35], v[200:203], v[96:99]
    v_mul_f32 v56, v56, v44
    v_mul_f32 v57, v57, v45
    v_mul_f32 v58, v58, v46
    v_mfma_f32_16x16x32_bf16 v[100:103], v[32:35], v[204:207], v[100:103]
    v_mul_f32 v59, v59, v47
    v_mul_f32 v60, v60, v48
    v_mul_f32 v61, v61, v49
    v_mfma_f32_16x16x32_bf16 v[104:107], v[32:35], v[244:247], v[104:107]
    v_mul_f32 v62, v62, v50
    v_mul_f32 v63, v63, v51
    v_mul_f32 v64, v64, v52
    v_cvt_pk_bf16_f32 v86, v90, v91
    v_cvt_pk_bf16_f32 v87, v94, v95
    v_mfma_f32_16x16x32_bf16 v[108:111], v[32:35], v[248:251], v[108:111]
    v_mul_f32 v65, v65, v53
    v_mul_f32 v66, v66, v54
    v_mul_f32 v67, v67, v55
    v_mfma_f32_16x16x16_bf16 v[96:99], v[36:37], v[208:209], v[96:99]
    v_cvt_pk_bf16_f32 v68, v56, v57
    v_cvt_pk_bf16_f32 v69, v58, v59
    v_cvt_pk_bf16_f32 v70, v60, v61
    v_mfma_f32_16x16x16_bf16 v[100:103], v[36:37], v[210:211], v[100:103]
    v_cvt_pk_bf16_f32 v71, v62, v63
    v_cvt_pk_bf16_f32 v72, v64, v65
    v_cvt_pk_bf16_f32 v73, v66, v67
    v_mfma_f32_16x16x16_bf16 v[104:107], v[36:37], v[252:253], v[104:107]
    v_and_or_b32 v84, v84, -2, s36
    global_store_dwordx4 v12, v[84:87], s[34:35] offset:0 sc1
    v_mfma_f32_16x16x16_bf16 v[108:111], v[36:37], v[254:255], v[108:111]
    ds_write_b64 v75, v[68:69] offset:6144
    ds_write_b64 v75, v[70:71] offset:8192
    ds_write_b64 v75, v[72:73] offset:10240
    s_waitcnt lgkmcnt(0)
    s_barrier
    v_cmp_eq_u32 vcc, 0, v76
    ds_read2st64_b64 v[16:19], v78 offset0:12 offset1:13
    ds_read2st64_b64 v[20:23], v78 offset0:14 offset1:15
    ds_read2st64_b64 v[24:27], v78 offset0:16 offset1:17
    ds_read2st64_b64 v[28:31], v78 offset0:18 offset1:19
    ds_read2st64_b64 v[32:35], v78 offset0:20 offset1:21
    ds_read_b64 v[36:37], v78 offset:11264
    s_cmp_eq_u64 vcc, 0
    s_cselect_b64 s[50:51], -1, 0
    s_waitcnt lgkmcnt(5)
    v_mfma_f32_16x16x32_bf16 v[40:43], v[16:19], a[192:195], 0
    v_mfma_f32_16x16x32_bf16 v[44:47], v[16:19], a[196:199], 0
    v_mfma_f32_16x16x32_bf16 v[48:51], v[16:19], a[236:239], 0
    v_cvt_pk_bf16_f32 v96, v96, v97
    v_cvt_pk_bf16_f32 v97, v100, v101
    v_mfma_f32_16x16x32_bf16 v[52:55], v[16:19], a[240:243], 0
    s_waitcnt lgkmcnt(4)
    v_mfma_f32_16x16x32_bf16 v[40:43], v[20:23], a[200:203], v[40:43]
    v_mfma_f32_16x16x32_bf16 v[44:47], v[20:23], a[204:207], v[44:47]
    v_mfma_f32_16x16x32_bf16 v[48:51], v[20:23], a[244:247], v[48:51]
    v_cvt_pk_bf16_f32 v100, v98, v99
    v_cvt_pk_bf16_f32 v98, v104, v105
    v_mfma_f32_16x16x32_bf16 v[52:55], v[20:23], a[248:251], v[52:55]
    s_waitcnt lgkmcnt(3)
    v_mfma_f32_16x16x32_bf16 v[40:43], v[24:27], a[208:211], v[40:43]
    s_add_u32 m0, s46, 0
    v_mfma_f32_16x16x32_bf16 v[44:47], v[24:27], a[212:215], v[44:47]
    s_mov_b64 exec, s[50:51]
    global_load_lds_dwordx4 v2, s[28:29] offset:0 sc1
    s_mov_b64 exec, -1
    v_mfma_f32_16x16x32_bf16 v[48:51], v[24:27], a[252:255], v[48:51]
    v_xor_b32 v113, 16, v2
    v_cvt_pk_bf16_f32 v99, v108, v109
    v_and_or_b32 v96, v96, -2, s36
    v_mfma_f32_16x16x32_bf16 v[52:55], v[24:27], v[144:147], v[52:55]
    s_mov_b64 exec, s[50:51]
    global_load_lds_dwordx4 v113, s[28:29] offset:1024 sc1
    s_mov_b64 exec, -1
    s_waitcnt lgkmcnt(2)
    v_mfma_f32_16x16x32_bf16 v[40:43], v[28:31], a[216:219], v[40:43]
    v_xor_b32 v114, 32, v2
    v_mfma_f32_16x16x32_bf16 v[44:47], v[28:31], a[220:223], v[44:47]
    s_mov_b64 exec, s[50:51]
    global_load_lds_dwordx4 v114, s[28:29] offset:2048 sc1
    s_mov_b64 exec, -1
    v_mfma_f32_16x16x32_bf16 v[48:51], v[28:31], v[148:151], v[48:51]
    v_xor_b32 v115, 48, v2
    global_store_dwordx4 v11, v[96:99], s[34:35] offset:1024 sc1
    v_cvt_pk_bf16_f32 v101, v102, v103
    v_mfma_f32_16x16x32_bf16 v[52:55], v[28:31], v[152:155], v[52:55]
    s_mov_b64 exec, s[50:51]
    global_load_lds_dwordx4 v115, s[28:29] offset:3072 sc1
    s_mov_b64 exec, -1
    s_waitcnt lgkmcnt(1)
    v_mfma_f32_16x16x32_bf16 v[40:43], v[32:35], a[224:227], v[40:43]
    s_add_u32 m0, s46, 4096
    v_mfma_f32_16x16x32_bf16 v[44:47], v[32:35], a[228:231], v[44:47]
    v_xor_b32 v116, 4160, v2
    v_mfma_f32_16x16x32_bf16 v[48:51], v[32:35], v[156:159], v[48:51]
    s_mov_b64 exec, s[50:51]
    global_load_lds_dwordx4 v116, s[28:29] offset:0 sc1
    s_mov_b64 exec, -1
    v_cvt_pk_bf16_f32 v102, v106, v107
    v_cvt_pk_bf16_f32 v103, v110, v111
    v_mfma_f32_16x16x32_bf16 v[52:55], v[32:35], v[160:163], v[52:55]
    v_xor_b32 v117, 4176, v2
    s_waitcnt lgkmcnt(0)
    v_mfma_f32_16x16x16_bf16 v[40:43], v[36:37], a[232:233], v[40:43]
    s_mov_b64 exec, s[50:51]
    global_load_lds_dwordx4 v117, s[28:29] offset:1024 sc1
    s_mov_b64 exec, -1
    v_mfma_f32_16x16x16_bf16 v[44:47], v[36:37], a[234:235], v[44:47]
    v_xor_b32 v118, 4192, v2
    v_mfma_f32_16x16x16_bf16 v[48:51], v[36:37], v[164:165], v[48:51]
    s_mov_b64 exec, s[50:51]
    global_load_lds_dwordx4 v118, s[28:29] offset:2048 sc1
    s_mov_b64 exec, -1
    v_and_or_b32 v100, v100, -2, s36
    global_store_dwordx4 v12, v[100:103], s[34:35] offset:1024 sc1
    v_mfma_f32_16x16x16_bf16 v[52:55], v[36:37], v[166:167], v[52:55]
    v_xor_b32 v119, 4208, v2
    v_mfma_f32_16x16x32_bf16 v[56:59], v[16:19], v[168:171], 0
    s_mov_b64 exec, s[50:51]
    global_load_lds_dwordx4 v119, s[28:29] offset:3072 sc1
    s_mov_b64 exec, -1
    v_mfma_f32_16x16x32_bf16 v[60:63], v[16:19], v[172:175], 0
    v_mfma_f32_16x16x32_bf16 v[64:67], v[16:19], v[212:215], 0
    v_cvt_pk_bf16_f32 v40, v40, v41
    v_cvt_pk_bf16_f32 v41, v44, v45
    v_mfma_f32_16x16x32_bf16 v[68:71], v[16:19], v[216:219], 0
    v_mfma_f32_16x16x32_bf16 v[56:59], v[20:23], v[176:179], v[56:59]
    v_mfma_f32_16x16x32_bf16 v[60:63], v[20:23], v[180:183], v[60:63]
    v_mfma_f32_16x16x32_bf16 v[64:67], v[20:23], v[220:223], v[64:67]
    v_cvt_pk_bf16_f32 v44, v42, v43
    v_cvt_pk_bf16_f32 v42, v48, v49
    v_mfma_f32_16x16x32_bf16 v[68:71], v[20:23], v[224:227], v[68:71]
    v_mfma_f32_16x16x32_bf16 v[56:59], v[24:27], v[184:187], v[56:59]
    v_mfma_f32_16x16x32_bf16 v[60:63], v[24:27], v[188:191], v[60:63]
    v_mfma_f32_16x16x32_bf16 v[64:67], v[24:27], v[228:231], v[64:67]
    v_cvt_pk_bf16_f32 v43, v52, v53
    v_and_or_b32 v40, v40, -2, s36
    v_mfma_f32_16x16x32_bf16 v[68:71], v[24:27], v[232:235], v[68:71]
    v_mfma_f32_16x16x32_bf16 v[56:59], v[28:31], v[192:195], v[56:59]
    v_mfma_f32_16x16x32_bf16 v[60:63], v[28:31], v[196:199], v[60:63]
    v_mfma_f32_16x16x32_bf16 v[64:67], v[28:31], v[236:239], v[64:67]
    global_store_dwordx4 v11, v[40:43], s[12:13] offset:0 sc1
    v_cvt_pk_bf16_f32 v45, v46, v47
    v_mfma_f32_16x16x32_bf16 v[68:71], v[28:31], v[240:243], v[68:71]
    v_mfma_f32_16x16x32_bf16 v[56:59], v[32:35], v[200:203], v[56:59]
    v_mfma_f32_16x16x32_bf16 v[60:63], v[32:35], v[204:207], v[60:63]
    v_mfma_f32_16x16x32_bf16 v[64:67], v[32:35], v[244:247], v[64:67]
    v_cvt_pk_bf16_f32 v46, v50, v51
    v_cvt_pk_bf16_f32 v47, v54, v55
    v_mfma_f32_16x16x32_bf16 v[68:71], v[32:35], v[248:251], v[68:71]
    v_mfma_f32_16x16x16_bf16 v[56:59], v[36:37], v[208:209], v[56:59]
    v_mfma_f32_16x16x16_bf16 v[60:63], v[36:37], v[210:211], v[60:63]
    v_mfma_f32_16x16x16_bf16 v[64:67], v[36:37], v[252:253], v[64:67]
    v_and_or_b32 v44, v44, -2, s36
    global_store_dwordx4 v12, v[44:47], s[12:13] offset:0 sc1
    v_mfma_f32_16x16x16_bf16 v[68:71], v[36:37], v[254:255], v[68:71]
    s_nop 2
    v_cvt_pk_bf16_f32 v56, v56, v57
    v_cvt_pk_bf16_f32 v57, v60, v61
    v_cvt_pk_bf16_f32 v60, v58, v59
    v_cvt_pk_bf16_f32 v58, v64, v65
    s_nop 0
    v_cvt_pk_bf16_f32 v59, v68, v69
    v_and_or_b32 v56, v56, -2, s36
    global_store_dwordx4 v11, v[56:59], s[12:13] offset:1024 sc1
    v_cvt_pk_bf16_f32 v61, v62, v63
    v_cvt_pk_bf16_f32 v62, v66, v67
    v_cvt_pk_bf16_f32 v63, v70, v71
    v_and_or_b32 v60, v60, -2, s36
    global_store_dwordx4 v12, v[60:63], s[12:13] offset:1024 sc1
    global_load_dword v76, v79, s[4:5] sc1
    s_mov_b64 s[16:17], s[14:15]
    global_load_dwordx4 v[16:19], v1, s[16:17] sc1
    s_add_u32 s16, s16, 2176
    s_addc_u32 s17, s17, 0
    global_load_dwordx4 v[20:23], v1, s[16:17] sc1
    s_add_u32 s16, s16, 2176
    s_addc_u32 s17, s17, 0
    global_load_dwordx4 v[24:27], v1, s[16:17] sc1
    s_add_u32 s16, s16, 2176
    s_addc_u32 s17, s17, 0
    global_load_dwordx4 v[28:31], v1, s[16:17] sc1
    s_add_u32 s16, s16, 2176
    s_addc_u32 s17, s17, 0
    global_load_dwordx4 v[32:35], v1, s[16:17] sc1
    s_add_u32 s16, s16, 2176
    s_addc_u32 s17, s17, 0
    global_load_dwordx4 v[36:39], v1, s[16:17] sc1
    s_add_u32 s16, s16, 2176
    s_addc_u32 s17, s17, 0
    global_load_dwordx4 v[40:43], v1, s[16:17] sc1
    s_add_u32 s16, s16, 2176
    s_addc_u32 s17, s17, 0
    global_load_dwordx4 v[44:47], v1, s[16:17] sc1
    v_lshrrev_b32 v48, 6, v1
    v_lshlrev_b32 v48, 5, v48
    v_bfe_u32 v52, v1, 4, 2
    v_lshl_add_u32 v48, v52, 2, v48
    s_lshr_b32 s38, s9, 1
    s_lshl_b32 s38, s38, 12
    s_and_b32 s39, s9, 1
    s_lshl_b32 s39, s39, 10
    s_add_u32 s38, s38, s39
    s_add_u32 s38, s38, 147456
    v_add_u32 v48, s38, v48
    v_add_u32 v49, 2048, v48
    s_lshl_b32 s38, s9, 11
    s_add_u32 s38, s38, 147456
    v_lshl_add_u32 v50, v1, 1, s38
    s_sub_u32 s40, 0, s36
    s_mov_b32 s41, 2097152
L_rp_183:
    s_waitcnt vmcnt(7)
    v_lshlrev_b32 v80, 16, v16
    v_and_b32 v81, 0xffff0000, v16
    v_lshlrev_b32 v82, 16, v17
    v_and_b32 v83, 0xffff0000, v17
    v_lshlrev_b32 v84, 16, v18
    v_and_b32 v85, 0xffff0000, v18
    v_lshlrev_b32 v86, 16, v19
    v_and_b32 v87, 0xffff0000, v19
    s_waitcnt vmcnt(6)
    v_lshlrev_b32 v88, 16, v20
    v_and_b32 v89, 0xffff0000, v20
    v_lshlrev_b32 v90, 16, v21
    v_and_b32 v91, 0xffff0000, v21
    v_lshlrev_b32 v92, 16, v22
    v_and_b32 v93, 0xffff0000, v22
    v_lshlrev_b32 v94, 16, v23
    v_and_b32 v95, 0xffff0000, v23
    v_pk_add_f32 v[80:81], v[80:81], v[88:89]
    v_pk_add_f32 v[82:83], v[82:83], v[90:91]
    v_pk_add_f32 v[84:85], v[84:85], v[92:93]
    v_pk_add_f32 v[86:87], v[86:87], v[94:95]
    v_bitop3_b32 v52, v16, v20, s40 bitop3:0x7e
    s_waitcnt vmcnt(5)
    v_lshlrev_b32 v88, 16, v24
    v_and_b32 v89, 0xffff0000, v24
    v_lshlrev_b32 v90, 16, v25
    v_and_b32 v91, 0xffff0000, v25
    v_lshlrev_b32 v92, 16, v26
    v_and_b32 v93, 0xffff0000, v26
    v_lshlrev_b32 v94, 16, v27
    v_and_b32 v95, 0xffff0000, v27
    v_pk_add_f32 v[80:81], v[80:81], v[88:89]
    v_pk_add_f32 v[82:83], v[82:83], v[90:91]
    v_pk_add_f32 v[84:85], v[84:85], v[92:93]
    v_pk_add_f32 v[86:87], v[86:87], v[94:95]
    s_waitcnt vmcnt(4)
    v_lshlrev_b32 v88, 16, v28
    v_and_b32 v89, 0xffff0000, v28
    v_lshlrev_b32 v90, 16, v29
    v_and_b32 v91, 0xffff0000, v29
    v_lshlrev_b32 v92, 16, v30
    v_and_b32 v93, 0xffff0000, v30
    v_lshlrev_b32 v94, 16, v31
    v_and_b32 v95, 0xffff0000, v31
    v_pk_add_f32 v[80:81], v[80:81], v[88:89]
    v_pk_add_f32 v[82:83], v[82:83], v[90:91]
    v_pk_add_f32 v[84:85], v[84:85], v[92:93]
    v_pk_add_f32 v[86:87], v[86:87], v[94:95]
    v_bitop3_b32 v53, v24, v28, s40 bitop3:0x7e
    s_waitcnt vmcnt(3)
    v_lshlrev_b32 v88, 16, v32
    v_and_b32 v89, 0xffff0000, v32
    v_lshlrev_b32 v90, 16, v33
    v_and_b32 v91, 0xffff0000, v33
    v_lshlrev_b32 v92, 16, v34
    v_and_b32 v93, 0xffff0000, v34
    v_lshlrev_b32 v94, 16, v35
    v_and_b32 v95, 0xffff0000, v35
    v_pk_add_f32 v[80:81], v[80:81], v[88:89]
    v_pk_add_f32 v[82:83], v[82:83], v[90:91]
    v_pk_add_f32 v[84:85], v[84:85], v[92:93]
    v_pk_add_f32 v[86:87], v[86:87], v[94:95]
    s_waitcnt vmcnt(2)
    v_lshlrev_b32 v88, 16, v36
    v_and_b32 v89, 0xffff0000, v36
    v_lshlrev_b32 v90, 16, v37
    v_and_b32 v91, 0xffff0000, v37
    v_lshlrev_b32 v92, 16, v38
    v_and_b32 v93, 0xffff0000, v38
    v_lshlrev_b32 v94, 16, v39
    v_and_b32 v95, 0xffff0000, v39
    v_pk_add_f32 v[80:81], v[80:81], v[88:89]
    v_pk_add_f32 v[82:83], v[82:83], v[90:91]
    v_pk_add_f32 v[84:85], v[84:85], v[92:93]
    v_pk_add_f32 v[86:87], v[86:87], v[94:95]
    v_bitop3_b32 v54, v32, v36, s40 bitop3:0x7e
    s_waitcnt vmcnt(1)
    v_lshlrev_b32 v88, 16, v40
    v_and_b32 v89, 0xffff0000, v40
    v_lshlrev_b32 v90, 16, v41
    v_and_b32 v91, 0xffff0000, v41
    v_lshlrev_b32 v92, 16, v42
    v_and_b32 v93, 0xffff0000, v42
    v_lshlrev_b32 v94, 16, v43
    v_and_b32 v95, 0xffff0000, v43
    v_pk_add_f32 v[80:81], v[80:81], v[88:89]
    v_pk_add_f32 v[82:83], v[82:83], v[90:91]
    v_pk_add_f32 v[84:85], v[84:85], v[92:93]
    v_pk_add_f32 v[86:87], v[86:87], v[94:95]
    s_waitcnt vmcnt(0)
    v_lshlrev_b32 v88, 16, v44
    v_and_b32 v89, 0xffff0000, v44
    v_lshlrev_b32 v90, 16, v45
    v_and_b32 v91, 0xffff0000, v45
    v_lshlrev_b32 v92, 16, v46
    v_and_b32 v93, 0xffff0000, v46
    v_lshlrev_b32 v94, 16, v47
    v_and_b32 v95, 0xffff0000, v47
    v_pk_add_f32 v[80:81], v[80:81], v[88:89]
    v_pk_add_f32 v[82:83], v[82:83], v[90:91]
    v_pk_add_f32 v[84:85], v[84:85], v[92:93]
    v_pk_add_f32 v[86:87], v[86:87], v[94:95]
    v_bitop3_b32 v55, v40, v44, s40 bitop3:0x7e
    v_or3_b32 v52, v52, v53, v54
    v_bitop3_b32 v52, v52, v55, 1 bitop3:0xa8
    v_cmp_ne_u32 vcc, 0, v52
    s_nop 4
    s_cbranch_vccz L_rg_184
    s_mov_b64 exec, vcc
    s_mov_b64 s[16:17], s[14:15]
    global_load_dwordx4 v[16:19], v1, s[16:17] sc1
    s_add_u32 s16, s16, 2176
    s_addc_u32 s17, s17, 0
    global_load_dwordx4 v[20:23], v1, s[16:17] sc1
    s_add_u32 s16, s16, 2176
    s_addc_u32 s17, s17, 0
    global_load_dwordx4 v[24:27], v1, s[16:17] sc1
    s_add_u32 s16, s16, 2176
    s_addc_u32 s17, s17, 0
    global_load_dwordx4 v[28:31], v1, s[16:17] sc1
    s_add_u32 s16, s16, 2176
    s_addc_u32 s17, s17, 0
    global_load_dwordx4 v[32:35], v1, s[16:17] sc1
    s_add_u32 s16, s16, 2176
    s_addc_u32 s17, s17, 0
    global_load_dwordx4 v[36:39], v1, s[16:17] sc1
    s_add_u32 s16, s16, 2176
    s_addc_u32 s17, s17, 0
    global_load_dwordx4 v[40:43], v1, s[16:17] sc1
    s_add_u32 s16, s16, 2176
    s_addc_u32 s17, s17, 0
    global_load_dwordx4 v[44:47], v1, s[16:17] sc1
    s_mov_b64 exec, -1
    s_sub_u32 s41, s41, 1
    s_cmp_eq_u32 s41, 0
    s_cbranch_scc1 L_end_165
    s_branch L_rp_183
L_rg_184:
    v_cmp_eq_u32 vcc, 0, v76
    ds_write2_b32 v48, v80, v82 offset0:0 offset1:4
    ds_write2_b32 v48, v84, v86 offset0:128 offset1:132
    ds_write2_b32 v49, v81, v83 offset0:0 offset1:4
    ds_write2_b32 v49, v85, v87 offset0:128 offset1:132
    s_nop 1
    s_or_b64 vcc, vcc, s[50:51]
    s_cbranch_scc1 L_f2s_185
    s_add_u32 m0, s46, 0
    s_nop 0
    global_load_lds_dwordx4 v2, s[28:29] offset:0 sc1
    v_xor_b32 v113, 16, v2
    global_load_lds_dwordx4 v113, s[28:29] offset:1024 sc1
    v_xor_b32 v114, 32, v2
    global_load_lds_dwordx4 v114, s[28:29] offset:2048 sc1
    v_xor_b32 v115, 48, v2
    global_load_lds_dwordx4 v115, s[28:29] offset:3072 sc1
    s_add_u32 m0, s46, 4096
    v_xor_b32 v116, 4160, v2
    global_load_lds_dwordx4 v116, s[28:29] offset:0 sc1
    v_xor_b32 v117, 4176, v2
    global_load_lds_dwordx4 v117, s[28:29] offset:1024 sc1
    v_xor_b32 v118, 4192, v2
    global_load_lds_dwordx4 v118, s[28:29] offset:2048 sc1
    v_xor_b32 v119, 4208, v2
    global_load_lds_dwordx4 v119, s[28:29] offset:3072 sc1
    s_mov_b64 s[50:51], -1
    s_mov_b32 s18, 1
L_f2s_185:
    s_waitcnt lgkmcnt(0)
    s_barrier
    ds_read_b128 v[16:19], v50
    ds_read_b128 v[20:23], v50 offset:16
    s_waitcnt lgkmcnt(0)
    v_cvt_pk_bf16_f32 v40, v16, v17
    v_cvt_pk_bf16_f32 v41, v18, v19
    v_cvt_pk_bf16_f32 v42, v20, v21
    v_cvt_pk_bf16_f32 v43, v22, v23
    v_lshlrev_b32 v16, 16, v40
    v_and_b32 v17, 0xffff0000, v40
    v_lshlrev_b32 v18, 16, v41
    v_and_b32 v19, 0xffff0000, v41
    v_lshlrev_b32 v20, 16, v42
    v_and_b32 v21, 0xffff0000, v42
    v_lshlrev_b32 v22, 16, v43
    v_and_b32 v23, 0xffff0000, v43
    v_lshlrev_b32 v24, 16, v140
    v_and_b32 v25, 0xffff0000, v140
    v_lshlrev_b32 v26, 16, v141
    v_and_b32 v27, 0xffff0000, v141
    v_lshlrev_b32 v28, 16, v142
    v_and_b32 v29, 0xffff0000, v142
    v_lshlrev_b32 v30, 16, v143
    v_and_b32 v31, 0xffff0000, v143
    v_pk_add_f32 v[16:17], v[16:17], v[24:25]
    v_pk_add_f32 v[18:19], v[18:19], v[26:27]
    v_pk_add_f32 v[20:21], v[20:21], v[28:29]
    v_pk_add_f32 v[22:23], v[22:23], v[30:31]
    v_cvt_pk_bf16_f32 v40, v16, v17
    v_cvt_pk_bf16_f32 v41, v18, v19
    v_cvt_pk_bf16_f32 v42, v20, v21
    v_cvt_pk_bf16_f32 v43, v22, v23
    v_lshlrev_b32 v16, 16, v40
    v_and_b32 v17, 0xffff0000, v40
    v_lshlrev_b32 v18, 16, v41
    v_and_b32 v19, 0xffff0000, v41
    v_lshlrev_b32 v20, 16, v42
    v_and_b32 v21, 0xffff0000, v42
    v_lshlrev_b32 v22, 16, v43
    v_and_b32 v23, 0xffff0000, v43
    v_lshlrev_b32 v24, 16, v124
    v_and_b32 v25, 0xffff0000, v124
    v_lshlrev_b32 v26, 16, v125
    v_and_b32 v27, 0xffff0000, v125
    v_lshlrev_b32 v28, 16, v126
    v_and_b32 v29, 0xffff0000, v126
    v_lshlrev_b32 v30, 16, v127
    v_and_b32 v31, 0xffff0000, v127
    v_pk_add_f32 v[24:25], v[24:25], v[16:17]
    v_pk_add_f32 v[26:27], v[26:27], v[18:19]
    v_pk_add_f32 v[28:29], v[28:29], v[20:21]
    v_pk_add_f32 v[30:31], v[30:31], v[22:23]
    v_cvt_pk_bf16_f32 v48, v24, v25
    v_cvt_pk_bf16_f32 v49, v26, v27
    v_cvt_pk_bf16_f32 v50, v28, v29
    v_cvt_pk_bf16_f32 v51, v30, v31
    s_cmp_lg_u32 s27, 0
    s_nop 0
    s_cbranch_scc1 L_fl1_186
    v_add_u32 v80, 130023424, v1
    global_store_dwordx4 v80, v[48:51], s[30:31] sc1
    v_lshlrev_b32 v24, 16, v48
    v_and_b32 v25, 0xffff0000, v48
    v_lshlrev_b32 v26, 16, v49
    v_and_b32 v27, 0xffff0000, v49
    v_lshlrev_b32 v28, 16, v50
    v_and_b32 v29, 0xffff0000, v50
    v_lshlrev_b32 v30, 16, v51
    v_and_b32 v31, 0xffff0000, v51
    v_pk_add_f32 v[32:33], v[24:25], v[26:27]
    v_pk_add_f32 v[34:35], v[28:29], v[30:31]
    v_pk_add_f32 v[32:33], v[32:33], v[34:35]
    v_add_f32 v44, v32, v33
    s_nop 1
    v_add_f32_dpp v45, v44, v44 quad_perm:[1,0,3,2] row_mask:0xf bank_mask:0xf
    s_nop 1
    v_add_f32_dpp v44, v45, v45 quad_perm:[2,3,0,1] row_mask:0xf bank_mask:0xf
    s_nop 1
    v_add_f32_dpp v45, v44, v44 row_half_mirror row_mask:0xf bank_mask:0xf
    s_nop 1
    v_add_f32_dpp v44, v45, v45 row_mirror row_mask:0xf bank_mask:0xf
    v_mov_b32 v45, v44
    s_nop 1
    v_permlane16_swap_b32 v45, v44
    v_add_f32 v44, v44, v45
    v_mov_b32 v45, v44
    s_nop 1
    v_permlane32_swap_b32 v45, v44
    v_add_f32 v44, v44, v45
    v_mul_f32 v44, 0x3b000000, v44
    v_pk_add_f32 v[32:33], v[24:25], v[44:45] op_sel_hi:[1,0] neg_lo:[0,1] neg_hi:[0,1]
    v_pk_add_f32 v[34:35], v[26:27], v[44:45] op_sel_hi:[1,0] neg_lo:[0,1] neg_hi:[0,1]
    v_pk_add_f32 v[36:37], v[28:29], v[44:45] op_sel_hi:[1,0] neg_lo:[0,1] neg_hi:[0,1]
    v_pk_add_f32 v[38:39], v[30:31], v[44:45] op_sel_hi:[1,0] neg_lo:[0,1] neg_hi:[0,1]
    v_pk_mul_f32 v[46:47], v[32:33], v[32:33]
    v_pk_fma_f32 v[46:47], v[34:35], v[34:35], v[46:47]
    v_pk_fma_f32 v[46:47], v[36:37], v[36:37], v[46:47]
    v_pk_fma_f32 v[46:47], v[38:39], v[38:39], v[46:47]
    v_add_f32 v46, v46, v47
    s_nop 1
    v_add_f32_dpp v47, v46, v46 quad_perm:[1,0,3,2] row_mask:0xf bank_mask:0xf
    s_nop 1
    v_add_f32_dpp v46, v47, v47 quad_perm:[2,3,0,1] row_mask:0xf bank_mask:0xf
    s_nop 1
    v_add_f32_dpp v47, v46, v46 row_half_mirror row_mask:0xf bank_mask:0xf
    s_nop 1
    v_add_f32_dpp v46, v47, v47 row_mirror row_mask:0xf bank_mask:0xf
    v_mov_b32 v47, v46
    s_nop 1
    v_permlane16_swap_b32 v47, v46
    v_add_f32 v46, v46, v47
    v_mov_b32 v47, v46
    s_nop 1
    v_permlane32_swap_b32 v47, v46
    v_add_f32 v46, v46, v47
    v_mul_f32 v46, 0x3b000000, v46
    v_cvt_pk_bf16_f32 v44, v44, v44
    v_and_b32 v44, 0xffff0000, v44
    v_cvt_pk_bf16_f32 v46, v46, v46
    v_and_b32 v46, 0xffff0000, v46
    v_add_f32 v46, 0x3727c5ac, v46
    v_cvt_pk_bf16_f32 v46, v46, v46
    v_and_b32 v46, 0xffff0000, v46
    v_sqrt_f32 v46, v46
    s_nop 0
    v_cvt_pk_bf16_f32 v46, v46, v46
    v_and_b32 v46, 0xffff0000, v46
    v_rcp_f32 v46, v46
    v_pk_add_f32 v[32:33], v[24:25], v[44:45] op_sel_hi:[1,0] neg_lo:[0,1] neg_hi:[0,1]
    v_pk_add_f32 v[34:35], v[26:27], v[44:45] op_sel_hi:[1,0] neg_lo:[0,1] neg_hi:[0,1]
    v_pk_add_f32 v[36:37], v[28:29], v[44:45] op_sel_hi:[1,0] neg_lo:[0,1] neg_hi:[0,1]
    v_pk_add_f32 v[38:39], v[30:31], v[44:45] op_sel_hi:[1,0] neg_lo:[0,1] neg_hi:[0,1]
    v_cvt_pk_bf16_f32 v40, v32, v33
    v_cvt_pk_bf16_f32 v41, v34, v35
    v_cvt_pk_bf16_f32 v42, v36, v37
    v_cvt_pk_bf16_f32 v43, v38, v39
    v_lshlrev_b32 v32, 16, v40
    v_and_b32 v33, 0xffff0000, v40
    v_lshlrev_b32 v34, 16, v41
    v_and_b32 v35, 0xffff0000, v41
    v_lshlrev_b32 v36, 16, v42
    v_and_b32 v37, 0xffff0000, v42
    v_lshlrev_b32 v38, 16, v43
    v_and_b32 v39, 0xffff0000, v43
    v_pk_mul_f32 v[32:33], v[32:33], v[46:47] op_sel_hi:[1,0]
    v_pk_mul_f32 v[34:35], v[34:35], v[46:47] op_sel_hi:[1,0]
    v_pk_mul_f32 v[36:37], v[36:37], v[46:47] op_sel_hi:[1,0]
    v_pk_mul_f32 v[38:39], v[38:39], v[46:47] op_sel_hi:[1,0]
    v_cvt_pk_bf16_f32 v40, v32, v33
    v_cvt_pk_bf16_f32 v41, v34, v35
    v_cvt_pk_bf16_f32 v42, v36, v37
    v_cvt_pk_bf16_f32 v43, v38, v39
    v_min_u32 v40, -2, v40
    v_add_u32 v81, 127926272, v1
    global_store_dwordx4 v81, v[40:43], s[30:31] sc1
    s_mov_b64 s[100:101], 1
    s_nop 0
    s_branch L_fl2_187
L_fl1_186:
    global_store_dwordx4 v1, v[48:51], s[32:33]
    s_nop 1
L_fl2_187:
    s_add_u32 s23, s23, 1
    s_mov_b32 s61, s63
    s_cmp_lt_u32 s61, 128
    s_cbranch_scc1 L_fj_179
    s_waitcnt vmcnt(0)
    s_mov_b64 exec, s[100:101]
    global_store_dword v15, v8, s[4:5] sc1
    s_mov_b64 exec, -1
    s_mov_b64 s[100:101], 0
L_end_165:
    s_waitcnt vmcnt(0) lgkmcnt(0)
    s_endpgm
L_end:
    s_endpgm
.section .rodata,"a"
.p2align 6
.amdhsa_kernel interleave_layers__memory_aug_recurrent_mem_tr__dense_activation_gelu__prompt_kernel
  .amdhsa_next_free_vgpr 512
  .amdhsa_next_free_sgpr 102
  .amdhsa_accum_offset 256
  .amdhsa_group_segment_fixed_size 0
  .amdhsa_kernarg_size 120
  .amdhsa_user_sgpr_count 2
  .amdhsa_user_sgpr_kernarg_segment_ptr 1
  .amdhsa_system_sgpr_workgroup_id_x 1
.end_amdhsa_kernel
```
